```python
import torch

def _softmax(x, axis=-1):
    return torch.softmax(x, dim=axis)

def _gelu(x):
    return torch.nn.functional.gelu(x, approximate='tanh')

def _silu(x):
    return torch.nn.functional.silu(x)

def _sigmoid(x):
    return torch.sigmoid(x)

def _layernorm(x, axis=-1, eps=1e-05):
    m = x.mean(dim=axis, keepdim=True)
    v = x.var(dim=axis, keepdim=True, unbiased=False)
    return (x - m) / torch.sqrt(v + eps)

def _scatter_add(tgt, idx, src, axis=0):
    return tgt.clone().index_add_(axis, idx, src)

def _segment_sum(src, seg, n):
    out = torch.zeros((n,) + src.shape[1:], dtype=src.dtype)
    return out.index_add_(0, seg, src)

def _pad(x, pw):
    flat = tuple((v for pair in reversed(pw) for v in pair))
    return torch.nn.functional.pad(x, flat)
kernel_name = 'adaLN_cond__sliding_block_cached__swiglu_ffn__prompt'

def setup_inputs():

    _w = lambda a: (lambda t: t.to(torch.bfloat16) if t.is_floating_point() else t)(torch.as_tensor(a))

    def _A_setup():
        B, Sq, D = (1, 2048, 640)
        Hq, Hkv, Sk, Dh = (32, 32, 2048, 128)
        assert Hq % Hkv == 0, (Hq, Hkv)
        return {'x': _w((lambda *s: torch.randn(*s, dtype=torch.bfloat16) * 0.05)(B, Sq, D)), 'k_cache': _w((lambda *s: torch.randn(*s, dtype=torch.bfloat16) * 3.2)(B, Hkv, Sk, Dh)), 'v_cache': _w((lambda *s: torch.randn(*s, dtype=torch.bfloat16) * 0.4)(B, Hkv, Sk, Dh)), 'wq': _w((lambda *s: torch.randn(*s, dtype=torch.bfloat16) * 3.2)(D, Hq * Dh) * D ** (-0.5)), 'wo': _w((lambda *s: torch.randn(*s, dtype=torch.bfloat16) * 0.4)(Hq * Dh, D) * (Hq * Dh) ** (-0.5))}
    _A_in = _A_setup()

    def _B_setup():
        B, S, D, F = (1, 2048, 640, 1728)
        return {'x': _w((lambda *s: torch.randn(*s, dtype=torch.bfloat16) * 0.05)(B, S, D)), 'w_gate': _w((lambda *s: torch.randn(*s, dtype=torch.bfloat16) * 0.05)(D, F)), 'w_up': _w((lambda *s: torch.randn(*s, dtype=torch.bfloat16) * 0.05)(D, F)), 'w_down': _w((lambda *s: torch.randn(*s, dtype=torch.bfloat16) * 0.05)(F, D))}
    _B_in = _B_setup()
    return {'A_x': _A_in['x'], 'A_k_cache': _A_in['k_cache'], 'A_v_cache': _A_in['v_cache'], 'A_wq': _A_in['wq'], 'A_wo': _A_in['wo'], 'B_x': _B_in['x'], 'B_w_gate': _B_in['w_gate'], 'B_w_up': _B_in['w_up'], 'B_w_down': _B_in['w_down'], 'c': _w((lambda *s: torch.randn(*s, dtype=torch.bfloat16) * 0.1)(1, 640) * 8.0), 'w_mod': _w((lambda *s: torch.randn(*s, dtype=torch.bfloat16) * 0.1)(640, 6 * 640) * 640 ** (-0.5) * 8.0)}

def reference(A_x, A_k_cache, A_v_cache, A_wq, A_wo, B_x, B_w_gate, B_w_up, B_w_down, c, w_mod):

    def _A_ref(x, k_cache, v_cache, wq, wo):
        B, Sq, D = x.shape
        Hq, Dh = (32, 128)
        Hkv, Sk = (k_cache.shape[1], k_cache.shape[2])
        W = min(4096, max(256, Sk // 4))
        rep = Hq // Hkv
        q = (lambda x, *d: x.permute(*d))((x @ wq).reshape(B, Sq, Hq, Dh), 0, 2, 1, 3)
        k = (lambda x, n, axis: torch.repeat_interleave(x, n, dim=axis))(k_cache[:, :, Sk - W:, :], rep, axis=1)
        v = (lambda x, n, axis: torch.repeat_interleave(x, n, dim=axis))(v_cache[:, :, Sk - W:, :], rep, axis=1)
        scores = torch.einsum('bhqd,bhkd->bhqk', q, k) * Dh ** (-0.5)
        p = _softmax(scores, axis=-1)
        o = torch.einsum('bhqk,bhkd->bhqd', p, v)
        return (lambda x, *d: x.permute(*d))(o, 0, 2, 1, 3).reshape(B, Sq, Hq * Dh) @ wo

    def _B_ref(x, w_gate, w_up, w_down):
        g = _silu(x @ w_gate)
        u = x @ w_up
        return g * u @ w_down
    x = A_x
    mod = (_silu(c) @ w_mod).reshape(c.shape[0], 6, 1, -1)
    sa, ca, ga, sb, cb, gb = (mod[:, 0].clone(), mod[:, 1].clone(), mod[:, 2].clone(), mod[:, 3].clone(), mod[:, 4].clone(), mod[:, 5].clone())
    h = _layernorm(x, axis=-1) * (1 + ca) + sa
    x = x + ga * _A_ref(h, A_k_cache, A_v_cache, A_wq, A_wo)
    h = _layernorm(x, axis=-1) * (1 + cb) + sb
    x = x + gb * _B_ref(h, B_w_gate, B_w_up, B_w_down)
    return x
```

```asm
; @launch grid=(256,1,1) block=(256,1,1) lds=163840
.amdgcn_target "amdgcn-amd-amdhsa--gfx950"
.text
.globl adaLN_cond__sliding_block_cached__swiglu_ffn__prompt_kernel
.p2align 8
.type adaLN_cond__sliding_block_cached__swiglu_ffn__prompt_kernel,@function
adaLN_cond__sliding_block_cached__swiglu_ffn__prompt_kernel:
s_cmp_ge_u32 s2, 256
s_cbranch_scc1 L_mega_end
s_load_dwordx4 s[4:7], s[0:1], 0
s_load_dwordx4 s[8:11], s[0:1], 16
s_load_dwordx4 s[52:55], s[0:1], 96
s_load_dwordx4 s[48:51], s[0:1], 72
v_lshrrev_b32 v1, 6, v0
v_and_b32 v2, 63, v0
v_readfirstlane_b32 s100, v1
s_and_b32 s3, s2, 7
s_lshr_b32 s44, s2, 3
s_and_b32 s40, s44, 3
s_lshr_b32 s41, s44, 2
s_lshl_b32 s41, s41, 3
s_add_u32 s41, s41, s3
s_lshl_b32 s42, s41, 2
s_add_u32 s42, s42, s40
s_lshl_b32 s40, s42, 5
s_cmp_ge_u32 s41, 60
s_cselect_b32 s43, 0x40000000, 0
s_and_b32 s45, s3, 1
s_lshl_b32 s45, s45, 2
s_and_b32 s46, s44, 3
s_add_u32 s45, s45, s46
s_lshr_b32 s3, s3, 1
s_lshl_b32 s3, s3, 3
s_lshr_b32 s44, s44, 2
s_add_u32 s30, s3, s44
s_lshl_b32 s29, s100, 12
s_lshl_b32 s33, s30, 8
v_lshrrev_b32 v3, 1, v2
v_mul_u32_u24 v4, 160, v1
v_add_u32 v3, v3, v4
v_lshlrev_b32 v5, 1, v3
v_mul_u32_u24 v4, 7680, v3
v_and_b32 v6, 1, v2
v_lshlrev_b32 v6, 4, v6
v_add3_u32 v4, v4, v6, s40
v_add_u32 v4, s43, v4
s_waitcnt lgkmcnt(0)
s_mov_b32 s12, s48
s_mov_b32 s13, s49
s_mov_b32 s14, 0x500
s_mov_b32 s15, 0x20000
s_mov_b32 s16, s50
s_mov_b32 s17, s51
s_mov_b32 s18, 0x4b0000
s_mov_b32 s19, 0x20000
buffer_load_ushort v8, v5, s[12:15], 0 offen offset:0
buffer_load_ushort v9, v5, s[12:15], 0 offen offset:64
buffer_load_ushort v10, v5, s[12:15], 0 offen offset:128
buffer_load_ushort v11, v5, s[12:15], 0 offen offset:192
buffer_load_ushort v12, v5, s[12:15], 0 offen offset:256
s_mov_b32 s38, 0
buffer_load_dwordx4 v[16:19], v4, s[16:19], s38 offen nt
s_mov_b32 s38, 245760
buffer_load_dwordx4 v[20:23], v4, s[16:19], s38 offen nt
s_mov_b32 s38, 491520
buffer_load_dwordx4 v[24:27], v4, s[16:19], s38 offen nt
s_mov_b32 s38, 737280
buffer_load_dwordx4 v[28:31], v4, s[16:19], s38 offen nt
s_mov_b32 s38, 983040
buffer_load_dwordx4 v[32:35], v4, s[16:19], s38 offen nt
s_mov_b32 s96, s54
s_mov_b32 s97, s55
s_mov_b32 s98, 0x4800000
s_mov_b32 s99, 0x20000
s_mov_b32 s12, s4
s_mov_b32 s13, s5
s_mov_b32 s14, 0x280000
s_mov_b32 s15, 0x20000
s_mov_b32 s20, s52
s_mov_b32 s21, s53
s_mov_b32 s22, 0x100
s_mov_b32 s23, 0x20000
s_lshl_b32 s46, s45, 5
s_add_u32 s46, s46, s30
s_lshl_b32 s46, s46, 3
v_lshrrev_b32 v3, 4, v2
v_and_b32 v4, 15, v2
v_lshl_add_u32 v56, v1, 2, v3
v_add_u32 v56, s46, v56
v_lshlrev_b32 v58, 4, v4
v_mul_u32_u24 v59, 1280, v56
v_add_u32 v59, v59, v58
s_cmp_ge_u32 s100, 2
s_cselect_b32 s38, 0x40000000, 0
buffer_load_dwordx4 v[60:63], v59, s[12:15], s38 offen offset:0
buffer_load_dwordx4 v[64:67], v59, s[12:15], s38 offen offset:256
buffer_load_dwordx4 v[68:71], v59, s[12:15], s38 offen offset:512
buffer_load_dwordx4 v[72:75], v59, s[12:15], s38 offen offset:768
buffer_load_dwordx4 v[76:79], v59, s[12:15], s38 offen offset:1024
s_getpc_b64 s[24:25]
L_pc0:
s_mov_b32 s26, L_code_end-L_pc0
s_mov_b32 s27, 0x20000
s_lshr_b32 s46, s2, 3
s_lshl_b32 s46, s46, 12
s_cmp_eq_u32 s100, 3
s_cselect_b32 s46, s46, 0x40000000
v_lshlrev_b32 v57, 6, v2
buffer_load_dword v252, v57, s[24:27], s46 offen
s_load_dwordx4 s[48:51], s[0:1], 48
s_load_dwordx2 s[52:53], s[0:1], 32
s_load_dwordx2 s[54:55], s[0:1], 64
s_mov_b32 s16, s8
s_mov_b32 s17, s9
s_mov_b32 s18, 0x1000000
s_mov_b32 s19, 0x20000
s_mov_b32 s8, s10
s_mov_b32 s9, s11
s_mov_b32 s10, 0x500000
s_mov_b32 s11, 0x20000
s_mov_b32 s12, s6
s_mov_b32 s13, s7
s_mov_b32 s14, 0x1000000
s_mov_b32 s15, 0x20000
s_waitcnt vmcnt(15)
v_lshlrev_b32 v8, 16, v8
v_mul_f32 v40, 0xbfb8aa3b, v8
v_exp_f32 v40, v40
s_nop 0
v_add_f32 v40, 1.0, v40
v_rcp_f32 v40, v40
s_nop 0
v_mul_f32 v8, v8, v40
v_cvt_pk_bf16_f32 v8, v8, v8
v_and_b32 v8, 0xffff0000, v8
s_waitcnt vmcnt(14)
v_lshlrev_b32 v9, 16, v9
v_mul_f32 v40, 0xbfb8aa3b, v9
v_exp_f32 v40, v40
s_nop 0
v_add_f32 v40, 1.0, v40
v_rcp_f32 v40, v40
s_nop 0
v_mul_f32 v9, v9, v40
v_cvt_pk_bf16_f32 v9, v9, v9
v_and_b32 v9, 0xffff0000, v9
s_waitcnt vmcnt(13)
v_lshlrev_b32 v10, 16, v10
v_mul_f32 v40, 0xbfb8aa3b, v10
v_exp_f32 v40, v40
s_nop 0
v_add_f32 v40, 1.0, v40
v_rcp_f32 v40, v40
s_nop 0
v_mul_f32 v10, v10, v40
v_cvt_pk_bf16_f32 v10, v10, v10
v_and_b32 v10, 0xffff0000, v10
s_waitcnt vmcnt(12)
v_lshlrev_b32 v11, 16, v11
v_mul_f32 v40, 0xbfb8aa3b, v11
v_exp_f32 v40, v40
s_nop 0
v_add_f32 v40, 1.0, v40
v_rcp_f32 v40, v40
s_nop 0
v_mul_f32 v11, v11, v40
v_cvt_pk_bf16_f32 v11, v11, v11
v_and_b32 v11, 0xffff0000, v11
s_waitcnt vmcnt(11)
v_lshlrev_b32 v12, 16, v12
v_mul_f32 v40, 0xbfb8aa3b, v12
v_exp_f32 v40, v40
s_nop 0
v_add_f32 v40, 1.0, v40
v_rcp_f32 v40, v40
s_nop 0
v_mul_f32 v12, v12, v40
v_cvt_pk_bf16_f32 v12, v12, v12
v_and_b32 v12, 0xffff0000, v12
s_waitcnt vmcnt(10)
v_lshlrev_b32 v40, 16, v16
v_and_b32 v41, 0xffff0000, v16
v_mul_f32 v48, v40, v8
v_mul_f32 v49, v41, v8
v_lshlrev_b32 v40, 16, v17
v_and_b32 v41, 0xffff0000, v17
v_mul_f32 v50, v40, v8
v_mul_f32 v51, v41, v8
v_lshlrev_b32 v40, 16, v18
v_and_b32 v41, 0xffff0000, v18
v_mul_f32 v52, v40, v8
v_mul_f32 v53, v41, v8
v_lshlrev_b32 v40, 16, v19
v_and_b32 v41, 0xffff0000, v19
v_mul_f32 v54, v40, v8
v_mul_f32 v55, v41, v8
s_waitcnt vmcnt(9)
v_lshlrev_b32 v40, 16, v20
v_and_b32 v41, 0xffff0000, v20
v_fmac_f32 v48, v40, v9
v_fmac_f32 v49, v41, v9
v_lshlrev_b32 v40, 16, v21
v_and_b32 v41, 0xffff0000, v21
v_fmac_f32 v50, v40, v9
v_fmac_f32 v51, v41, v9
v_lshlrev_b32 v40, 16, v22
v_and_b32 v41, 0xffff0000, v22
v_fmac_f32 v52, v40, v9
v_fmac_f32 v53, v41, v9
v_lshlrev_b32 v40, 16, v23
v_and_b32 v41, 0xffff0000, v23
v_fmac_f32 v54, v40, v9
v_fmac_f32 v55, v41, v9
s_waitcnt vmcnt(8)
v_lshlrev_b32 v40, 16, v24
v_and_b32 v41, 0xffff0000, v24
v_fmac_f32 v48, v40, v10
v_fmac_f32 v49, v41, v10
v_lshlrev_b32 v40, 16, v25
v_and_b32 v41, 0xffff0000, v25
v_fmac_f32 v50, v40, v10
v_fmac_f32 v51, v41, v10
v_lshlrev_b32 v40, 16, v26
v_and_b32 v41, 0xffff0000, v26
v_fmac_f32 v52, v40, v10
v_fmac_f32 v53, v41, v10
v_lshlrev_b32 v40, 16, v27
v_and_b32 v41, 0xffff0000, v27
v_fmac_f32 v54, v40, v10
v_fmac_f32 v55, v41, v10
s_waitcnt vmcnt(7)
v_lshlrev_b32 v40, 16, v28
v_and_b32 v41, 0xffff0000, v28
v_fmac_f32 v48, v40, v11
v_fmac_f32 v49, v41, v11
v_lshlrev_b32 v40, 16, v29
v_and_b32 v41, 0xffff0000, v29
v_fmac_f32 v50, v40, v11
v_fmac_f32 v51, v41, v11
v_lshlrev_b32 v40, 16, v30
v_and_b32 v41, 0xffff0000, v30
v_fmac_f32 v52, v40, v11
v_fmac_f32 v53, v41, v11
v_lshlrev_b32 v40, 16, v31
v_and_b32 v41, 0xffff0000, v31
v_fmac_f32 v54, v40, v11
v_fmac_f32 v55, v41, v11
s_waitcnt vmcnt(6)
v_lshlrev_b32 v40, 16, v32
v_and_b32 v41, 0xffff0000, v32
v_fmac_f32 v48, v40, v12
v_fmac_f32 v49, v41, v12
v_lshlrev_b32 v40, 16, v33
v_and_b32 v41, 0xffff0000, v33
v_fmac_f32 v50, v40, v12
v_fmac_f32 v51, v41, v12
v_lshlrev_b32 v40, 16, v34
v_and_b32 v41, 0xffff0000, v34
v_fmac_f32 v52, v40, v12
v_fmac_f32 v53, v41, v12
v_lshlrev_b32 v40, 16, v35
v_and_b32 v41, 0xffff0000, v35
v_fmac_f32 v54, v40, v12
v_fmac_f32 v55, v41, v12
v_add_f32_dpp v48, v48, v48 quad_perm:[2,3,0,1] row_mask:0xf bank_mask:0xf
v_add_f32_dpp v49, v49, v49 quad_perm:[2,3,0,1] row_mask:0xf bank_mask:0xf
v_add_f32_dpp v50, v50, v50 quad_perm:[2,3,0,1] row_mask:0xf bank_mask:0xf
v_add_f32_dpp v51, v51, v51 quad_perm:[2,3,0,1] row_mask:0xf bank_mask:0xf
v_add_f32_dpp v52, v52, v52 quad_perm:[2,3,0,1] row_mask:0xf bank_mask:0xf
v_add_f32_dpp v53, v53, v53 quad_perm:[2,3,0,1] row_mask:0xf bank_mask:0xf
v_add_f32_dpp v54, v54, v54 quad_perm:[2,3,0,1] row_mask:0xf bank_mask:0xf
v_add_f32_dpp v55, v55, v55 quad_perm:[2,3,0,1] row_mask:0xf bank_mask:0xf
v_add_f32_dpp v48, v48, v48 row_ror:4 row_mask:0xf bank_mask:0xf
v_add_f32_dpp v49, v49, v49 row_ror:4 row_mask:0xf bank_mask:0xf
v_add_f32_dpp v50, v50, v50 row_ror:4 row_mask:0xf bank_mask:0xf
v_add_f32_dpp v51, v51, v51 row_ror:4 row_mask:0xf bank_mask:0xf
v_add_f32_dpp v52, v52, v52 row_ror:4 row_mask:0xf bank_mask:0xf
v_add_f32_dpp v53, v53, v53 row_ror:4 row_mask:0xf bank_mask:0xf
v_add_f32_dpp v54, v54, v54 row_ror:4 row_mask:0xf bank_mask:0xf
v_add_f32_dpp v55, v55, v55 row_ror:4 row_mask:0xf bank_mask:0xf
v_add_f32_dpp v48, v48, v48 row_ror:8 row_mask:0xf bank_mask:0xf
v_add_f32_dpp v49, v49, v49 row_ror:8 row_mask:0xf bank_mask:0xf
v_add_f32_dpp v50, v50, v50 row_ror:8 row_mask:0xf bank_mask:0xf
v_add_f32_dpp v51, v51, v51 row_ror:8 row_mask:0xf bank_mask:0xf
v_add_f32_dpp v52, v52, v52 row_ror:8 row_mask:0xf bank_mask:0xf
v_add_f32_dpp v53, v53, v53 row_ror:8 row_mask:0xf bank_mask:0xf
v_add_f32_dpp v54, v54, v54 row_ror:8 row_mask:0xf bank_mask:0xf
v_add_f32_dpp v55, v55, v55 row_ror:8 row_mask:0xf bank_mask:0xf
v_lshrrev_b32 v7, 4, v0
v_lshlrev_b32 v7, 6, v7
v_lshl_add_u32 v7, v6, 1, v7
v_add_u32 v7, 159744, v7
v_and_b32 v40, 14, v0
v_cmp_eq_u32 vcc, 0, v40
s_nop 0
s_and_saveexec_b64 s[46:47], vcc
ds_write_b128 v7, v[48:51]
ds_write_b128 v7, v[52:55] offset:16
s_mov_b64 exec, s[46:47]
v_lshrrev_b32 v5, 5, v2
v_bfe_u32 v6, v2, 2, 2
v_and_b32 v7, 3, v2
s_waitcnt lgkmcnt(0)
s_barrier
s_cmp_ge_u32 s100, 2
s_cbranch_scc1 L_roleB
s_cmp_lg_u32 s100, 0
s_cbranch_scc1 L_ln
v_and_b32 v40, 15, v0
v_lshlrev_b32 v40, 2, v40
v_add_u32 v42, 159744, v40
ds_read_b32 v16, v42 offset:0
ds_read_b32 v17, v42 offset:64
ds_read_b32 v18, v42 offset:128
ds_read_b32 v19, v42 offset:192
ds_read_b32 v20, v42 offset:256
ds_read_b32 v21, v42 offset:320
ds_read_b32 v22, v42 offset:384
ds_read_b32 v23, v42 offset:448
ds_read_b32 v24, v42 offset:512
ds_read_b32 v25, v42 offset:576
ds_read_b32 v26, v42 offset:640
ds_read_b32 v27, v42 offset:704
ds_read_b32 v28, v42 offset:768
ds_read_b32 v29, v42 offset:832
ds_read_b32 v30, v42 offset:896
ds_read_b32 v31, v42 offset:960
s_waitcnt lgkmcnt(14)
v_add_f32 v16, v16, v17
s_waitcnt lgkmcnt(13)
v_add_f32 v16, v16, v18
s_waitcnt lgkmcnt(12)
v_add_f32 v16, v16, v19
s_waitcnt lgkmcnt(11)
v_add_f32 v16, v16, v20
s_waitcnt lgkmcnt(10)
v_add_f32 v16, v16, v21
s_waitcnt lgkmcnt(9)
v_add_f32 v16, v16, v22
s_waitcnt lgkmcnt(8)
v_add_f32 v16, v16, v23
s_waitcnt lgkmcnt(7)
v_add_f32 v16, v16, v24
s_waitcnt lgkmcnt(6)
v_add_f32 v16, v16, v25
s_waitcnt lgkmcnt(5)
v_add_f32 v16, v16, v26
s_waitcnt lgkmcnt(4)
v_add_f32 v16, v16, v27
s_waitcnt lgkmcnt(3)
v_add_f32 v16, v16, v28
s_waitcnt lgkmcnt(2)
v_add_f32 v16, v16, v29
s_waitcnt lgkmcnt(1)
v_add_f32 v16, v16, v30
s_waitcnt lgkmcnt(0)
v_add_f32 v16, v16, v31
v_cvt_pk_bf16_f32 v16, v16, v16
v_and_b32 v16, 0xffff0000, v16
v_lshrrev_b32 v41, 1, v40
v_add_u32 v41, s40, v41
s_lshl_b32 s40, s40, 1
v_add_u32 v40, s40, v40
v_add_u32 v40, s43, v40
s_cmp_ge_u32 s41, 10
s_cselect_b32 s38, 1.0, 0
v_add_f32 v17, s38, v16
v_cvt_pk_bf16_f32 v17, v17, v17
s_lshl_b32 s39, s42, 2
s_mul_i32 s39, s39, 4352
s_add_u32 s39, s39, 49283072
s_cmp_lt_u32 s41, 20
s_cselect_b32 s38, 16384, 0x40000000
s_cselect_b32 s39, s39, 0x40000000
s_cselect_b32 s40, 0, 0x40000000
v_mul_u32_u24 v42, 4352, v2
v_mov_b32 v44, 0
s_mov_b64 exec, 0xffff
buffer_store_short v17, v41, s[96:99], s38 offen sc1
buffer_store_dword v16, v40, s[96:99], 0 offen sc1
s_mov_b64 exec, 15
buffer_store_dword v44, v42, s[96:99], s39 offen sc1
s_waitcnt vmcnt(0)
s_mov_b64 exec, 1
v_mov_b32 v41, 1
v_mov_b32 v40, s40
v_mov_b32 v42, 1
buffer_atomic_add v41, v40, s[20:23], 0 offen sc0
s_waitcnt vmcnt(0)
v_cmp_eq_u32 vcc, 79, v41
v_mov_b32 v43, 0x40000000
s_nop 0
v_cndmask_b32 v40, v43, v40, vcc
buffer_store_dword v42, v40, s[20:23], 0 offen offset:128 sc1
s_mov_b64 exec, -1
L_ln:
s_waitcnt vmcnt(0)
v_lshlrev_b32 v120, 16, v60
v_and_b32 v121, 0xffff0000, v60
v_lshlrev_b32 v122, 16, v61
v_and_b32 v123, 0xffff0000, v61
v_lshlrev_b32 v124, 16, v62
v_and_b32 v125, 0xffff0000, v62
v_lshlrev_b32 v126, 16, v63
v_and_b32 v127, 0xffff0000, v63
v_lshlrev_b32 v128, 16, v64
v_and_b32 v129, 0xffff0000, v64
v_lshlrev_b32 v130, 16, v65
v_and_b32 v131, 0xffff0000, v65
v_lshlrev_b32 v132, 16, v66
v_and_b32 v133, 0xffff0000, v66
v_lshlrev_b32 v134, 16, v67
v_and_b32 v135, 0xffff0000, v67
v_lshlrev_b32 v136, 16, v68
v_and_b32 v137, 0xffff0000, v68
v_lshlrev_b32 v138, 16, v69
v_and_b32 v139, 0xffff0000, v69
v_lshlrev_b32 v140, 16, v70
v_and_b32 v141, 0xffff0000, v70
v_lshlrev_b32 v142, 16, v71
v_and_b32 v143, 0xffff0000, v71
v_lshlrev_b32 v144, 16, v72
v_and_b32 v145, 0xffff0000, v72
v_lshlrev_b32 v146, 16, v73
v_and_b32 v147, 0xffff0000, v73
v_lshlrev_b32 v148, 16, v74
v_and_b32 v149, 0xffff0000, v74
v_lshlrev_b32 v150, 16, v75
v_and_b32 v151, 0xffff0000, v75
v_lshlrev_b32 v152, 16, v76
v_and_b32 v153, 0xffff0000, v76
v_lshlrev_b32 v154, 16, v77
v_and_b32 v155, 0xffff0000, v77
v_lshlrev_b32 v156, 16, v78
v_and_b32 v157, 0xffff0000, v78
v_lshlrev_b32 v158, 16, v79
v_and_b32 v159, 0xffff0000, v79
v_add_f32 v10, v120, v121
v_add_f32 v11, v122, v123
v_add_f32 v10, v10, v124
v_add_f32 v11, v11, v125
v_add_f32 v10, v10, v126
v_add_f32 v11, v11, v127
v_add_f32 v10, v10, v128
v_add_f32 v11, v11, v129
v_add_f32 v10, v10, v130
v_add_f32 v11, v11, v131
v_add_f32 v10, v10, v132
v_add_f32 v11, v11, v133
v_add_f32 v10, v10, v134
v_add_f32 v11, v11, v135
v_add_f32 v10, v10, v136
v_add_f32 v11, v11, v137
v_add_f32 v10, v10, v138
v_add_f32 v11, v11, v139
v_add_f32 v10, v10, v140
v_add_f32 v11, v11, v141
v_add_f32 v10, v10, v142
v_add_f32 v11, v11, v143
v_add_f32 v10, v10, v144
v_add_f32 v11, v11, v145
v_add_f32 v10, v10, v146
v_add_f32 v11, v11, v147
v_add_f32 v10, v10, v148
v_add_f32 v11, v11, v149
v_add_f32 v10, v10, v150
v_add_f32 v11, v11, v151
v_add_f32 v10, v10, v152
v_add_f32 v11, v11, v153
v_add_f32 v10, v10, v154
v_add_f32 v11, v11, v155
v_add_f32 v10, v10, v156
v_add_f32 v11, v11, v157
v_add_f32 v10, v10, v158
v_add_f32 v11, v11, v159
v_add_f32 v10, v10, v11
s_nop 1
v_add_f32_dpp v10, v10, v10 quad_perm:[1,0,3,2] row_mask:0xf bank_mask:0xf
s_nop 1
v_add_f32_dpp v10, v10, v10 quad_perm:[2,3,0,1] row_mask:0xf bank_mask:0xf
s_nop 1
v_add_f32_dpp v10, v10, v10 row_ror:4 row_mask:0xf bank_mask:0xf
s_nop 1
v_add_f32_dpp v10, v10, v10 row_ror:8 row_mask:0xf bank_mask:0xf
v_mul_f32 v10, 0x3acccccd, v10
v_lshlrev_b32 v12, 2, v56
s_mov_b32 s34, 0x8000
s_mov_b32 exec_lo, 0x10001
s_mov_b32 exec_hi, 0x10001
buffer_store_dword v10, v12, s[96:99], s34 offen sc1
s_mov_b64 exec, -1
v_sub_f32 v14, v120, v10
v_mul_f32 v12, v14, v14
v_sub_f32 v15, v121, v10
v_mul_f32 v13, v15, v15
v_sub_f32 v14, v122, v10
v_fmac_f32 v12, v14, v14
v_sub_f32 v15, v123, v10
v_fmac_f32 v13, v15, v15
v_sub_f32 v14, v124, v10
v_fmac_f32 v12, v14, v14
v_sub_f32 v15, v125, v10
v_fmac_f32 v13, v15, v15
v_sub_f32 v14, v126, v10
v_fmac_f32 v12, v14, v14
v_sub_f32 v15, v127, v10
v_fmac_f32 v13, v15, v15
v_sub_f32 v14, v128, v10
v_fmac_f32 v12, v14, v14
v_sub_f32 v15, v129, v10
v_fmac_f32 v13, v15, v15
v_sub_f32 v14, v130, v10
v_fmac_f32 v12, v14, v14
v_sub_f32 v15, v131, v10
v_fmac_f32 v13, v15, v15
v_sub_f32 v14, v132, v10
v_fmac_f32 v12, v14, v14
v_sub_f32 v15, v133, v10
v_fmac_f32 v13, v15, v15
v_sub_f32 v14, v134, v10
v_fmac_f32 v12, v14, v14
v_sub_f32 v15, v135, v10
v_fmac_f32 v13, v15, v15
v_sub_f32 v14, v136, v10
v_fmac_f32 v12, v14, v14
v_sub_f32 v15, v137, v10
v_fmac_f32 v13, v15, v15
v_sub_f32 v14, v138, v10
v_fmac_f32 v12, v14, v14
v_sub_f32 v15, v139, v10
v_fmac_f32 v13, v15, v15
v_sub_f32 v14, v140, v10
v_fmac_f32 v12, v14, v14
v_sub_f32 v15, v141, v10
v_fmac_f32 v13, v15, v15
v_sub_f32 v14, v142, v10
v_fmac_f32 v12, v14, v14
v_sub_f32 v15, v143, v10
v_fmac_f32 v13, v15, v15
v_sub_f32 v14, v144, v10
v_fmac_f32 v12, v14, v14
v_sub_f32 v15, v145, v10
v_fmac_f32 v13, v15, v15
v_sub_f32 v14, v146, v10
v_fmac_f32 v12, v14, v14
v_sub_f32 v15, v147, v10
v_fmac_f32 v13, v15, v15
v_sub_f32 v14, v148, v10
v_fmac_f32 v12, v14, v14
v_sub_f32 v15, v149, v10
v_fmac_f32 v13, v15, v15
v_sub_f32 v14, v150, v10
v_fmac_f32 v12, v14, v14
v_sub_f32 v15, v151, v10
v_fmac_f32 v13, v15, v15
v_sub_f32 v14, v152, v10
v_fmac_f32 v12, v14, v14
v_sub_f32 v15, v153, v10
v_fmac_f32 v13, v15, v15
v_sub_f32 v14, v154, v10
v_fmac_f32 v12, v14, v14
v_sub_f32 v15, v155, v10
v_fmac_f32 v13, v15, v15
v_sub_f32 v14, v156, v10
v_fmac_f32 v12, v14, v14
v_sub_f32 v15, v157, v10
v_fmac_f32 v13, v15, v15
v_sub_f32 v14, v158, v10
v_fmac_f32 v12, v14, v14
v_sub_f32 v15, v159, v10
v_fmac_f32 v13, v15, v15
v_add_f32 v13, v12, v13
s_nop 1
v_add_f32_dpp v13, v13, v13 quad_perm:[1,0,3,2] row_mask:0xf bank_mask:0xf
s_nop 1
v_add_f32_dpp v13, v13, v13 quad_perm:[2,3,0,1] row_mask:0xf bank_mask:0xf
s_nop 1
v_add_f32_dpp v13, v13, v13 row_ror:4 row_mask:0xf bank_mask:0xf
s_nop 1
v_add_f32_dpp v13, v13, v13 row_ror:8 row_mask:0xf bank_mask:0xf
v_mul_f32 v13, 0x3acccccd, v13
v_cvt_pk_bf16_f32 v10, v10, v10
v_and_b32 v10, 0xffff0000, v10
v_cvt_pk_bf16_f32 v13, v13, v13
v_and_b32 v13, 0xffff0000, v13
v_add_f32 v13, 0x3727c5ac, v13
v_cvt_pk_bf16_f32 v13, v13, v13
v_and_b32 v13, 0xffff0000, v13
v_sqrt_f32 v13, v13
s_nop 0
v_cvt_pk_bf16_f32 v13, v13, v13
v_and_b32 v13, 0xffff0000, v13
v_rcp_f32 v13, v13
v_lshrrev_b32 v11, 5, v56
v_mul_u32_u24 v11, 40960, v11
v_lshl_add_u32 v11, v4, 9, v11
v_and_b32 v12, 31, v56
v_lshl_add_u32 v11, v12, 4, v11
v_sub_f32 v120, v120, v10
v_sub_f32 v121, v121, v10
v_cvt_pk_bf16_f32 v14, v120, v121
v_lshlrev_b32 v120, 16, v14
v_and_b32 v121, 0xffff0000, v14
v_mul_f32 v120, v120, v13
v_mul_f32 v121, v121, v13
v_cvt_pk_bf16_f32 v14, v120, v121
v_lshlrev_b32 v120, 16, v14
v_and_b32 v121, 0xffff0000, v14
v_sub_f32 v122, v122, v10
v_sub_f32 v123, v123, v10
v_cvt_pk_bf16_f32 v14, v122, v123
v_lshlrev_b32 v122, 16, v14
v_and_b32 v123, 0xffff0000, v14
v_mul_f32 v122, v122, v13
v_mul_f32 v123, v123, v13
v_cvt_pk_bf16_f32 v14, v122, v123
v_lshlrev_b32 v122, 16, v14
v_and_b32 v123, 0xffff0000, v14
v_sub_f32 v124, v124, v10
v_sub_f32 v125, v125, v10
v_cvt_pk_bf16_f32 v14, v124, v125
v_lshlrev_b32 v124, 16, v14
v_and_b32 v125, 0xffff0000, v14
v_mul_f32 v124, v124, v13
v_mul_f32 v125, v125, v13
v_cvt_pk_bf16_f32 v14, v124, v125
v_lshlrev_b32 v124, 16, v14
v_and_b32 v125, 0xffff0000, v14
v_sub_f32 v126, v126, v10
v_sub_f32 v127, v127, v10
v_cvt_pk_bf16_f32 v14, v126, v127
v_lshlrev_b32 v126, 16, v14
v_and_b32 v127, 0xffff0000, v14
v_mul_f32 v126, v126, v13
v_mul_f32 v127, v127, v13
v_cvt_pk_bf16_f32 v14, v126, v127
v_lshlrev_b32 v126, 16, v14
v_and_b32 v127, 0xffff0000, v14
v_sub_f32 v128, v128, v10
v_sub_f32 v129, v129, v10
v_cvt_pk_bf16_f32 v14, v128, v129
v_lshlrev_b32 v128, 16, v14
v_and_b32 v129, 0xffff0000, v14
v_mul_f32 v128, v128, v13
v_mul_f32 v129, v129, v13
v_cvt_pk_bf16_f32 v14, v128, v129
v_lshlrev_b32 v128, 16, v14
v_and_b32 v129, 0xffff0000, v14
v_sub_f32 v130, v130, v10
v_sub_f32 v131, v131, v10
v_cvt_pk_bf16_f32 v14, v130, v131
v_lshlrev_b32 v130, 16, v14
v_and_b32 v131, 0xffff0000, v14
v_mul_f32 v130, v130, v13
v_mul_f32 v131, v131, v13
v_cvt_pk_bf16_f32 v14, v130, v131
v_lshlrev_b32 v130, 16, v14
v_and_b32 v131, 0xffff0000, v14
v_sub_f32 v132, v132, v10
v_sub_f32 v133, v133, v10
v_cvt_pk_bf16_f32 v14, v132, v133
v_lshlrev_b32 v132, 16, v14
v_and_b32 v133, 0xffff0000, v14
v_mul_f32 v132, v132, v13
v_mul_f32 v133, v133, v13
v_cvt_pk_bf16_f32 v14, v132, v133
v_lshlrev_b32 v132, 16, v14
v_and_b32 v133, 0xffff0000, v14
v_sub_f32 v134, v134, v10
v_sub_f32 v135, v135, v10
v_cvt_pk_bf16_f32 v14, v134, v135
v_lshlrev_b32 v134, 16, v14
v_and_b32 v135, 0xffff0000, v14
v_mul_f32 v134, v134, v13
v_mul_f32 v135, v135, v13
v_cvt_pk_bf16_f32 v14, v134, v135
v_lshlrev_b32 v134, 16, v14
v_and_b32 v135, 0xffff0000, v14
v_sub_f32 v136, v136, v10
v_sub_f32 v137, v137, v10
v_cvt_pk_bf16_f32 v14, v136, v137
v_lshlrev_b32 v136, 16, v14
v_and_b32 v137, 0xffff0000, v14
v_mul_f32 v136, v136, v13
v_mul_f32 v137, v137, v13
v_cvt_pk_bf16_f32 v14, v136, v137
v_lshlrev_b32 v136, 16, v14
v_and_b32 v137, 0xffff0000, v14
v_sub_f32 v138, v138, v10
v_sub_f32 v139, v139, v10
v_cvt_pk_bf16_f32 v14, v138, v139
v_lshlrev_b32 v138, 16, v14
v_and_b32 v139, 0xffff0000, v14
v_mul_f32 v138, v138, v13
v_mul_f32 v139, v139, v13
v_cvt_pk_bf16_f32 v14, v138, v139
v_lshlrev_b32 v138, 16, v14
v_and_b32 v139, 0xffff0000, v14
v_sub_f32 v140, v140, v10
v_sub_f32 v141, v141, v10
v_cvt_pk_bf16_f32 v14, v140, v141
v_lshlrev_b32 v140, 16, v14
v_and_b32 v141, 0xffff0000, v14
v_mul_f32 v140, v140, v13
v_mul_f32 v141, v141, v13
v_cvt_pk_bf16_f32 v14, v140, v141
v_lshlrev_b32 v140, 16, v14
v_and_b32 v141, 0xffff0000, v14
v_sub_f32 v142, v142, v10
v_sub_f32 v143, v143, v10
v_cvt_pk_bf16_f32 v14, v142, v143
v_lshlrev_b32 v142, 16, v14
v_and_b32 v143, 0xffff0000, v14
v_mul_f32 v142, v142, v13
v_mul_f32 v143, v143, v13
v_cvt_pk_bf16_f32 v14, v142, v143
v_lshlrev_b32 v142, 16, v14
v_and_b32 v143, 0xffff0000, v14
v_sub_f32 v144, v144, v10
v_sub_f32 v145, v145, v10
v_cvt_pk_bf16_f32 v14, v144, v145
v_lshlrev_b32 v144, 16, v14
v_and_b32 v145, 0xffff0000, v14
v_mul_f32 v144, v144, v13
v_mul_f32 v145, v145, v13
v_cvt_pk_bf16_f32 v14, v144, v145
v_lshlrev_b32 v144, 16, v14
v_and_b32 v145, 0xffff0000, v14
v_sub_f32 v146, v146, v10
v_sub_f32 v147, v147, v10
v_cvt_pk_bf16_f32 v14, v146, v147
v_lshlrev_b32 v146, 16, v14
v_and_b32 v147, 0xffff0000, v14
v_mul_f32 v146, v146, v13
v_mul_f32 v147, v147, v13
v_cvt_pk_bf16_f32 v14, v146, v147
v_lshlrev_b32 v146, 16, v14
v_and_b32 v147, 0xffff0000, v14
v_sub_f32 v148, v148, v10
v_sub_f32 v149, v149, v10
v_cvt_pk_bf16_f32 v14, v148, v149
v_lshlrev_b32 v148, 16, v14
v_and_b32 v149, 0xffff0000, v14
v_mul_f32 v148, v148, v13
v_mul_f32 v149, v149, v13
v_cvt_pk_bf16_f32 v14, v148, v149
v_lshlrev_b32 v148, 16, v14
v_and_b32 v149, 0xffff0000, v14
v_sub_f32 v150, v150, v10
v_sub_f32 v151, v151, v10
v_cvt_pk_bf16_f32 v14, v150, v151
v_lshlrev_b32 v150, 16, v14
v_and_b32 v151, 0xffff0000, v14
v_mul_f32 v150, v150, v13
v_mul_f32 v151, v151, v13
v_cvt_pk_bf16_f32 v14, v150, v151
v_lshlrev_b32 v150, 16, v14
v_and_b32 v151, 0xffff0000, v14
v_sub_f32 v152, v152, v10
v_sub_f32 v153, v153, v10
v_cvt_pk_bf16_f32 v14, v152, v153
v_lshlrev_b32 v152, 16, v14
v_and_b32 v153, 0xffff0000, v14
v_mul_f32 v152, v152, v13
v_mul_f32 v153, v153, v13
v_cvt_pk_bf16_f32 v14, v152, v153
v_lshlrev_b32 v152, 16, v14
v_and_b32 v153, 0xffff0000, v14
v_sub_f32 v154, v154, v10
v_sub_f32 v155, v155, v10
v_cvt_pk_bf16_f32 v14, v154, v155
v_lshlrev_b32 v154, 16, v14
v_and_b32 v155, 0xffff0000, v14
v_mul_f32 v154, v154, v13
v_mul_f32 v155, v155, v13
v_cvt_pk_bf16_f32 v14, v154, v155
v_lshlrev_b32 v154, 16, v14
v_and_b32 v155, 0xffff0000, v14
v_sub_f32 v156, v156, v10
v_sub_f32 v157, v157, v10
v_cvt_pk_bf16_f32 v14, v156, v157
v_lshlrev_b32 v156, 16, v14
v_and_b32 v157, 0xffff0000, v14
v_mul_f32 v156, v156, v13
v_mul_f32 v157, v157, v13
v_cvt_pk_bf16_f32 v14, v156, v157
v_lshlrev_b32 v156, 16, v14
v_and_b32 v157, 0xffff0000, v14
v_sub_f32 v158, v158, v10
v_sub_f32 v159, v159, v10
v_cvt_pk_bf16_f32 v14, v158, v159
v_lshlrev_b32 v158, 16, v14
v_and_b32 v159, 0xffff0000, v14
v_mul_f32 v158, v158, v13
v_mul_f32 v159, v159, v13
v_cvt_pk_bf16_f32 v14, v158, v159
v_lshlrev_b32 v158, 16, v14
v_and_b32 v159, 0xffff0000, v14
v_mov_b32 v14, 0
s_mov_b32 s101, 0
L_pollm:
buffer_load_dword v15, v14, s[20:23], 0 offen offset:128 sc1
s_add_u32 s101, s101, 1
s_waitcnt vmcnt(0)
v_cmp_eq_u32 vcc, 0, v15
s_nop 0
s_cbranch_vccz L_pollm_go
s_sleep 2
s_cmp_lt_u32 s101, 0x20000
s_cbranch_scc1 L_pollm
L_pollm_go:
s_mov_b32 s34, 16384
buffer_load_dwordx4 v[100:103], v58, s[96:99], s34 offen offset:1280 sc1
buffer_load_dwordx4 v[80:83], v58, s[96:99], s34 offen offset:0 sc1
buffer_load_dwordx4 v[104:107], v58, s[96:99], s34 offen offset:1536 sc1
buffer_load_dwordx4 v[84:87], v58, s[96:99], s34 offen offset:256 sc1
buffer_load_dwordx4 v[108:111], v58, s[96:99], s34 offen offset:1792 sc1
buffer_load_dwordx4 v[88:91], v58, s[96:99], s34 offen offset:512 sc1
buffer_load_dwordx4 v[112:115], v58, s[96:99], s34 offen offset:2048 sc1
buffer_load_dwordx4 v[92:95], v58, s[96:99], s34 offen offset:768 sc1
buffer_load_dwordx4 v[116:119], v58, s[96:99], s34 offen offset:2304 sc1
buffer_load_dwordx4 v[96:99], v58, s[96:99], s34 offen offset:1024 sc1
s_waitcnt vmcnt(9)
v_lshlrev_b32 v14, 16, v100
v_and_b32 v15, 0xffff0000, v100
v_mul_f32 v120, v120, v14
v_mul_f32 v121, v121, v15
v_cvt_pk_bf16_f32 v14, v120, v121
v_lshlrev_b32 v120, 16, v14
v_and_b32 v121, 0xffff0000, v14
s_waitcnt vmcnt(8)
v_lshlrev_b32 v14, 16, v80
v_and_b32 v15, 0xffff0000, v80
v_add_f32 v120, v120, v14
v_add_f32 v121, v121, v15
v_cvt_pk_bf16_f32 v60, v120, v121
v_lshlrev_b32 v14, 16, v101
v_and_b32 v15, 0xffff0000, v101
v_mul_f32 v122, v122, v14
v_mul_f32 v123, v123, v15
v_cvt_pk_bf16_f32 v14, v122, v123
v_lshlrev_b32 v122, 16, v14
v_and_b32 v123, 0xffff0000, v14
v_lshlrev_b32 v14, 16, v81
v_and_b32 v15, 0xffff0000, v81
v_add_f32 v122, v122, v14
v_add_f32 v123, v123, v15
v_cvt_pk_bf16_f32 v61, v122, v123
v_lshlrev_b32 v14, 16, v102
v_and_b32 v15, 0xffff0000, v102
v_mul_f32 v124, v124, v14
v_mul_f32 v125, v125, v15
v_cvt_pk_bf16_f32 v14, v124, v125
v_lshlrev_b32 v124, 16, v14
v_and_b32 v125, 0xffff0000, v14
v_lshlrev_b32 v14, 16, v82
v_and_b32 v15, 0xffff0000, v82
v_add_f32 v124, v124, v14
v_add_f32 v125, v125, v15
v_cvt_pk_bf16_f32 v62, v124, v125
v_lshlrev_b32 v14, 16, v103
v_and_b32 v15, 0xffff0000, v103
v_mul_f32 v126, v126, v14
v_mul_f32 v127, v127, v15
v_cvt_pk_bf16_f32 v14, v126, v127
v_lshlrev_b32 v126, 16, v14
v_and_b32 v127, 0xffff0000, v14
v_lshlrev_b32 v14, 16, v83
v_and_b32 v15, 0xffff0000, v83
v_add_f32 v126, v126, v14
v_add_f32 v127, v127, v15
v_cvt_pk_bf16_f32 v63, v126, v127
s_mov_b32 s34, 1048576
buffer_store_dwordx4 v[60:63], v11, s[96:99], s34 offen sc1
s_waitcnt vmcnt(8)
v_lshlrev_b32 v14, 16, v104
v_and_b32 v15, 0xffff0000, v104
v_mul_f32 v128, v128, v14
v_mul_f32 v129, v129, v15
v_cvt_pk_bf16_f32 v14, v128, v129
v_lshlrev_b32 v128, 16, v14
v_and_b32 v129, 0xffff0000, v14
s_waitcnt vmcnt(7)
v_lshlrev_b32 v14, 16, v84
v_and_b32 v15, 0xffff0000, v84
v_add_f32 v128, v128, v14
v_add_f32 v129, v129, v15
v_cvt_pk_bf16_f32 v64, v128, v129
v_lshlrev_b32 v14, 16, v105
v_and_b32 v15, 0xffff0000, v105
v_mul_f32 v130, v130, v14
v_mul_f32 v131, v131, v15
v_cvt_pk_bf16_f32 v14, v130, v131
v_lshlrev_b32 v130, 16, v14
v_and_b32 v131, 0xffff0000, v14
v_lshlrev_b32 v14, 16, v85
v_and_b32 v15, 0xffff0000, v85
v_add_f32 v130, v130, v14
v_add_f32 v131, v131, v15
v_cvt_pk_bf16_f32 v65, v130, v131
v_lshlrev_b32 v14, 16, v106
v_and_b32 v15, 0xffff0000, v106
v_mul_f32 v132, v132, v14
v_mul_f32 v133, v133, v15
v_cvt_pk_bf16_f32 v14, v132, v133
v_lshlrev_b32 v132, 16, v14
v_and_b32 v133, 0xffff0000, v14
v_lshlrev_b32 v14, 16, v86
v_and_b32 v15, 0xffff0000, v86
v_add_f32 v132, v132, v14
v_add_f32 v133, v133, v15
v_cvt_pk_bf16_f32 v66, v132, v133
v_lshlrev_b32 v14, 16, v107
v_and_b32 v15, 0xffff0000, v107
v_mul_f32 v134, v134, v14
v_mul_f32 v135, v135, v15
v_cvt_pk_bf16_f32 v14, v134, v135
v_lshlrev_b32 v134, 16, v14
v_and_b32 v135, 0xffff0000, v14
v_lshlrev_b32 v14, 16, v87
v_and_b32 v15, 0xffff0000, v87
v_add_f32 v134, v134, v14
v_add_f32 v135, v135, v15
v_cvt_pk_bf16_f32 v67, v134, v135
s_mov_b32 s34, 1056768
buffer_store_dwordx4 v[64:67], v11, s[96:99], s34 offen sc1
s_waitcnt vmcnt(7)
v_lshlrev_b32 v14, 16, v108
v_and_b32 v15, 0xffff0000, v108
v_mul_f32 v136, v136, v14
v_mul_f32 v137, v137, v15
v_cvt_pk_bf16_f32 v14, v136, v137
v_lshlrev_b32 v136, 16, v14
v_and_b32 v137, 0xffff0000, v14
s_waitcnt vmcnt(6)
v_lshlrev_b32 v14, 16, v88
v_and_b32 v15, 0xffff0000, v88
v_add_f32 v136, v136, v14
v_add_f32 v137, v137, v15
v_cvt_pk_bf16_f32 v68, v136, v137
v_lshlrev_b32 v14, 16, v109
v_and_b32 v15, 0xffff0000, v109
v_mul_f32 v138, v138, v14
v_mul_f32 v139, v139, v15
v_cvt_pk_bf16_f32 v14, v138, v139
v_lshlrev_b32 v138, 16, v14
v_and_b32 v139, 0xffff0000, v14
v_lshlrev_b32 v14, 16, v89
v_and_b32 v15, 0xffff0000, v89
v_add_f32 v138, v138, v14
v_add_f32 v139, v139, v15
v_cvt_pk_bf16_f32 v69, v138, v139
v_lshlrev_b32 v14, 16, v110
v_and_b32 v15, 0xffff0000, v110
v_mul_f32 v140, v140, v14
v_mul_f32 v141, v141, v15
v_cvt_pk_bf16_f32 v14, v140, v141
v_lshlrev_b32 v140, 16, v14
v_and_b32 v141, 0xffff0000, v14
v_lshlrev_b32 v14, 16, v90
v_and_b32 v15, 0xffff0000, v90
v_add_f32 v140, v140, v14
v_add_f32 v141, v141, v15
v_cvt_pk_bf16_f32 v70, v140, v141
v_lshlrev_b32 v14, 16, v111
v_and_b32 v15, 0xffff0000, v111
v_mul_f32 v142, v142, v14
v_mul_f32 v143, v143, v15
v_cvt_pk_bf16_f32 v14, v142, v143
v_lshlrev_b32 v142, 16, v14
v_and_b32 v143, 0xffff0000, v14
v_lshlrev_b32 v14, 16, v91
v_and_b32 v15, 0xffff0000, v91
v_add_f32 v142, v142, v14
v_add_f32 v143, v143, v15
v_cvt_pk_bf16_f32 v71, v142, v143
s_mov_b32 s34, 1064960
buffer_store_dwordx4 v[68:71], v11, s[96:99], s34 offen sc1
s_waitcnt vmcnt(6)
v_lshlrev_b32 v14, 16, v112
v_and_b32 v15, 0xffff0000, v112
v_mul_f32 v144, v144, v14
v_mul_f32 v145, v145, v15
v_cvt_pk_bf16_f32 v14, v144, v145
v_lshlrev_b32 v144, 16, v14
v_and_b32 v145, 0xffff0000, v14
s_waitcnt vmcnt(5)
v_lshlrev_b32 v14, 16, v92
v_and_b32 v15, 0xffff0000, v92
v_add_f32 v144, v144, v14
v_add_f32 v145, v145, v15
v_cvt_pk_bf16_f32 v72, v144, v145
v_lshlrev_b32 v14, 16, v113
v_and_b32 v15, 0xffff0000, v113
v_mul_f32 v146, v146, v14
v_mul_f32 v147, v147, v15
v_cvt_pk_bf16_f32 v14, v146, v147
v_lshlrev_b32 v146, 16, v14
v_and_b32 v147, 0xffff0000, v14
v_lshlrev_b32 v14, 16, v93
v_and_b32 v15, 0xffff0000, v93
v_add_f32 v146, v146, v14
v_add_f32 v147, v147, v15
v_cvt_pk_bf16_f32 v73, v146, v147
v_lshlrev_b32 v14, 16, v114
v_and_b32 v15, 0xffff0000, v114
v_mul_f32 v148, v148, v14
v_mul_f32 v149, v149, v15
v_cvt_pk_bf16_f32 v14, v148, v149
v_lshlrev_b32 v148, 16, v14
v_and_b32 v149, 0xffff0000, v14
v_lshlrev_b32 v14, 16, v94
v_and_b32 v15, 0xffff0000, v94
v_add_f32 v148, v148, v14
v_add_f32 v149, v149, v15
v_cvt_pk_bf16_f32 v74, v148, v149
v_lshlrev_b32 v14, 16, v115
v_and_b32 v15, 0xffff0000, v115
v_mul_f32 v150, v150, v14
v_mul_f32 v151, v151, v15
v_cvt_pk_bf16_f32 v14, v150, v151
v_lshlrev_b32 v150, 16, v14
v_and_b32 v151, 0xffff0000, v14
v_lshlrev_b32 v14, 16, v95
v_and_b32 v15, 0xffff0000, v95
v_add_f32 v150, v150, v14
v_add_f32 v151, v151, v15
v_cvt_pk_bf16_f32 v75, v150, v151
s_mov_b32 s34, 1073152
buffer_store_dwordx4 v[72:75], v11, s[96:99], s34 offen sc1
s_waitcnt vmcnt(5)
v_lshlrev_b32 v14, 16, v116
v_and_b32 v15, 0xffff0000, v116
v_mul_f32 v152, v152, v14
v_mul_f32 v153, v153, v15
v_cvt_pk_bf16_f32 v14, v152, v153
v_lshlrev_b32 v152, 16, v14
v_and_b32 v153, 0xffff0000, v14
s_waitcnt vmcnt(4)
v_lshlrev_b32 v14, 16, v96
v_and_b32 v15, 0xffff0000, v96
v_add_f32 v152, v152, v14
v_add_f32 v153, v153, v15
v_cvt_pk_bf16_f32 v76, v152, v153
v_lshlrev_b32 v14, 16, v117
v_and_b32 v15, 0xffff0000, v117
v_mul_f32 v154, v154, v14
v_mul_f32 v155, v155, v15
v_cvt_pk_bf16_f32 v14, v154, v155
v_lshlrev_b32 v154, 16, v14
v_and_b32 v155, 0xffff0000, v14
v_lshlrev_b32 v14, 16, v97
v_and_b32 v15, 0xffff0000, v97
v_add_f32 v154, v154, v14
v_add_f32 v155, v155, v15
v_cvt_pk_bf16_f32 v77, v154, v155
v_lshlrev_b32 v14, 16, v118
v_and_b32 v15, 0xffff0000, v118
v_mul_f32 v156, v156, v14
v_mul_f32 v157, v157, v15
v_cvt_pk_bf16_f32 v14, v156, v157
v_lshlrev_b32 v156, 16, v14
v_and_b32 v157, 0xffff0000, v14
v_lshlrev_b32 v14, 16, v98
v_and_b32 v15, 0xffff0000, v98
v_add_f32 v156, v156, v14
v_add_f32 v157, v157, v15
v_cvt_pk_bf16_f32 v78, v156, v157
v_lshlrev_b32 v14, 16, v119
v_and_b32 v15, 0xffff0000, v119
v_mul_f32 v158, v158, v14
v_mul_f32 v159, v159, v15
v_cvt_pk_bf16_f32 v14, v158, v159
v_lshlrev_b32 v158, 16, v14
v_and_b32 v159, 0xffff0000, v14
v_lshlrev_b32 v14, 16, v99
v_and_b32 v15, 0xffff0000, v99
v_add_f32 v158, v158, v14
v_add_f32 v159, v159, v15
v_cvt_pk_bf16_f32 v79, v158, v159
s_mov_b32 s34, 1081344
buffer_store_dwordx4 v[76:79], v11, s[96:99], s34 offen sc1
s_mul_i32 s46, s45, 4352
s_waitcnt vmcnt(0)
s_barrier
s_cmp_lg_u32 s100, 0
s_cbranch_scc1 L_sig1
s_mov_b64 exec, 1
v_mov_b32 v24, 1
v_mov_b32 v25, 49283072
v_mov_b32 v26, 1
buffer_atomic_add v24, v25, s[96:99], s46 offen sc0
s_waitcnt vmcnt(0)
v_cmp_eq_u32 vcc, 31, v24
v_mov_b32 v27, 0x40000000
s_nop 0
v_cndmask_b32 v25, v27, v25, vcc
v_add_u32 v25, 34816, v25
buffer_store_dword v26, v25, s[96:99], s46 offen sc1
s_mov_b64 exec, -1
L_sig1:
s_waitcnt lgkmcnt(0)
s_lshl_b32 s46, s45, 3
s_lshl_b32 s47, s100, 1
s_add_u32 s46, s46, s47
s_mul_i32 s46, s46, 40960
v_lshlrev_b32 v14, 4, v2
v_add_u32 v237, s46, v14
v_add_u32 v238, 40960, v237
v_lshl_add_u32 v8, v5, 3, v6
v_lshlrev_b32 v8, 8, v8
v_and_b32 v9, 1, v3
v_lshl_add_u32 v8, v9, 5, v8
v_and_b32 v9, 1, v7
v_lshl_add_u32 v8, v9, 4, v8
v_lshrrev_b32 v9, 1, v7
v_lshl_add_u32 v8, v9, 3, v8
v_xor_b32 v9, 0, v6
v_lshl_add_u32 v216, v9, 6, v8
v_add_u32 v220, 0x10000, v216
v_add_u32 v224, 0x20000, v216
v_xor_b32 v9, 1, v6
v_lshl_add_u32 v217, v9, 6, v8
v_add_u32 v221, 0x10000, v217
v_add_u32 v225, 0x20000, v217
v_xor_b32 v9, 2, v6
v_lshl_add_u32 v218, v9, 6, v8
v_add_u32 v222, 0x10000, v218
v_add_u32 v226, 0x20000, v218
v_xor_b32 v9, 3, v6
v_lshl_add_u32 v219, v9, 6, v8
v_add_u32 v223, 0x10000, v219
v_add_u32 v227, 0x20000, v219
v_and_b32 v8, 0x13, v2
v_bfe_u32 v9, v2, 2, 1
v_lshl_add_u32 v8, v9, 3, v8
v_bfe_u32 v9, v2, 3, 1
v_lshl_add_u32 v8, v9, 2, v8
v_and_b32 v9, 15, v8
v_xor_b32 v9, v9, v5
v_lshlrev_b32 v8, 8, v8
v_xor_b32 v10, 0, v9
v_lshl_add_u32 v208, v10, 4, v8
v_xor_b32 v10, 2, v9
v_lshl_add_u32 v209, v10, 4, v8
v_xor_b32 v10, 4, v9
v_lshl_add_u32 v210, v10, 4, v8
v_xor_b32 v10, 6, v9
v_lshl_add_u32 v211, v10, 4, v8
v_xor_b32 v10, 8, v9
v_lshl_add_u32 v212, v10, 4, v8
v_xor_b32 v10, 10, v9
v_lshl_add_u32 v213, v10, 4, v8
v_xor_b32 v10, 12, v9
v_lshl_add_u32 v214, v10, 4, v8
v_xor_b32 v10, 14, v9
v_lshl_add_u32 v215, v10, 4, v8
v_lshlrev_b32 v8, 8, v3
v_lshl_add_u32 v8, v1, 12, v8
v_xor_b32 v9, v4, v3
v_xor_b32 v10, 0, v9
v_lshl_add_u32 v228, v10, 4, v8
v_xor_b32 v10, 4, v9
v_lshl_add_u32 v229, v10, 4, v8
v_xor_b32 v10, 8, v9
v_lshl_add_u32 v230, v10, 4, v8
v_xor_b32 v10, 12, v9
v_lshl_add_u32 v231, v10, 4, v8
v_lshlrev_b32 v10, 2, v3
v_xor_b32 v10, v10, v4
v_lshl_add_u32 v232, v10, 4, v8
s_lshl_b32 s32, s30, 19
s_add_u32 s32, s32, 393216
s_lshl_b32 s46, s45, 3
s_lshl_b32 s47, s100, 1
s_add_u32 s46, s46, s47
s_lshl_b32 s46, s46, 8
s_lshl_b32 s47, s30, 3
s_add_u32 s46, s46, s47
s_lshl_b32 s46, s46, 10
v_add_u32 v239, s46, v14
s_mov_b32 s44, 0x5f800000
s_mov_b32 s20, s52
s_mov_b32 s21, s53
s_mov_b32 s22, 0x500000
s_mov_b32 s23, 0x20000
s_mov_b32 s24, s54
s_mov_b32 s25, s55
s_mov_b32 s26, 0x21c000
s_mov_b32 s27, 0x20000
s_mov_b32 s40, s48
s_mov_b32 s41, s49
s_mov_b32 s42, 0x21c000
s_mov_b32 s43, 0x20000
s_mov_b32 s48, s50
s_mov_b32 s49, s51
s_mov_b32 s50, 0x21c000
s_mov_b32 s51, 0x20000
v_bfe_u32 v8, v2, 4, 1
v_lshl_add_u32 v8, v8, 2, v6
v_lshl_add_u32 v8, v5, 4, v8
v_mul_u32_u24 v8, 160, v8
v_lshl_add_u32 v8, v7, 3, v8
s_lshl_b32 s56, s100, 13
s_add_u32 s56, s56, 0x20000
v_add_u32 v13, s56, v8
s_lshr_b32 s46, s2, 1
s_and_b32 s47, s2, 1
s_lshl_b32 s47, s47, 2
s_add_u32 s47, s47, s100
s_mul_i32 s57, s46, 40960
s_mul_i32 s3, s47, 160
s_add_u32 s57, s57, s3
s_lshl_b32 s3, s47, 7
s_add_u32 s3, s3, s46
s_mul_i32 s4, s3, 5120
s_add_u32 s4, s4, 0x2400000
s_mul_i32 s3, s47, 54
s_add_u32 s3, s3, s46
s_mul_i32 s5, s3, 5120
s_add_u32 s5, s5, 0x2a00000
s_cmp_ge_u32 s46, 54
s_cselect_b32 s3, 0x40000000, 0
s_add_u32 s5, s5, s3
s_add_u32 s6, s4, 4096
s_add_u32 s7, s5, 4096
s_lshl_b32 s3, s2, 2
s_add_u32 s3, s3, s100
s_mul_i32 s3, s3, 2176
v_lshlrev_b32 v15, 6, v2
v_add_u32 v15, s3, v15
v_cmp_gt_u32 vcc, 34, v2
v_mov_b32 v9, 0x40000000
s_nop 0
v_cndmask_b32 v15, v9, v15, vcc
s_mul_i32 s37, s45, 4352
s_bfe_u32 s3, s2, 0x20001
s_lshl_b32 s3, s3, 5
s_lshr_b32 s28, s2, 3
s_add_u32 s28, s28, s3
s_lshl_b32 s28, s28, 2
s_add_u32 s28, s28, s100
s_mul_i32 s28, s28, 10240
v_lshlrev_b32 v7, 6, v2
s_lshl_b32 s36, s45, 2
s_lshr_b32 s3, s30, 3
s_add_u32 s36, s36, s3
s_mul_i32 s36, s36, 4352
v_add_u32 v244, 0, v2
v_mul_u32_u24 v245, 6554, v244
v_lshrrev_b32 v245, 16, v245
v_mul_u32_u24 v246, 10, v245
v_sub_u32 v246, v244, v246
v_and_b32 v247, 0x13, v245
v_bfe_u32 v248, v245, 2, 1
v_lshl_add_u32 v247, v248, 3, v247
v_bfe_u32 v248, v245, 3, 1
v_lshl_add_u32 v247, v248, 2, v247
v_mul_u32_u24 v247, 1280, v247
v_lshl_add_u32 v247, v246, 4, v247
v_subrev_u32 v8, 0, v247
v_add_u32 v244, 64, v2
v_mul_u32_u24 v245, 6554, v244
v_lshrrev_b32 v245, 16, v245
v_mul_u32_u24 v246, 10, v245
v_sub_u32 v246, v244, v246
v_and_b32 v247, 0x13, v245
v_bfe_u32 v248, v245, 2, 1
v_lshl_add_u32 v247, v248, 3, v247
v_bfe_u32 v248, v245, 3, 1
v_lshl_add_u32 v247, v248, 2, v247
v_mul_u32_u24 v247, 1280, v247
v_lshl_add_u32 v247, v246, 4, v247
v_subrev_u32 v9, 1024, v247
v_add_u32 v244, 128, v2
v_mul_u32_u24 v245, 6554, v244
v_lshrrev_b32 v245, 16, v245
v_mul_u32_u24 v246, 10, v245
v_sub_u32 v246, v244, v246
v_and_b32 v247, 0x13, v245
v_bfe_u32 v248, v245, 2, 1
v_lshl_add_u32 v247, v248, 3, v247
v_bfe_u32 v248, v245, 3, 1
v_lshl_add_u32 v247, v248, 2, v247
v_mul_u32_u24 v247, 1280, v247
v_lshl_add_u32 v247, v246, 4, v247
v_subrev_u32 v10, 2048, v247
v_add_u32 v244, 192, v2
v_mul_u32_u24 v245, 6554, v244
v_lshrrev_b32 v245, 16, v245
v_mul_u32_u24 v246, 10, v245
v_sub_u32 v246, v244, v246
v_and_b32 v247, 0x13, v245
v_bfe_u32 v248, v245, 2, 1
v_lshl_add_u32 v247, v248, 3, v247
v_bfe_u32 v248, v245, 3, 1
v_lshl_add_u32 v247, v248, 2, v247
v_mul_u32_u24 v247, 1280, v247
v_lshl_add_u32 v247, v246, 4, v247
v_subrev_u32 v11, 3072, v247
v_add_u32 v244, 256, v2
v_mul_u32_u24 v245, 6554, v244
v_lshrrev_b32 v245, 16, v245
v_mul_u32_u24 v246, 10, v245
v_sub_u32 v246, v244, v246
v_and_b32 v247, 0x13, v245
v_bfe_u32 v248, v245, 2, 1
v_lshl_add_u32 v247, v248, 3, v247
v_bfe_u32 v248, v245, 3, 1
v_lshl_add_u32 v247, v248, 2, v247
v_mul_u32_u24 v247, 1280, v247
v_lshl_add_u32 v247, v246, 4, v247
v_subrev_u32 v12, 0, v247
v_mov_b32 v24, 49317888
s_mov_b32 s101, 0
L_poll2:
buffer_load_dword v25, v24, s[96:99], s37 offen sc1
s_add_u32 s101, s101, 1
s_waitcnt vmcnt(0)
v_cmp_gt_u32 vcc, 1, v25
s_nop 0
s_cbranch_vccz L_poll2_go
s_sleep 2
s_cmp_lt_u32 s101, 0x20000
s_cbranch_scc1 L_poll2
L_poll2_go:
s_branch L_join
L_roleB:
s_sub_u32 s46, s100, 2
s_lshl_b32 s39, s46, 13
s_lshl_b32 s46, s46, 5
v_lshlrev_b32 v8, 2, v3
v_xor_b32 v8, v8, v4
v_lshlrev_b32 v8, 4, v8
v_add_u32 v9, s46, v3
v_lshl_add_u32 v233, v9, 13, v8
v_add_u32 v234, 31744, v233
v_add_u32 v235, 63488, v233
v_add_u32 v236, 95232, v233
s_add_u32 m0, s39, 0
s_add_u32 s31, s33, 0
buffer_load_dwordx4 v233, s[8:11], s31 offen offset:0 lds
buffer_load_dwordx4 v234, s[8:11], s31 offen offset:1024 lds
buffer_load_dwordx4 v235, s[8:11], s31 offen offset:2048 lds
buffer_load_dwordx4 v236, s[8:11], s31 offen offset:3072 lds
s_add_u32 m0, s39, 4096
s_add_u32 s31, s33, 131072
buffer_load_dwordx4 v233, s[8:11], s31 offen offset:0 lds
buffer_load_dwordx4 v234, s[8:11], s31 offen offset:1024 lds
buffer_load_dwordx4 v235, s[8:11], s31 offen offset:2048 lds
buffer_load_dwordx4 v236, s[8:11], s31 offen offset:3072 lds
s_add_u32 m0, s39, 16384
s_add_u32 s31, s33, 524288
buffer_load_dwordx4 v233, s[8:11], s31 offen offset:0 lds
buffer_load_dwordx4 v234, s[8:11], s31 offen offset:1024 lds
buffer_load_dwordx4 v235, s[8:11], s31 offen offset:2048 lds
buffer_load_dwordx4 v236, s[8:11], s31 offen offset:3072 lds
s_add_u32 m0, s39, 20480
s_add_u32 s31, s33, 655360
buffer_load_dwordx4 v233, s[8:11], s31 offen offset:0 lds
buffer_load_dwordx4 v234, s[8:11], s31 offen offset:1024 lds
buffer_load_dwordx4 v235, s[8:11], s31 offen offset:2048 lds
buffer_load_dwordx4 v236, s[8:11], s31 offen offset:3072 lds
s_add_u32 m0, s39, 32768
s_add_u32 s31, s33, 1048576
buffer_load_dwordx4 v233, s[8:11], s31 offen offset:0 lds
buffer_load_dwordx4 v234, s[8:11], s31 offen offset:1024 lds
buffer_load_dwordx4 v235, s[8:11], s31 offen offset:2048 lds
buffer_load_dwordx4 v236, s[8:11], s31 offen offset:3072 lds
s_add_u32 m0, s39, 36864
s_add_u32 s31, s33, 1179648
buffer_load_dwordx4 v233, s[8:11], s31 offen offset:0 lds
buffer_load_dwordx4 v234, s[8:11], s31 offen offset:1024 lds
buffer_load_dwordx4 v235, s[8:11], s31 offen offset:2048 lds
buffer_load_dwordx4 v236, s[8:11], s31 offen offset:3072 lds
s_add_u32 m0, s39, 49152
s_add_u32 s31, s33, 1572864
buffer_load_dwordx4 v233, s[8:11], s31 offen offset:0 lds
buffer_load_dwordx4 v234, s[8:11], s31 offen offset:1024 lds
buffer_load_dwordx4 v235, s[8:11], s31 offen offset:2048 lds
buffer_load_dwordx4 v236, s[8:11], s31 offen offset:3072 lds
s_add_u32 m0, s39, 53248
s_add_u32 s31, s33, 1703936
buffer_load_dwordx4 v233, s[8:11], s31 offen offset:0 lds
buffer_load_dwordx4 v234, s[8:11], s31 offen offset:1024 lds
buffer_load_dwordx4 v235, s[8:11], s31 offen offset:2048 lds
buffer_load_dwordx4 v236, s[8:11], s31 offen offset:3072 lds
s_add_u32 m0, s39, 65536
s_add_u32 s31, s33, 2097152
buffer_load_dwordx4 v233, s[8:11], s31 offen offset:0 lds
buffer_load_dwordx4 v234, s[8:11], s31 offen offset:1024 lds
buffer_load_dwordx4 v235, s[8:11], s31 offen offset:2048 lds
buffer_load_dwordx4 v236, s[8:11], s31 offen offset:3072 lds
s_add_u32 m0, s39, 69632
s_add_u32 s31, s33, 2228224
buffer_load_dwordx4 v233, s[8:11], s31 offen offset:0 lds
buffer_load_dwordx4 v234, s[8:11], s31 offen offset:1024 lds
buffer_load_dwordx4 v235, s[8:11], s31 offen offset:2048 lds
buffer_load_dwordx4 v236, s[8:11], s31 offen offset:3072 lds
s_add_u32 m0, s39, 81920
s_add_u32 s31, s33, 2621440
buffer_load_dwordx4 v233, s[8:11], s31 offen offset:0 lds
buffer_load_dwordx4 v234, s[8:11], s31 offen offset:1024 lds
buffer_load_dwordx4 v235, s[8:11], s31 offen offset:2048 lds
buffer_load_dwordx4 v236, s[8:11], s31 offen offset:3072 lds
s_add_u32 m0, s39, 86016
s_add_u32 s31, s33, 2752512
buffer_load_dwordx4 v233, s[8:11], s31 offen offset:0 lds
buffer_load_dwordx4 v234, s[8:11], s31 offen offset:1024 lds
buffer_load_dwordx4 v235, s[8:11], s31 offen offset:2048 lds
buffer_load_dwordx4 v236, s[8:11], s31 offen offset:3072 lds
s_add_u32 m0, s39, 98304
s_add_u32 s31, s33, 3145728
buffer_load_dwordx4 v233, s[8:11], s31 offen offset:0 lds
buffer_load_dwordx4 v234, s[8:11], s31 offen offset:1024 lds
buffer_load_dwordx4 v235, s[8:11], s31 offen offset:2048 lds
buffer_load_dwordx4 v236, s[8:11], s31 offen offset:3072 lds
s_add_u32 m0, s39, 102400
s_add_u32 s31, s33, 3276800
buffer_load_dwordx4 v233, s[8:11], s31 offen offset:0 lds
buffer_load_dwordx4 v234, s[8:11], s31 offen offset:1024 lds
buffer_load_dwordx4 v235, s[8:11], s31 offen offset:2048 lds
buffer_load_dwordx4 v236, s[8:11], s31 offen offset:3072 lds
s_add_u32 m0, s39, 114688
s_add_u32 s31, s33, 3670016
buffer_load_dwordx4 v233, s[8:11], s31 offen offset:0 lds
buffer_load_dwordx4 v234, s[8:11], s31 offen offset:1024 lds
buffer_load_dwordx4 v235, s[8:11], s31 offen offset:2048 lds
buffer_load_dwordx4 v236, s[8:11], s31 offen offset:3072 lds
s_add_u32 m0, s39, 118784
s_add_u32 s31, s33, 3801088
buffer_load_dwordx4 v233, s[8:11], s31 offen offset:0 lds
buffer_load_dwordx4 v234, s[8:11], s31 offen offset:1024 lds
buffer_load_dwordx4 v235, s[8:11], s31 offen offset:2048 lds
buffer_load_dwordx4 v236, s[8:11], s31 offen offset:3072 lds
s_add_u32 m0, s39, 131072
s_add_u32 s31, s33, 4194304
buffer_load_dwordx4 v233, s[8:11], s31 offen offset:0 lds
buffer_load_dwordx4 v234, s[8:11], s31 offen offset:1024 lds
buffer_load_dwordx4 v235, s[8:11], s31 offen offset:2048 lds
buffer_load_dwordx4 v236, s[8:11], s31 offen offset:3072 lds
s_add_u32 m0, s39, 135168
s_add_u32 s31, s33, 4325376
buffer_load_dwordx4 v233, s[8:11], s31 offen offset:0 lds
buffer_load_dwordx4 v234, s[8:11], s31 offen offset:1024 lds
buffer_load_dwordx4 v235, s[8:11], s31 offen offset:2048 lds
buffer_load_dwordx4 v236, s[8:11], s31 offen offset:3072 lds
s_waitcnt lgkmcnt(0)
s_lshl_b32 s46, s45, 3
s_lshl_b32 s47, s100, 1
s_add_u32 s46, s46, s47
s_mul_i32 s46, s46, 40960
v_lshlrev_b32 v14, 4, v2
v_add_u32 v237, s46, v14
v_add_u32 v238, 40960, v237
v_lshl_add_u32 v8, v5, 3, v6
v_lshlrev_b32 v8, 8, v8
v_and_b32 v9, 1, v3
v_lshl_add_u32 v8, v9, 5, v8
v_and_b32 v9, 1, v7
v_lshl_add_u32 v8, v9, 4, v8
v_lshrrev_b32 v9, 1, v7
v_lshl_add_u32 v8, v9, 3, v8
v_xor_b32 v9, 0, v6
v_lshl_add_u32 v216, v9, 6, v8
v_add_u32 v220, 0x10000, v216
v_add_u32 v224, 0x20000, v216
v_xor_b32 v9, 1, v6
v_lshl_add_u32 v217, v9, 6, v8
v_add_u32 v221, 0x10000, v217
v_add_u32 v225, 0x20000, v217
v_xor_b32 v9, 2, v6
v_lshl_add_u32 v218, v9, 6, v8
v_add_u32 v222, 0x10000, v218
v_add_u32 v226, 0x20000, v218
v_xor_b32 v9, 3, v6
v_lshl_add_u32 v219, v9, 6, v8
v_add_u32 v223, 0x10000, v219
v_add_u32 v227, 0x20000, v219
v_and_b32 v8, 0x13, v2
v_bfe_u32 v9, v2, 2, 1
v_lshl_add_u32 v8, v9, 3, v8
v_bfe_u32 v9, v2, 3, 1
v_lshl_add_u32 v8, v9, 2, v8
v_and_b32 v9, 15, v8
v_xor_b32 v9, v9, v5
v_lshlrev_b32 v8, 8, v8
v_xor_b32 v10, 0, v9
v_lshl_add_u32 v208, v10, 4, v8
v_xor_b32 v10, 2, v9
v_lshl_add_u32 v209, v10, 4, v8
v_xor_b32 v10, 4, v9
v_lshl_add_u32 v210, v10, 4, v8
v_xor_b32 v10, 6, v9
v_lshl_add_u32 v211, v10, 4, v8
v_xor_b32 v10, 8, v9
v_lshl_add_u32 v212, v10, 4, v8
v_xor_b32 v10, 10, v9
v_lshl_add_u32 v213, v10, 4, v8
v_xor_b32 v10, 12, v9
v_lshl_add_u32 v214, v10, 4, v8
v_xor_b32 v10, 14, v9
v_lshl_add_u32 v215, v10, 4, v8
v_lshlrev_b32 v8, 8, v3
v_lshl_add_u32 v8, v1, 12, v8
v_xor_b32 v9, v4, v3
v_xor_b32 v10, 0, v9
v_lshl_add_u32 v228, v10, 4, v8
v_xor_b32 v10, 4, v9
v_lshl_add_u32 v229, v10, 4, v8
v_xor_b32 v10, 8, v9
v_lshl_add_u32 v230, v10, 4, v8
v_xor_b32 v10, 12, v9
v_lshl_add_u32 v231, v10, 4, v8
v_lshlrev_b32 v10, 2, v3
v_xor_b32 v10, v10, v4
v_lshl_add_u32 v232, v10, 4, v8
s_lshl_b32 s32, s30, 19
s_add_u32 s32, s32, 393216
s_lshl_b32 s46, s45, 3
s_lshl_b32 s47, s100, 1
s_add_u32 s46, s46, s47
s_lshl_b32 s46, s46, 8
s_lshl_b32 s47, s30, 3
s_add_u32 s46, s46, s47
s_lshl_b32 s46, s46, 10
v_add_u32 v239, s46, v14
s_mov_b32 s44, 0x5f800000
s_mov_b32 s20, s52
s_mov_b32 s21, s53
s_mov_b32 s22, 0x500000
s_mov_b32 s23, 0x20000
s_mov_b32 s24, s54
s_mov_b32 s25, s55
s_mov_b32 s26, 0x21c000
s_mov_b32 s27, 0x20000
s_mov_b32 s40, s48
s_mov_b32 s41, s49
s_mov_b32 s42, 0x21c000
s_mov_b32 s43, 0x20000
s_mov_b32 s48, s50
s_mov_b32 s49, s51
s_mov_b32 s50, 0x21c000
s_mov_b32 s51, 0x20000
v_bfe_u32 v8, v2, 4, 1
v_lshl_add_u32 v8, v8, 2, v6
v_lshl_add_u32 v8, v5, 4, v8
v_mul_u32_u24 v8, 160, v8
v_lshl_add_u32 v8, v7, 3, v8
s_lshl_b32 s56, s100, 13
s_add_u32 s56, s56, 0x20000
v_add_u32 v13, s56, v8
s_lshr_b32 s46, s2, 1
s_and_b32 s47, s2, 1
s_lshl_b32 s47, s47, 2
s_add_u32 s47, s47, s100
s_mul_i32 s57, s46, 40960
s_mul_i32 s3, s47, 160
s_add_u32 s57, s57, s3
s_lshl_b32 s3, s47, 7
s_add_u32 s3, s3, s46
s_mul_i32 s4, s3, 5120
s_add_u32 s4, s4, 0x2400000
s_mul_i32 s3, s47, 54
s_add_u32 s3, s3, s46
s_mul_i32 s5, s3, 5120
s_add_u32 s5, s5, 0x2a00000
s_cmp_ge_u32 s46, 54
s_cselect_b32 s3, 0x40000000, 0
s_add_u32 s5, s5, s3
s_add_u32 s6, s4, 4096
s_add_u32 s7, s5, 4096
s_lshl_b32 s3, s2, 2
s_add_u32 s3, s3, s100
s_mul_i32 s3, s3, 2176
v_lshlrev_b32 v15, 6, v2
v_add_u32 v15, s3, v15
v_cmp_gt_u32 vcc, 34, v2
v_mov_b32 v9, 0x40000000
s_nop 0
v_cndmask_b32 v15, v9, v15, vcc
s_mul_i32 s37, s45, 4352
s_bfe_u32 s3, s2, 0x20001
s_lshl_b32 s3, s3, 5
s_lshr_b32 s28, s2, 3
s_add_u32 s28, s28, s3
s_lshl_b32 s28, s28, 2
s_add_u32 s28, s28, s100
s_mul_i32 s28, s28, 10240
v_lshlrev_b32 v7, 6, v2
s_lshl_b32 s36, s45, 2
s_lshr_b32 s3, s30, 3
s_add_u32 s36, s36, s3
s_mul_i32 s36, s36, 4352
v_add_u32 v244, 0, v2
v_mul_u32_u24 v245, 6554, v244
v_lshrrev_b32 v245, 16, v245
v_mul_u32_u24 v246, 10, v245
v_sub_u32 v246, v244, v246
v_and_b32 v247, 0x13, v245
v_bfe_u32 v248, v245, 2, 1
v_lshl_add_u32 v247, v248, 3, v247
v_bfe_u32 v248, v245, 3, 1
v_lshl_add_u32 v247, v248, 2, v247
v_mul_u32_u24 v247, 1280, v247
v_lshl_add_u32 v247, v246, 4, v247
v_subrev_u32 v8, 0, v247
v_add_u32 v244, 64, v2
v_mul_u32_u24 v245, 6554, v244
v_lshrrev_b32 v245, 16, v245
v_mul_u32_u24 v246, 10, v245
v_sub_u32 v246, v244, v246
v_and_b32 v247, 0x13, v245
v_bfe_u32 v248, v245, 2, 1
v_lshl_add_u32 v247, v248, 3, v247
v_bfe_u32 v248, v245, 3, 1
v_lshl_add_u32 v247, v248, 2, v247
v_mul_u32_u24 v247, 1280, v247
v_lshl_add_u32 v247, v246, 4, v247
v_subrev_u32 v9, 1024, v247
v_add_u32 v244, 128, v2
v_mul_u32_u24 v245, 6554, v244
v_lshrrev_b32 v245, 16, v245
v_mul_u32_u24 v246, 10, v245
v_sub_u32 v246, v244, v246
v_and_b32 v247, 0x13, v245
v_bfe_u32 v248, v245, 2, 1
v_lshl_add_u32 v247, v248, 3, v247
v_bfe_u32 v248, v245, 3, 1
v_lshl_add_u32 v247, v248, 2, v247
v_mul_u32_u24 v247, 1280, v247
v_lshl_add_u32 v247, v246, 4, v247
v_subrev_u32 v10, 2048, v247
v_add_u32 v244, 192, v2
v_mul_u32_u24 v245, 6554, v244
v_lshrrev_b32 v245, 16, v245
v_mul_u32_u24 v246, 10, v245
v_sub_u32 v246, v244, v246
v_and_b32 v247, 0x13, v245
v_bfe_u32 v248, v245, 2, 1
v_lshl_add_u32 v247, v248, 3, v247
v_bfe_u32 v248, v245, 3, 1
v_lshl_add_u32 v247, v248, 2, v247
v_mul_u32_u24 v247, 1280, v247
v_lshl_add_u32 v247, v246, 4, v247
v_subrev_u32 v11, 3072, v247
v_add_u32 v244, 256, v2
v_mul_u32_u24 v245, 6554, v244
v_lshrrev_b32 v245, 16, v245
v_mul_u32_u24 v246, 10, v245
v_sub_u32 v246, v244, v246
v_and_b32 v247, 0x13, v245
v_bfe_u32 v248, v245, 2, 1
v_lshl_add_u32 v247, v248, 3, v247
v_bfe_u32 v248, v245, 3, 1
v_lshl_add_u32 v247, v248, 2, v247
v_mul_u32_u24 v247, 1280, v247
v_lshl_add_u32 v247, v246, 4, v247
v_subrev_u32 v12, 0, v247
s_barrier
s_add_u32 m0, s39, 147456
s_add_u32 s31, s33, 4718592
buffer_load_dwordx4 v233, s[8:11], s31 offen offset:0 lds
buffer_load_dwordx4 v234, s[8:11], s31 offen offset:1024 lds
buffer_load_dwordx4 v235, s[8:11], s31 offen offset:2048 lds
buffer_load_dwordx4 v236, s[8:11], s31 offen offset:3072 lds
s_add_u32 m0, s39, 151552
s_add_u32 s31, s33, 4849664
buffer_load_dwordx4 v233, s[8:11], s31 offen offset:0 lds
buffer_load_dwordx4 v234, s[8:11], s31 offen offset:1024 lds
buffer_load_dwordx4 v235, s[8:11], s31 offen offset:2048 lds
buffer_load_dwordx4 v236, s[8:11], s31 offen offset:3072 lds
s_waitcnt vmcnt(0)
L_join:
s_barrier
s_mov_b32 s34, 1048576
buffer_load_dwordx4 a[0:3], v237, s[96:99], s34 offen offset:0 sc1
buffer_load_dwordx4 a[4:7], v238, s[96:99], s34 offen offset:0 sc1
buffer_load_dwordx4 a[8:11], v237, s[96:99], s34 offen offset:1024 sc1
buffer_load_dwordx4 a[12:15], v238, s[96:99], s34 offen offset:1024 sc1
buffer_load_dwordx4 a[16:19], v237, s[96:99], s34 offen offset:2048 sc1
buffer_load_dwordx4 a[20:23], v238, s[96:99], s34 offen offset:2048 sc1
buffer_load_dwordx4 a[24:27], v237, s[96:99], s34 offen offset:3072 sc1
buffer_load_dwordx4 a[28:31], v238, s[96:99], s34 offen offset:3072 sc1
s_mov_b32 s34, 1052672
buffer_load_dwordx4 a[32:35], v237, s[96:99], s34 offen offset:0 sc1
buffer_load_dwordx4 a[36:39], v238, s[96:99], s34 offen offset:0 sc1
buffer_load_dwordx4 a[40:43], v237, s[96:99], s34 offen offset:1024 sc1
buffer_load_dwordx4 a[44:47], v238, s[96:99], s34 offen offset:1024 sc1
buffer_load_dwordx4 a[48:51], v237, s[96:99], s34 offen offset:2048 sc1
buffer_load_dwordx4 a[52:55], v238, s[96:99], s34 offen offset:2048 sc1
buffer_load_dwordx4 a[56:59], v237, s[96:99], s34 offen offset:3072 sc1
buffer_load_dwordx4 a[60:63], v238, s[96:99], s34 offen offset:3072 sc1
s_mov_b32 s34, 1056768
buffer_load_dwordx4 a[64:67], v237, s[96:99], s34 offen offset:0 sc1
buffer_load_dwordx4 a[68:71], v238, s[96:99], s34 offen offset:0 sc1
buffer_load_dwordx4 a[72:75], v237, s[96:99], s34 offen offset:1024 sc1
buffer_load_dwordx4 a[76:79], v238, s[96:99], s34 offen offset:1024 sc1
buffer_load_dwordx4 a[80:83], v237, s[96:99], s34 offen offset:2048 sc1
buffer_load_dwordx4 a[84:87], v238, s[96:99], s34 offen offset:2048 sc1
buffer_load_dwordx4 a[88:91], v237, s[96:99], s34 offen offset:3072 sc1
buffer_load_dwordx4 a[92:95], v238, s[96:99], s34 offen offset:3072 sc1
ds_read_b64_tr_b16 a[192:193], v216 offset:0
ds_read_b64_tr_b16 a[194:195], v216 offset:1024
ds_read_b64_tr_b16 a[196:197], v217 offset:0
ds_read_b64_tr_b16 a[198:199], v217 offset:1024
ds_read_b64_tr_b16 a[200:201], v218 offset:0
ds_read_b64_tr_b16 a[202:203], v218 offset:1024
ds_read_b64_tr_b16 a[204:205], v219 offset:0
ds_read_b64_tr_b16 a[206:207], v219 offset:1024
ds_read_b64_tr_b16 a[208:209], v216 offset:4096
ds_read_b64_tr_b16 a[210:211], v216 offset:5120
ds_read_b64_tr_b16 a[212:213], v217 offset:4096
ds_read_b64_tr_b16 a[214:215], v217 offset:5120
ds_read_b64_tr_b16 a[216:217], v218 offset:4096
ds_read_b64_tr_b16 a[218:219], v218 offset:5120
ds_read_b64_tr_b16 a[220:221], v219 offset:4096
ds_read_b64_tr_b16 a[222:223], v219 offset:5120
s_waitcnt vmcnt(23) lgkmcnt(14)
v_mfma_f32_32x32x16_bf16 v[80:95], a[192:195], a[0:3], 0
ds_read_b64_tr_b16 a[224:225], v216 offset:8192
s_mov_b32 s34, 1060864
buffer_load_dwordx4 a[96:99], v237, s[96:99], s34 offen offset:0 sc1
s_waitcnt vmcnt(23)
v_mfma_f32_32x32x16_bf16 v[144:159], a[192:195], a[4:7], 0
ds_read_b64_tr_b16 a[226:227], v216 offset:9216
s_waitcnt lgkmcnt(14)
v_mfma_f32_32x32x16_bf16 v[96:111], a[196:199], a[0:3], 0
ds_read_b64_tr_b16 a[228:229], v217 offset:8192
v_mfma_f32_32x32x16_bf16 v[160:175], a[196:199], a[4:7], 0
ds_read_b64_tr_b16 a[230:231], v217 offset:9216
s_waitcnt lgkmcnt(14)
v_mfma_f32_32x32x16_bf16 v[112:127], a[200:203], a[0:3], 0
ds_read_b64_tr_b16 a[232:233], v218 offset:8192
buffer_load_dwordx4 a[100:103], v238, s[96:99], s34 offen offset:0 sc1
v_mfma_f32_32x32x16_bf16 v[176:191], a[200:203], a[4:7], 0
ds_read_b64_tr_b16 a[234:235], v218 offset:9216
s_waitcnt lgkmcnt(5)
v_mfma_f32_32x32x16_bf16 v[128:143], a[204:207], a[0:3], 0
ds_read_b64_tr_b16 a[236:237], v219 offset:8192
v_mfma_f32_32x32x16_bf16 v[192:207], a[204:207], a[4:7], 0
ds_read_b64_tr_b16 a[238:239], v219 offset:9216
s_waitcnt vmcnt(23)
v_mfma_f32_32x32x16_bf16 v[80:95], a[208:211], a[8:11], v[80:95]
ds_read_b64_tr_b16 a[240:241], v216 offset:12288
buffer_load_dwordx4 a[104:107], v237, s[96:99], s34 offen offset:1024 sc1
s_waitcnt vmcnt(23)
v_mfma_f32_32x32x16_bf16 v[144:159], a[208:211], a[12:15], v[144:159]
ds_read_b64_tr_b16 a[242:243], v216 offset:13312
v_mfma_f32_32x32x16_bf16 v[96:111], a[212:215], a[8:11], v[96:111]
ds_read_b64_tr_b16 a[244:245], v217 offset:12288
v_mfma_f32_32x32x16_bf16 v[160:175], a[212:215], a[12:15], v[160:175]
ds_read_b64_tr_b16 a[246:247], v217 offset:13312
v_mfma_f32_32x32x16_bf16 v[112:127], a[216:219], a[8:11], v[112:127]
ds_read_b64_tr_b16 a[248:249], v218 offset:12288
buffer_load_dwordx4 a[108:111], v238, s[96:99], s34 offen offset:1024 sc1
v_mfma_f32_32x32x16_bf16 v[176:191], a[216:219], a[12:15], v[176:191]
ds_read_b64_tr_b16 a[250:251], v218 offset:13312
v_mfma_f32_32x32x16_bf16 v[128:143], a[220:223], a[8:11], v[128:143]
ds_read_b64_tr_b16 a[252:253], v219 offset:12288
v_mfma_f32_32x32x16_bf16 v[192:207], a[220:223], a[12:15], v[192:207]
ds_read_b64_tr_b16 a[254:255], v219 offset:13312
s_waitcnt vmcnt(23) lgkmcnt(5)
v_mfma_f32_32x32x16_bf16 v[80:95], a[224:227], a[16:19], v[80:95]
ds_read_b64_tr_b16 a[192:193], v216 offset:16384
buffer_load_dwordx4 a[112:115], v237, s[96:99], s34 offen offset:2048 sc1
s_waitcnt vmcnt(23)
v_mfma_f32_32x32x16_bf16 v[144:159], a[224:227], a[20:23], v[144:159]
ds_read_b64_tr_b16 a[194:195], v216 offset:17408
v_mfma_f32_32x32x16_bf16 v[96:111], a[228:231], a[16:19], v[96:111]
ds_read_b64_tr_b16 a[196:197], v217 offset:16384
v_mfma_f32_32x32x16_bf16 v[160:175], a[228:231], a[20:23], v[160:175]
ds_read_b64_tr_b16 a[198:199], v217 offset:17408
v_mfma_f32_32x32x16_bf16 v[112:127], a[232:235], a[16:19], v[112:127]
ds_read_b64_tr_b16 a[200:201], v218 offset:16384
buffer_load_dwordx4 a[116:119], v238, s[96:99], s34 offen offset:2048 sc1
v_mfma_f32_32x32x16_bf16 v[176:191], a[232:235], a[20:23], v[176:191]
ds_read_b64_tr_b16 a[202:203], v218 offset:17408
v_mfma_f32_32x32x16_bf16 v[128:143], a[236:239], a[16:19], v[128:143]
ds_read_b64_tr_b16 a[204:205], v219 offset:16384
v_mfma_f32_32x32x16_bf16 v[192:207], a[236:239], a[20:23], v[192:207]
ds_read_b64_tr_b16 a[206:207], v219 offset:17408
s_waitcnt vmcnt(23)
v_mfma_f32_32x32x16_bf16 v[80:95], a[240:243], a[24:27], v[80:95]
ds_read_b64_tr_b16 a[208:209], v216 offset:20480
buffer_load_dwordx4 a[120:123], v237, s[96:99], s34 offen offset:3072 sc1
s_waitcnt vmcnt(23)
v_mfma_f32_32x32x16_bf16 v[144:159], a[240:243], a[28:31], v[144:159]
ds_read_b64_tr_b16 a[210:211], v216 offset:21504
s_waitcnt lgkmcnt(5)
v_mfma_f32_32x32x16_bf16 v[96:111], a[244:247], a[24:27], v[96:111]
ds_read_b64_tr_b16 a[212:213], v217 offset:20480
v_mfma_f32_32x32x16_bf16 v[160:175], a[244:247], a[28:31], v[160:175]
ds_read_b64_tr_b16 a[214:215], v217 offset:21504
v_mfma_f32_32x32x16_bf16 v[112:127], a[248:251], a[24:27], v[112:127]
ds_read_b64_tr_b16 a[216:217], v218 offset:20480
buffer_load_dwordx4 a[124:127], v238, s[96:99], s34 offen offset:3072 sc1
v_mfma_f32_32x32x16_bf16 v[176:191], a[248:251], a[28:31], v[176:191]
ds_read_b64_tr_b16 a[218:219], v218 offset:21504
s_mov_b32 s34, 1064960
v_mfma_f32_32x32x16_bf16 v[128:143], a[252:255], a[24:27], v[128:143]
ds_read_b64_tr_b16 a[220:221], v219 offset:20480
v_mfma_f32_32x32x16_bf16 v[192:207], a[252:255], a[28:31], v[192:207]
ds_read_b64_tr_b16 a[222:223], v219 offset:21504
s_waitcnt vmcnt(23)
v_mfma_f32_32x32x16_bf16 v[80:95], a[192:195], a[32:35], v[80:95]
ds_read_b64_tr_b16 a[224:225], v216 offset:24576
buffer_load_dwordx4 a[128:131], v237, s[96:99], s34 offen offset:0 sc1
s_waitcnt vmcnt(23)
v_mfma_f32_32x32x16_bf16 v[144:159], a[192:195], a[36:39], v[144:159]
ds_read_b64_tr_b16 a[226:227], v216 offset:25600
v_mfma_f32_32x32x16_bf16 v[96:111], a[196:199], a[32:35], v[96:111]
ds_read_b64_tr_b16 a[228:229], v217 offset:24576
v_mfma_f32_32x32x16_bf16 v[160:175], a[196:199], a[36:39], v[160:175]
ds_read_b64_tr_b16 a[230:231], v217 offset:25600
s_waitcnt lgkmcnt(5)
v_mfma_f32_32x32x16_bf16 v[112:127], a[200:203], a[32:35], v[112:127]
ds_read_b64_tr_b16 a[232:233], v218 offset:24576
buffer_load_dwordx4 a[132:135], v238, s[96:99], s34 offen offset:0 sc1
v_mfma_f32_32x32x16_bf16 v[176:191], a[200:203], a[36:39], v[176:191]
ds_read_b64_tr_b16 a[234:235], v218 offset:25600
v_mfma_f32_32x32x16_bf16 v[128:143], a[204:207], a[32:35], v[128:143]
ds_read_b64_tr_b16 a[236:237], v219 offset:24576
v_mfma_f32_32x32x16_bf16 v[192:207], a[204:207], a[36:39], v[192:207]
ds_read_b64_tr_b16 a[238:239], v219 offset:25600
s_waitcnt vmcnt(23)
v_mfma_f32_32x32x16_bf16 v[80:95], a[208:211], a[40:43], v[80:95]
ds_read_b64_tr_b16 a[240:241], v216 offset:28672
buffer_load_dwordx4 a[136:139], v237, s[96:99], s34 offen offset:1024 sc1
s_waitcnt vmcnt(23)
v_mfma_f32_32x32x16_bf16 v[144:159], a[208:211], a[44:47], v[144:159]
ds_read_b64_tr_b16 a[242:243], v216 offset:29696
v_mfma_f32_32x32x16_bf16 v[96:111], a[212:215], a[40:43], v[96:111]
ds_read_b64_tr_b16 a[244:245], v217 offset:28672
v_mfma_f32_32x32x16_bf16 v[160:175], a[212:215], a[44:47], v[160:175]
ds_read_b64_tr_b16 a[246:247], v217 offset:29696
v_mfma_f32_32x32x16_bf16 v[112:127], a[216:219], a[40:43], v[112:127]
ds_read_b64_tr_b16 a[248:249], v218 offset:28672
buffer_load_dwordx4 a[140:143], v238, s[96:99], s34 offen offset:1024 sc1
v_mfma_f32_32x32x16_bf16 v[176:191], a[216:219], a[44:47], v[176:191]
ds_read_b64_tr_b16 a[250:251], v218 offset:29696
s_waitcnt lgkmcnt(5)
v_mfma_f32_32x32x16_bf16 v[128:143], a[220:223], a[40:43], v[128:143]
ds_read_b64_tr_b16 a[252:253], v219 offset:28672
v_mfma_f32_32x32x16_bf16 v[192:207], a[220:223], a[44:47], v[192:207]
ds_read_b64_tr_b16 a[254:255], v219 offset:29696
s_waitcnt vmcnt(23)
v_mfma_f32_32x32x16_bf16 v[80:95], a[224:227], a[48:51], v[80:95]
ds_read_b64_tr_b16 a[192:193], v216 offset:32768
buffer_load_dwordx4 a[144:147], v237, s[96:99], s34 offen offset:2048 sc1
s_waitcnt vmcnt(23)
v_mfma_f32_32x32x16_bf16 v[144:159], a[224:227], a[52:55], v[144:159]
ds_read_b64_tr_b16 a[194:195], v216 offset:33792
v_mfma_f32_32x32x16_bf16 v[96:111], a[228:231], a[48:51], v[96:111]
ds_read_b64_tr_b16 a[196:197], v217 offset:32768
v_mfma_f32_32x32x16_bf16 v[160:175], a[228:231], a[52:55], v[160:175]
ds_read_b64_tr_b16 a[198:199], v217 offset:33792
v_mfma_f32_32x32x16_bf16 v[112:127], a[232:235], a[48:51], v[112:127]
ds_read_b64_tr_b16 a[200:201], v218 offset:32768
buffer_load_dwordx4 a[148:151], v238, s[96:99], s34 offen offset:2048 sc1
v_mfma_f32_32x32x16_bf16 v[176:191], a[232:235], a[52:55], v[176:191]
ds_read_b64_tr_b16 a[202:203], v218 offset:33792
v_mfma_f32_32x32x16_bf16 v[128:143], a[236:239], a[48:51], v[128:143]
ds_read_b64_tr_b16 a[204:205], v219 offset:32768
v_mfma_f32_32x32x16_bf16 v[192:207], a[236:239], a[52:55], v[192:207]
ds_read_b64_tr_b16 a[206:207], v219 offset:33792
s_waitcnt vmcnt(23) lgkmcnt(5)
v_mfma_f32_32x32x16_bf16 v[80:95], a[240:243], a[56:59], v[80:95]
ds_read_b64_tr_b16 a[208:209], v216 offset:36864
buffer_load_dwordx4 a[152:155], v237, s[96:99], s34 offen offset:3072 sc1
s_waitcnt vmcnt(23)
v_mfma_f32_32x32x16_bf16 v[144:159], a[240:243], a[60:63], v[144:159]
ds_read_b64_tr_b16 a[210:211], v216 offset:37888
v_mfma_f32_32x32x16_bf16 v[96:111], a[244:247], a[56:59], v[96:111]
ds_read_b64_tr_b16 a[212:213], v217 offset:36864
v_mfma_f32_32x32x16_bf16 v[160:175], a[244:247], a[60:63], v[160:175]
ds_read_b64_tr_b16 a[214:215], v217 offset:37888
v_mfma_f32_32x32x16_bf16 v[112:127], a[248:251], a[56:59], v[112:127]
ds_read_b64_tr_b16 a[216:217], v218 offset:36864
buffer_load_dwordx4 a[156:159], v238, s[96:99], s34 offen offset:3072 sc1
v_mfma_f32_32x32x16_bf16 v[176:191], a[248:251], a[60:63], v[176:191]
ds_read_b64_tr_b16 a[218:219], v218 offset:37888
s_mov_b32 s34, 1069056
v_mfma_f32_32x32x16_bf16 v[128:143], a[252:255], a[56:59], v[128:143]
ds_read_b64_tr_b16 a[220:221], v219 offset:36864
v_mfma_f32_32x32x16_bf16 v[192:207], a[252:255], a[60:63], v[192:207]
ds_read_b64_tr_b16 a[222:223], v219 offset:37888
s_waitcnt vmcnt(23)
v_mfma_f32_32x32x16_bf16 v[80:95], a[192:195], a[64:67], v[80:95]
ds_read_b64_tr_b16 a[224:225], v216 offset:40960
buffer_load_dwordx4 a[160:163], v237, s[96:99], s34 offen offset:0 sc1
s_waitcnt vmcnt(23)
v_mfma_f32_32x32x16_bf16 v[144:159], a[192:195], a[68:71], v[144:159]
ds_read_b64_tr_b16 a[226:227], v216 offset:41984
s_waitcnt lgkmcnt(5)
v_mfma_f32_32x32x16_bf16 v[96:111], a[196:199], a[64:67], v[96:111]
ds_read_b64_tr_b16 a[228:229], v217 offset:40960
v_mfma_f32_32x32x16_bf16 v[160:175], a[196:199], a[68:71], v[160:175]
ds_read_b64_tr_b16 a[230:231], v217 offset:41984
v_mfma_f32_32x32x16_bf16 v[112:127], a[200:203], a[64:67], v[112:127]
ds_read_b64_tr_b16 a[232:233], v218 offset:40960
buffer_load_dwordx4 a[164:167], v238, s[96:99], s34 offen offset:0 sc1
v_mfma_f32_32x32x16_bf16 v[176:191], a[200:203], a[68:71], v[176:191]
ds_read_b64_tr_b16 a[234:235], v218 offset:41984
v_mfma_f32_32x32x16_bf16 v[128:143], a[204:207], a[64:67], v[128:143]
ds_read_b64_tr_b16 a[236:237], v219 offset:40960
v_mfma_f32_32x32x16_bf16 v[192:207], a[204:207], a[68:71], v[192:207]
ds_read_b64_tr_b16 a[238:239], v219 offset:41984
s_waitcnt vmcnt(23)
v_mfma_f32_32x32x16_bf16 v[80:95], a[208:211], a[72:75], v[80:95]
ds_read_b64_tr_b16 a[240:241], v216 offset:45056
buffer_load_dwordx4 a[168:171], v237, s[96:99], s34 offen offset:1024 sc1
s_waitcnt vmcnt(23)
v_mfma_f32_32x32x16_bf16 v[144:159], a[208:211], a[76:79], v[144:159]
ds_read_b64_tr_b16 a[242:243], v216 offset:46080
v_mfma_f32_32x32x16_bf16 v[96:111], a[212:215], a[72:75], v[96:111]
ds_read_b64_tr_b16 a[244:245], v217 offset:45056
v_mfma_f32_32x32x16_bf16 v[160:175], a[212:215], a[76:79], v[160:175]
ds_read_b64_tr_b16 a[246:247], v217 offset:46080
s_waitcnt lgkmcnt(5)
v_mfma_f32_32x32x16_bf16 v[112:127], a[216:219], a[72:75], v[112:127]
ds_read_b64_tr_b16 a[248:249], v218 offset:45056
buffer_load_dwordx4 a[172:175], v238, s[96:99], s34 offen offset:1024 sc1
v_mfma_f32_32x32x16_bf16 v[176:191], a[216:219], a[76:79], v[176:191]
ds_read_b64_tr_b16 a[250:251], v218 offset:46080
v_mfma_f32_32x32x16_bf16 v[128:143], a[220:223], a[72:75], v[128:143]
ds_read_b64_tr_b16 a[252:253], v219 offset:45056
v_mfma_f32_32x32x16_bf16 v[192:207], a[220:223], a[76:79], v[192:207]
ds_read_b64_tr_b16 a[254:255], v219 offset:46080
s_barrier
s_waitcnt vmcnt(23)
v_mfma_f32_32x32x16_bf16 v[80:95], a[224:227], a[80:83], v[80:95]
ds_read_b64_tr_b16 a[192:193], v216 offset:49152
buffer_load_dwordx4 a[176:179], v237, s[96:99], s34 offen offset:2048 sc1
s_waitcnt vmcnt(23)
v_mfma_f32_32x32x16_bf16 v[144:159], a[224:227], a[84:87], v[144:159]
ds_read_b64_tr_b16 a[194:195], v216 offset:50176
v_mfma_f32_32x32x16_bf16 v[96:111], a[228:231], a[80:83], v[96:111]
ds_read_b64_tr_b16 a[196:197], v217 offset:49152
v_mfma_f32_32x32x16_bf16 v[160:175], a[228:231], a[84:87], v[160:175]
ds_read_b64_tr_b16 a[198:199], v217 offset:50176
v_mfma_f32_32x32x16_bf16 v[112:127], a[232:235], a[80:83], v[112:127]
ds_read_b64_tr_b16 a[200:201], v218 offset:49152
buffer_load_dwordx4 a[180:183], v238, s[96:99], s34 offen offset:2048 sc1
v_mfma_f32_32x32x16_bf16 v[176:191], a[232:235], a[84:87], v[176:191]
ds_read_b64_tr_b16 a[202:203], v218 offset:50176
s_waitcnt lgkmcnt(5)
v_mfma_f32_32x32x16_bf16 v[128:143], a[236:239], a[80:83], v[128:143]
ds_read_b64_tr_b16 a[204:205], v219 offset:49152
v_mfma_f32_32x32x16_bf16 v[192:207], a[236:239], a[84:87], v[192:207]
ds_read_b64_tr_b16 a[206:207], v219 offset:50176
s_waitcnt vmcnt(23)
v_mfma_f32_32x32x16_bf16 v[80:95], a[240:243], a[88:91], v[80:95]
ds_read_b64_tr_b16 a[208:209], v216 offset:53248
buffer_load_dwordx4 a[184:187], v237, s[96:99], s34 offen offset:3072 sc1
s_waitcnt vmcnt(23)
v_mfma_f32_32x32x16_bf16 v[144:159], a[240:243], a[92:95], v[144:159]
ds_read_b64_tr_b16 a[210:211], v216 offset:54272
v_mfma_f32_32x32x16_bf16 v[96:111], a[244:247], a[88:91], v[96:111]
ds_read_b64_tr_b16 a[212:213], v217 offset:53248
v_mfma_f32_32x32x16_bf16 v[160:175], a[244:247], a[92:95], v[160:175]
ds_read_b64_tr_b16 a[214:215], v217 offset:54272
v_mfma_f32_32x32x16_bf16 v[112:127], a[248:251], a[88:91], v[112:127]
ds_read_b64_tr_b16 a[216:217], v218 offset:53248
buffer_load_dwordx4 a[188:191], v238, s[96:99], s34 offen offset:3072 sc1
v_mfma_f32_32x32x16_bf16 v[176:191], a[248:251], a[92:95], v[176:191]
ds_read_b64_tr_b16 a[218:219], v218 offset:54272
s_mov_b32 s34, 1073152
v_mfma_f32_32x32x16_bf16 v[128:143], a[252:255], a[88:91], v[128:143]
ds_read_b64_tr_b16 a[220:221], v219 offset:53248
v_mfma_f32_32x32x16_bf16 v[192:207], a[252:255], a[92:95], v[192:207]
ds_read_b64_tr_b16 a[222:223], v219 offset:54272
s_waitcnt vmcnt(23) lgkmcnt(5)
v_mfma_f32_32x32x16_bf16 v[80:95], a[192:195], a[96:99], v[80:95]
ds_read_b64_tr_b16 a[224:225], v216 offset:57344
buffer_load_dwordx4 a[0:3], v237, s[96:99], s34 offen offset:0 sc1
s_waitcnt vmcnt(23)
v_mfma_f32_32x32x16_bf16 v[144:159], a[192:195], a[100:103], v[144:159]
ds_read_b64_tr_b16 a[226:227], v216 offset:58368
v_mfma_f32_32x32x16_bf16 v[96:111], a[196:199], a[96:99], v[96:111]
ds_read_b64_tr_b16 a[228:229], v217 offset:57344
v_mfma_f32_32x32x16_bf16 v[160:175], a[196:199], a[100:103], v[160:175]
ds_read_b64_tr_b16 a[230:231], v217 offset:58368
v_mfma_f32_32x32x16_bf16 v[112:127], a[200:203], a[96:99], v[112:127]
ds_read_b64_tr_b16 a[232:233], v218 offset:57344
buffer_load_dwordx4 a[4:7], v238, s[96:99], s34 offen offset:0 sc1
v_mfma_f32_32x32x16_bf16 v[176:191], a[200:203], a[100:103], v[176:191]
ds_read_b64_tr_b16 a[234:235], v218 offset:58368
v_mfma_f32_32x32x16_bf16 v[128:143], a[204:207], a[96:99], v[128:143]
ds_read_b64_tr_b16 a[236:237], v219 offset:57344
v_mfma_f32_32x32x16_bf16 v[192:207], a[204:207], a[100:103], v[192:207]
ds_read_b64_tr_b16 a[238:239], v219 offset:58368
s_waitcnt vmcnt(23)
v_mfma_f32_32x32x16_bf16 v[80:95], a[208:211], a[104:107], v[80:95]
ds_read_b64_tr_b16 a[240:241], v216 offset:61440
buffer_load_dwordx4 a[8:11], v237, s[96:99], s34 offen offset:1024 sc1
s_waitcnt vmcnt(23)
v_mfma_f32_32x32x16_bf16 v[144:159], a[208:211], a[108:111], v[144:159]
ds_read_b64_tr_b16 a[242:243], v216 offset:62464
s_waitcnt lgkmcnt(5)
v_mfma_f32_32x32x16_bf16 v[96:111], a[212:215], a[104:107], v[96:111]
ds_read_b64_tr_b16 a[244:245], v217 offset:61440
v_mfma_f32_32x32x16_bf16 v[160:175], a[212:215], a[108:111], v[160:175]
ds_read_b64_tr_b16 a[246:247], v217 offset:62464
v_mfma_f32_32x32x16_bf16 v[112:127], a[216:219], a[104:107], v[112:127]
ds_read_b64_tr_b16 a[248:249], v218 offset:61440
buffer_load_dwordx4 a[12:15], v238, s[96:99], s34 offen offset:1024 sc1
v_mfma_f32_32x32x16_bf16 v[176:191], a[216:219], a[108:111], v[176:191]
ds_read_b64_tr_b16 a[250:251], v218 offset:62464
v_mfma_f32_32x32x16_bf16 v[128:143], a[220:223], a[104:107], v[128:143]
ds_read_b64_tr_b16 a[252:253], v219 offset:61440
v_mfma_f32_32x32x16_bf16 v[192:207], a[220:223], a[108:111], v[192:207]
ds_read_b64_tr_b16 a[254:255], v219 offset:62464
s_waitcnt vmcnt(23)
v_mfma_f32_32x32x16_bf16 v[80:95], a[224:227], a[112:115], v[80:95]
ds_read_b64_tr_b16 a[192:193], v220 offset:0
buffer_load_dwordx4 a[16:19], v237, s[96:99], s34 offen offset:2048 sc1
s_waitcnt vmcnt(23)
v_mfma_f32_32x32x16_bf16 v[144:159], a[224:227], a[116:119], v[144:159]
ds_read_b64_tr_b16 a[194:195], v220 offset:1024
v_mfma_f32_32x32x16_bf16 v[96:111], a[228:231], a[112:115], v[96:111]
ds_read_b64_tr_b16 a[196:197], v221 offset:0
v_mfma_f32_32x32x16_bf16 v[160:175], a[228:231], a[116:119], v[160:175]
ds_read_b64_tr_b16 a[198:199], v221 offset:1024
s_waitcnt lgkmcnt(5)
v_mfma_f32_32x32x16_bf16 v[112:127], a[232:235], a[112:115], v[112:127]
ds_read_b64_tr_b16 a[200:201], v222 offset:0
buffer_load_dwordx4 a[20:23], v238, s[96:99], s34 offen offset:2048 sc1
v_mfma_f32_32x32x16_bf16 v[176:191], a[232:235], a[116:119], v[176:191]
ds_read_b64_tr_b16 a[202:203], v222 offset:1024
v_mfma_f32_32x32x16_bf16 v[128:143], a[236:239], a[112:115], v[128:143]
ds_read_b64_tr_b16 a[204:205], v223 offset:0
v_mfma_f32_32x32x16_bf16 v[192:207], a[236:239], a[116:119], v[192:207]
ds_read_b64_tr_b16 a[206:207], v223 offset:1024
s_waitcnt vmcnt(23)
v_mfma_f32_32x32x16_bf16 v[80:95], a[240:243], a[120:123], v[80:95]
ds_read_b64_tr_b16 a[208:209], v220 offset:4096
buffer_load_dwordx4 a[24:27], v237, s[96:99], s34 offen offset:3072 sc1
s_waitcnt vmcnt(23)
v_mfma_f32_32x32x16_bf16 v[144:159], a[240:243], a[124:127], v[144:159]
ds_read_b64_tr_b16 a[210:211], v220 offset:5120
v_mfma_f32_32x32x16_bf16 v[96:111], a[244:247], a[120:123], v[96:111]
ds_read_b64_tr_b16 a[212:213], v221 offset:4096
v_mfma_f32_32x32x16_bf16 v[160:175], a[244:247], a[124:127], v[160:175]
ds_read_b64_tr_b16 a[214:215], v221 offset:5120
v_mfma_f32_32x32x16_bf16 v[112:127], a[248:251], a[120:123], v[112:127]
ds_read_b64_tr_b16 a[216:217], v222 offset:4096
buffer_load_dwordx4 a[28:31], v238, s[96:99], s34 offen offset:3072 sc1
v_mfma_f32_32x32x16_bf16 v[176:191], a[248:251], a[124:127], v[176:191]
ds_read_b64_tr_b16 a[218:219], v222 offset:5120
s_add_u32 m0, s29, 0
s_add_u32 s31, s32, 0
buffer_load_dwordx4 v228, s[12:15], s31 offen offset:0 lds
s_waitcnt lgkmcnt(5)
v_mfma_f32_32x32x16_bf16 v[128:143], a[252:255], a[120:123], v[128:143]
ds_read_b64_tr_b16 a[220:221], v223 offset:4096
buffer_load_dwordx4 v229, s[12:15], s31 offen offset:1024 lds
v_mfma_f32_32x32x16_bf16 v[192:207], a[252:255], a[124:127], v[192:207]
ds_read_b64_tr_b16 a[222:223], v223 offset:5120
buffer_load_dwordx4 v230, s[12:15], s31 offen offset:2048 lds
s_waitcnt vmcnt(26)
v_mfma_f32_32x32x16_bf16 v[80:95], a[192:195], a[128:131], v[80:95]
ds_read_b64_tr_b16 a[224:225], v220 offset:8192
buffer_load_dwordx4 v231, s[12:15], s31 offen offset:3072 lds
s_waitcnt vmcnt(26)
v_mfma_f32_32x32x16_bf16 v[144:159], a[192:195], a[132:135], v[144:159]
ds_read_b64_tr_b16 a[226:227], v220 offset:9216
s_mov_b32 s34, 1077248
buffer_load_dwordx4 a[32:35], v237, s[96:99], s34 offen offset:0 sc1
v_mfma_f32_32x32x16_bf16 v[96:111], a[196:199], a[128:131], v[96:111]
ds_read_b64_tr_b16 a[228:229], v221 offset:8192
v_mfma_f32_32x32x16_bf16 v[160:175], a[196:199], a[132:135], v[160:175]
ds_read_b64_tr_b16 a[230:231], v221 offset:9216
v_mfma_f32_32x32x16_bf16 v[112:127], a[200:203], a[128:131], v[112:127]
ds_read_b64_tr_b16 a[232:233], v222 offset:8192
buffer_load_dwordx4 a[36:39], v238, s[96:99], s34 offen offset:0 sc1
v_mfma_f32_32x32x16_bf16 v[176:191], a[200:203], a[132:135], v[176:191]
ds_read_b64_tr_b16 a[234:235], v222 offset:9216
v_mfma_f32_32x32x16_bf16 v[128:143], a[204:207], a[128:131], v[128:143]
ds_read_b64_tr_b16 a[236:237], v223 offset:8192
v_mfma_f32_32x32x16_bf16 v[192:207], a[204:207], a[132:135], v[192:207]
ds_read_b64_tr_b16 a[238:239], v223 offset:9216
s_waitcnt vmcnt(27) lgkmcnt(5)
v_mfma_f32_32x32x16_bf16 v[80:95], a[208:211], a[136:139], v[80:95]
ds_read_b64_tr_b16 a[240:241], v220 offset:12288
buffer_load_dwordx4 a[40:43], v237, s[96:99], s34 offen offset:1024 sc1
s_waitcnt vmcnt(27)
v_mfma_f32_32x32x16_bf16 v[144:159], a[208:211], a[140:143], v[144:159]
ds_read_b64_tr_b16 a[242:243], v220 offset:13312
v_mfma_f32_32x32x16_bf16 v[96:111], a[212:215], a[136:139], v[96:111]
ds_read_b64_tr_b16 a[244:245], v221 offset:12288
v_mfma_f32_32x32x16_bf16 v[160:175], a[212:215], a[140:143], v[160:175]
ds_read_b64_tr_b16 a[246:247], v221 offset:13312
v_mfma_f32_32x32x16_bf16 v[112:127], a[216:219], a[136:139], v[112:127]
ds_read_b64_tr_b16 a[248:249], v222 offset:12288
buffer_load_dwordx4 a[44:47], v238, s[96:99], s34 offen offset:1024 sc1
v_mfma_f32_32x32x16_bf16 v[176:191], a[216:219], a[140:143], v[176:191]
ds_read_b64_tr_b16 a[250:251], v222 offset:13312
v_mfma_f32_32x32x16_bf16 v[128:143], a[220:223], a[136:139], v[128:143]
ds_read_b64_tr_b16 a[252:253], v223 offset:12288
v_mfma_f32_32x32x16_bf16 v[192:207], a[220:223], a[140:143], v[192:207]
ds_read_b64_tr_b16 a[254:255], v223 offset:13312
s_barrier
s_waitcnt vmcnt(27)
v_mfma_f32_32x32x16_bf16 v[80:95], a[224:227], a[144:147], v[80:95]
ds_read_b64_tr_b16 a[192:193], v220 offset:16384
buffer_load_dwordx4 a[48:51], v237, s[96:99], s34 offen offset:2048 sc1
s_waitcnt vmcnt(27)
v_mfma_f32_32x32x16_bf16 v[144:159], a[224:227], a[148:151], v[144:159]
ds_read_b64_tr_b16 a[194:195], v220 offset:17408
s_waitcnt lgkmcnt(5)
v_mfma_f32_32x32x16_bf16 v[96:111], a[228:231], a[144:147], v[96:111]
ds_read_b64_tr_b16 a[196:197], v221 offset:16384
v_mfma_f32_32x32x16_bf16 v[160:175], a[228:231], a[148:151], v[160:175]
ds_read_b64_tr_b16 a[198:199], v221 offset:17408
v_mfma_f32_32x32x16_bf16 v[112:127], a[232:235], a[144:147], v[112:127]
ds_read_b64_tr_b16 a[200:201], v222 offset:16384
buffer_load_dwordx4 a[52:55], v238, s[96:99], s34 offen offset:2048 sc1
v_mfma_f32_32x32x16_bf16 v[176:191], a[232:235], a[148:151], v[176:191]
ds_read_b64_tr_b16 a[202:203], v222 offset:17408
v_mfma_f32_32x32x16_bf16 v[128:143], a[236:239], a[144:147], v[128:143]
ds_read_b64_tr_b16 a[204:205], v223 offset:16384
v_mfma_f32_32x32x16_bf16 v[192:207], a[236:239], a[148:151], v[192:207]
ds_read_b64_tr_b16 a[206:207], v223 offset:17408
s_waitcnt vmcnt(27)
v_mfma_f32_32x32x16_bf16 v[80:95], a[240:243], a[152:155], v[80:95]
ds_read_b64_tr_b16 a[208:209], v220 offset:20480
buffer_load_dwordx4 a[56:59], v237, s[96:99], s34 offen offset:3072 sc1
s_waitcnt vmcnt(27)
v_mfma_f32_32x32x16_bf16 v[144:159], a[240:243], a[156:159], v[144:159]
ds_read_b64_tr_b16 a[210:211], v220 offset:21504
v_mfma_f32_32x32x16_bf16 v[96:111], a[244:247], a[152:155], v[96:111]
ds_read_b64_tr_b16 a[212:213], v221 offset:20480
v_mfma_f32_32x32x16_bf16 v[160:175], a[244:247], a[156:159], v[160:175]
ds_read_b64_tr_b16 a[214:215], v221 offset:21504
s_waitcnt lgkmcnt(5)
v_mfma_f32_32x32x16_bf16 v[112:127], a[248:251], a[152:155], v[112:127]
ds_read_b64_tr_b16 a[216:217], v222 offset:20480
buffer_load_dwordx4 a[60:63], v238, s[96:99], s34 offen offset:3072 sc1
v_mfma_f32_32x32x16_bf16 v[176:191], a[248:251], a[156:159], v[176:191]
ds_read_b64_tr_b16 a[218:219], v222 offset:21504
s_add_u32 m0, s29, 16384
s_add_u32 s31, s32, 16384
buffer_load_dwordx4 v228, s[12:15], s31 offen offset:0 lds
v_mfma_f32_32x32x16_bf16 v[128:143], a[252:255], a[152:155], v[128:143]
ds_read_b64_tr_b16 a[220:221], v223 offset:20480
buffer_load_dwordx4 v229, s[12:15], s31 offen offset:1024 lds
v_mfma_f32_32x32x16_bf16 v[192:207], a[252:255], a[156:159], v[192:207]
ds_read_b64_tr_b16 a[222:223], v223 offset:21504
buffer_load_dwordx4 v230, s[12:15], s31 offen offset:2048 lds
s_waitcnt vmcnt(30)
v_mfma_f32_32x32x16_bf16 v[80:95], a[192:195], a[160:163], v[80:95]
ds_read_b64_tr_b16 a[224:225], v220 offset:24576
buffer_load_dwordx4 v231, s[12:15], s31 offen offset:3072 lds
s_waitcnt vmcnt(30)
v_mfma_f32_32x32x16_bf16 v[144:159], a[192:195], a[164:167], v[144:159]
ds_read_b64_tr_b16 a[226:227], v220 offset:25600
s_mov_b32 s34, 1081344
buffer_load_dwordx4 a[64:67], v237, s[96:99], s34 offen offset:0 sc1
v_mfma_f32_32x32x16_bf16 v[96:111], a[196:199], a[160:163], v[96:111]
ds_read_b64_tr_b16 a[228:229], v221 offset:24576
v_mfma_f32_32x32x16_bf16 v[160:175], a[196:199], a[164:167], v[160:175]
ds_read_b64_tr_b16 a[230:231], v221 offset:25600
v_mfma_f32_32x32x16_bf16 v[112:127], a[200:203], a[160:163], v[112:127]
ds_read_b64_tr_b16 a[232:233], v222 offset:24576
buffer_load_dwordx4 a[68:71], v238, s[96:99], s34 offen offset:0 sc1
v_mfma_f32_32x32x16_bf16 v[176:191], a[200:203], a[164:167], v[176:191]
ds_read_b64_tr_b16 a[234:235], v222 offset:25600
s_waitcnt lgkmcnt(5)
v_mfma_f32_32x32x16_bf16 v[128:143], a[204:207], a[160:163], v[128:143]
ds_read_b64_tr_b16 a[236:237], v223 offset:24576
v_mfma_f32_32x32x16_bf16 v[192:207], a[204:207], a[164:167], v[192:207]
ds_read_b64_tr_b16 a[238:239], v223 offset:25600
s_waitcnt vmcnt(31)
v_mfma_f32_32x32x16_bf16 v[80:95], a[208:211], a[168:171], v[80:95]
ds_read_b64_tr_b16 a[240:241], v220 offset:28672
buffer_load_dwordx4 a[72:75], v237, s[96:99], s34 offen offset:1024 sc1
s_waitcnt vmcnt(31)
v_mfma_f32_32x32x16_bf16 v[144:159], a[208:211], a[172:175], v[144:159]
ds_read_b64_tr_b16 a[242:243], v220 offset:29696
v_mfma_f32_32x32x16_bf16 v[96:111], a[212:215], a[168:171], v[96:111]
ds_read_b64_tr_b16 a[244:245], v221 offset:28672
v_mfma_f32_32x32x16_bf16 v[160:175], a[212:215], a[172:175], v[160:175]
ds_read_b64_tr_b16 a[246:247], v221 offset:29696
v_mfma_f32_32x32x16_bf16 v[112:127], a[216:219], a[168:171], v[112:127]
ds_read_b64_tr_b16 a[248:249], v222 offset:28672
buffer_load_dwordx4 a[76:79], v238, s[96:99], s34 offen offset:1024 sc1
v_mfma_f32_32x32x16_bf16 v[176:191], a[216:219], a[172:175], v[176:191]
ds_read_b64_tr_b16 a[250:251], v222 offset:29696
v_mfma_f32_32x32x16_bf16 v[128:143], a[220:223], a[168:171], v[128:143]
ds_read_b64_tr_b16 a[252:253], v223 offset:28672
v_mfma_f32_32x32x16_bf16 v[192:207], a[220:223], a[172:175], v[192:207]
ds_read_b64_tr_b16 a[254:255], v223 offset:29696
s_waitcnt vmcnt(31) lgkmcnt(5)
v_mfma_f32_32x32x16_bf16 v[80:95], a[224:227], a[176:179], v[80:95]
ds_read_b64_tr_b16 a[192:193], v220 offset:32768
buffer_load_dwordx4 a[80:83], v237, s[96:99], s34 offen offset:2048 sc1
s_waitcnt vmcnt(31)
v_mfma_f32_32x32x16_bf16 v[144:159], a[224:227], a[180:183], v[144:159]
ds_read_b64_tr_b16 a[194:195], v220 offset:33792
v_mfma_f32_32x32x16_bf16 v[96:111], a[228:231], a[176:179], v[96:111]
ds_read_b64_tr_b16 a[196:197], v221 offset:32768
v_mfma_f32_32x32x16_bf16 v[160:175], a[228:231], a[180:183], v[160:175]
ds_read_b64_tr_b16 a[198:199], v221 offset:33792
v_mfma_f32_32x32x16_bf16 v[112:127], a[232:235], a[176:179], v[112:127]
ds_read_b64_tr_b16 a[200:201], v222 offset:32768
buffer_load_dwordx4 a[84:87], v238, s[96:99], s34 offen offset:2048 sc1
v_mfma_f32_32x32x16_bf16 v[176:191], a[232:235], a[180:183], v[176:191]
ds_read_b64_tr_b16 a[202:203], v222 offset:33792
v_mfma_f32_32x32x16_bf16 v[128:143], a[236:239], a[176:179], v[128:143]
ds_read_b64_tr_b16 a[204:205], v223 offset:32768
v_mfma_f32_32x32x16_bf16 v[192:207], a[236:239], a[180:183], v[192:207]
ds_read_b64_tr_b16 a[206:207], v223 offset:33792
s_waitcnt vmcnt(31)
v_mfma_f32_32x32x16_bf16 v[80:95], a[240:243], a[184:187], v[80:95]
ds_read_b64_tr_b16 a[208:209], v220 offset:36864
buffer_load_dwordx4 a[88:91], v237, s[96:99], s34 offen offset:3072 sc1
s_waitcnt vmcnt(31)
v_mfma_f32_32x32x16_bf16 v[144:159], a[240:243], a[188:191], v[144:159]
ds_read_b64_tr_b16 a[210:211], v220 offset:37888
s_waitcnt lgkmcnt(5)
v_mfma_f32_32x32x16_bf16 v[96:111], a[244:247], a[184:187], v[96:111]
ds_read_b64_tr_b16 a[212:213], v221 offset:36864
v_mfma_f32_32x32x16_bf16 v[160:175], a[244:247], a[188:191], v[160:175]
ds_read_b64_tr_b16 a[214:215], v221 offset:37888
v_mfma_f32_32x32x16_bf16 v[112:127], a[248:251], a[184:187], v[112:127]
ds_read_b64_tr_b16 a[216:217], v222 offset:36864
buffer_load_dwordx4 a[92:95], v238, s[96:99], s34 offen offset:3072 sc1
v_mfma_f32_32x32x16_bf16 v[176:191], a[248:251], a[188:191], v[176:191]
ds_read_b64_tr_b16 a[218:219], v222 offset:37888
s_add_u32 m0, s29, 32768
s_add_u32 s31, s32, 32768
buffer_load_dwordx4 v228, s[12:15], s31 offen offset:0 lds
v_mfma_f32_32x32x16_bf16 v[128:143], a[252:255], a[184:187], v[128:143]
ds_read_b64_tr_b16 a[220:221], v223 offset:36864
buffer_load_dwordx4 v229, s[12:15], s31 offen offset:1024 lds
v_mfma_f32_32x32x16_bf16 v[192:207], a[252:255], a[188:191], v[192:207]
ds_read_b64_tr_b16 a[222:223], v223 offset:37888
buffer_load_dwordx4 v230, s[12:15], s31 offen offset:2048 lds
s_waitcnt vmcnt(34)
v_mfma_f32_32x32x16_bf16 v[80:95], a[192:195], a[0:3], v[80:95]
ds_read_b64_tr_b16 a[224:225], v220 offset:40960
buffer_load_dwordx4 v231, s[12:15], s31 offen offset:3072 lds
s_waitcnt vmcnt(34)
v_mfma_f32_32x32x16_bf16 v[144:159], a[192:195], a[4:7], v[144:159]
ds_read_b64_tr_b16 a[226:227], v220 offset:41984
s_mov_b32 s34, 1085440
buffer_load_dwordx4 a[96:99], v237, s[96:99], s34 offen offset:0 sc1
v_mfma_f32_32x32x16_bf16 v[96:111], a[196:199], a[0:3], v[96:111]
ds_read_b64_tr_b16 a[228:229], v221 offset:40960
v_mfma_f32_32x32x16_bf16 v[160:175], a[196:199], a[4:7], v[160:175]
ds_read_b64_tr_b16 a[230:231], v221 offset:41984
s_waitcnt lgkmcnt(5)
v_mfma_f32_32x32x16_bf16 v[112:127], a[200:203], a[0:3], v[112:127]
ds_read_b64_tr_b16 a[232:233], v222 offset:40960
buffer_load_dwordx4 a[100:103], v238, s[96:99], s34 offen offset:0 sc1
v_mfma_f32_32x32x16_bf16 v[176:191], a[200:203], a[4:7], v[176:191]
ds_read_b64_tr_b16 a[234:235], v222 offset:41984
v_mfma_f32_32x32x16_bf16 v[128:143], a[204:207], a[0:3], v[128:143]
ds_read_b64_tr_b16 a[236:237], v223 offset:40960
v_mfma_f32_32x32x16_bf16 v[192:207], a[204:207], a[4:7], v[192:207]
ds_read_b64_tr_b16 a[238:239], v223 offset:41984
s_waitcnt vmcnt(35)
v_mfma_f32_32x32x16_bf16 v[80:95], a[208:211], a[8:11], v[80:95]
ds_read_b64_tr_b16 a[240:241], v220 offset:45056
buffer_load_dwordx4 a[104:107], v237, s[96:99], s34 offen offset:1024 sc1
s_waitcnt vmcnt(35)
v_mfma_f32_32x32x16_bf16 v[144:159], a[208:211], a[12:15], v[144:159]
ds_read_b64_tr_b16 a[242:243], v220 offset:46080
v_mfma_f32_32x32x16_bf16 v[96:111], a[212:215], a[8:11], v[96:111]
ds_read_b64_tr_b16 a[244:245], v221 offset:45056
v_mfma_f32_32x32x16_bf16 v[160:175], a[212:215], a[12:15], v[160:175]
ds_read_b64_tr_b16 a[246:247], v221 offset:46080
v_mfma_f32_32x32x16_bf16 v[112:127], a[216:219], a[8:11], v[112:127]
ds_read_b64_tr_b16 a[248:249], v222 offset:45056
buffer_load_dwordx4 a[108:111], v238, s[96:99], s34 offen offset:1024 sc1
v_mfma_f32_32x32x16_bf16 v[176:191], a[216:219], a[12:15], v[176:191]
ds_read_b64_tr_b16 a[250:251], v222 offset:46080
s_waitcnt lgkmcnt(5)
v_mfma_f32_32x32x16_bf16 v[128:143], a[220:223], a[8:11], v[128:143]
ds_read_b64_tr_b16 a[252:253], v223 offset:45056
v_mfma_f32_32x32x16_bf16 v[192:207], a[220:223], a[12:15], v[192:207]
ds_read_b64_tr_b16 a[254:255], v223 offset:46080
s_barrier
s_waitcnt vmcnt(35)
v_mfma_f32_32x32x16_bf16 v[80:95], a[224:227], a[16:19], v[80:95]
ds_read_b64_tr_b16 a[192:193], v220 offset:49152
buffer_load_dwordx4 a[112:115], v237, s[96:99], s34 offen offset:2048 sc1
s_waitcnt vmcnt(35)
v_mfma_f32_32x32x16_bf16 v[144:159], a[224:227], a[20:23], v[144:159]
ds_read_b64_tr_b16 a[194:195], v220 offset:50176
v_mfma_f32_32x32x16_bf16 v[96:111], a[228:231], a[16:19], v[96:111]
ds_read_b64_tr_b16 a[196:197], v221 offset:49152
v_mfma_f32_32x32x16_bf16 v[160:175], a[228:231], a[20:23], v[160:175]
ds_read_b64_tr_b16 a[198:199], v221 offset:50176
v_mfma_f32_32x32x16_bf16 v[112:127], a[232:235], a[16:19], v[112:127]
ds_read_b64_tr_b16 a[200:201], v222 offset:49152
buffer_load_dwordx4 a[116:119], v238, s[96:99], s34 offen offset:2048 sc1
v_mfma_f32_32x32x16_bf16 v[176:191], a[232:235], a[20:23], v[176:191]
ds_read_b64_tr_b16 a[202:203], v222 offset:50176
v_mfma_f32_32x32x16_bf16 v[128:143], a[236:239], a[16:19], v[128:143]
ds_read_b64_tr_b16 a[204:205], v223 offset:49152
v_mfma_f32_32x32x16_bf16 v[192:207], a[236:239], a[20:23], v[192:207]
ds_read_b64_tr_b16 a[206:207], v223 offset:50176
s_waitcnt vmcnt(35) lgkmcnt(5)
v_mfma_f32_32x32x16_bf16 v[80:95], a[240:243], a[24:27], v[80:95]
ds_read_b64_tr_b16 a[208:209], v220 offset:53248
buffer_load_dwordx4 a[120:123], v237, s[96:99], s34 offen offset:3072 sc1
s_waitcnt vmcnt(35)
v_mfma_f32_32x32x16_bf16 v[144:159], a[240:243], a[28:31], v[144:159]
ds_read_b64_tr_b16 a[210:211], v220 offset:54272
v_mfma_f32_32x32x16_bf16 v[96:111], a[244:247], a[24:27], v[96:111]
ds_read_b64_tr_b16 a[212:213], v221 offset:53248
v_mfma_f32_32x32x16_bf16 v[160:175], a[244:247], a[28:31], v[160:175]
ds_read_b64_tr_b16 a[214:215], v221 offset:54272
v_mfma_f32_32x32x16_bf16 v[112:127], a[248:251], a[24:27], v[112:127]
ds_read_b64_tr_b16 a[216:217], v222 offset:53248
buffer_load_dwordx4 a[124:127], v238, s[96:99], s34 offen offset:3072 sc1
v_mfma_f32_32x32x16_bf16 v[176:191], a[248:251], a[28:31], v[176:191]
ds_read_b64_tr_b16 a[218:219], v222 offset:54272
s_add_u32 m0, s29, 49152
s_add_u32 s31, s32, 49152
buffer_load_dwordx4 v228, s[12:15], s31 offen offset:0 lds
v_mfma_f32_32x32x16_bf16 v[128:143], a[252:255], a[24:27], v[128:143]
ds_read_b64_tr_b16 a[220:221], v223 offset:53248
buffer_load_dwordx4 v229, s[12:15], s31 offen offset:1024 lds
v_mfma_f32_32x32x16_bf16 v[192:207], a[252:255], a[28:31], v[192:207]
ds_read_b64_tr_b16 a[222:223], v223 offset:54272
buffer_load_dwordx4 v230, s[12:15], s31 offen offset:2048 lds
s_waitcnt vmcnt(34)
v_mfma_f32_32x32x16_bf16 v[80:95], a[192:195], a[32:35], v[80:95]
ds_read_b64_tr_b16 a[224:225], v220 offset:57344
buffer_load_dwordx4 v231, s[12:15], s31 offen offset:3072 lds
s_waitcnt vmcnt(34)
v_mfma_f32_32x32x16_bf16 v[144:159], a[192:195], a[36:39], v[144:159]
ds_read_b64_tr_b16 a[226:227], v220 offset:58368
s_add_u32 m0, s29, 65536
s_add_u32 s31, s32, 0
buffer_load_dwordx4 v232, s[16:19], s31 offen offset:0 lds
s_waitcnt lgkmcnt(5)
v_mfma_f32_32x32x16_bf16 v[96:111], a[196:199], a[32:35], v[96:111]
ds_read_b64_tr_b16 a[228:229], v221 offset:57344
buffer_load_dwordx4 v232, s[16:19], s31 offen offset:1024 lds
v_mfma_f32_32x32x16_bf16 v[160:175], a[196:199], a[36:39], v[160:175]
ds_read_b64_tr_b16 a[230:231], v221 offset:58368
buffer_load_dwordx4 v232, s[16:19], s31 offen offset:2048 lds
v_mfma_f32_32x32x16_bf16 v[112:127], a[200:203], a[32:35], v[112:127]
ds_read_b64_tr_b16 a[232:233], v222 offset:57344
buffer_load_dwordx4 v232, s[16:19], s31 offen offset:3072 lds
v_mfma_f32_32x32x16_bf16 v[176:191], a[200:203], a[36:39], v[176:191]
ds_read_b64_tr_b16 a[234:235], v222 offset:58368
s_add_u32 m0, s29, 81920
s_add_u32 s31, s32, 16384
buffer_load_dwordx4 v232, s[16:19], s31 offen offset:0 lds
v_mfma_f32_32x32x16_bf16 v[128:143], a[204:207], a[32:35], v[128:143]
ds_read_b64_tr_b16 a[236:237], v223 offset:57344
buffer_load_dwordx4 v232, s[16:19], s31 offen offset:1024 lds
v_mfma_f32_32x32x16_bf16 v[192:207], a[204:207], a[36:39], v[192:207]
ds_read_b64_tr_b16 a[238:239], v223 offset:58368
buffer_load_dwordx4 v232, s[16:19], s31 offen offset:2048 lds
s_waitcnt vmcnt(40)
v_mfma_f32_32x32x16_bf16 v[80:95], a[208:211], a[40:43], v[80:95]
ds_read_b64_tr_b16 a[240:241], v220 offset:61440
buffer_load_dwordx4 v232, s[16:19], s31 offen offset:3072 lds
s_waitcnt vmcnt(40)
v_mfma_f32_32x32x16_bf16 v[144:159], a[208:211], a[44:47], v[144:159]
ds_read_b64_tr_b16 a[242:243], v220 offset:62464
v_mfma_f32_32x32x16_bf16 v[96:111], a[212:215], a[40:43], v[96:111]
ds_read_b64_tr_b16 a[244:245], v221 offset:61440
v_mfma_f32_32x32x16_bf16 v[160:175], a[212:215], a[44:47], v[160:175]
ds_read_b64_tr_b16 a[246:247], v221 offset:62464
s_waitcnt lgkmcnt(5)
v_mfma_f32_32x32x16_bf16 v[112:127], a[216:219], a[40:43], v[112:127]
ds_read_b64_tr_b16 a[248:249], v222 offset:61440
v_mfma_f32_32x32x16_bf16 v[176:191], a[216:219], a[44:47], v[176:191]
ds_read_b64_tr_b16 a[250:251], v222 offset:62464
v_mfma_f32_32x32x16_bf16 v[128:143], a[220:223], a[40:43], v[128:143]
ds_read_b64_tr_b16 a[252:253], v223 offset:61440
v_mfma_f32_32x32x16_bf16 v[192:207], a[220:223], a[44:47], v[192:207]
ds_read_b64_tr_b16 a[254:255], v223 offset:62464
s_waitcnt vmcnt(39)
v_mfma_f32_32x32x16_bf16 v[80:95], a[224:227], a[48:51], v[80:95]
ds_read_b64_tr_b16 a[192:193], v224 offset:0
s_waitcnt vmcnt(38)
v_mfma_f32_32x32x16_bf16 v[144:159], a[224:227], a[52:55], v[144:159]
ds_read_b64_tr_b16 a[194:195], v224 offset:1024
v_mfma_f32_32x32x16_bf16 v[96:111], a[228:231], a[48:51], v[96:111]
ds_read_b64_tr_b16 a[196:197], v225 offset:0
v_mfma_f32_32x32x16_bf16 v[160:175], a[228:231], a[52:55], v[160:175]
ds_read_b64_tr_b16 a[198:199], v225 offset:1024
v_mfma_f32_32x32x16_bf16 v[112:127], a[232:235], a[48:51], v[112:127]
ds_read_b64_tr_b16 a[200:201], v226 offset:0
v_mfma_f32_32x32x16_bf16 v[176:191], a[232:235], a[52:55], v[176:191]
ds_read_b64_tr_b16 a[202:203], v226 offset:1024
s_waitcnt lgkmcnt(5)
v_mfma_f32_32x32x16_bf16 v[128:143], a[236:239], a[48:51], v[128:143]
ds_read_b64_tr_b16 a[204:205], v227 offset:0
v_mfma_f32_32x32x16_bf16 v[192:207], a[236:239], a[52:55], v[192:207]
ds_read_b64_tr_b16 a[206:207], v227 offset:1024
s_waitcnt vmcnt(37)
v_mfma_f32_32x32x16_bf16 v[80:95], a[240:243], a[56:59], v[80:95]
ds_read_b64_tr_b16 a[208:209], v224 offset:4096
s_waitcnt vmcnt(36)
v_mfma_f32_32x32x16_bf16 v[144:159], a[240:243], a[60:63], v[144:159]
ds_read_b64_tr_b16 a[210:211], v224 offset:5120
v_mfma_f32_32x32x16_bf16 v[96:111], a[244:247], a[56:59], v[96:111]
ds_read_b64_tr_b16 a[212:213], v225 offset:4096
v_mfma_f32_32x32x16_bf16 v[160:175], a[244:247], a[60:63], v[160:175]
ds_read_b64_tr_b16 a[214:215], v225 offset:5120
v_mfma_f32_32x32x16_bf16 v[112:127], a[248:251], a[56:59], v[112:127]
ds_read_b64_tr_b16 a[216:217], v226 offset:4096
v_mfma_f32_32x32x16_bf16 v[176:191], a[248:251], a[60:63], v[176:191]
ds_read_b64_tr_b16 a[218:219], v226 offset:5120
v_mfma_f32_32x32x16_bf16 v[128:143], a[252:255], a[56:59], v[128:143]
ds_read_b64_tr_b16 a[220:221], v227 offset:4096
v_mfma_f32_32x32x16_bf16 v[192:207], a[252:255], a[60:63], v[192:207]
ds_read_b64_tr_b16 a[222:223], v227 offset:5120
s_waitcnt vmcnt(31) lgkmcnt(5)
v_mfma_f32_32x32x16_bf16 v[80:95], a[192:195], a[64:67], v[80:95]
ds_read_b64_tr_b16 a[224:225], v224 offset:8192
s_waitcnt vmcnt(30)
v_mfma_f32_32x32x16_bf16 v[144:159], a[192:195], a[68:71], v[144:159]
ds_read_b64_tr_b16 a[226:227], v224 offset:9216
v_mfma_f32_32x32x16_bf16 v[96:111], a[196:199], a[64:67], v[96:111]
ds_read_b64_tr_b16 a[228:229], v225 offset:8192
v_mfma_f32_32x32x16_bf16 v[160:175], a[196:199], a[68:71], v[160:175]
ds_read_b64_tr_b16 a[230:231], v225 offset:9216
v_mfma_f32_32x32x16_bf16 v[112:127], a[200:203], a[64:67], v[112:127]
ds_read_b64_tr_b16 a[232:233], v226 offset:8192
v_mfma_f32_32x32x16_bf16 v[176:191], a[200:203], a[68:71], v[176:191]
ds_read_b64_tr_b16 a[234:235], v226 offset:9216
v_mfma_f32_32x32x16_bf16 v[128:143], a[204:207], a[64:67], v[128:143]
ds_read_b64_tr_b16 a[236:237], v227 offset:8192
v_mfma_f32_32x32x16_bf16 v[192:207], a[204:207], a[68:71], v[192:207]
ds_read_b64_tr_b16 a[238:239], v227 offset:9216
s_waitcnt vmcnt(29)
v_mfma_f32_32x32x16_bf16 v[80:95], a[208:211], a[72:75], v[80:95]
ds_read_b64_tr_b16 a[240:241], v224 offset:12288
s_waitcnt vmcnt(28)
v_mfma_f32_32x32x16_bf16 v[144:159], a[208:211], a[76:79], v[144:159]
ds_read_b64_tr_b16 a[242:243], v224 offset:13312
s_waitcnt lgkmcnt(5)
v_mfma_f32_32x32x16_bf16 v[96:111], a[212:215], a[72:75], v[96:111]
ds_read_b64_tr_b16 a[244:245], v225 offset:12288
v_mfma_f32_32x32x16_bf16 v[160:175], a[212:215], a[76:79], v[160:175]
ds_read_b64_tr_b16 a[246:247], v225 offset:13312
v_mfma_f32_32x32x16_bf16 v[112:127], a[216:219], a[72:75], v[112:127]
ds_read_b64_tr_b16 a[248:249], v226 offset:12288
v_mfma_f32_32x32x16_bf16 v[176:191], a[216:219], a[76:79], v[176:191]
ds_read_b64_tr_b16 a[250:251], v226 offset:13312
v_mfma_f32_32x32x16_bf16 v[128:143], a[220:223], a[72:75], v[128:143]
ds_read_b64_tr_b16 a[252:253], v227 offset:12288
v_mfma_f32_32x32x16_bf16 v[192:207], a[220:223], a[76:79], v[192:207]
ds_read_b64_tr_b16 a[254:255], v227 offset:13312
s_barrier
s_waitcnt vmcnt(27)
v_mfma_f32_32x32x16_bf16 v[80:95], a[224:227], a[80:83], v[80:95]
ds_read_b64_tr_b16 a[192:193], v224 offset:16384
s_add_u32 m0, s29, 98304
s_add_u32 s31, s32, 32768
buffer_load_dwordx4 v232, s[16:19], s31 offen offset:0 lds
s_waitcnt vmcnt(27)
v_mfma_f32_32x32x16_bf16 v[144:159], a[224:227], a[84:87], v[144:159]
ds_read_b64_tr_b16 a[194:195], v224 offset:17408
buffer_load_dwordx4 v232, s[16:19], s31 offen offset:1024 lds
v_mfma_f32_32x32x16_bf16 v[96:111], a[228:231], a[80:83], v[96:111]
ds_read_b64_tr_b16 a[196:197], v225 offset:16384
buffer_load_dwordx4 v232, s[16:19], s31 offen offset:2048 lds
v_mfma_f32_32x32x16_bf16 v[160:175], a[228:231], a[84:87], v[160:175]
ds_read_b64_tr_b16 a[198:199], v225 offset:17408
buffer_load_dwordx4 v232, s[16:19], s31 offen offset:3072 lds
s_waitcnt lgkmcnt(5)
v_mfma_f32_32x32x16_bf16 v[112:127], a[232:235], a[80:83], v[112:127]
ds_read_b64_tr_b16 a[200:201], v226 offset:16384
s_add_u32 m0, s29, 114688
s_add_u32 s31, s32, 49152
buffer_load_dwordx4 v232, s[16:19], s31 offen offset:0 lds
v_mfma_f32_32x32x16_bf16 v[176:191], a[232:235], a[84:87], v[176:191]
ds_read_b64_tr_b16 a[202:203], v226 offset:17408
buffer_load_dwordx4 v232, s[16:19], s31 offen offset:1024 lds
v_mfma_f32_32x32x16_bf16 v[128:143], a[236:239], a[80:83], v[128:143]
ds_read_b64_tr_b16 a[204:205], v227 offset:16384
buffer_load_dwordx4 v232, s[16:19], s31 offen offset:2048 lds
v_mfma_f32_32x32x16_bf16 v[192:207], a[236:239], a[84:87], v[192:207]
ds_read_b64_tr_b16 a[206:207], v227 offset:17408
buffer_load_dwordx4 v232, s[16:19], s31 offen offset:3072 lds
s_waitcnt vmcnt(33)
v_mfma_f32_32x32x16_bf16 v[80:95], a[240:243], a[88:91], v[80:95]
ds_read_b64_tr_b16 a[208:209], v224 offset:20480
s_waitcnt vmcnt(32)
v_mfma_f32_32x32x16_bf16 v[144:159], a[240:243], a[92:95], v[144:159]
ds_read_b64_tr_b16 a[210:211], v224 offset:21504
v_mfma_f32_32x32x16_bf16 v[96:111], a[244:247], a[88:91], v[96:111]
ds_read_b64_tr_b16 a[212:213], v225 offset:20480
v_mfma_f32_32x32x16_bf16 v[160:175], a[244:247], a[92:95], v[160:175]
ds_read_b64_tr_b16 a[214:215], v225 offset:21504
v_mfma_f32_32x32x16_bf16 v[112:127], a[248:251], a[88:91], v[112:127]
ds_read_b64_tr_b16 a[216:217], v226 offset:20480
v_mfma_f32_32x32x16_bf16 v[176:191], a[248:251], a[92:95], v[176:191]
ds_read_b64_tr_b16 a[218:219], v226 offset:21504
s_waitcnt lgkmcnt(5)
v_mfma_f32_32x32x16_bf16 v[128:143], a[252:255], a[88:91], v[128:143]
ds_read_b64_tr_b16 a[220:221], v227 offset:20480
v_mfma_f32_32x32x16_bf16 v[192:207], a[252:255], a[92:95], v[192:207]
ds_read_b64_tr_b16 a[222:223], v227 offset:21504
s_waitcnt vmcnt(27)
v_mfma_f32_32x32x16_bf16 v[80:95], a[192:195], a[96:99], v[80:95]
ds_read_b64_tr_b16 a[224:225], v224 offset:24576
ds_read_b64_tr_b16 a[226:227], v224 offset:25600
v_mfma_f32_32x32x16_bf16 v[96:111], a[196:199], a[96:99], v[96:111]
ds_read_b64_tr_b16 a[228:229], v225 offset:24576
ds_read_b64_tr_b16 a[230:231], v225 offset:25600
v_mfma_f32_32x32x16_bf16 v[112:127], a[200:203], a[96:99], v[112:127]
ds_read_b64_tr_b16 a[232:233], v226 offset:24576
ds_read_b64_tr_b16 a[234:235], v226 offset:25600
v_mfma_f32_32x32x16_bf16 v[128:143], a[204:207], a[96:99], v[128:143]
ds_read_b64_tr_b16 a[236:237], v227 offset:24576
ds_read_b64_tr_b16 a[238:239], v227 offset:25600
s_waitcnt vmcnt(25) lgkmcnt(9)
v_mfma_f32_32x32x16_bf16 v[80:95], a[208:211], a[104:107], v[80:95]
ds_read_b64_tr_b16 a[240:241], v224 offset:28672
ds_read_b64_tr_b16 a[242:243], v224 offset:29696
v_mfma_f32_32x32x16_bf16 v[96:111], a[212:215], a[104:107], v[96:111]
ds_read_b64_tr_b16 a[244:245], v225 offset:28672
ds_read_b64_tr_b16 a[246:247], v225 offset:29696
v_mfma_f32_32x32x16_bf16 v[112:127], a[216:219], a[104:107], v[112:127]
ds_read_b64_tr_b16 a[248:249], v226 offset:28672
ds_read_b64_tr_b16 a[250:251], v226 offset:29696
s_waitcnt lgkmcnt(10)
v_mfma_f32_32x32x16_bf16 v[128:143], a[220:223], a[104:107], v[128:143]
ds_read_b64_tr_b16 a[252:253], v227 offset:28672
ds_read_b64_tr_b16 a[254:255], v227 offset:29696
s_waitcnt vmcnt(23)
v_mfma_f32_32x32x16_bf16 v[80:95], a[224:227], a[112:115], v[80:95]
v_mfma_f32_32x32x16_bf16 v[96:111], a[228:231], a[112:115], v[96:111]
s_waitcnt lgkmcnt(6)
v_mfma_f32_32x32x16_bf16 v[112:127], a[232:235], a[112:115], v[112:127]
s_waitcnt vmcnt(12)
s_barrier
v_mfma_f32_32x32x16_bf16 v[128:143], a[236:239], a[112:115], v[128:143]
v_mfma_f32_32x32x16_bf16 v[80:95], a[240:243], a[120:123], v[80:95]
s_waitcnt lgkmcnt(0)
v_mfma_f32_32x32x16_bf16 v[96:111], a[244:247], a[120:123], v[96:111]
v_mfma_f32_32x32x16_bf16 v[112:127], a[248:251], a[120:123], v[112:127]
v_mfma_f32_32x32x16_bf16 v[128:143], a[252:255], a[120:123], v[128:143]
v_mfma_f32_32x32x16_bf16 v[144:159], a[192:195], a[100:103], v[144:159]
ds_read_b128 a[128:131], v208 offset:0
v_mfma_f32_32x32x16_bf16 v[160:175], a[196:199], a[100:103], v[160:175]
s_nop 4
v_mul_f32 v80, 0x3e0293ee, v80
v_mul_f32 v81, 0x3e0293ee, v81
v_mul_f32 v82, 0x3e0293ee, v82
v_mul_f32 v83, 0x3e0293ee, v83
v_mul_f32 v84, 0x3e0293ee, v84
v_mul_f32 v85, 0x3e0293ee, v85
v_mul_f32 v86, 0x3e0293ee, v86
v_mfma_f32_32x32x16_bf16 v[176:191], a[200:203], a[100:103], v[176:191]
v_mul_f32 v87, 0x3e0293ee, v87
v_cvt_pk_bf16_f32 v16, v80, v81
v_cvt_pk_bf16_f32 v17, v82, v83
v_cvt_pk_bf16_f32 v18, v84, v85
v_cvt_pk_bf16_f32 v19, v86, v87
v_mul_f32 v88, 0x3e0293ee, v88
ds_read_b128 a[132:135], v209 offset:0
v_mfma_f32_32x32x16_bf16 v[192:207], a[204:207], a[100:103], v[192:207]
v_mul_f32 v89, 0x3e0293ee, v89
v_mul_f32 v90, 0x3e0293ee, v90
v_mul_f32 v91, 0x3e0293ee, v91
v_mul_f32 v92, 0x3e0293ee, v92
v_mul_f32 v93, 0x3e0293ee, v93
v_mul_f32 v94, 0x3e0293ee, v94
v_mul_f32 v95, 0x3e0293ee, v95
v_mfma_f32_32x32x16_bf16 v[144:159], a[208:211], a[108:111], v[144:159]
v_cvt_pk_bf16_f32 v20, v88, v89
v_cvt_pk_bf16_f32 v21, v90, v91
v_cvt_pk_bf16_f32 v22, v92, v93
v_cvt_pk_bf16_f32 v23, v94, v95
v_mul_f32 v96, 0x3e0293ee, v96
v_mul_f32 v97, 0x3e0293ee, v97
ds_read_b128 a[136:139], v210 offset:0
v_mfma_f32_32x32x16_bf16 v[160:175], a[212:215], a[108:111], v[160:175]
v_mul_f32 v98, 0x3e0293ee, v98
v_mul_f32 v99, 0x3e0293ee, v99
v_mul_f32 v100, 0x3e0293ee, v100
v_mul_f32 v101, 0x3e0293ee, v101
v_mul_f32 v102, 0x3e0293ee, v102
v_mul_f32 v103, 0x3e0293ee, v103
v_mfma_f32_32x32x16_bf16 v[176:191], a[216:219], a[108:111], v[176:191]
v_cvt_pk_bf16_f32 v24, v96, v97
v_cvt_pk_bf16_f32 v25, v98, v99
v_cvt_pk_bf16_f32 v26, v100, v101
v_cvt_pk_bf16_f32 v27, v102, v103
v_mul_f32 v104, 0x3e0293ee, v104
v_mul_f32 v105, 0x3e0293ee, v105
v_mul_f32 v106, 0x3e0293ee, v106
ds_read_b128 a[140:143], v211 offset:0
v_mfma_f32_32x32x16_bf16 v[192:207], a[220:223], a[108:111], v[192:207]
v_mul_f32 v107, 0x3e0293ee, v107
v_mul_f32 v108, 0x3e0293ee, v108
v_mul_f32 v109, 0x3e0293ee, v109
v_mul_f32 v110, 0x3e0293ee, v110
v_mul_f32 v111, 0x3e0293ee, v111
v_cvt_pk_bf16_f32 v28, v104, v105
v_mfma_f32_32x32x16_bf16 v[144:159], a[224:227], a[116:119], v[144:159]
v_cvt_pk_bf16_f32 v29, v106, v107
v_cvt_pk_bf16_f32 v30, v108, v109
v_cvt_pk_bf16_f32 v31, v110, v111
v_mul_f32 v112, 0x3e0293ee, v112
v_mul_f32 v113, 0x3e0293ee, v113
v_mul_f32 v114, 0x3e0293ee, v114
v_mul_f32 v115, 0x3e0293ee, v115
ds_read_b128 a[144:147], v212 offset:0
v_mfma_f32_32x32x16_bf16 v[160:175], a[228:231], a[116:119], v[160:175]
v_mul_f32 v116, 0x3e0293ee, v116
v_mul_f32 v117, 0x3e0293ee, v117
v_mul_f32 v118, 0x3e0293ee, v118
v_mul_f32 v119, 0x3e0293ee, v119
v_cvt_pk_bf16_f32 v32, v112, v113
v_cvt_pk_bf16_f32 v33, v114, v115
v_mfma_f32_32x32x16_bf16 v[176:191], a[232:235], a[116:119], v[176:191]
v_cvt_pk_bf16_f32 v34, v116, v117
v_cvt_pk_bf16_f32 v35, v118, v119
v_mul_f32 v120, 0x3e0293ee, v120
v_mul_f32 v121, 0x3e0293ee, v121
v_mul_f32 v122, 0x3e0293ee, v122
v_mul_f32 v123, 0x3e0293ee, v123
ds_read_b128 a[148:151], v213 offset:0
v_mfma_f32_32x32x16_bf16 v[192:207], a[236:239], a[116:119], v[192:207]
v_mul_f32 v124, 0x3e0293ee, v124
v_mul_f32 v125, 0x3e0293ee, v125
v_mul_f32 v126, 0x3e0293ee, v126
v_mul_f32 v127, 0x3e0293ee, v127
v_cvt_pk_bf16_f32 v36, v120, v121
v_cvt_pk_bf16_f32 v37, v122, v123
v_cvt_pk_bf16_f32 v38, v124, v125
v_mfma_f32_32x32x16_bf16 v[144:159], a[240:243], a[124:127], v[144:159]
v_cvt_pk_bf16_f32 v39, v126, v127
v_mul_f32 v128, 0x3e0293ee, v128
v_mul_f32 v129, 0x3e0293ee, v129
v_mul_f32 v130, 0x3e0293ee, v130
v_mul_f32 v131, 0x3e0293ee, v131
v_mul_f32 v132, 0x3e0293ee, v132
ds_read_b128 a[152:155], v214 offset:0
v_mfma_f32_32x32x16_bf16 v[160:175], a[244:247], a[124:127], v[160:175]
v_mul_f32 v133, 0x3e0293ee, v133
v_mul_f32 v134, 0x3e0293ee, v134
v_mul_f32 v135, 0x3e0293ee, v135
v_cvt_pk_bf16_f32 v40, v128, v129
v_cvt_pk_bf16_f32 v41, v130, v131
v_cvt_pk_bf16_f32 v42, v132, v133
v_cvt_pk_bf16_f32 v43, v134, v135
v_mfma_f32_32x32x16_bf16 v[176:191], a[248:251], a[124:127], v[176:191]
v_mul_f32 v136, 0x3e0293ee, v136
v_mul_f32 v137, 0x3e0293ee, v137
v_mul_f32 v138, 0x3e0293ee, v138
v_mul_f32 v139, 0x3e0293ee, v139
v_mul_f32 v140, 0x3e0293ee, v140
v_mul_f32 v141, 0x3e0293ee, v141
ds_read_b128 a[156:159], v215 offset:0
v_mfma_f32_32x32x16_bf16 v[192:207], a[252:255], a[124:127], v[192:207]
v_mul_f32 v142, 0x3e0293ee, v142
v_mul_f32 v143, 0x3e0293ee, v143
v_cvt_pk_bf16_f32 v44, v136, v137
v_cvt_pk_bf16_f32 v45, v138, v139
v_cvt_pk_bf16_f32 v46, v140, v141
v_cvt_pk_bf16_f32 v47, v142, v143
s_waitcnt lgkmcnt(2)
v_mfma_f32_32x32x16_bf16 v[80:95], a[128:131], v[16:19], 0
v_mul_f32 v144, 0x3e0293ee, v144
v_mul_f32 v145, 0x3e0293ee, v145
v_mul_f32 v146, 0x3e0293ee, v146
v_mul_f32 v147, 0x3e0293ee, v147
v_mul_f32 v148, 0x3e0293ee, v148
v_mul_f32 v149, 0x3e0293ee, v149
v_mul_f32 v150, 0x3e0293ee, v150
v_mul_f32 v151, 0x3e0293ee, v151
v_cvt_pk_bf16_f32 v48, v144, v145
v_cvt_pk_bf16_f32 v49, v146, v147
v_cvt_pk_bf16_f32 v50, v148, v149
v_cvt_pk_bf16_f32 v51, v150, v151
v_mfma_f32_32x32x16_bf16 v[80:95], a[132:135], v[20:23], v[80:95]
v_mul_f32 v152, 0x3e0293ee, v152
v_mul_f32 v153, 0x3e0293ee, v153
v_mul_f32 v154, 0x3e0293ee, v154
v_mul_f32 v155, 0x3e0293ee, v155
v_mul_f32 v156, 0x3e0293ee, v156
v_mul_f32 v157, 0x3e0293ee, v157
v_mul_f32 v158, 0x3e0293ee, v158
v_mul_f32 v159, 0x3e0293ee, v159
v_cvt_pk_bf16_f32 v52, v152, v153
v_cvt_pk_bf16_f32 v53, v154, v155
v_cvt_pk_bf16_f32 v54, v156, v157
v_cvt_pk_bf16_f32 v55, v158, v159
v_mfma_f32_32x32x16_bf16 v[80:95], a[136:139], v[24:27], v[80:95]
v_mul_f32 v160, 0x3e0293ee, v160
v_mul_f32 v161, 0x3e0293ee, v161
v_mul_f32 v162, 0x3e0293ee, v162
v_mul_f32 v163, 0x3e0293ee, v163
v_mul_f32 v164, 0x3e0293ee, v164
v_mul_f32 v165, 0x3e0293ee, v165
v_mul_f32 v166, 0x3e0293ee, v166
v_mul_f32 v167, 0x3e0293ee, v167
v_cvt_pk_bf16_f32 v56, v160, v161
v_cvt_pk_bf16_f32 v57, v162, v163
v_cvt_pk_bf16_f32 v58, v164, v165
v_cvt_pk_bf16_f32 v59, v166, v167
v_mfma_f32_32x32x16_bf16 v[80:95], a[140:143], v[28:31], v[80:95]
v_mul_f32 v168, 0x3e0293ee, v168
v_mul_f32 v169, 0x3e0293ee, v169
v_mul_f32 v170, 0x3e0293ee, v170
v_mul_f32 v171, 0x3e0293ee, v171
v_mul_f32 v172, 0x3e0293ee, v172
v_mul_f32 v173, 0x3e0293ee, v173
v_mul_f32 v174, 0x3e0293ee, v174
v_mul_f32 v175, 0x3e0293ee, v175
v_cvt_pk_bf16_f32 v60, v168, v169
v_cvt_pk_bf16_f32 v61, v170, v171
v_cvt_pk_bf16_f32 v62, v172, v173
v_cvt_pk_bf16_f32 v63, v174, v175
v_mfma_f32_32x32x16_bf16 v[80:95], a[144:147], v[32:35], v[80:95]
v_mul_f32 v176, 0x3e0293ee, v176
v_mul_f32 v177, 0x3e0293ee, v177
v_mul_f32 v178, 0x3e0293ee, v178
v_mul_f32 v179, 0x3e0293ee, v179
v_mul_f32 v180, 0x3e0293ee, v180
v_mul_f32 v181, 0x3e0293ee, v181
v_mul_f32 v182, 0x3e0293ee, v182
v_mul_f32 v183, 0x3e0293ee, v183
v_cvt_pk_bf16_f32 v64, v176, v177
v_cvt_pk_bf16_f32 v65, v178, v179
v_cvt_pk_bf16_f32 v66, v180, v181
v_cvt_pk_bf16_f32 v67, v182, v183
v_mfma_f32_32x32x16_bf16 v[80:95], a[148:151], v[36:39], v[80:95]
v_mul_f32 v184, 0x3e0293ee, v184
v_mul_f32 v185, 0x3e0293ee, v185
v_mul_f32 v186, 0x3e0293ee, v186
v_mul_f32 v187, 0x3e0293ee, v187
v_mul_f32 v188, 0x3e0293ee, v188
v_mul_f32 v189, 0x3e0293ee, v189
v_mul_f32 v190, 0x3e0293ee, v190
v_mul_f32 v191, 0x3e0293ee, v191
v_cvt_pk_bf16_f32 v68, v184, v185
v_cvt_pk_bf16_f32 v69, v186, v187
v_cvt_pk_bf16_f32 v70, v188, v189
v_cvt_pk_bf16_f32 v71, v190, v191
s_waitcnt lgkmcnt(0)
v_mfma_f32_32x32x16_bf16 v[80:95], a[152:155], v[40:43], v[80:95]
v_mul_f32 v192, 0x3e0293ee, v192
v_mul_f32 v193, 0x3e0293ee, v193
v_mul_f32 v194, 0x3e0293ee, v194
v_mul_f32 v195, 0x3e0293ee, v195
v_mul_f32 v196, 0x3e0293ee, v196
v_mul_f32 v197, 0x3e0293ee, v197
v_mul_f32 v198, 0x3e0293ee, v198
v_mul_f32 v199, 0x3e0293ee, v199
v_cvt_pk_bf16_f32 v72, v192, v193
v_cvt_pk_bf16_f32 v73, v194, v195
v_cvt_pk_bf16_f32 v74, v196, v197
v_cvt_pk_bf16_f32 v75, v198, v199
v_mfma_f32_32x32x16_bf16 v[80:95], a[156:159], v[44:47], v[80:95]
v_mul_f32 v200, 0x3e0293ee, v200
v_mul_f32 v201, 0x3e0293ee, v201
v_mul_f32 v202, 0x3e0293ee, v202
v_mul_f32 v203, 0x3e0293ee, v203
v_mul_f32 v204, 0x3e0293ee, v204
v_mul_f32 v205, 0x3e0293ee, v205
v_mul_f32 v206, 0x3e0293ee, v206
v_mul_f32 v207, 0x3e0293ee, v207
v_cvt_pk_bf16_f32 v76, v200, v201
v_cvt_pk_bf16_f32 v77, v202, v203
v_cvt_pk_bf16_f32 v78, v204, v205
v_cvt_pk_bf16_f32 v79, v206, v207
v_mfma_f32_32x32x16_bf16 v[96:111], a[128:131], v[48:51], 0
v_mfma_f32_32x32x16_bf16 v[96:111], a[132:135], v[52:55], v[96:111]
v_max3_f32 v252, v80, v81, v82
v_max3_f32 v252, v252, v83, v84
v_max3_f32 v252, v252, v85, v86
v_max3_f32 v252, v252, v87, v88
v_max3_f32 v252, v252, v89, v90
v_max3_f32 v252, v252, v91, v92
v_max3_f32 v252, v252, v93, v94
v_max_f32 v252, v252, v95
v_mov_b32 v253, v252
s_nop 1
v_permlane32_swap_b32 v253, v252
v_max_f32 v252, v252, v253
v_sub_f32 v144, 0, v252
ds_read_b128 a[128:131], v208 offset:8192
ds_read_b128 a[132:135], v209 offset:8192
v_mfma_f32_32x32x16_bf16 v[96:111], a[136:139], v[56:59], v[96:111]
v_sub_f32 v145, 0, v252
v_sub_f32 v146, 0, v252
v_sub_f32 v147, 0, v252
v_sub_f32 v148, 0, v252
v_sub_f32 v149, 0, v252
v_sub_f32 v150, 0, v252
v_sub_f32 v151, 0, v252
v_sub_f32 v152, 0, v252
v_sub_f32 v153, 0, v252
v_sub_f32 v154, 0, v252
v_sub_f32 v155, 0, v252
v_sub_f32 v156, 0, v252
ds_read_b128 a[136:139], v210 offset:8192
v_mfma_f32_32x32x16_bf16 v[96:111], a[140:143], v[60:63], v[96:111]
v_sub_f32 v157, 0, v252
v_sub_f32 v158, 0, v252
v_sub_f32 v159, 0, v252
v_add_f32 v80, v80, v144
v_exp_f32 v244, v80
v_add_f32 v81, v81, v144
v_exp_f32 v245, v81
v_add_f32 v82, v82, v144
v_exp_f32 v246, v82
v_add_f32 v83, v83, v144
v_exp_f32 v247, v83
v_add_f32 v242, v244, v245
ds_read_b128 a[140:143], v211 offset:8192
v_mfma_f32_32x32x16_bf16 v[96:111], a[144:147], v[64:67], v[96:111]
v_add_f32 v84, v84, v144
v_exp_f32 v248, v84
v_cvt_pk_bf16_f32 v112, v244, v245
v_add_f32 v242, v242, v246
v_add_f32 v242, v242, v247
v_add_f32 v85, v85, v144
v_exp_f32 v249, v85
v_cvt_pk_bf16_f32 v113, v246, v247
v_add_f32 v242, v242, v248
v_add_f32 v86, v86, v144
v_exp_f32 v250, v86
v_add_f32 v242, v242, v249
ds_read_b128 a[144:147], v212 offset:8192
v_mfma_f32_32x32x16_bf16 v[96:111], a[148:151], v[68:71], v[96:111]
v_cvt_pk_bf16_f32 v114, v248, v249
v_add_f32 v87, v87, v144
v_exp_f32 v251, v87
v_add_f32 v242, v242, v250
v_add_f32 v88, v88, v144
v_exp_f32 v244, v88
v_add_f32 v242, v242, v251
v_cvt_pk_bf16_f32 v115, v250, v251
v_add_f32 v89, v89, v144
v_exp_f32 v245, v89
v_add_f32 v242, v242, v244
v_add_f32 v90, v90, v144
ds_read_b128 a[148:151], v213 offset:8192
v_mfma_f32_32x32x16_bf16 v[96:111], a[152:155], v[72:75], v[96:111]
v_exp_f32 v246, v90
v_add_f32 v242, v242, v245
v_cvt_pk_bf16_f32 v116, v244, v245
v_add_f32 v91, v91, v144
v_exp_f32 v247, v91
v_add_f32 v242, v242, v246
v_add_f32 v92, v92, v144
v_exp_f32 v248, v92
v_add_f32 v242, v242, v247
v_cvt_pk_bf16_f32 v117, v246, v247
v_add_f32 v93, v93, v144
v_exp_f32 v249, v93
ds_read_b128 a[152:155], v214 offset:8192
v_mfma_f32_32x32x16_bf16 v[96:111], a[156:159], v[76:79], v[96:111]
v_add_f32 v242, v242, v248
v_add_f32 v94, v94, v144
v_exp_f32 v250, v94
v_add_f32 v242, v242, v249
v_cvt_pk_bf16_f32 v118, v248, v249
v_add_f32 v95, v95, v144
v_exp_f32 v251, v95
v_add_f32 v242, v242, v250
v_add_f32 v242, v242, v251
v_cvt_pk_bf16_f32 v119, v250, v251
v_mov_b32 v240, v242
ds_read_b128 a[156:159], v215 offset:8192
s_waitcnt lgkmcnt(5)
v_mfma_f32_32x32x16_bf16 v[80:95], a[128:131], v[16:19], v[144:159]
v_max3_f32 v252, v96, v97, v98
v_max3_f32 v252, v252, v99, v100
v_max3_f32 v252, v252, v101, v102
v_max3_f32 v252, v252, v103, v104
v_max3_f32 v252, v252, v105, v106
v_max3_f32 v252, v252, v107, v108
ds_read_b64_tr_b16 a[160:161], v220 offset:0
ds_read_b64_tr_b16 a[164:165], v220 offset:4096
v_mfma_f32_32x32x16_bf16 v[80:95], a[132:135], v[20:23], v[80:95]
v_max3_f32 v252, v252, v109, v110
v_max_f32 v252, v252, v111
v_mov_b32 v253, v252
s_nop 1
v_permlane32_swap_b32 v253, v252
v_max_f32 v252, v252, v253
ds_read_b64_tr_b16 a[168:169], v221 offset:0
ds_read_b64_tr_b16 a[172:173], v221 offset:4096
v_mfma_f32_32x32x16_bf16 v[80:95], a[136:139], v[24:27], v[80:95]
v_sub_f32 v160, 0, v252
v_sub_f32 v161, 0, v252
v_sub_f32 v162, 0, v252
v_sub_f32 v163, 0, v252
v_sub_f32 v164, 0, v252
ds_read_b64_tr_b16 a[176:177], v222 offset:0
ds_read_b64_tr_b16 a[180:181], v222 offset:4096
s_waitcnt lgkmcnt(8)
v_mfma_f32_32x32x16_bf16 v[80:95], a[140:143], v[28:31], v[80:95]
v_sub_f32 v165, 0, v252
v_sub_f32 v166, 0, v252
v_sub_f32 v167, 0, v252
v_sub_f32 v168, 0, v252
v_sub_f32 v169, 0, v252
ds_read_b64_tr_b16 a[184:185], v223 offset:0
ds_read_b64_tr_b16 a[188:189], v223 offset:4096
v_mfma_f32_32x32x16_bf16 v[80:95], a[144:147], v[32:35], v[80:95]
v_sub_f32 v170, 0, v252
v_sub_f32 v171, 0, v252
v_sub_f32 v172, 0, v252
v_sub_f32 v173, 0, v252
v_sub_f32 v174, 0, v252
ds_read_b64_tr_b16 a[162:163], v220 offset:1024
ds_read_b64_tr_b16 a[166:167], v220 offset:5120
v_mfma_f32_32x32x16_bf16 v[80:95], a[148:151], v[36:39], v[80:95]
v_sub_f32 v175, 0, v252
v_add_f32 v96, v96, v160
v_exp_f32 v244, v96
v_add_f32 v97, v97, v160
v_exp_f32 v245, v97
v_add_f32 v98, v98, v160
ds_read_b64_tr_b16 a[170:171], v221 offset:1024
ds_read_b64_tr_b16 a[174:175], v221 offset:5120
s_waitcnt lgkmcnt(10)
v_mfma_f32_32x32x16_bf16 v[80:95], a[152:155], v[40:43], v[80:95]
v_exp_f32 v246, v98
v_add_f32 v99, v99, v160
v_exp_f32 v247, v99
v_add_f32 v243, v244, v245
v_add_f32 v100, v100, v160
ds_read_b64_tr_b16 a[178:179], v222 offset:1024
ds_read_b64_tr_b16 a[182:183], v222 offset:5120
v_mfma_f32_32x32x16_bf16 v[80:95], a[156:159], v[44:47], v[80:95]
v_exp_f32 v248, v100
v_cvt_pk_bf16_f32 v120, v244, v245
v_add_f32 v243, v243, v246
v_add_f32 v243, v243, v247
v_add_f32 v101, v101, v160
ds_read_b64_tr_b16 a[186:187], v223 offset:1024
ds_read_b64_tr_b16 a[190:191], v223 offset:5120
s_waitcnt lgkmcnt(7)
v_mfma_f32_32x32x16_bf16 a[0:15], a[160:163], v[112:115], 0
v_exp_f32 v249, v101
v_cvt_pk_bf16_f32 v121, v246, v247
v_add_f32 v243, v243, v248
v_add_f32 v102, v102, v160
v_exp_f32 v250, v102
s_waitcnt lgkmcnt(6)
v_mfma_f32_32x32x16_bf16 a[0:15], a[164:167], v[116:119], a[0:15]
v_add_f32 v243, v243, v249
v_cvt_pk_bf16_f32 v122, v248, v249
v_add_f32 v103, v103, v160
v_exp_f32 v251, v103
v_add_f32 v243, v243, v250
s_waitcnt lgkmcnt(5)
v_mfma_f32_32x32x16_bf16 a[16:31], a[168:171], v[112:115], 0
v_add_f32 v104, v104, v160
v_exp_f32 v244, v104
v_add_f32 v243, v243, v251
v_cvt_pk_bf16_f32 v123, v250, v251
v_add_f32 v105, v105, v160
v_exp_f32 v245, v105
s_waitcnt lgkmcnt(4)
v_mfma_f32_32x32x16_bf16 a[16:31], a[172:175], v[116:119], a[16:31]
v_add_f32 v243, v243, v244
v_add_f32 v106, v106, v160
v_exp_f32 v246, v106
v_add_f32 v243, v243, v245
v_cvt_pk_bf16_f32 v124, v244, v245
s_waitcnt lgkmcnt(2)
v_mfma_f32_32x32x16_bf16 a[32:47], a[176:179], v[112:115], 0
v_add_f32 v107, v107, v160
v_exp_f32 v247, v107
v_add_f32 v243, v243, v246
v_add_f32 v108, v108, v160
v_exp_f32 v248, v108
v_mfma_f32_32x32x16_bf16 a[32:47], a[180:183], v[116:119], a[32:47]
v_add_f32 v243, v243, v247
v_cvt_pk_bf16_f32 v125, v246, v247
v_add_f32 v109, v109, v160
v_exp_f32 v249, v109
v_add_f32 v243, v243, v248
s_waitcnt lgkmcnt(0)
v_mfma_f32_32x32x16_bf16 a[48:63], a[184:187], v[112:115], 0
v_add_f32 v110, v110, v160
v_exp_f32 v250, v110
v_add_f32 v243, v243, v249
v_cvt_pk_bf16_f32 v126, v248, v249
v_add_f32 v111, v111, v160
v_mfma_f32_32x32x16_bf16 a[48:63], a[188:191], v[116:119], a[48:63]
v_exp_f32 v251, v111
v_add_f32 v243, v243, v250
v_add_f32 v243, v243, v251
v_cvt_pk_bf16_f32 v127, v250, v251
v_mov_b32 v241, v243
v_mfma_f32_32x32x16_bf16 v[96:111], a[128:131], v[48:51], v[160:175]
s_waitcnt vmcnt(8)
s_barrier
v_exp_f32 v244, v80
v_exp_f32 v245, v81
v_mfma_f32_32x32x16_bf16 v[96:111], a[132:135], v[52:55], v[96:111]
v_exp_f32 v246, v82
v_exp_f32 v247, v83
v_add_f32 v242, v244, v245
ds_read_b128 a[128:131], v208 offset:16384
v_mfma_f32_32x32x16_bf16 v[96:111], a[136:139], v[56:59], v[96:111]
v_exp_f32 v248, v84
v_cvt_pk_bf16_f32 v112, v244, v245
v_add_f32 v242, v242, v246
v_add_f32 v242, v242, v247
ds_read_b128 a[132:135], v209 offset:16384
v_mfma_f32_32x32x16_bf16 v[96:111], a[140:143], v[60:63], v[96:111]
v_exp_f32 v249, v85
v_cvt_pk_bf16_f32 v113, v246, v247
v_add_f32 v242, v242, v248
ds_read_b128 a[136:139], v210 offset:16384
v_mfma_f32_32x32x16_bf16 v[96:111], a[144:147], v[64:67], v[96:111]
v_exp_f32 v250, v86
v_add_f32 v242, v242, v249
v_cvt_pk_bf16_f32 v114, v248, v249
ds_read_b128 a[140:143], v211 offset:16384
v_mfma_f32_32x32x16_bf16 v[96:111], a[148:151], v[68:71], v[96:111]
v_exp_f32 v251, v87
v_add_f32 v242, v242, v250
ds_read_b128 a[144:147], v212 offset:16384
v_mfma_f32_32x32x16_bf16 v[96:111], a[152:155], v[72:75], v[96:111]
v_exp_f32 v244, v88
v_add_f32 v242, v242, v251
v_cvt_pk_bf16_f32 v115, v250, v251
ds_read_b128 a[148:151], v213 offset:16384
v_mfma_f32_32x32x16_bf16 v[96:111], a[156:159], v[76:79], v[96:111]
v_exp_f32 v245, v89
v_add_f32 v242, v242, v244
ds_read_b128 a[152:155], v214 offset:16384
v_mfma_f32_32x32x16_bf16 a[64:79], a[160:163], v[120:123], 0
v_exp_f32 v246, v90
v_add_f32 v242, v242, v245
v_cvt_pk_bf16_f32 v116, v244, v245
ds_read_b128 a[156:159], v215 offset:16384
ds_read_b64_tr_b16 a[160:161], v220 offset:8192
v_mfma_f32_32x32x16_bf16 a[64:79], a[164:167], v[124:127], a[64:79]
v_exp_f32 v247, v91
v_add_f32 v242, v242, v246
ds_read_b64_tr_b16 a[164:165], v220 offset:12288
v_mfma_f32_32x32x16_bf16 a[80:95], a[168:171], v[120:123], 0
v_exp_f32 v248, v92
v_add_f32 v242, v242, v247
v_cvt_pk_bf16_f32 v117, v246, v247
ds_read_b64_tr_b16 a[168:169], v221 offset:8192
v_mfma_f32_32x32x16_bf16 a[80:95], a[172:175], v[124:127], a[80:95]
v_exp_f32 v249, v93
v_add_f32 v242, v242, v248
ds_read_b64_tr_b16 a[172:173], v221 offset:12288
v_mfma_f32_32x32x16_bf16 a[96:111], a[176:179], v[120:123], 0
v_exp_f32 v250, v94
v_add_f32 v242, v242, v249
v_cvt_pk_bf16_f32 v118, v248, v249
ds_read_b64_tr_b16 a[176:177], v222 offset:8192
v_mfma_f32_32x32x16_bf16 a[96:111], a[180:183], v[124:127], a[96:111]
v_exp_f32 v251, v95
v_add_f32 v242, v242, v250
ds_read_b64_tr_b16 a[180:181], v222 offset:12288
v_mfma_f32_32x32x16_bf16 a[112:127], a[184:187], v[120:123], 0
v_add_f32 v242, v242, v251
v_cvt_pk_bf16_f32 v119, v250, v251
v_cmp_nge_f32 vcc, s44, v242
ds_read_b64_tr_b16 a[184:185], v223 offset:8192
v_mfma_f32_32x32x16_bf16 a[112:127], a[188:191], v[124:127], a[112:127]
s_cbranch_vccnz L_slow_2
L_back_2:
v_add_f32 v240, v240, v242
ds_read_b64_tr_b16 a[188:189], v223 offset:12288
s_waitcnt lgkmcnt(5)
v_mfma_f32_32x32x16_bf16 v[80:95], a[128:131], v[16:19], v[144:159]
v_exp_f32 v244, v96
v_exp_f32 v245, v97
ds_read_b64_tr_b16 a[162:163], v220 offset:9216
v_mfma_f32_32x32x16_bf16 v[80:95], a[132:135], v[20:23], v[80:95]
v_exp_f32 v246, v98
v_exp_f32 v247, v99
v_add_f32 v243, v244, v245
ds_read_b64_tr_b16 a[166:167], v220 offset:13312
v_mfma_f32_32x32x16_bf16 v[80:95], a[136:139], v[24:27], v[80:95]
v_exp_f32 v248, v100
v_cvt_pk_bf16_f32 v120, v244, v245
v_add_f32 v243, v243, v246
v_add_f32 v243, v243, v247
ds_read_b64_tr_b16 a[170:171], v221 offset:9216
v_mfma_f32_32x32x16_bf16 v[80:95], a[140:143], v[28:31], v[80:95]
v_exp_f32 v249, v101
v_cvt_pk_bf16_f32 v121, v246, v247
v_add_f32 v243, v243, v248
ds_read_b64_tr_b16 a[174:175], v221 offset:13312
v_mfma_f32_32x32x16_bf16 v[80:95], a[144:147], v[32:35], v[80:95]
v_exp_f32 v250, v102
v_add_f32 v243, v243, v249
v_cvt_pk_bf16_f32 v122, v248, v249
ds_read_b64_tr_b16 a[178:179], v222 offset:9216
v_mfma_f32_32x32x16_bf16 v[80:95], a[148:151], v[36:39], v[80:95]
v_exp_f32 v251, v103
v_add_f32 v243, v243, v250
ds_read_b64_tr_b16 a[182:183], v222 offset:13312
v_mfma_f32_32x32x16_bf16 v[80:95], a[152:155], v[40:43], v[80:95]
v_exp_f32 v244, v104
v_add_f32 v243, v243, v251
v_cvt_pk_bf16_f32 v123, v250, v251
ds_read_b64_tr_b16 a[186:187], v223 offset:9216
v_mfma_f32_32x32x16_bf16 v[80:95], a[156:159], v[44:47], v[80:95]
v_exp_f32 v245, v105
v_add_f32 v243, v243, v244
ds_read_b64_tr_b16 a[190:191], v223 offset:13312
s_waitcnt lgkmcnt(5)
v_mfma_f32_32x32x16_bf16 a[0:15], a[160:163], v[112:115], a[0:15]
v_exp_f32 v246, v106
v_add_f32 v243, v243, v245
v_cvt_pk_bf16_f32 v124, v244, v245
s_add_u32 m0, s29, 0
s_add_u32 s31, s32, 65536
buffer_load_dwordx4 v228, s[12:15], s31 offen offset:0 lds
v_mfma_f32_32x32x16_bf16 a[0:15], a[164:167], v[116:119], a[0:15]
v_exp_f32 v247, v107
v_add_f32 v243, v243, v246
buffer_load_dwordx4 v229, s[12:15], s31 offen offset:1024 lds
v_mfma_f32_32x32x16_bf16 a[16:31], a[168:171], v[112:115], a[16:31]
v_exp_f32 v248, v108
v_add_f32 v243, v243, v247
v_cvt_pk_bf16_f32 v125, v246, v247
buffer_load_dwordx4 v230, s[12:15], s31 offen offset:2048 lds
s_waitcnt lgkmcnt(2)
v_mfma_f32_32x32x16_bf16 a[16:31], a[172:175], v[116:119], a[16:31]
v_exp_f32 v249, v109
v_add_f32 v243, v243, v248
buffer_load_dwordx4 v231, s[12:15], s31 offen offset:3072 lds
v_mfma_f32_32x32x16_bf16 a[32:47], a[176:179], v[112:115], a[32:47]
v_exp_f32 v250, v110
v_add_f32 v243, v243, v249
v_cvt_pk_bf16_f32 v126, v248, v249
s_mov_b32 m0, s56
s_nop 0
buffer_load_dwordx4 v8, s[24:27], s57 offen offset:0 lds
v_mfma_f32_32x32x16_bf16 a[32:47], a[180:183], v[116:119], a[32:47]
v_exp_f32 v251, v111
v_add_f32 v243, v243, v250
buffer_load_dwordx4 v9, s[24:27], s57 offen offset:1024 lds
s_waitcnt lgkmcnt(0)
v_mfma_f32_32x32x16_bf16 a[48:63], a[184:187], v[112:115], a[48:63]
v_add_f32 v243, v243, v251
v_cvt_pk_bf16_f32 v127, v250, v251
v_cmp_nge_f32 vcc, s44, v243
buffer_load_dwordx4 v10, s[24:27], s57 offen offset:2048 lds
v_mfma_f32_32x32x16_bf16 a[48:63], a[188:191], v[116:119], a[48:63]
s_cbranch_vccnz L_slow_3
L_back_3:
v_add_f32 v241, v241, v243
buffer_load_dwordx4 v11, s[24:27], s57 offen offset:3072 lds
v_mfma_f32_32x32x16_bf16 v[96:111], a[128:131], v[48:51], v[160:175]
v_exp_f32 v244, v80
v_exp_f32 v245, v81
v_mfma_f32_32x32x16_bf16 v[96:111], a[132:135], v[52:55], v[96:111]
v_exp_f32 v246, v82
v_exp_f32 v247, v83
v_add_f32 v242, v244, v245
ds_read_b128 a[128:131], v208 offset:24576
v_mfma_f32_32x32x16_bf16 v[96:111], a[136:139], v[56:59], v[96:111]
v_exp_f32 v248, v84
v_cvt_pk_bf16_f32 v112, v244, v245
v_add_f32 v242, v242, v246
v_add_f32 v242, v242, v247
ds_read_b128 a[132:135], v209 offset:24576
v_mfma_f32_32x32x16_bf16 v[96:111], a[140:143], v[60:63], v[96:111]
v_exp_f32 v249, v85
v_cvt_pk_bf16_f32 v113, v246, v247
v_add_f32 v242, v242, v248
ds_read_b128 a[136:139], v210 offset:24576
v_mfma_f32_32x32x16_bf16 v[96:111], a[144:147], v[64:67], v[96:111]
v_exp_f32 v250, v86
v_add_f32 v242, v242, v249
v_cvt_pk_bf16_f32 v114, v248, v249
ds_read_b128 a[140:143], v211 offset:24576
v_mfma_f32_32x32x16_bf16 v[96:111], a[148:151], v[68:71], v[96:111]
v_exp_f32 v251, v87
v_add_f32 v242, v242, v250
ds_read_b128 a[144:147], v212 offset:24576
v_mfma_f32_32x32x16_bf16 v[96:111], a[152:155], v[72:75], v[96:111]
v_exp_f32 v244, v88
v_add_f32 v242, v242, v251
v_cvt_pk_bf16_f32 v115, v250, v251
ds_read_b128 a[148:151], v213 offset:24576
v_mfma_f32_32x32x16_bf16 v[96:111], a[156:159], v[76:79], v[96:111]
v_exp_f32 v245, v89
v_add_f32 v242, v242, v244
ds_read_b128 a[152:155], v214 offset:24576
v_mfma_f32_32x32x16_bf16 a[64:79], a[160:163], v[120:123], a[64:79]
v_exp_f32 v246, v90
v_add_f32 v242, v242, v245
v_cvt_pk_bf16_f32 v116, v244, v245
ds_read_b128 a[156:159], v215 offset:24576
ds_read_b64_tr_b16 a[160:161], v220 offset:16384
v_mfma_f32_32x32x16_bf16 a[64:79], a[164:167], v[124:127], a[64:79]
v_exp_f32 v247, v91
v_add_f32 v242, v242, v246
ds_read_b64_tr_b16 a[164:165], v220 offset:20480
v_mfma_f32_32x32x16_bf16 a[80:95], a[168:171], v[120:123], a[80:95]
v_exp_f32 v248, v92
v_add_f32 v242, v242, v247
v_cvt_pk_bf16_f32 v117, v246, v247
ds_read_b64_tr_b16 a[168:169], v221 offset:16384
v_mfma_f32_32x32x16_bf16 a[80:95], a[172:175], v[124:127], a[80:95]
v_exp_f32 v249, v93
v_add_f32 v242, v242, v248
ds_read_b64_tr_b16 a[172:173], v221 offset:20480
v_mfma_f32_32x32x16_bf16 a[96:111], a[176:179], v[120:123], a[96:111]
v_exp_f32 v250, v94
v_add_f32 v242, v242, v249
v_cvt_pk_bf16_f32 v118, v248, v249
ds_read_b64_tr_b16 a[176:177], v222 offset:16384
v_mfma_f32_32x32x16_bf16 a[96:111], a[180:183], v[124:127], a[96:111]
v_exp_f32 v251, v95
v_add_f32 v242, v242, v250
ds_read_b64_tr_b16 a[180:181], v222 offset:20480
v_mfma_f32_32x32x16_bf16 a[112:127], a[184:187], v[120:123], a[112:127]
v_add_f32 v242, v242, v251
v_cvt_pk_bf16_f32 v119, v250, v251
v_cmp_nge_f32 vcc, s44, v242
ds_read_b64_tr_b16 a[184:185], v223 offset:16384
v_mfma_f32_32x32x16_bf16 a[112:127], a[188:191], v[124:127], a[112:127]
s_cbranch_vccnz L_slow_4
L_back_4:
v_add_f32 v240, v240, v242
ds_read_b64_tr_b16 a[188:189], v223 offset:20480
s_waitcnt lgkmcnt(5)
v_mfma_f32_32x32x16_bf16 v[80:95], a[128:131], v[16:19], v[144:159]
v_exp_f32 v244, v96
v_exp_f32 v245, v97
ds_read_b64_tr_b16 a[162:163], v220 offset:17408
v_mfma_f32_32x32x16_bf16 v[80:95], a[132:135], v[20:23], v[80:95]
v_exp_f32 v246, v98
v_exp_f32 v247, v99
v_add_f32 v243, v244, v245
ds_read_b64_tr_b16 a[166:167], v220 offset:21504
v_mfma_f32_32x32x16_bf16 v[80:95], a[136:139], v[24:27], v[80:95]
v_exp_f32 v248, v100
v_cvt_pk_bf16_f32 v120, v244, v245
v_add_f32 v243, v243, v246
v_add_f32 v243, v243, v247
ds_read_b64_tr_b16 a[170:171], v221 offset:17408
v_mfma_f32_32x32x16_bf16 v[80:95], a[140:143], v[28:31], v[80:95]
v_exp_f32 v249, v101
v_cvt_pk_bf16_f32 v121, v246, v247
v_add_f32 v243, v243, v248
ds_read_b64_tr_b16 a[174:175], v221 offset:21504
v_mfma_f32_32x32x16_bf16 v[80:95], a[144:147], v[32:35], v[80:95]
v_exp_f32 v250, v102
v_add_f32 v243, v243, v249
v_cvt_pk_bf16_f32 v122, v248, v249
ds_read_b64_tr_b16 a[178:179], v222 offset:17408
v_mfma_f32_32x32x16_bf16 v[80:95], a[148:151], v[36:39], v[80:95]
v_exp_f32 v251, v103
v_add_f32 v243, v243, v250
ds_read_b64_tr_b16 a[182:183], v222 offset:21504
v_mfma_f32_32x32x16_bf16 v[80:95], a[152:155], v[40:43], v[80:95]
v_exp_f32 v244, v104
v_add_f32 v243, v243, v251
v_cvt_pk_bf16_f32 v123, v250, v251
ds_read_b64_tr_b16 a[186:187], v223 offset:17408
v_mfma_f32_32x32x16_bf16 v[80:95], a[156:159], v[44:47], v[80:95]
v_exp_f32 v245, v105
v_add_f32 v243, v243, v244
ds_read_b64_tr_b16 a[190:191], v223 offset:21504
s_waitcnt lgkmcnt(5)
v_mfma_f32_32x32x16_bf16 a[0:15], a[160:163], v[112:115], a[0:15]
v_exp_f32 v246, v106
v_add_f32 v243, v243, v245
v_cvt_pk_bf16_f32 v124, v244, v245
s_add_u32 m0, s56, 4096
s_nop 0
buffer_load_dwordx4 v12, s[24:27], s57 offen offset:0 lds
v_mfma_f32_32x32x16_bf16 a[0:15], a[164:167], v[116:119], a[0:15]
v_exp_f32 v247, v107
v_add_f32 v243, v243, v246
v_mfma_f32_32x32x16_bf16 a[16:31], a[168:171], v[112:115], a[16:31]
v_exp_f32 v248, v108
v_add_f32 v243, v243, v247
v_cvt_pk_bf16_f32 v125, v246, v247
s_waitcnt lgkmcnt(2)
v_mfma_f32_32x32x16_bf16 a[16:31], a[172:175], v[116:119], a[16:31]
v_exp_f32 v249, v109
v_add_f32 v243, v243, v248
v_mfma_f32_32x32x16_bf16 a[32:47], a[176:179], v[112:115], a[32:47]
v_exp_f32 v250, v110
v_add_f32 v243, v243, v249
v_cvt_pk_bf16_f32 v126, v248, v249
v_mfma_f32_32x32x16_bf16 a[32:47], a[180:183], v[116:119], a[32:47]
v_exp_f32 v251, v111
v_add_f32 v243, v243, v250
s_waitcnt lgkmcnt(0)
v_mfma_f32_32x32x16_bf16 a[48:63], a[184:187], v[112:115], a[48:63]
v_add_f32 v243, v243, v251
v_cvt_pk_bf16_f32 v127, v250, v251
v_cmp_nge_f32 vcc, s44, v243
v_mfma_f32_32x32x16_bf16 a[48:63], a[188:191], v[116:119], a[48:63]
s_cbranch_vccnz L_slow_5
L_back_5:
v_add_f32 v241, v241, v243
v_mfma_f32_32x32x16_bf16 v[96:111], a[128:131], v[48:51], v[160:175]
s_waitcnt vmcnt(13)
s_barrier
v_exp_f32 v244, v80
v_exp_f32 v245, v81
v_mfma_f32_32x32x16_bf16 v[96:111], a[132:135], v[52:55], v[96:111]
v_exp_f32 v246, v82
v_exp_f32 v247, v83
v_add_f32 v242, v244, v245
ds_read_b128 a[128:131], v208 offset:32768
v_mfma_f32_32x32x16_bf16 v[96:111], a[136:139], v[56:59], v[96:111]
v_exp_f32 v248, v84
v_cvt_pk_bf16_f32 v112, v244, v245
v_add_f32 v242, v242, v246
v_add_f32 v242, v242, v247
ds_read_b128 a[132:135], v209 offset:32768
v_mfma_f32_32x32x16_bf16 v[96:111], a[140:143], v[60:63], v[96:111]
v_exp_f32 v249, v85
v_cvt_pk_bf16_f32 v113, v246, v247
v_add_f32 v242, v242, v248
ds_read_b128 a[136:139], v210 offset:32768
v_mfma_f32_32x32x16_bf16 v[96:111], a[144:147], v[64:67], v[96:111]
v_exp_f32 v250, v86
v_add_f32 v242, v242, v249
v_cvt_pk_bf16_f32 v114, v248, v249
ds_read_b128 a[140:143], v211 offset:32768
v_mfma_f32_32x32x16_bf16 v[96:111], a[148:151], v[68:71], v[96:111]
v_exp_f32 v251, v87
v_add_f32 v242, v242, v250
ds_read_b128 a[144:147], v212 offset:32768
v_mfma_f32_32x32x16_bf16 v[96:111], a[152:155], v[72:75], v[96:111]
v_exp_f32 v244, v88
v_add_f32 v242, v242, v251
v_cvt_pk_bf16_f32 v115, v250, v251
ds_read_b128 a[148:151], v213 offset:32768
v_mfma_f32_32x32x16_bf16 v[96:111], a[156:159], v[76:79], v[96:111]
v_exp_f32 v245, v89
v_add_f32 v242, v242, v244
ds_read_b128 a[152:155], v214 offset:32768
v_mfma_f32_32x32x16_bf16 a[64:79], a[160:163], v[120:123], a[64:79]
v_exp_f32 v246, v90
v_add_f32 v242, v242, v245
v_cvt_pk_bf16_f32 v116, v244, v245
ds_read_b128 a[156:159], v215 offset:32768
ds_read_b64_tr_b16 a[160:161], v220 offset:24576
v_mfma_f32_32x32x16_bf16 a[64:79], a[164:167], v[124:127], a[64:79]
v_exp_f32 v247, v91
v_add_f32 v242, v242, v246
ds_read_b64_tr_b16 a[164:165], v220 offset:28672
v_mfma_f32_32x32x16_bf16 a[80:95], a[168:171], v[120:123], a[80:95]
v_exp_f32 v248, v92
v_add_f32 v242, v242, v247
v_cvt_pk_bf16_f32 v117, v246, v247
ds_read_b64_tr_b16 a[168:169], v221 offset:24576
v_mfma_f32_32x32x16_bf16 a[80:95], a[172:175], v[124:127], a[80:95]
v_exp_f32 v249, v93
v_add_f32 v242, v242, v248
ds_read_b64_tr_b16 a[172:173], v221 offset:28672
v_mfma_f32_32x32x16_bf16 a[96:111], a[176:179], v[120:123], a[96:111]
v_exp_f32 v250, v94
v_add_f32 v242, v242, v249
v_cvt_pk_bf16_f32 v118, v248, v249
ds_read_b64_tr_b16 a[176:177], v222 offset:24576
v_mfma_f32_32x32x16_bf16 a[96:111], a[180:183], v[124:127], a[96:111]
v_exp_f32 v251, v95
v_add_f32 v242, v242, v250
ds_read_b64_tr_b16 a[180:181], v222 offset:28672
v_mfma_f32_32x32x16_bf16 a[112:127], a[184:187], v[120:123], a[112:127]
v_add_f32 v242, v242, v251
v_cvt_pk_bf16_f32 v119, v250, v251
v_cmp_nge_f32 vcc, s44, v242
ds_read_b64_tr_b16 a[184:185], v223 offset:24576
v_mfma_f32_32x32x16_bf16 a[112:127], a[188:191], v[124:127], a[112:127]
s_cbranch_vccnz L_slow_6
L_back_6:
v_add_f32 v240, v240, v242
ds_read_b64_tr_b16 a[188:189], v223 offset:28672
s_waitcnt lgkmcnt(5)
v_mfma_f32_32x32x16_bf16 v[80:95], a[128:131], v[16:19], v[144:159]
v_exp_f32 v244, v96
v_exp_f32 v245, v97
ds_read_b64_tr_b16 a[162:163], v220 offset:25600
v_mfma_f32_32x32x16_bf16 v[80:95], a[132:135], v[20:23], v[80:95]
v_exp_f32 v246, v98
v_exp_f32 v247, v99
v_add_f32 v243, v244, v245
ds_read_b64_tr_b16 a[166:167], v220 offset:29696
v_mfma_f32_32x32x16_bf16 v[80:95], a[136:139], v[24:27], v[80:95]
v_exp_f32 v248, v100
v_cvt_pk_bf16_f32 v120, v244, v245
v_add_f32 v243, v243, v246
v_add_f32 v243, v243, v247
ds_read_b64_tr_b16 a[170:171], v221 offset:25600
v_mfma_f32_32x32x16_bf16 v[80:95], a[140:143], v[28:31], v[80:95]
v_exp_f32 v249, v101
v_cvt_pk_bf16_f32 v121, v246, v247
v_add_f32 v243, v243, v248
ds_read_b64_tr_b16 a[174:175], v221 offset:29696
v_mfma_f32_32x32x16_bf16 v[80:95], a[144:147], v[32:35], v[80:95]
v_exp_f32 v250, v102
v_add_f32 v243, v243, v249
v_cvt_pk_bf16_f32 v122, v248, v249
ds_read_b64_tr_b16 a[178:179], v222 offset:25600
v_mfma_f32_32x32x16_bf16 v[80:95], a[148:151], v[36:39], v[80:95]
v_exp_f32 v251, v103
v_add_f32 v243, v243, v250
ds_read_b64_tr_b16 a[182:183], v222 offset:29696
v_mfma_f32_32x32x16_bf16 v[80:95], a[152:155], v[40:43], v[80:95]
v_exp_f32 v244, v104
v_add_f32 v243, v243, v251
v_cvt_pk_bf16_f32 v123, v250, v251
ds_read_b64_tr_b16 a[186:187], v223 offset:25600
v_mfma_f32_32x32x16_bf16 v[80:95], a[156:159], v[44:47], v[80:95]
v_exp_f32 v245, v105
v_add_f32 v243, v243, v244
ds_read_b64_tr_b16 a[190:191], v223 offset:29696
s_waitcnt lgkmcnt(5)
v_mfma_f32_32x32x16_bf16 a[0:15], a[160:163], v[112:115], a[0:15]
v_exp_f32 v246, v106
v_add_f32 v243, v243, v245
v_cvt_pk_bf16_f32 v124, v244, v245
s_add_u32 m0, s29, 16384
s_add_u32 s31, s32, 81920
buffer_load_dwordx4 v228, s[12:15], s31 offen offset:0 lds
v_mfma_f32_32x32x16_bf16 a[0:15], a[164:167], v[116:119], a[0:15]
v_exp_f32 v247, v107
v_add_f32 v243, v243, v246
buffer_load_dwordx4 v229, s[12:15], s31 offen offset:1024 lds
v_mfma_f32_32x32x16_bf16 a[16:31], a[168:171], v[112:115], a[16:31]
v_exp_f32 v248, v108
v_add_f32 v243, v243, v247
v_cvt_pk_bf16_f32 v125, v246, v247
buffer_load_dwordx4 v230, s[12:15], s31 offen offset:2048 lds
s_waitcnt lgkmcnt(2)
v_mfma_f32_32x32x16_bf16 a[16:31], a[172:175], v[116:119], a[16:31]
v_exp_f32 v249, v109
v_add_f32 v243, v243, v248
buffer_load_dwordx4 v231, s[12:15], s31 offen offset:3072 lds
v_mfma_f32_32x32x16_bf16 a[32:47], a[176:179], v[112:115], a[32:47]
v_exp_f32 v250, v110
v_add_f32 v243, v243, v249
v_cvt_pk_bf16_f32 v126, v248, v249
s_add_u32 m0, s29, 65536
s_add_u32 s31, s32, 65536
buffer_load_dwordx4 v232, s[16:19], s31 offen offset:0 lds
v_mfma_f32_32x32x16_bf16 a[32:47], a[180:183], v[116:119], a[32:47]
v_exp_f32 v251, v111
v_add_f32 v243, v243, v250
buffer_load_dwordx4 v232, s[16:19], s31 offen offset:1024 lds
s_waitcnt lgkmcnt(0)
v_mfma_f32_32x32x16_bf16 a[48:63], a[184:187], v[112:115], a[48:63]
v_add_f32 v243, v243, v251
v_cvt_pk_bf16_f32 v127, v250, v251
v_cmp_nge_f32 vcc, s44, v243
buffer_load_dwordx4 v232, s[16:19], s31 offen offset:2048 lds
v_mfma_f32_32x32x16_bf16 a[48:63], a[188:191], v[116:119], a[48:63]
s_cbranch_vccnz L_slow_7
L_back_7:
v_add_f32 v241, v241, v243
buffer_load_dwordx4 v232, s[16:19], s31 offen offset:3072 lds
v_mfma_f32_32x32x16_bf16 v[96:111], a[128:131], v[48:51], v[160:175]
v_exp_f32 v244, v80
v_exp_f32 v245, v81
v_mfma_f32_32x32x16_bf16 v[96:111], a[132:135], v[52:55], v[96:111]
v_exp_f32 v246, v82
v_exp_f32 v247, v83
v_add_f32 v242, v244, v245
ds_read_b128 a[128:131], v208 offset:40960
v_mfma_f32_32x32x16_bf16 v[96:111], a[136:139], v[56:59], v[96:111]
v_exp_f32 v248, v84
v_cvt_pk_bf16_f32 v112, v244, v245
v_add_f32 v242, v242, v246
v_add_f32 v242, v242, v247
ds_read_b128 a[132:135], v209 offset:40960
v_mfma_f32_32x32x16_bf16 v[96:111], a[140:143], v[60:63], v[96:111]
v_exp_f32 v249, v85
v_cvt_pk_bf16_f32 v113, v246, v247
v_add_f32 v242, v242, v248
ds_read_b128 a[136:139], v210 offset:40960
v_mfma_f32_32x32x16_bf16 v[96:111], a[144:147], v[64:67], v[96:111]
v_exp_f32 v250, v86
v_add_f32 v242, v242, v249
v_cvt_pk_bf16_f32 v114, v248, v249
ds_read_b128 a[140:143], v211 offset:40960
v_mfma_f32_32x32x16_bf16 v[96:111], a[148:151], v[68:71], v[96:111]
v_exp_f32 v251, v87
v_add_f32 v242, v242, v250
ds_read_b128 a[144:147], v212 offset:40960
v_mfma_f32_32x32x16_bf16 v[96:111], a[152:155], v[72:75], v[96:111]
v_exp_f32 v244, v88
v_add_f32 v242, v242, v251
v_cvt_pk_bf16_f32 v115, v250, v251
ds_read_b128 a[148:151], v213 offset:40960
v_mfma_f32_32x32x16_bf16 v[96:111], a[156:159], v[76:79], v[96:111]
v_exp_f32 v245, v89
v_add_f32 v242, v242, v244
ds_read_b128 a[152:155], v214 offset:40960
v_mfma_f32_32x32x16_bf16 a[64:79], a[160:163], v[120:123], a[64:79]
v_exp_f32 v246, v90
v_add_f32 v242, v242, v245
v_cvt_pk_bf16_f32 v116, v244, v245
ds_read_b128 a[156:159], v215 offset:40960
ds_read_b64_tr_b16 a[160:161], v220 offset:32768
v_mfma_f32_32x32x16_bf16 a[64:79], a[164:167], v[124:127], a[64:79]
v_exp_f32 v247, v91
v_add_f32 v242, v242, v246
ds_read_b64_tr_b16 a[164:165], v220 offset:36864
v_mfma_f32_32x32x16_bf16 a[80:95], a[168:171], v[120:123], a[80:95]
v_exp_f32 v248, v92
v_add_f32 v242, v242, v247
v_cvt_pk_bf16_f32 v117, v246, v247
ds_read_b64_tr_b16 a[168:169], v221 offset:32768
v_mfma_f32_32x32x16_bf16 a[80:95], a[172:175], v[124:127], a[80:95]
v_exp_f32 v249, v93
v_add_f32 v242, v242, v248
ds_read_b64_tr_b16 a[172:173], v221 offset:36864
v_mfma_f32_32x32x16_bf16 a[96:111], a[176:179], v[120:123], a[96:111]
v_exp_f32 v250, v94
v_add_f32 v242, v242, v249
v_cvt_pk_bf16_f32 v118, v248, v249
ds_read_b64_tr_b16 a[176:177], v222 offset:32768
v_mfma_f32_32x32x16_bf16 a[96:111], a[180:183], v[124:127], a[96:111]
v_exp_f32 v251, v95
v_add_f32 v242, v242, v250
ds_read_b64_tr_b16 a[180:181], v222 offset:36864
v_mfma_f32_32x32x16_bf16 a[112:127], a[184:187], v[120:123], a[112:127]
v_add_f32 v242, v242, v251
v_cvt_pk_bf16_f32 v119, v250, v251
v_cmp_nge_f32 vcc, s44, v242
ds_read_b64_tr_b16 a[184:185], v223 offset:32768
v_mfma_f32_32x32x16_bf16 a[112:127], a[188:191], v[124:127], a[112:127]
s_cbranch_vccnz L_slow_8
L_back_8:
v_add_f32 v240, v240, v242
ds_read_b64_tr_b16 a[188:189], v223 offset:36864
s_waitcnt lgkmcnt(5)
v_mfma_f32_32x32x16_bf16 v[80:95], a[128:131], v[16:19], v[144:159]
v_exp_f32 v244, v96
v_exp_f32 v245, v97
ds_read_b64_tr_b16 a[162:163], v220 offset:33792
v_mfma_f32_32x32x16_bf16 v[80:95], a[132:135], v[20:23], v[80:95]
v_exp_f32 v246, v98
v_exp_f32 v247, v99
v_add_f32 v243, v244, v245
ds_read_b64_tr_b16 a[166:167], v220 offset:37888
v_mfma_f32_32x32x16_bf16 v[80:95], a[136:139], v[24:27], v[80:95]
v_exp_f32 v248, v100
v_cvt_pk_bf16_f32 v120, v244, v245
v_add_f32 v243, v243, v246
v_add_f32 v243, v243, v247
ds_read_b64_tr_b16 a[170:171], v221 offset:33792
v_mfma_f32_32x32x16_bf16 v[80:95], a[140:143], v[28:31], v[80:95]
v_exp_f32 v249, v101
v_cvt_pk_bf16_f32 v121, v246, v247
v_add_f32 v243, v243, v248
ds_read_b64_tr_b16 a[174:175], v221 offset:37888
v_mfma_f32_32x32x16_bf16 v[80:95], a[144:147], v[32:35], v[80:95]
v_exp_f32 v250, v102
v_add_f32 v243, v243, v249
v_cvt_pk_bf16_f32 v122, v248, v249
ds_read_b64_tr_b16 a[178:179], v222 offset:33792
v_mfma_f32_32x32x16_bf16 v[80:95], a[148:151], v[36:39], v[80:95]
v_exp_f32 v251, v103
v_add_f32 v243, v243, v250
ds_read_b64_tr_b16 a[182:183], v222 offset:37888
v_mfma_f32_32x32x16_bf16 v[80:95], a[152:155], v[40:43], v[80:95]
v_exp_f32 v244, v104
v_add_f32 v243, v243, v251
v_cvt_pk_bf16_f32 v123, v250, v251
ds_read_b64_tr_b16 a[186:187], v223 offset:33792
v_mfma_f32_32x32x16_bf16 v[80:95], a[156:159], v[44:47], v[80:95]
v_exp_f32 v245, v105
v_add_f32 v243, v243, v244
ds_read_b64_tr_b16 a[190:191], v223 offset:37888
s_waitcnt lgkmcnt(5)
v_mfma_f32_32x32x16_bf16 a[0:15], a[160:163], v[112:115], a[0:15]
v_exp_f32 v246, v106
v_add_f32 v243, v243, v245
v_cvt_pk_bf16_f32 v124, v244, v245
v_mfma_f32_32x32x16_bf16 a[0:15], a[164:167], v[116:119], a[0:15]
v_exp_f32 v247, v107
v_add_f32 v243, v243, v246
v_mfma_f32_32x32x16_bf16 a[16:31], a[168:171], v[112:115], a[16:31]
v_exp_f32 v248, v108
v_add_f32 v243, v243, v247
v_cvt_pk_bf16_f32 v125, v246, v247
s_waitcnt lgkmcnt(2)
v_mfma_f32_32x32x16_bf16 a[16:31], a[172:175], v[116:119], a[16:31]
v_exp_f32 v249, v109
v_add_f32 v243, v243, v248
v_mfma_f32_32x32x16_bf16 a[32:47], a[176:179], v[112:115], a[32:47]
v_exp_f32 v250, v110
v_add_f32 v243, v243, v249
v_cvt_pk_bf16_f32 v126, v248, v249
v_mfma_f32_32x32x16_bf16 a[32:47], a[180:183], v[116:119], a[32:47]
v_exp_f32 v251, v111
v_add_f32 v243, v243, v250
s_waitcnt lgkmcnt(0)
v_mfma_f32_32x32x16_bf16 a[48:63], a[184:187], v[112:115], a[48:63]
v_add_f32 v243, v243, v251
v_cvt_pk_bf16_f32 v127, v250, v251
v_cmp_nge_f32 vcc, s44, v243
v_mfma_f32_32x32x16_bf16 a[48:63], a[188:191], v[116:119], a[48:63]
s_cbranch_vccnz L_slow_9
L_back_9:
v_add_f32 v241, v241, v243
v_mfma_f32_32x32x16_bf16 v[96:111], a[128:131], v[48:51], v[160:175]
s_waitcnt vmcnt(17)
s_barrier
v_exp_f32 v244, v80
v_exp_f32 v245, v81
v_mfma_f32_32x32x16_bf16 v[96:111], a[132:135], v[52:55], v[96:111]
v_exp_f32 v246, v82
v_exp_f32 v247, v83
v_add_f32 v242, v244, v245
ds_read_b128 a[128:131], v208 offset:49152
v_mfma_f32_32x32x16_bf16 v[96:111], a[136:139], v[56:59], v[96:111]
v_exp_f32 v248, v84
v_cvt_pk_bf16_f32 v112, v244, v245
v_add_f32 v242, v242, v246
v_add_f32 v242, v242, v247
ds_read_b128 a[132:135], v209 offset:49152
v_mfma_f32_32x32x16_bf16 v[96:111], a[140:143], v[60:63], v[96:111]
v_exp_f32 v249, v85
v_cvt_pk_bf16_f32 v113, v246, v247
v_add_f32 v242, v242, v248
ds_read_b128 a[136:139], v210 offset:49152
v_mfma_f32_32x32x16_bf16 v[96:111], a[144:147], v[64:67], v[96:111]
v_exp_f32 v250, v86
v_add_f32 v242, v242, v249
v_cvt_pk_bf16_f32 v114, v248, v249
ds_read_b128 a[140:143], v211 offset:49152
v_mfma_f32_32x32x16_bf16 v[96:111], a[148:151], v[68:71], v[96:111]
v_exp_f32 v251, v87
v_add_f32 v242, v242, v250
ds_read_b128 a[144:147], v212 offset:49152
v_mfma_f32_32x32x16_bf16 v[96:111], a[152:155], v[72:75], v[96:111]
v_exp_f32 v244, v88
v_add_f32 v242, v242, v251
v_cvt_pk_bf16_f32 v115, v250, v251
ds_read_b128 a[148:151], v213 offset:49152
v_mfma_f32_32x32x16_bf16 v[96:111], a[156:159], v[76:79], v[96:111]
v_exp_f32 v245, v89
v_add_f32 v242, v242, v244
ds_read_b128 a[152:155], v214 offset:49152
v_mfma_f32_32x32x16_bf16 a[64:79], a[160:163], v[120:123], a[64:79]
v_exp_f32 v246, v90
v_add_f32 v242, v242, v245
v_cvt_pk_bf16_f32 v116, v244, v245
ds_read_b128 a[156:159], v215 offset:49152
ds_read_b64_tr_b16 a[160:161], v220 offset:40960
v_mfma_f32_32x32x16_bf16 a[64:79], a[164:167], v[124:127], a[64:79]
v_exp_f32 v247, v91
v_add_f32 v242, v242, v246
ds_read_b64_tr_b16 a[164:165], v220 offset:45056
v_mfma_f32_32x32x16_bf16 a[80:95], a[168:171], v[120:123], a[80:95]
v_exp_f32 v248, v92
v_add_f32 v242, v242, v247
v_cvt_pk_bf16_f32 v117, v246, v247
ds_read_b64_tr_b16 a[168:169], v221 offset:40960
v_mfma_f32_32x32x16_bf16 a[80:95], a[172:175], v[124:127], a[80:95]
v_exp_f32 v249, v93
v_add_f32 v242, v242, v248
ds_read_b64_tr_b16 a[172:173], v221 offset:45056
v_mfma_f32_32x32x16_bf16 a[96:111], a[176:179], v[120:123], a[96:111]
v_exp_f32 v250, v94
v_add_f32 v242, v242, v249
v_cvt_pk_bf16_f32 v118, v248, v249
ds_read_b64_tr_b16 a[176:177], v222 offset:40960
v_mfma_f32_32x32x16_bf16 a[96:111], a[180:183], v[124:127], a[96:111]
v_exp_f32 v251, v95
v_add_f32 v242, v242, v250
ds_read_b64_tr_b16 a[180:181], v222 offset:45056
v_mfma_f32_32x32x16_bf16 a[112:127], a[184:187], v[120:123], a[112:127]
v_add_f32 v242, v242, v251
v_cvt_pk_bf16_f32 v119, v250, v251
v_cmp_nge_f32 vcc, s44, v242
ds_read_b64_tr_b16 a[184:185], v223 offset:40960
v_mfma_f32_32x32x16_bf16 a[112:127], a[188:191], v[124:127], a[112:127]
s_cbranch_vccnz L_slow_10
L_back_10:
v_add_f32 v240, v240, v242
ds_read_b64_tr_b16 a[188:189], v223 offset:45056
s_waitcnt lgkmcnt(5)
v_mfma_f32_32x32x16_bf16 v[80:95], a[128:131], v[16:19], v[144:159]
v_exp_f32 v244, v96
v_exp_f32 v245, v97
ds_read_b64_tr_b16 a[162:163], v220 offset:41984
v_mfma_f32_32x32x16_bf16 v[80:95], a[132:135], v[20:23], v[80:95]
v_exp_f32 v246, v98
v_exp_f32 v247, v99
v_add_f32 v243, v244, v245
ds_read_b64_tr_b16 a[166:167], v220 offset:46080
v_mfma_f32_32x32x16_bf16 v[80:95], a[136:139], v[24:27], v[80:95]
v_exp_f32 v248, v100
v_cvt_pk_bf16_f32 v120, v244, v245
v_add_f32 v243, v243, v246
v_add_f32 v243, v243, v247
ds_read_b64_tr_b16 a[170:171], v221 offset:41984
v_mfma_f32_32x32x16_bf16 v[80:95], a[140:143], v[28:31], v[80:95]
v_exp_f32 v249, v101
v_cvt_pk_bf16_f32 v121, v246, v247
v_add_f32 v243, v243, v248
ds_read_b64_tr_b16 a[174:175], v221 offset:46080
v_mfma_f32_32x32x16_bf16 v[80:95], a[144:147], v[32:35], v[80:95]
v_exp_f32 v250, v102
v_add_f32 v243, v243, v249
v_cvt_pk_bf16_f32 v122, v248, v249
ds_read_b64_tr_b16 a[178:179], v222 offset:41984
v_mfma_f32_32x32x16_bf16 v[80:95], a[148:151], v[36:39], v[80:95]
v_exp_f32 v251, v103
v_add_f32 v243, v243, v250
ds_read_b64_tr_b16 a[182:183], v222 offset:46080
v_mfma_f32_32x32x16_bf16 v[80:95], a[152:155], v[40:43], v[80:95]
v_exp_f32 v244, v104
v_add_f32 v243, v243, v251
v_cvt_pk_bf16_f32 v123, v250, v251
ds_read_b64_tr_b16 a[186:187], v223 offset:41984
v_mfma_f32_32x32x16_bf16 v[80:95], a[156:159], v[44:47], v[80:95]
v_exp_f32 v245, v105
v_add_f32 v243, v243, v244
ds_read_b64_tr_b16 a[190:191], v223 offset:46080
s_waitcnt lgkmcnt(5)
v_mfma_f32_32x32x16_bf16 a[0:15], a[160:163], v[112:115], a[0:15]
v_exp_f32 v246, v106
v_add_f32 v243, v243, v245
v_cvt_pk_bf16_f32 v124, v244, v245
s_add_u32 m0, s29, 32768
s_add_u32 s31, s32, 98304
buffer_load_dwordx4 v228, s[12:15], s31 offen offset:0 lds
v_mfma_f32_32x32x16_bf16 a[0:15], a[164:167], v[116:119], a[0:15]
v_exp_f32 v247, v107
v_add_f32 v243, v243, v246
buffer_load_dwordx4 v229, s[12:15], s31 offen offset:1024 lds
v_mfma_f32_32x32x16_bf16 a[16:31], a[168:171], v[112:115], a[16:31]
v_exp_f32 v248, v108
v_add_f32 v243, v243, v247
v_cvt_pk_bf16_f32 v125, v246, v247
buffer_load_dwordx4 v230, s[12:15], s31 offen offset:2048 lds
s_waitcnt lgkmcnt(2)
v_mfma_f32_32x32x16_bf16 a[16:31], a[172:175], v[116:119], a[16:31]
v_exp_f32 v249, v109
v_add_f32 v243, v243, v248
buffer_load_dwordx4 v231, s[12:15], s31 offen offset:3072 lds
v_mfma_f32_32x32x16_bf16 a[32:47], a[176:179], v[112:115], a[32:47]
v_exp_f32 v250, v110
v_add_f32 v243, v243, v249
v_cvt_pk_bf16_f32 v126, v248, v249
s_add_u32 m0, s29, 81920
s_add_u32 s31, s32, 81920
buffer_load_dwordx4 v232, s[16:19], s31 offen offset:0 lds
v_mfma_f32_32x32x16_bf16 a[32:47], a[180:183], v[116:119], a[32:47]
v_exp_f32 v251, v111
v_add_f32 v243, v243, v250
buffer_load_dwordx4 v232, s[16:19], s31 offen offset:1024 lds
s_waitcnt lgkmcnt(0)
v_mfma_f32_32x32x16_bf16 a[48:63], a[184:187], v[112:115], a[48:63]
v_add_f32 v243, v243, v251
v_cvt_pk_bf16_f32 v127, v250, v251
v_cmp_nge_f32 vcc, s44, v243
buffer_load_dwordx4 v232, s[16:19], s31 offen offset:2048 lds
v_mfma_f32_32x32x16_bf16 a[48:63], a[188:191], v[116:119], a[48:63]
s_cbranch_vccnz L_slow_11
L_back_11:
v_add_f32 v241, v241, v243
buffer_load_dwordx4 v232, s[16:19], s31 offen offset:3072 lds
v_mfma_f32_32x32x16_bf16 v[96:111], a[128:131], v[48:51], v[160:175]
v_exp_f32 v244, v80
v_exp_f32 v245, v81
v_mfma_f32_32x32x16_bf16 v[96:111], a[132:135], v[52:55], v[96:111]
v_exp_f32 v246, v82
v_exp_f32 v247, v83
v_add_f32 v242, v244, v245
ds_read_b128 a[128:131], v208 offset:57344
v_mfma_f32_32x32x16_bf16 v[96:111], a[136:139], v[56:59], v[96:111]
v_exp_f32 v248, v84
v_cvt_pk_bf16_f32 v112, v244, v245
v_add_f32 v242, v242, v246
v_add_f32 v242, v242, v247
ds_read_b128 a[132:135], v209 offset:57344
v_mfma_f32_32x32x16_bf16 v[96:111], a[140:143], v[60:63], v[96:111]
v_exp_f32 v249, v85
v_cvt_pk_bf16_f32 v113, v246, v247
v_add_f32 v242, v242, v248
ds_read_b128 a[136:139], v210 offset:57344
v_mfma_f32_32x32x16_bf16 v[96:111], a[144:147], v[64:67], v[96:111]
v_exp_f32 v250, v86
v_add_f32 v242, v242, v249
v_cvt_pk_bf16_f32 v114, v248, v249
ds_read_b128 a[140:143], v211 offset:57344
v_mfma_f32_32x32x16_bf16 v[96:111], a[148:151], v[68:71], v[96:111]
v_exp_f32 v251, v87
v_add_f32 v242, v242, v250
ds_read_b128 a[144:147], v212 offset:57344
v_mfma_f32_32x32x16_bf16 v[96:111], a[152:155], v[72:75], v[96:111]
v_exp_f32 v244, v88
v_add_f32 v242, v242, v251
v_cvt_pk_bf16_f32 v115, v250, v251
ds_read_b128 a[148:151], v213 offset:57344
v_mfma_f32_32x32x16_bf16 v[96:111], a[156:159], v[76:79], v[96:111]
v_exp_f32 v245, v89
v_add_f32 v242, v242, v244
ds_read_b128 a[152:155], v214 offset:57344
v_mfma_f32_32x32x16_bf16 a[64:79], a[160:163], v[120:123], a[64:79]
v_exp_f32 v246, v90
v_add_f32 v242, v242, v245
v_cvt_pk_bf16_f32 v116, v244, v245
ds_read_b128 a[156:159], v215 offset:57344
ds_read_b64_tr_b16 a[160:161], v220 offset:49152
v_mfma_f32_32x32x16_bf16 a[64:79], a[164:167], v[124:127], a[64:79]
v_exp_f32 v247, v91
v_add_f32 v242, v242, v246
ds_read_b64_tr_b16 a[164:165], v220 offset:53248
v_mfma_f32_32x32x16_bf16 a[80:95], a[168:171], v[120:123], a[80:95]
v_exp_f32 v248, v92
v_add_f32 v242, v242, v247
v_cvt_pk_bf16_f32 v117, v246, v247
ds_read_b64_tr_b16 a[168:169], v221 offset:49152
v_mfma_f32_32x32x16_bf16 a[80:95], a[172:175], v[124:127], a[80:95]
v_exp_f32 v249, v93
v_add_f32 v242, v242, v248
ds_read_b64_tr_b16 a[172:173], v221 offset:53248
v_mfma_f32_32x32x16_bf16 a[96:111], a[176:179], v[120:123], a[96:111]
v_exp_f32 v250, v94
v_add_f32 v242, v242, v249
v_cvt_pk_bf16_f32 v118, v248, v249
ds_read_b64_tr_b16 a[176:177], v222 offset:49152
v_mfma_f32_32x32x16_bf16 a[96:111], a[180:183], v[124:127], a[96:111]
v_exp_f32 v251, v95
v_add_f32 v242, v242, v250
ds_read_b64_tr_b16 a[180:181], v222 offset:53248
v_mfma_f32_32x32x16_bf16 a[112:127], a[184:187], v[120:123], a[112:127]
v_add_f32 v242, v242, v251
v_cvt_pk_bf16_f32 v119, v250, v251
v_cmp_nge_f32 vcc, s44, v242
ds_read_b64_tr_b16 a[184:185], v223 offset:49152
v_mfma_f32_32x32x16_bf16 a[112:127], a[188:191], v[124:127], a[112:127]
s_cbranch_vccnz L_slow_12
L_back_12:
v_add_f32 v240, v240, v242
ds_read_b64_tr_b16 a[188:189], v223 offset:53248
s_waitcnt lgkmcnt(5)
v_mfma_f32_32x32x16_bf16 v[80:95], a[128:131], v[16:19], v[144:159]
v_exp_f32 v244, v96
v_exp_f32 v245, v97
ds_read_b64_tr_b16 a[162:163], v220 offset:50176
v_mfma_f32_32x32x16_bf16 v[80:95], a[132:135], v[20:23], v[80:95]
v_exp_f32 v246, v98
v_exp_f32 v247, v99
v_add_f32 v243, v244, v245
ds_read_b64_tr_b16 a[166:167], v220 offset:54272
v_mfma_f32_32x32x16_bf16 v[80:95], a[136:139], v[24:27], v[80:95]
v_exp_f32 v248, v100
v_cvt_pk_bf16_f32 v120, v244, v245
v_add_f32 v243, v243, v246
v_add_f32 v243, v243, v247
ds_read_b64_tr_b16 a[170:171], v221 offset:50176
v_mfma_f32_32x32x16_bf16 v[80:95], a[140:143], v[28:31], v[80:95]
v_exp_f32 v249, v101
v_cvt_pk_bf16_f32 v121, v246, v247
v_add_f32 v243, v243, v248
ds_read_b64_tr_b16 a[174:175], v221 offset:54272
v_mfma_f32_32x32x16_bf16 v[80:95], a[144:147], v[32:35], v[80:95]
v_exp_f32 v250, v102
v_add_f32 v243, v243, v249
v_cvt_pk_bf16_f32 v122, v248, v249
ds_read_b64_tr_b16 a[178:179], v222 offset:50176
v_mfma_f32_32x32x16_bf16 v[80:95], a[148:151], v[36:39], v[80:95]
v_exp_f32 v251, v103
v_add_f32 v243, v243, v250
ds_read_b64_tr_b16 a[182:183], v222 offset:54272
v_mfma_f32_32x32x16_bf16 v[80:95], a[152:155], v[40:43], v[80:95]
v_exp_f32 v244, v104
v_add_f32 v243, v243, v251
v_cvt_pk_bf16_f32 v123, v250, v251
ds_read_b64_tr_b16 a[186:187], v223 offset:50176
v_mfma_f32_32x32x16_bf16 v[80:95], a[156:159], v[44:47], v[80:95]
v_exp_f32 v245, v105
v_add_f32 v243, v243, v244
ds_read_b64_tr_b16 a[190:191], v223 offset:54272
s_waitcnt lgkmcnt(5)
v_mfma_f32_32x32x16_bf16 a[0:15], a[160:163], v[112:115], a[0:15]
v_exp_f32 v246, v106
v_add_f32 v243, v243, v245
v_cvt_pk_bf16_f32 v124, v244, v245
s_waitcnt vmcnt(16)
ds_read_b64_tr_b16 a[192:193], v13 offset:0
v_mfma_f32_32x32x16_bf16 a[0:15], a[164:167], v[116:119], a[0:15]
v_exp_f32 v247, v107
v_add_f32 v243, v243, v246
ds_read_b64_tr_b16 a[194:195], v13 offset:1280
v_mfma_f32_32x32x16_bf16 a[16:31], a[168:171], v[112:115], a[16:31]
v_exp_f32 v248, v108
v_add_f32 v243, v243, v247
v_cvt_pk_bf16_f32 v125, v246, v247
ds_read_b64_tr_b16 a[196:197], v13 offset:32
ds_read_b64_tr_b16 a[198:199], v13 offset:1312
s_waitcnt lgkmcnt(6)
v_mfma_f32_32x32x16_bf16 a[16:31], a[172:175], v[116:119], a[16:31]
v_exp_f32 v249, v109
v_add_f32 v243, v243, v248
ds_read_b64_tr_b16 a[200:201], v13 offset:64
v_mfma_f32_32x32x16_bf16 a[32:47], a[176:179], v[112:115], a[32:47]
v_exp_f32 v250, v110
v_add_f32 v243, v243, v249
v_cvt_pk_bf16_f32 v126, v248, v249
ds_read_b64_tr_b16 a[202:203], v13 offset:1344
v_mfma_f32_32x32x16_bf16 a[32:47], a[180:183], v[116:119], a[32:47]
v_exp_f32 v251, v111
v_add_f32 v243, v243, v250
ds_read_b64_tr_b16 a[204:205], v13 offset:96
ds_read_b64_tr_b16 a[206:207], v13 offset:1376
s_waitcnt lgkmcnt(7)
v_mfma_f32_32x32x16_bf16 a[48:63], a[184:187], v[112:115], a[48:63]
v_add_f32 v243, v243, v251
v_cvt_pk_bf16_f32 v127, v250, v251
v_cmp_nge_f32 vcc, s44, v243
ds_read_b64_tr_b16 a[208:209], v13 offset:128
v_mfma_f32_32x32x16_bf16 a[48:63], a[188:191], v[116:119], a[48:63]
s_cbranch_vccnz L_slow_13
L_back_13:
v_add_f32 v241, v241, v243
ds_read_b64_tr_b16 a[210:211], v13 offset:1408
v_mfma_f32_32x32x16_bf16 v[96:111], a[128:131], v[48:51], v[160:175]
s_waitcnt vmcnt(8)
s_barrier
v_exp_f32 v244, v80
v_exp_f32 v245, v81
v_mfma_f32_32x32x16_bf16 v[96:111], a[132:135], v[52:55], v[96:111]
v_exp_f32 v246, v82
v_exp_f32 v247, v83
v_add_f32 v242, v244, v245
ds_read_b128 a[128:131], v208 offset:0
v_mfma_f32_32x32x16_bf16 v[96:111], a[136:139], v[56:59], v[96:111]
v_exp_f32 v248, v84
v_cvt_pk_bf16_f32 v112, v244, v245
v_add_f32 v242, v242, v246
v_add_f32 v242, v242, v247
ds_read_b128 a[132:135], v209 offset:0
v_mfma_f32_32x32x16_bf16 v[96:111], a[140:143], v[60:63], v[96:111]
v_exp_f32 v249, v85
v_cvt_pk_bf16_f32 v113, v246, v247
v_add_f32 v242, v242, v248
ds_read_b128 a[136:139], v210 offset:0
v_mfma_f32_32x32x16_bf16 v[96:111], a[144:147], v[64:67], v[96:111]
v_exp_f32 v250, v86
v_add_f32 v242, v242, v249
v_cvt_pk_bf16_f32 v114, v248, v249
ds_read_b128 a[140:143], v211 offset:0
v_mfma_f32_32x32x16_bf16 v[96:111], a[148:151], v[68:71], v[96:111]
v_exp_f32 v251, v87
v_add_f32 v242, v242, v250
ds_read_b128 a[144:147], v212 offset:0
v_mfma_f32_32x32x16_bf16 v[96:111], a[152:155], v[72:75], v[96:111]
v_exp_f32 v244, v88
v_add_f32 v242, v242, v251
v_cvt_pk_bf16_f32 v115, v250, v251
ds_read_b128 a[148:151], v213 offset:0
v_mfma_f32_32x32x16_bf16 v[96:111], a[156:159], v[76:79], v[96:111]
v_exp_f32 v245, v89
v_add_f32 v242, v242, v244
ds_read_b128 a[152:155], v214 offset:0
v_mfma_f32_32x32x16_bf16 a[64:79], a[160:163], v[120:123], a[64:79]
v_exp_f32 v246, v90
v_add_f32 v242, v242, v245
v_cvt_pk_bf16_f32 v116, v244, v245
ds_read_b128 a[156:159], v215 offset:0
ds_read_b64_tr_b16 a[160:161], v220 offset:57344
v_mfma_f32_32x32x16_bf16 a[64:79], a[164:167], v[124:127], a[64:79]
v_exp_f32 v247, v91
v_add_f32 v242, v242, v246
ds_read_b64_tr_b16 a[164:165], v220 offset:61440
v_mfma_f32_32x32x16_bf16 a[80:95], a[168:171], v[120:123], a[80:95]
v_exp_f32 v248, v92
v_add_f32 v242, v242, v247
v_cvt_pk_bf16_f32 v117, v246, v247
ds_read_b64_tr_b16 a[168:169], v221 offset:57344
v_mfma_f32_32x32x16_bf16 a[80:95], a[172:175], v[124:127], a[80:95]
v_exp_f32 v249, v93
v_add_f32 v242, v242, v248
ds_read_b64_tr_b16 a[172:173], v221 offset:61440
v_mfma_f32_32x32x16_bf16 a[96:111], a[176:179], v[120:123], a[96:111]
v_exp_f32 v250, v94
v_add_f32 v242, v242, v249
v_cvt_pk_bf16_f32 v118, v248, v249
ds_read_b64_tr_b16 a[176:177], v222 offset:57344
v_mfma_f32_32x32x16_bf16 a[96:111], a[180:183], v[124:127], a[96:111]
v_exp_f32 v251, v95
v_add_f32 v242, v242, v250
ds_read_b64_tr_b16 a[180:181], v222 offset:61440
v_mfma_f32_32x32x16_bf16 a[112:127], a[184:187], v[120:123], a[112:127]
v_add_f32 v242, v242, v251
v_cvt_pk_bf16_f32 v119, v250, v251
v_cmp_nge_f32 vcc, s44, v242
ds_read_b64_tr_b16 a[184:185], v223 offset:57344
v_mfma_f32_32x32x16_bf16 a[112:127], a[188:191], v[124:127], a[112:127]
s_cbranch_vccnz L_slow_14
L_back_14:
v_add_f32 v240, v240, v242
ds_read_b64_tr_b16 a[188:189], v223 offset:61440
s_waitcnt lgkmcnt(5)
v_mfma_f32_32x32x16_bf16 v[80:95], a[128:131], v[16:19], v[144:159]
v_exp_f32 v244, v96
v_exp_f32 v245, v97
ds_read_b64_tr_b16 a[162:163], v220 offset:58368
v_mfma_f32_32x32x16_bf16 v[80:95], a[132:135], v[20:23], v[80:95]
v_exp_f32 v246, v98
v_exp_f32 v247, v99
v_add_f32 v243, v244, v245
ds_read_b64_tr_b16 a[166:167], v220 offset:62464
v_mfma_f32_32x32x16_bf16 v[80:95], a[136:139], v[24:27], v[80:95]
v_exp_f32 v248, v100
v_cvt_pk_bf16_f32 v120, v244, v245
v_add_f32 v243, v243, v246
v_add_f32 v243, v243, v247
ds_read_b64_tr_b16 a[170:171], v221 offset:58368
v_mfma_f32_32x32x16_bf16 v[80:95], a[140:143], v[28:31], v[80:95]
v_exp_f32 v249, v101
v_cvt_pk_bf16_f32 v121, v246, v247
v_add_f32 v243, v243, v248
ds_read_b64_tr_b16 a[174:175], v221 offset:62464
v_mfma_f32_32x32x16_bf16 v[80:95], a[144:147], v[32:35], v[80:95]
v_exp_f32 v250, v102
v_add_f32 v243, v243, v249
v_cvt_pk_bf16_f32 v122, v248, v249
ds_read_b64_tr_b16 a[178:179], v222 offset:58368
v_mfma_f32_32x32x16_bf16 v[80:95], a[148:151], v[36:39], v[80:95]
v_exp_f32 v251, v103
v_add_f32 v243, v243, v250
ds_read_b64_tr_b16 a[182:183], v222 offset:62464
v_mfma_f32_32x32x16_bf16 v[80:95], a[152:155], v[40:43], v[80:95]
v_exp_f32 v244, v104
v_add_f32 v243, v243, v251
v_cvt_pk_bf16_f32 v123, v250, v251
ds_read_b64_tr_b16 a[186:187], v223 offset:58368
v_mfma_f32_32x32x16_bf16 v[80:95], a[156:159], v[44:47], v[80:95]
v_exp_f32 v245, v105
v_add_f32 v243, v243, v244
ds_read_b64_tr_b16 a[190:191], v223 offset:62464
s_waitcnt lgkmcnt(5)
v_mfma_f32_32x32x16_bf16 a[0:15], a[160:163], v[112:115], a[0:15]
v_exp_f32 v246, v106
v_add_f32 v243, v243, v245
v_cvt_pk_bf16_f32 v124, v244, v245
s_add_u32 m0, s29, 49152
s_add_u32 s31, s32, 114688
buffer_load_dwordx4 v228, s[12:15], s31 offen offset:0 lds
v_mfma_f32_32x32x16_bf16 a[0:15], a[164:167], v[116:119], a[0:15]
v_exp_f32 v247, v107
v_add_f32 v243, v243, v246
buffer_load_dwordx4 v229, s[12:15], s31 offen offset:1024 lds
v_mfma_f32_32x32x16_bf16 a[16:31], a[168:171], v[112:115], a[16:31]
v_exp_f32 v248, v108
v_add_f32 v243, v243, v247
v_cvt_pk_bf16_f32 v125, v246, v247
buffer_load_dwordx4 v230, s[12:15], s31 offen offset:2048 lds
s_waitcnt lgkmcnt(2)
v_mfma_f32_32x32x16_bf16 a[16:31], a[172:175], v[116:119], a[16:31]
v_exp_f32 v249, v109
v_add_f32 v243, v243, v248
buffer_load_dwordx4 v231, s[12:15], s31 offen offset:3072 lds
v_mfma_f32_32x32x16_bf16 a[32:47], a[176:179], v[112:115], a[32:47]
v_exp_f32 v250, v110
v_add_f32 v243, v243, v249
v_cvt_pk_bf16_f32 v126, v248, v249
s_add_u32 m0, s29, 98304
s_add_u32 s31, s32, 98304
buffer_load_dwordx4 v232, s[16:19], s31 offen offset:0 lds
v_mfma_f32_32x32x16_bf16 a[32:47], a[180:183], v[116:119], a[32:47]
v_exp_f32 v251, v111
v_add_f32 v243, v243, v250
buffer_load_dwordx4 v232, s[16:19], s31 offen offset:1024 lds
s_waitcnt lgkmcnt(0)
v_mfma_f32_32x32x16_bf16 a[48:63], a[184:187], v[112:115], a[48:63]
v_add_f32 v243, v243, v251
v_cvt_pk_bf16_f32 v127, v250, v251
v_cmp_nge_f32 vcc, s44, v243
buffer_load_dwordx4 v232, s[16:19], s31 offen offset:2048 lds
v_mfma_f32_32x32x16_bf16 a[48:63], a[188:191], v[116:119], a[48:63]
s_cbranch_vccnz L_slow_15
L_back_15:
v_add_f32 v241, v241, v243
buffer_load_dwordx4 v232, s[16:19], s31 offen offset:3072 lds
v_mfma_f32_32x32x16_bf16 v[96:111], a[128:131], v[48:51], v[160:175]
v_exp_f32 v244, v80
v_exp_f32 v245, v81
v_mfma_f32_32x32x16_bf16 v[96:111], a[132:135], v[52:55], v[96:111]
v_exp_f32 v246, v82
v_exp_f32 v247, v83
v_add_f32 v242, v244, v245
ds_read_b128 a[128:131], v208 offset:8192
v_mfma_f32_32x32x16_bf16 v[96:111], a[136:139], v[56:59], v[96:111]
v_exp_f32 v248, v84
v_cvt_pk_bf16_f32 v112, v244, v245
v_add_f32 v242, v242, v246
v_add_f32 v242, v242, v247
ds_read_b128 a[132:135], v209 offset:8192
v_mfma_f32_32x32x16_bf16 v[96:111], a[140:143], v[60:63], v[96:111]
v_exp_f32 v249, v85
v_cvt_pk_bf16_f32 v113, v246, v247
v_add_f32 v242, v242, v248
ds_read_b128 a[136:139], v210 offset:8192
v_mfma_f32_32x32x16_bf16 v[96:111], a[144:147], v[64:67], v[96:111]
v_exp_f32 v250, v86
v_add_f32 v242, v242, v249
v_cvt_pk_bf16_f32 v114, v248, v249
ds_read_b128 a[140:143], v211 offset:8192
v_mfma_f32_32x32x16_bf16 v[96:111], a[148:151], v[68:71], v[96:111]
v_exp_f32 v251, v87
v_add_f32 v242, v242, v250
ds_read_b128 a[144:147], v212 offset:8192
v_mfma_f32_32x32x16_bf16 v[96:111], a[152:155], v[72:75], v[96:111]
v_exp_f32 v244, v88
v_add_f32 v242, v242, v251
v_cvt_pk_bf16_f32 v115, v250, v251
ds_read_b128 a[148:151], v213 offset:8192
v_mfma_f32_32x32x16_bf16 v[96:111], a[156:159], v[76:79], v[96:111]
v_exp_f32 v245, v89
v_add_f32 v242, v242, v244
ds_read_b128 a[152:155], v214 offset:8192
v_mfma_f32_32x32x16_bf16 a[64:79], a[160:163], v[120:123], a[64:79]
v_exp_f32 v246, v90
v_add_f32 v242, v242, v245
v_cvt_pk_bf16_f32 v116, v244, v245
ds_read_b128 a[156:159], v215 offset:8192
ds_read_b64_tr_b16 a[160:161], v220 offset:0
v_mfma_f32_32x32x16_bf16 a[64:79], a[164:167], v[124:127], a[64:79]
v_exp_f32 v247, v91
v_add_f32 v242, v242, v246
ds_read_b64_tr_b16 a[164:165], v220 offset:4096
v_mfma_f32_32x32x16_bf16 a[80:95], a[168:171], v[120:123], a[80:95]
v_exp_f32 v248, v92
v_add_f32 v242, v242, v247
v_cvt_pk_bf16_f32 v117, v246, v247
ds_read_b64_tr_b16 a[168:169], v221 offset:0
v_mfma_f32_32x32x16_bf16 a[80:95], a[172:175], v[124:127], a[80:95]
v_exp_f32 v249, v93
v_add_f32 v242, v242, v248
ds_read_b64_tr_b16 a[172:173], v221 offset:4096
v_mfma_f32_32x32x16_bf16 a[96:111], a[176:179], v[120:123], a[96:111]
v_exp_f32 v250, v94
v_add_f32 v242, v242, v249
v_cvt_pk_bf16_f32 v118, v248, v249
ds_read_b64_tr_b16 a[176:177], v222 offset:0
v_mfma_f32_32x32x16_bf16 a[96:111], a[180:183], v[124:127], a[96:111]
v_exp_f32 v251, v95
v_add_f32 v242, v242, v250
ds_read_b64_tr_b16 a[180:181], v222 offset:4096
v_mfma_f32_32x32x16_bf16 a[112:127], a[184:187], v[120:123], a[112:127]
v_add_f32 v242, v242, v251
v_cvt_pk_bf16_f32 v119, v250, v251
v_cmp_nge_f32 vcc, s44, v242
ds_read_b64_tr_b16 a[184:185], v223 offset:0
v_mfma_f32_32x32x16_bf16 a[112:127], a[188:191], v[124:127], a[112:127]
s_cbranch_vccnz L_slow_16
L_back_16:
v_add_f32 v240, v240, v242
ds_read_b64_tr_b16 a[188:189], v223 offset:4096
s_waitcnt lgkmcnt(5)
v_mfma_f32_32x32x16_bf16 v[80:95], a[128:131], v[16:19], v[144:159]
v_exp_f32 v244, v96
v_exp_f32 v245, v97
ds_read_b64_tr_b16 a[162:163], v220 offset:1024
v_mfma_f32_32x32x16_bf16 v[80:95], a[132:135], v[20:23], v[80:95]
v_exp_f32 v246, v98
v_exp_f32 v247, v99
v_add_f32 v243, v244, v245
ds_read_b64_tr_b16 a[166:167], v220 offset:5120
v_mfma_f32_32x32x16_bf16 v[80:95], a[136:139], v[24:27], v[80:95]
v_exp_f32 v248, v100
v_cvt_pk_bf16_f32 v120, v244, v245
v_add_f32 v243, v243, v246
v_add_f32 v243, v243, v247
ds_read_b64_tr_b16 a[170:171], v221 offset:1024
v_mfma_f32_32x32x16_bf16 v[80:95], a[140:143], v[28:31], v[80:95]
v_exp_f32 v249, v101
v_cvt_pk_bf16_f32 v121, v246, v247
v_add_f32 v243, v243, v248
ds_read_b64_tr_b16 a[174:175], v221 offset:5120
v_mfma_f32_32x32x16_bf16 v[80:95], a[144:147], v[32:35], v[80:95]
v_exp_f32 v250, v102
v_add_f32 v243, v243, v249
v_cvt_pk_bf16_f32 v122, v248, v249
ds_read_b64_tr_b16 a[178:179], v222 offset:1024
v_mfma_f32_32x32x16_bf16 v[80:95], a[148:151], v[36:39], v[80:95]
v_exp_f32 v251, v103
v_add_f32 v243, v243, v250
ds_read_b64_tr_b16 a[182:183], v222 offset:5120
v_mfma_f32_32x32x16_bf16 v[80:95], a[152:155], v[40:43], v[80:95]
v_exp_f32 v244, v104
v_add_f32 v243, v243, v251
v_cvt_pk_bf16_f32 v123, v250, v251
ds_read_b64_tr_b16 a[186:187], v223 offset:1024
v_mfma_f32_32x32x16_bf16 v[80:95], a[156:159], v[44:47], v[80:95]
v_exp_f32 v245, v105
v_add_f32 v243, v243, v244
ds_read_b64_tr_b16 a[190:191], v223 offset:5120
s_waitcnt lgkmcnt(5)
v_mfma_f32_32x32x16_bf16 a[0:15], a[160:163], v[112:115], a[0:15]
v_exp_f32 v246, v106
v_add_f32 v243, v243, v245
v_cvt_pk_bf16_f32 v124, v244, v245
buffer_store_dwordx4 a[192:195], v14, s[96:99], s5 offen offset:0 sc1
v_mfma_f32_32x32x16_bf16 a[0:15], a[164:167], v[116:119], a[0:15]
v_exp_f32 v247, v107
v_add_f32 v243, v243, v246
buffer_store_dwordx4 a[196:199], v14, s[96:99], s5 offen offset:1024 sc1
v_mfma_f32_32x32x16_bf16 a[16:31], a[168:171], v[112:115], a[16:31]
v_exp_f32 v248, v108
v_add_f32 v243, v243, v247
v_cvt_pk_bf16_f32 v125, v246, v247
buffer_store_dwordx4 a[200:203], v14, s[96:99], s5 offen offset:2048 sc1
s_waitcnt lgkmcnt(2)
v_mfma_f32_32x32x16_bf16 a[16:31], a[172:175], v[116:119], a[16:31]
v_exp_f32 v249, v109
v_add_f32 v243, v243, v248
buffer_store_dwordx4 a[204:207], v14, s[96:99], s5 offen offset:3072 sc1
v_mfma_f32_32x32x16_bf16 a[32:47], a[176:179], v[112:115], a[32:47]
v_exp_f32 v250, v110
v_add_f32 v243, v243, v249
v_cvt_pk_bf16_f32 v126, v248, v249
buffer_store_dwordx4 a[208:211], v14, s[96:99], s7 offen offset:0 sc1
v_mfma_f32_32x32x16_bf16 a[32:47], a[180:183], v[116:119], a[32:47]
v_exp_f32 v251, v111
v_add_f32 v243, v243, v250
s_waitcnt lgkmcnt(0)
v_mfma_f32_32x32x16_bf16 a[48:63], a[184:187], v[112:115], a[48:63]
v_add_f32 v243, v243, v251
v_cvt_pk_bf16_f32 v127, v250, v251
v_cmp_nge_f32 vcc, s44, v243
v_mfma_f32_32x32x16_bf16 a[48:63], a[188:191], v[116:119], a[48:63]
s_cbranch_vccnz L_slow_17
L_back_17:
v_add_f32 v241, v241, v243
v_mfma_f32_32x32x16_bf16 v[96:111], a[128:131], v[48:51], v[160:175]
s_waitcnt vmcnt(13)
s_barrier
v_exp_f32 v244, v80
v_exp_f32 v245, v81
v_mfma_f32_32x32x16_bf16 v[96:111], a[132:135], v[52:55], v[96:111]
v_exp_f32 v246, v82
v_exp_f32 v247, v83
v_add_f32 v242, v244, v245
ds_read_b128 a[128:131], v208 offset:16384
v_mfma_f32_32x32x16_bf16 v[96:111], a[136:139], v[56:59], v[96:111]
v_exp_f32 v248, v84
v_cvt_pk_bf16_f32 v112, v244, v245
v_add_f32 v242, v242, v246
v_add_f32 v242, v242, v247
ds_read_b128 a[132:135], v209 offset:16384
v_mfma_f32_32x32x16_bf16 v[96:111], a[140:143], v[60:63], v[96:111]
v_exp_f32 v249, v85
v_cvt_pk_bf16_f32 v113, v246, v247
v_add_f32 v242, v242, v248
ds_read_b128 a[136:139], v210 offset:16384
v_mfma_f32_32x32x16_bf16 v[96:111], a[144:147], v[64:67], v[96:111]
v_exp_f32 v250, v86
v_add_f32 v242, v242, v249
v_cvt_pk_bf16_f32 v114, v248, v249
ds_read_b128 a[140:143], v211 offset:16384
v_mfma_f32_32x32x16_bf16 v[96:111], a[148:151], v[68:71], v[96:111]
v_exp_f32 v251, v87
v_add_f32 v242, v242, v250
ds_read_b128 a[144:147], v212 offset:16384
v_mfma_f32_32x32x16_bf16 v[96:111], a[152:155], v[72:75], v[96:111]
v_exp_f32 v244, v88
v_add_f32 v242, v242, v251
v_cvt_pk_bf16_f32 v115, v250, v251
ds_read_b128 a[148:151], v213 offset:16384
v_mfma_f32_32x32x16_bf16 v[96:111], a[156:159], v[76:79], v[96:111]
v_exp_f32 v245, v89
v_add_f32 v242, v242, v244
ds_read_b128 a[152:155], v214 offset:16384
v_mfma_f32_32x32x16_bf16 a[64:79], a[160:163], v[120:123], a[64:79]
v_exp_f32 v246, v90
v_add_f32 v242, v242, v245
v_cvt_pk_bf16_f32 v116, v244, v245
ds_read_b128 a[156:159], v215 offset:16384
ds_read_b64_tr_b16 a[160:161], v220 offset:8192
v_mfma_f32_32x32x16_bf16 a[64:79], a[164:167], v[124:127], a[64:79]
v_exp_f32 v247, v91
v_add_f32 v242, v242, v246
ds_read_b64_tr_b16 a[164:165], v220 offset:12288
v_mfma_f32_32x32x16_bf16 a[80:95], a[168:171], v[120:123], a[80:95]
v_exp_f32 v248, v92
v_add_f32 v242, v242, v247
v_cvt_pk_bf16_f32 v117, v246, v247
ds_read_b64_tr_b16 a[168:169], v221 offset:8192
v_mfma_f32_32x32x16_bf16 a[80:95], a[172:175], v[124:127], a[80:95]
v_exp_f32 v249, v93
v_add_f32 v242, v242, v248
ds_read_b64_tr_b16 a[172:173], v221 offset:12288
v_mfma_f32_32x32x16_bf16 a[96:111], a[176:179], v[120:123], a[96:111]
v_exp_f32 v250, v94
v_add_f32 v242, v242, v249
v_cvt_pk_bf16_f32 v118, v248, v249
ds_read_b64_tr_b16 a[176:177], v222 offset:8192
v_mfma_f32_32x32x16_bf16 a[96:111], a[180:183], v[124:127], a[96:111]
v_exp_f32 v251, v95
v_add_f32 v242, v242, v250
ds_read_b64_tr_b16 a[180:181], v222 offset:12288
v_mfma_f32_32x32x16_bf16 a[112:127], a[184:187], v[120:123], a[112:127]
v_add_f32 v242, v242, v251
v_cvt_pk_bf16_f32 v119, v250, v251
v_cmp_nge_f32 vcc, s44, v242
ds_read_b64_tr_b16 a[184:185], v223 offset:8192
v_mfma_f32_32x32x16_bf16 a[112:127], a[188:191], v[124:127], a[112:127]
s_cbranch_vccnz L_slow_18
L_back_18:
v_add_f32 v240, v240, v242
ds_read_b64_tr_b16 a[188:189], v223 offset:12288
s_waitcnt lgkmcnt(5)
v_mfma_f32_32x32x16_bf16 v[80:95], a[128:131], v[16:19], v[144:159]
v_exp_f32 v244, v96
v_exp_f32 v245, v97
ds_read_b64_tr_b16 a[162:163], v220 offset:9216
v_mfma_f32_32x32x16_bf16 v[80:95], a[132:135], v[20:23], v[80:95]
v_exp_f32 v246, v98
v_exp_f32 v247, v99
v_add_f32 v243, v244, v245
ds_read_b64_tr_b16 a[166:167], v220 offset:13312
v_mfma_f32_32x32x16_bf16 v[80:95], a[136:139], v[24:27], v[80:95]
v_exp_f32 v248, v100
v_cvt_pk_bf16_f32 v120, v244, v245
v_add_f32 v243, v243, v246
v_add_f32 v243, v243, v247
ds_read_b64_tr_b16 a[170:171], v221 offset:9216
v_mfma_f32_32x32x16_bf16 v[80:95], a[140:143], v[28:31], v[80:95]
v_exp_f32 v249, v101
v_cvt_pk_bf16_f32 v121, v246, v247
v_add_f32 v243, v243, v248
ds_read_b64_tr_b16 a[174:175], v221 offset:13312
v_mfma_f32_32x32x16_bf16 v[80:95], a[144:147], v[32:35], v[80:95]
v_exp_f32 v250, v102
v_add_f32 v243, v243, v249
v_cvt_pk_bf16_f32 v122, v248, v249
ds_read_b64_tr_b16 a[178:179], v222 offset:9216
v_mfma_f32_32x32x16_bf16 v[80:95], a[148:151], v[36:39], v[80:95]
v_exp_f32 v251, v103
v_add_f32 v243, v243, v250
ds_read_b64_tr_b16 a[182:183], v222 offset:13312
v_mfma_f32_32x32x16_bf16 v[80:95], a[152:155], v[40:43], v[80:95]
v_exp_f32 v244, v104
v_add_f32 v243, v243, v251
v_cvt_pk_bf16_f32 v123, v250, v251
ds_read_b64_tr_b16 a[186:187], v223 offset:9216
v_mfma_f32_32x32x16_bf16 v[80:95], a[156:159], v[44:47], v[80:95]
v_exp_f32 v245, v105
v_add_f32 v243, v243, v244
ds_read_b64_tr_b16 a[190:191], v223 offset:13312
s_waitcnt lgkmcnt(5)
v_mfma_f32_32x32x16_bf16 a[0:15], a[160:163], v[112:115], a[0:15]
v_exp_f32 v246, v106
v_add_f32 v243, v243, v245
v_cvt_pk_bf16_f32 v124, v244, v245
s_add_u32 m0, s29, 114688
s_add_u32 s31, s32, 114688
buffer_load_dwordx4 v232, s[16:19], s31 offen offset:0 lds
v_mfma_f32_32x32x16_bf16 a[0:15], a[164:167], v[116:119], a[0:15]
v_exp_f32 v247, v107
v_add_f32 v243, v243, v246
buffer_load_dwordx4 v232, s[16:19], s31 offen offset:1024 lds
v_mfma_f32_32x32x16_bf16 a[16:31], a[168:171], v[112:115], a[16:31]
v_exp_f32 v248, v108
v_add_f32 v243, v243, v247
v_cvt_pk_bf16_f32 v125, v246, v247
buffer_load_dwordx4 v232, s[16:19], s31 offen offset:2048 lds
s_waitcnt lgkmcnt(2)
v_mfma_f32_32x32x16_bf16 a[16:31], a[172:175], v[116:119], a[16:31]
v_exp_f32 v249, v109
v_add_f32 v243, v243, v248
buffer_load_dwordx4 v232, s[16:19], s31 offen offset:3072 lds
v_mfma_f32_32x32x16_bf16 a[32:47], a[176:179], v[112:115], a[32:47]
v_exp_f32 v250, v110
v_add_f32 v243, v243, v249
v_cvt_pk_bf16_f32 v126, v248, v249
buffer_load_dword v138, v15, s[40:43], 0 offen
v_mfma_f32_32x32x16_bf16 a[32:47], a[180:183], v[116:119], a[32:47]
v_exp_f32 v251, v111
v_add_f32 v243, v243, v250
buffer_load_dword v139, v15, s[48:51], 0 offen
s_waitcnt lgkmcnt(0)
v_mfma_f32_32x32x16_bf16 a[48:63], a[184:187], v[112:115], a[48:63]
v_add_f32 v243, v243, v251
v_cvt_pk_bf16_f32 v127, v250, v251
v_cmp_nge_f32 vcc, s44, v243
v_mfma_f32_32x32x16_bf16 a[48:63], a[188:191], v[116:119], a[48:63]
s_cbranch_vccnz L_slow_19
L_back_19:
v_add_f32 v241, v241, v243
v_mfma_f32_32x32x16_bf16 v[96:111], a[128:131], v[48:51], v[160:175]
v_exp_f32 v244, v80
v_exp_f32 v245, v81
v_mfma_f32_32x32x16_bf16 v[96:111], a[132:135], v[52:55], v[96:111]
v_exp_f32 v246, v82
v_exp_f32 v247, v83
v_add_f32 v242, v244, v245
ds_read_b128 a[128:131], v208 offset:24576
v_mfma_f32_32x32x16_bf16 v[96:111], a[136:139], v[56:59], v[96:111]
v_exp_f32 v248, v84
v_cvt_pk_bf16_f32 v112, v244, v245
v_add_f32 v242, v242, v246
v_add_f32 v242, v242, v247
ds_read_b128 a[132:135], v209 offset:24576
v_mfma_f32_32x32x16_bf16 v[96:111], a[140:143], v[60:63], v[96:111]
v_exp_f32 v249, v85
v_cvt_pk_bf16_f32 v113, v246, v247
v_add_f32 v242, v242, v248
ds_read_b128 a[136:139], v210 offset:24576
v_mfma_f32_32x32x16_bf16 v[96:111], a[144:147], v[64:67], v[96:111]
v_exp_f32 v250, v86
v_add_f32 v242, v242, v249
v_cvt_pk_bf16_f32 v114, v248, v249
ds_read_b128 a[140:143], v211 offset:24576
v_mfma_f32_32x32x16_bf16 v[96:111], a[148:151], v[68:71], v[96:111]
v_exp_f32 v251, v87
v_add_f32 v242, v242, v250
ds_read_b128 a[144:147], v212 offset:24576
v_mfma_f32_32x32x16_bf16 v[96:111], a[152:155], v[72:75], v[96:111]
v_exp_f32 v244, v88
v_add_f32 v242, v242, v251
v_cvt_pk_bf16_f32 v115, v250, v251
ds_read_b128 a[148:151], v213 offset:24576
v_mfma_f32_32x32x16_bf16 v[96:111], a[156:159], v[76:79], v[96:111]
v_exp_f32 v245, v89
v_add_f32 v242, v242, v244
ds_read_b128 a[152:155], v214 offset:24576
v_mfma_f32_32x32x16_bf16 a[64:79], a[160:163], v[120:123], a[64:79]
v_exp_f32 v246, v90
v_add_f32 v242, v242, v245
v_cvt_pk_bf16_f32 v116, v244, v245
ds_read_b128 a[156:159], v215 offset:24576
ds_read_b64_tr_b16 a[160:161], v220 offset:16384
v_mfma_f32_32x32x16_bf16 a[64:79], a[164:167], v[124:127], a[64:79]
v_exp_f32 v247, v91
v_add_f32 v242, v242, v246
ds_read_b64_tr_b16 a[164:165], v220 offset:20480
v_mfma_f32_32x32x16_bf16 a[80:95], a[168:171], v[120:123], a[80:95]
v_exp_f32 v248, v92
v_add_f32 v242, v242, v247
v_cvt_pk_bf16_f32 v117, v246, v247
ds_read_b64_tr_b16 a[168:169], v221 offset:16384
v_mfma_f32_32x32x16_bf16 a[80:95], a[172:175], v[124:127], a[80:95]
v_exp_f32 v249, v93
v_add_f32 v242, v242, v248
ds_read_b64_tr_b16 a[172:173], v221 offset:20480
v_mfma_f32_32x32x16_bf16 a[96:111], a[176:179], v[120:123], a[96:111]
v_exp_f32 v250, v94
v_add_f32 v242, v242, v249
v_cvt_pk_bf16_f32 v118, v248, v249
ds_read_b64_tr_b16 a[176:177], v222 offset:16384
v_mfma_f32_32x32x16_bf16 a[96:111], a[180:183], v[124:127], a[96:111]
v_exp_f32 v251, v95
v_add_f32 v242, v242, v250
ds_read_b64_tr_b16 a[180:181], v222 offset:20480
v_mfma_f32_32x32x16_bf16 a[112:127], a[184:187], v[120:123], a[112:127]
v_add_f32 v242, v242, v251
v_cvt_pk_bf16_f32 v119, v250, v251
v_cmp_nge_f32 vcc, s44, v242
ds_read_b64_tr_b16 a[184:185], v223 offset:16384
v_mfma_f32_32x32x16_bf16 a[112:127], a[188:191], v[124:127], a[112:127]
s_cbranch_vccnz L_slow_20
L_back_20:
v_add_f32 v240, v240, v242
ds_read_b64_tr_b16 a[188:189], v223 offset:20480
s_waitcnt lgkmcnt(5)
v_mfma_f32_32x32x16_bf16 v[80:95], a[128:131], v[16:19], v[144:159]
v_exp_f32 v244, v96
v_exp_f32 v245, v97
ds_read_b64_tr_b16 a[162:163], v220 offset:17408
v_mfma_f32_32x32x16_bf16 v[80:95], a[132:135], v[20:23], v[80:95]
v_exp_f32 v246, v98
v_exp_f32 v247, v99
v_add_f32 v243, v244, v245
ds_read_b64_tr_b16 a[166:167], v220 offset:21504
v_mfma_f32_32x32x16_bf16 v[80:95], a[136:139], v[24:27], v[80:95]
v_exp_f32 v248, v100
v_cvt_pk_bf16_f32 v120, v244, v245
v_add_f32 v243, v243, v246
v_add_f32 v243, v243, v247
ds_read_b64_tr_b16 a[170:171], v221 offset:17408
v_mfma_f32_32x32x16_bf16 v[80:95], a[140:143], v[28:31], v[80:95]
v_exp_f32 v249, v101
v_cvt_pk_bf16_f32 v121, v246, v247
v_add_f32 v243, v243, v248
ds_read_b64_tr_b16 a[174:175], v221 offset:21504
v_mfma_f32_32x32x16_bf16 v[80:95], a[144:147], v[32:35], v[80:95]
v_exp_f32 v250, v102
v_add_f32 v243, v243, v249
v_cvt_pk_bf16_f32 v122, v248, v249
ds_read_b64_tr_b16 a[178:179], v222 offset:17408
v_mfma_f32_32x32x16_bf16 v[80:95], a[148:151], v[36:39], v[80:95]
v_exp_f32 v251, v103
v_add_f32 v243, v243, v250
ds_read_b64_tr_b16 a[182:183], v222 offset:21504
v_mfma_f32_32x32x16_bf16 v[80:95], a[152:155], v[40:43], v[80:95]
v_exp_f32 v244, v104
v_add_f32 v243, v243, v251
v_cvt_pk_bf16_f32 v123, v250, v251
ds_read_b64_tr_b16 a[186:187], v223 offset:17408
v_mfma_f32_32x32x16_bf16 v[80:95], a[156:159], v[44:47], v[80:95]
v_exp_f32 v245, v105
v_add_f32 v243, v243, v244
ds_read_b64_tr_b16 a[190:191], v223 offset:21504
s_waitcnt lgkmcnt(5)
v_mfma_f32_32x32x16_bf16 a[0:15], a[160:163], v[112:115], a[0:15]
v_exp_f32 v246, v106
v_add_f32 v243, v243, v245
v_cvt_pk_bf16_f32 v124, v244, v245
v_mfma_f32_32x32x16_bf16 a[0:15], a[164:167], v[116:119], a[0:15]
v_exp_f32 v247, v107
v_add_f32 v243, v243, v246
v_mfma_f32_32x32x16_bf16 a[16:31], a[168:171], v[112:115], a[16:31]
v_exp_f32 v248, v108
v_add_f32 v243, v243, v247
v_cvt_pk_bf16_f32 v125, v246, v247
s_waitcnt lgkmcnt(2)
v_mfma_f32_32x32x16_bf16 a[16:31], a[172:175], v[116:119], a[16:31]
v_exp_f32 v249, v109
v_add_f32 v243, v243, v248
v_mfma_f32_32x32x16_bf16 a[32:47], a[176:179], v[112:115], a[32:47]
v_exp_f32 v250, v110
v_add_f32 v243, v243, v249
v_cvt_pk_bf16_f32 v126, v248, v249
v_mfma_f32_32x32x16_bf16 a[32:47], a[180:183], v[116:119], a[32:47]
v_exp_f32 v251, v111
v_add_f32 v243, v243, v250
s_waitcnt lgkmcnt(0)
v_mfma_f32_32x32x16_bf16 a[48:63], a[184:187], v[112:115], a[48:63]
v_add_f32 v243, v243, v251
v_cvt_pk_bf16_f32 v127, v250, v251
v_cmp_nge_f32 vcc, s44, v243
v_mfma_f32_32x32x16_bf16 a[48:63], a[188:191], v[116:119], a[48:63]
s_cbranch_vccnz L_slow_21
L_back_21:
v_add_f32 v241, v241, v243
v_mfma_f32_32x32x16_bf16 v[96:111], a[128:131], v[48:51], v[160:175]
s_waitcnt vmcnt(11)
s_barrier
v_exp_f32 v244, v80
v_exp_f32 v245, v81
v_mfma_f32_32x32x16_bf16 v[96:111], a[132:135], v[52:55], v[96:111]
v_exp_f32 v246, v82
v_exp_f32 v247, v83
v_add_f32 v242, v244, v245
ds_read_b128 a[128:131], v208 offset:32768
v_mfma_f32_32x32x16_bf16 v[96:111], a[136:139], v[56:59], v[96:111]
v_exp_f32 v248, v84
v_cvt_pk_bf16_f32 v112, v244, v245
v_add_f32 v242, v242, v246
v_add_f32 v242, v242, v247
ds_read_b128 a[132:135], v209 offset:32768
v_mfma_f32_32x32x16_bf16 v[96:111], a[140:143], v[60:63], v[96:111]
v_exp_f32 v249, v85
v_cvt_pk_bf16_f32 v113, v246, v247
v_add_f32 v242, v242, v248
ds_read_b128 a[136:139], v210 offset:32768
v_mfma_f32_32x32x16_bf16 v[96:111], a[144:147], v[64:67], v[96:111]
v_exp_f32 v250, v86
v_add_f32 v242, v242, v249
v_cvt_pk_bf16_f32 v114, v248, v249
ds_read_b128 a[140:143], v211 offset:32768
v_mfma_f32_32x32x16_bf16 v[96:111], a[148:151], v[68:71], v[96:111]
v_exp_f32 v251, v87
v_add_f32 v242, v242, v250
ds_read_b128 a[144:147], v212 offset:32768
v_mfma_f32_32x32x16_bf16 v[96:111], a[152:155], v[72:75], v[96:111]
v_exp_f32 v244, v88
v_add_f32 v242, v242, v251
v_cvt_pk_bf16_f32 v115, v250, v251
ds_read_b128 a[148:151], v213 offset:32768
v_mfma_f32_32x32x16_bf16 v[96:111], a[156:159], v[76:79], v[96:111]
v_exp_f32 v245, v89
v_add_f32 v242, v242, v244
ds_read_b128 a[152:155], v214 offset:32768
v_mfma_f32_32x32x16_bf16 a[64:79], a[160:163], v[120:123], a[64:79]
v_exp_f32 v246, v90
v_add_f32 v242, v242, v245
v_cvt_pk_bf16_f32 v116, v244, v245
ds_read_b128 a[156:159], v215 offset:32768
ds_read_b64_tr_b16 a[160:161], v220 offset:24576
v_mfma_f32_32x32x16_bf16 a[64:79], a[164:167], v[124:127], a[64:79]
v_exp_f32 v247, v91
v_add_f32 v242, v242, v246
ds_read_b64_tr_b16 a[164:165], v220 offset:28672
v_mfma_f32_32x32x16_bf16 a[80:95], a[168:171], v[120:123], a[80:95]
v_exp_f32 v248, v92
v_add_f32 v242, v242, v247
v_cvt_pk_bf16_f32 v117, v246, v247
ds_read_b64_tr_b16 a[168:169], v221 offset:24576
v_mfma_f32_32x32x16_bf16 a[80:95], a[172:175], v[124:127], a[80:95]
v_exp_f32 v249, v93
v_add_f32 v242, v242, v248
ds_read_b64_tr_b16 a[172:173], v221 offset:28672
v_mfma_f32_32x32x16_bf16 a[96:111], a[176:179], v[120:123], a[96:111]
v_exp_f32 v250, v94
v_add_f32 v242, v242, v249
v_cvt_pk_bf16_f32 v118, v248, v249
ds_read_b64_tr_b16 a[176:177], v222 offset:24576
v_mfma_f32_32x32x16_bf16 a[96:111], a[180:183], v[124:127], a[96:111]
v_exp_f32 v251, v95
v_add_f32 v242, v242, v250
ds_read_b64_tr_b16 a[180:181], v222 offset:28672
v_mfma_f32_32x32x16_bf16 a[112:127], a[184:187], v[120:123], a[112:127]
v_add_f32 v242, v242, v251
v_cvt_pk_bf16_f32 v119, v250, v251
v_cmp_nge_f32 vcc, s44, v242
ds_read_b64_tr_b16 a[184:185], v223 offset:24576
v_mfma_f32_32x32x16_bf16 a[112:127], a[188:191], v[124:127], a[112:127]
s_cbranch_vccnz L_slow_22
L_back_22:
v_add_f32 v240, v240, v242
ds_read_b64_tr_b16 a[188:189], v223 offset:28672
s_waitcnt lgkmcnt(5)
v_mfma_f32_32x32x16_bf16 v[80:95], a[128:131], v[16:19], v[144:159]
v_exp_f32 v244, v96
v_exp_f32 v245, v97
ds_read_b64_tr_b16 a[162:163], v220 offset:25600
v_mfma_f32_32x32x16_bf16 v[80:95], a[132:135], v[20:23], v[80:95]
v_exp_f32 v246, v98
v_exp_f32 v247, v99
v_add_f32 v243, v244, v245
ds_read_b64_tr_b16 a[166:167], v220 offset:29696
v_mfma_f32_32x32x16_bf16 v[80:95], a[136:139], v[24:27], v[80:95]
v_exp_f32 v248, v100
v_cvt_pk_bf16_f32 v120, v244, v245
v_add_f32 v243, v243, v246
v_add_f32 v243, v243, v247
ds_read_b64_tr_b16 a[170:171], v221 offset:25600
v_mfma_f32_32x32x16_bf16 v[80:95], a[140:143], v[28:31], v[80:95]
v_exp_f32 v249, v101
v_cvt_pk_bf16_f32 v121, v246, v247
v_add_f32 v243, v243, v248
ds_read_b64_tr_b16 a[174:175], v221 offset:29696
v_mfma_f32_32x32x16_bf16 v[80:95], a[144:147], v[32:35], v[80:95]
v_exp_f32 v250, v102
v_add_f32 v243, v243, v249
v_cvt_pk_bf16_f32 v122, v248, v249
ds_read_b64_tr_b16 a[178:179], v222 offset:25600
v_mfma_f32_32x32x16_bf16 v[80:95], a[148:151], v[36:39], v[80:95]
v_exp_f32 v251, v103
v_add_f32 v243, v243, v250
ds_read_b64_tr_b16 a[182:183], v222 offset:29696
v_mfma_f32_32x32x16_bf16 v[80:95], a[152:155], v[40:43], v[80:95]
v_exp_f32 v244, v104
v_add_f32 v243, v243, v251
v_cvt_pk_bf16_f32 v123, v250, v251
ds_read_b64_tr_b16 a[186:187], v223 offset:25600
v_mfma_f32_32x32x16_bf16 v[80:95], a[156:159], v[44:47], v[80:95]
v_exp_f32 v245, v105
v_add_f32 v243, v243, v244
ds_read_b64_tr_b16 a[190:191], v223 offset:29696
s_waitcnt lgkmcnt(5)
v_mfma_f32_32x32x16_bf16 a[0:15], a[160:163], v[112:115], a[0:15]
v_exp_f32 v246, v106
v_add_f32 v243, v243, v245
v_cvt_pk_bf16_f32 v124, v244, v245
s_add_u32 s31, s28, 0
buffer_load_dword v132, v7, s[20:23], s31 offen
v_mfma_f32_32x32x16_bf16 a[0:15], a[164:167], v[116:119], a[0:15]
v_exp_f32 v247, v107
v_add_f32 v243, v243, v246
s_add_u32 s31, s28, 3072
buffer_load_dword v133, v7, s[20:23], s31 offen
v_mfma_f32_32x32x16_bf16 a[16:31], a[168:171], v[112:115], a[16:31]
v_exp_f32 v248, v108
v_add_f32 v243, v243, v247
v_cvt_pk_bf16_f32 v125, v246, v247
s_add_u32 s31, s28, 6144
buffer_load_dword v134, v7, s[20:23], s31 offen
s_waitcnt lgkmcnt(2)
v_mfma_f32_32x32x16_bf16 a[16:31], a[172:175], v[116:119], a[16:31]
v_exp_f32 v249, v109
v_add_f32 v243, v243, v248
v_mfma_f32_32x32x16_bf16 a[32:47], a[176:179], v[112:115], a[32:47]
v_exp_f32 v250, v110
v_add_f32 v243, v243, v249
v_cvt_pk_bf16_f32 v126, v248, v249
v_mfma_f32_32x32x16_bf16 a[32:47], a[180:183], v[116:119], a[32:47]
v_exp_f32 v251, v111
v_add_f32 v243, v243, v250
s_waitcnt lgkmcnt(0)
v_mfma_f32_32x32x16_bf16 a[48:63], a[184:187], v[112:115], a[48:63]
v_add_f32 v243, v243, v251
v_cvt_pk_bf16_f32 v127, v250, v251
v_cmp_nge_f32 vcc, s44, v243
v_mfma_f32_32x32x16_bf16 a[48:63], a[188:191], v[116:119], a[48:63]
s_cbranch_vccnz L_slow_23
L_back_23:
v_add_f32 v241, v241, v243
v_mfma_f32_32x32x16_bf16 v[96:111], a[128:131], v[48:51], v[160:175]
v_exp_f32 v244, v80
v_exp_f32 v245, v81
v_mfma_f32_32x32x16_bf16 v[96:111], a[132:135], v[52:55], v[96:111]
v_exp_f32 v246, v82
v_exp_f32 v247, v83
v_add_f32 v242, v244, v245
ds_read_b128 a[128:131], v208 offset:40960
v_mfma_f32_32x32x16_bf16 v[96:111], a[136:139], v[56:59], v[96:111]
v_exp_f32 v248, v84
v_cvt_pk_bf16_f32 v112, v244, v245
v_add_f32 v242, v242, v246
v_add_f32 v242, v242, v247
ds_read_b128 a[132:135], v209 offset:40960
v_mfma_f32_32x32x16_bf16 v[96:111], a[140:143], v[60:63], v[96:111]
v_exp_f32 v249, v85
v_cvt_pk_bf16_f32 v113, v246, v247
v_add_f32 v242, v242, v248
ds_read_b128 a[136:139], v210 offset:40960
v_mfma_f32_32x32x16_bf16 v[96:111], a[144:147], v[64:67], v[96:111]
v_exp_f32 v250, v86
v_add_f32 v242, v242, v249
v_cvt_pk_bf16_f32 v114, v248, v249
ds_read_b128 a[140:143], v211 offset:40960
v_mfma_f32_32x32x16_bf16 v[96:111], a[148:151], v[68:71], v[96:111]
v_exp_f32 v251, v87
v_add_f32 v242, v242, v250
ds_read_b128 a[144:147], v212 offset:40960
v_mfma_f32_32x32x16_bf16 v[96:111], a[152:155], v[72:75], v[96:111]
v_exp_f32 v244, v88
v_add_f32 v242, v242, v251
v_cvt_pk_bf16_f32 v115, v250, v251
ds_read_b128 a[148:151], v213 offset:40960
v_mfma_f32_32x32x16_bf16 v[96:111], a[156:159], v[76:79], v[96:111]
v_exp_f32 v245, v89
v_add_f32 v242, v242, v244
ds_read_b128 a[152:155], v214 offset:40960
v_mfma_f32_32x32x16_bf16 a[64:79], a[160:163], v[120:123], a[64:79]
v_exp_f32 v246, v90
v_add_f32 v242, v242, v245
v_cvt_pk_bf16_f32 v116, v244, v245
ds_read_b128 a[156:159], v215 offset:40960
ds_read_b64_tr_b16 a[160:161], v220 offset:32768
v_mfma_f32_32x32x16_bf16 a[64:79], a[164:167], v[124:127], a[64:79]
v_exp_f32 v247, v91
v_add_f32 v242, v242, v246
ds_read_b64_tr_b16 a[164:165], v220 offset:36864
v_mfma_f32_32x32x16_bf16 a[80:95], a[168:171], v[120:123], a[80:95]
v_exp_f32 v248, v92
v_add_f32 v242, v242, v247
v_cvt_pk_bf16_f32 v117, v246, v247
ds_read_b64_tr_b16 a[168:169], v221 offset:32768
v_mfma_f32_32x32x16_bf16 a[80:95], a[172:175], v[124:127], a[80:95]
v_exp_f32 v249, v93
v_add_f32 v242, v242, v248
ds_read_b64_tr_b16 a[172:173], v221 offset:36864
v_mfma_f32_32x32x16_bf16 a[96:111], a[176:179], v[120:123], a[96:111]
v_exp_f32 v250, v94
v_add_f32 v242, v242, v249
v_cvt_pk_bf16_f32 v118, v248, v249
ds_read_b64_tr_b16 a[176:177], v222 offset:32768
v_mfma_f32_32x32x16_bf16 a[96:111], a[180:183], v[124:127], a[96:111]
v_exp_f32 v251, v95
v_add_f32 v242, v242, v250
ds_read_b64_tr_b16 a[180:181], v222 offset:36864
v_mfma_f32_32x32x16_bf16 a[112:127], a[184:187], v[120:123], a[112:127]
v_add_f32 v242, v242, v251
v_cvt_pk_bf16_f32 v119, v250, v251
v_cmp_nge_f32 vcc, s44, v242
ds_read_b64_tr_b16 a[184:185], v223 offset:32768
v_mfma_f32_32x32x16_bf16 a[112:127], a[188:191], v[124:127], a[112:127]
s_cbranch_vccnz L_slow_24
L_back_24:
v_add_f32 v240, v240, v242
ds_read_b64_tr_b16 a[188:189], v223 offset:36864
s_waitcnt lgkmcnt(5)
v_mfma_f32_32x32x16_bf16 v[80:95], a[128:131], v[16:19], v[144:159]
v_exp_f32 v244, v96
v_exp_f32 v245, v97
ds_read_b64_tr_b16 a[162:163], v220 offset:33792
v_mfma_f32_32x32x16_bf16 v[80:95], a[132:135], v[20:23], v[80:95]
v_exp_f32 v246, v98
v_exp_f32 v247, v99
v_add_f32 v243, v244, v245
ds_read_b64_tr_b16 a[166:167], v220 offset:37888
v_mfma_f32_32x32x16_bf16 v[80:95], a[136:139], v[24:27], v[80:95]
v_exp_f32 v248, v100
v_cvt_pk_bf16_f32 v120, v244, v245
v_add_f32 v243, v243, v246
v_add_f32 v243, v243, v247
ds_read_b64_tr_b16 a[170:171], v221 offset:33792
v_mfma_f32_32x32x16_bf16 v[80:95], a[140:143], v[28:31], v[80:95]
v_exp_f32 v249, v101
v_cvt_pk_bf16_f32 v121, v246, v247
v_add_f32 v243, v243, v248
ds_read_b64_tr_b16 a[174:175], v221 offset:37888
v_mfma_f32_32x32x16_bf16 v[80:95], a[144:147], v[32:35], v[80:95]
v_exp_f32 v250, v102
v_add_f32 v243, v243, v249
v_cvt_pk_bf16_f32 v122, v248, v249
ds_read_b64_tr_b16 a[178:179], v222 offset:33792
v_mfma_f32_32x32x16_bf16 v[80:95], a[148:151], v[36:39], v[80:95]
v_exp_f32 v251, v103
v_add_f32 v243, v243, v250
ds_read_b64_tr_b16 a[182:183], v222 offset:37888
v_mfma_f32_32x32x16_bf16 v[80:95], a[152:155], v[40:43], v[80:95]
v_exp_f32 v244, v104
v_add_f32 v243, v243, v251
v_cvt_pk_bf16_f32 v123, v250, v251
ds_read_b64_tr_b16 a[186:187], v223 offset:33792
v_mfma_f32_32x32x16_bf16 v[80:95], a[156:159], v[44:47], v[80:95]
v_exp_f32 v245, v105
v_add_f32 v243, v243, v244
ds_read_b64_tr_b16 a[190:191], v223 offset:37888
s_waitcnt lgkmcnt(5)
v_mfma_f32_32x32x16_bf16 a[0:15], a[160:163], v[112:115], a[0:15]
v_exp_f32 v246, v106
v_add_f32 v243, v243, v245
v_cvt_pk_bf16_f32 v124, v244, v245
v_mfma_f32_32x32x16_bf16 a[0:15], a[164:167], v[116:119], a[0:15]
v_exp_f32 v247, v107
v_add_f32 v243, v243, v246
v_mfma_f32_32x32x16_bf16 a[16:31], a[168:171], v[112:115], a[16:31]
v_exp_f32 v248, v108
v_add_f32 v243, v243, v247
v_cvt_pk_bf16_f32 v125, v246, v247
s_waitcnt lgkmcnt(2)
v_mfma_f32_32x32x16_bf16 a[16:31], a[172:175], v[116:119], a[16:31]
v_exp_f32 v249, v109
v_add_f32 v243, v243, v248
v_mfma_f32_32x32x16_bf16 a[32:47], a[176:179], v[112:115], a[32:47]
v_exp_f32 v250, v110
v_add_f32 v243, v243, v249
v_cvt_pk_bf16_f32 v126, v248, v249
v_mfma_f32_32x32x16_bf16 a[32:47], a[180:183], v[116:119], a[32:47]
v_exp_f32 v251, v111
v_add_f32 v243, v243, v250
s_waitcnt lgkmcnt(0)
v_mfma_f32_32x32x16_bf16 a[48:63], a[184:187], v[112:115], a[48:63]
v_add_f32 v243, v243, v251
v_cvt_pk_bf16_f32 v127, v250, v251
v_cmp_nge_f32 vcc, s44, v243
v_mfma_f32_32x32x16_bf16 a[48:63], a[188:191], v[116:119], a[48:63]
s_cbranch_vccnz L_slow_25
L_back_25:
v_add_f32 v241, v241, v243
v_mfma_f32_32x32x16_bf16 v[96:111], a[128:131], v[48:51], v[160:175]
s_waitcnt vmcnt(5)
s_barrier
v_exp_f32 v244, v80
v_exp_f32 v245, v81
v_mfma_f32_32x32x16_bf16 v[96:111], a[132:135], v[52:55], v[96:111]
v_cmp_eq_u32 vcc, 0, v0
v_mov_b32 v128, 1
v_mov_b32 v129, 0x40000000
v_mov_b32 v130, 49491968
v_cndmask_b32 v129, v129, v130, vcc
buffer_atomic_add v128, v129, s[96:99], 0 offen
v_exp_f32 v246, v82
v_exp_f32 v247, v83
v_add_f32 v242, v244, v245
ds_read_b128 a[128:131], v208 offset:49152
v_mfma_f32_32x32x16_bf16 v[96:111], a[136:139], v[56:59], v[96:111]
v_exp_f32 v248, v84
v_cvt_pk_bf16_f32 v112, v244, v245
v_add_f32 v242, v242, v246
v_add_f32 v242, v242, v247
ds_read_b128 a[132:135], v209 offset:49152
v_mfma_f32_32x32x16_bf16 v[96:111], a[140:143], v[60:63], v[96:111]
v_exp_f32 v249, v85
v_cvt_pk_bf16_f32 v113, v246, v247
v_add_f32 v242, v242, v248
ds_read_b128 a[136:139], v210 offset:49152
v_mfma_f32_32x32x16_bf16 v[96:111], a[144:147], v[64:67], v[96:111]
v_exp_f32 v250, v86
v_add_f32 v242, v242, v249
v_cvt_pk_bf16_f32 v114, v248, v249
ds_read_b128 a[140:143], v211 offset:49152
v_mfma_f32_32x32x16_bf16 v[96:111], a[148:151], v[68:71], v[96:111]
v_exp_f32 v251, v87
v_add_f32 v242, v242, v250
ds_read_b128 a[144:147], v212 offset:49152
v_mfma_f32_32x32x16_bf16 v[96:111], a[152:155], v[72:75], v[96:111]
v_exp_f32 v244, v88
v_add_f32 v242, v242, v251
v_cvt_pk_bf16_f32 v115, v250, v251
ds_read_b128 a[148:151], v213 offset:49152
v_mfma_f32_32x32x16_bf16 v[96:111], a[156:159], v[76:79], v[96:111]
v_exp_f32 v245, v89
v_add_f32 v242, v242, v244
ds_read_b128 a[152:155], v214 offset:49152
v_mfma_f32_32x32x16_bf16 a[64:79], a[160:163], v[120:123], a[64:79]
v_exp_f32 v246, v90
v_add_f32 v242, v242, v245
v_cvt_pk_bf16_f32 v116, v244, v245
ds_read_b128 a[156:159], v215 offset:49152
ds_read_b64_tr_b16 a[160:161], v220 offset:40960
v_mfma_f32_32x32x16_bf16 a[64:79], a[164:167], v[124:127], a[64:79]
v_exp_f32 v247, v91
v_add_f32 v242, v242, v246
ds_read_b64_tr_b16 a[164:165], v220 offset:45056
v_mfma_f32_32x32x16_bf16 a[80:95], a[168:171], v[120:123], a[80:95]
v_exp_f32 v248, v92
v_add_f32 v242, v242, v247
v_cvt_pk_bf16_f32 v117, v246, v247
ds_read_b64_tr_b16 a[168:169], v221 offset:40960
v_mfma_f32_32x32x16_bf16 a[80:95], a[172:175], v[124:127], a[80:95]
v_exp_f32 v249, v93
v_add_f32 v242, v242, v248
ds_read_b64_tr_b16 a[172:173], v221 offset:45056
v_mfma_f32_32x32x16_bf16 a[96:111], a[176:179], v[120:123], a[96:111]
v_exp_f32 v250, v94
v_add_f32 v242, v242, v249
v_cvt_pk_bf16_f32 v118, v248, v249
ds_read_b64_tr_b16 a[176:177], v222 offset:40960
v_mfma_f32_32x32x16_bf16 a[96:111], a[180:183], v[124:127], a[96:111]
v_exp_f32 v251, v95
v_add_f32 v242, v242, v250
ds_read_b64_tr_b16 a[180:181], v222 offset:45056
v_mfma_f32_32x32x16_bf16 a[112:127], a[184:187], v[120:123], a[112:127]
v_add_f32 v242, v242, v251
v_cvt_pk_bf16_f32 v119, v250, v251
v_cmp_nge_f32 vcc, s44, v242
ds_read_b64_tr_b16 a[184:185], v223 offset:40960
v_mfma_f32_32x32x16_bf16 a[112:127], a[188:191], v[124:127], a[112:127]
s_cbranch_vccnz L_slow_26
L_back_26:
v_add_f32 v240, v240, v242
ds_read_b64_tr_b16 a[188:189], v223 offset:45056
s_waitcnt lgkmcnt(5)
v_mfma_f32_32x32x16_bf16 v[80:95], a[128:131], v[16:19], v[144:159]
v_exp_f32 v244, v96
v_exp_f32 v245, v97
ds_read_b64_tr_b16 a[162:163], v220 offset:41984
v_mfma_f32_32x32x16_bf16 v[80:95], a[132:135], v[20:23], v[80:95]
v_exp_f32 v246, v98
v_exp_f32 v247, v99
v_add_f32 v243, v244, v245
ds_read_b64_tr_b16 a[166:167], v220 offset:46080
v_mfma_f32_32x32x16_bf16 v[80:95], a[136:139], v[24:27], v[80:95]
v_exp_f32 v248, v100
v_cvt_pk_bf16_f32 v120, v244, v245
v_add_f32 v243, v243, v246
v_add_f32 v243, v243, v247
ds_read_b64_tr_b16 a[170:171], v221 offset:41984
v_mfma_f32_32x32x16_bf16 v[80:95], a[140:143], v[28:31], v[80:95]
v_exp_f32 v249, v101
v_cvt_pk_bf16_f32 v121, v246, v247
v_add_f32 v243, v243, v248
ds_read_b64_tr_b16 a[174:175], v221 offset:46080
v_mfma_f32_32x32x16_bf16 v[80:95], a[144:147], v[32:35], v[80:95]
v_exp_f32 v250, v102
v_add_f32 v243, v243, v249
v_cvt_pk_bf16_f32 v122, v248, v249
ds_read_b64_tr_b16 a[178:179], v222 offset:41984
v_mfma_f32_32x32x16_bf16 v[80:95], a[148:151], v[36:39], v[80:95]
v_exp_f32 v251, v103
v_add_f32 v243, v243, v250
ds_read_b64_tr_b16 a[182:183], v222 offset:46080
v_mfma_f32_32x32x16_bf16 v[80:95], a[152:155], v[40:43], v[80:95]
v_exp_f32 v244, v104
v_add_f32 v243, v243, v251
v_cvt_pk_bf16_f32 v123, v250, v251
ds_read_b64_tr_b16 a[186:187], v223 offset:41984
v_mfma_f32_32x32x16_bf16 v[80:95], a[156:159], v[44:47], v[80:95]
v_exp_f32 v245, v105
v_add_f32 v243, v243, v244
ds_read_b64_tr_b16 a[190:191], v223 offset:46080
s_waitcnt lgkmcnt(5)
v_mfma_f32_32x32x16_bf16 a[0:15], a[160:163], v[112:115], a[0:15]
v_exp_f32 v246, v106
v_add_f32 v243, v243, v245
v_cvt_pk_bf16_f32 v124, v244, v245
v_mfma_f32_32x32x16_bf16 a[0:15], a[164:167], v[116:119], a[0:15]
v_exp_f32 v247, v107
v_add_f32 v243, v243, v246
v_mfma_f32_32x32x16_bf16 a[16:31], a[168:171], v[112:115], a[16:31]
v_exp_f32 v248, v108
v_add_f32 v243, v243, v247
v_cvt_pk_bf16_f32 v125, v246, v247
s_waitcnt lgkmcnt(2)
v_mfma_f32_32x32x16_bf16 a[16:31], a[172:175], v[116:119], a[16:31]
v_exp_f32 v249, v109
v_add_f32 v243, v243, v248
v_mfma_f32_32x32x16_bf16 a[32:47], a[176:179], v[112:115], a[32:47]
v_exp_f32 v250, v110
v_add_f32 v243, v243, v249
v_cvt_pk_bf16_f32 v126, v248, v249
v_mfma_f32_32x32x16_bf16 a[32:47], a[180:183], v[116:119], a[32:47]
v_exp_f32 v251, v111
v_add_f32 v243, v243, v250
s_waitcnt lgkmcnt(0)
v_mfma_f32_32x32x16_bf16 a[48:63], a[184:187], v[112:115], a[48:63]
v_add_f32 v243, v243, v251
v_cvt_pk_bf16_f32 v127, v250, v251
v_cmp_nge_f32 vcc, s44, v243
v_mfma_f32_32x32x16_bf16 a[48:63], a[188:191], v[116:119], a[48:63]
s_cbranch_vccnz L_slow_27
L_back_27:
v_add_f32 v241, v241, v243
v_mfma_f32_32x32x16_bf16 v[96:111], a[128:131], v[48:51], v[160:175]
v_exp_f32 v244, v80
v_exp_f32 v245, v81
v_mfma_f32_32x32x16_bf16 v[96:111], a[132:135], v[52:55], v[96:111]
v_exp_f32 v246, v82
v_exp_f32 v247, v83
v_add_f32 v242, v244, v245
ds_read_b128 a[128:131], v208 offset:57344
v_mfma_f32_32x32x16_bf16 v[96:111], a[136:139], v[56:59], v[96:111]
v_exp_f32 v248, v84
v_cvt_pk_bf16_f32 v112, v244, v245
v_add_f32 v242, v242, v246
v_add_f32 v242, v242, v247
ds_read_b128 a[132:135], v209 offset:57344
v_mfma_f32_32x32x16_bf16 v[96:111], a[140:143], v[60:63], v[96:111]
v_exp_f32 v249, v85
v_cvt_pk_bf16_f32 v113, v246, v247
v_add_f32 v242, v242, v248
ds_read_b128 a[136:139], v210 offset:57344
v_mfma_f32_32x32x16_bf16 v[96:111], a[144:147], v[64:67], v[96:111]
v_exp_f32 v250, v86
v_add_f32 v242, v242, v249
v_cvt_pk_bf16_f32 v114, v248, v249
ds_read_b128 a[140:143], v211 offset:57344
v_mfma_f32_32x32x16_bf16 v[96:111], a[148:151], v[68:71], v[96:111]
v_exp_f32 v251, v87
v_add_f32 v242, v242, v250
ds_read_b128 a[144:147], v212 offset:57344
v_mfma_f32_32x32x16_bf16 v[96:111], a[152:155], v[72:75], v[96:111]
v_exp_f32 v244, v88
v_add_f32 v242, v242, v251
v_cvt_pk_bf16_f32 v115, v250, v251
ds_read_b128 a[148:151], v213 offset:57344
v_mfma_f32_32x32x16_bf16 v[96:111], a[156:159], v[76:79], v[96:111]
v_exp_f32 v245, v89
v_add_f32 v242, v242, v244
ds_read_b128 a[152:155], v214 offset:57344
v_mfma_f32_32x32x16_bf16 a[64:79], a[160:163], v[120:123], a[64:79]
v_exp_f32 v246, v90
v_add_f32 v242, v242, v245
v_cvt_pk_bf16_f32 v116, v244, v245
ds_read_b128 a[156:159], v215 offset:57344
ds_read_b64_tr_b16 a[160:161], v220 offset:49152
v_mfma_f32_32x32x16_bf16 a[64:79], a[164:167], v[124:127], a[64:79]
v_exp_f32 v247, v91
v_add_f32 v242, v242, v246
ds_read_b64_tr_b16 a[164:165], v220 offset:53248
v_mfma_f32_32x32x16_bf16 a[80:95], a[168:171], v[120:123], a[80:95]
v_exp_f32 v248, v92
v_add_f32 v242, v242, v247
v_cvt_pk_bf16_f32 v117, v246, v247
ds_read_b64_tr_b16 a[168:169], v221 offset:49152
v_mfma_f32_32x32x16_bf16 a[80:95], a[172:175], v[124:127], a[80:95]
v_exp_f32 v249, v93
v_add_f32 v242, v242, v248
ds_read_b64_tr_b16 a[172:173], v221 offset:53248
v_mfma_f32_32x32x16_bf16 a[96:111], a[176:179], v[120:123], a[96:111]
v_exp_f32 v250, v94
v_add_f32 v242, v242, v249
v_cvt_pk_bf16_f32 v118, v248, v249
ds_read_b64_tr_b16 a[176:177], v222 offset:49152
v_mfma_f32_32x32x16_bf16 a[96:111], a[180:183], v[124:127], a[96:111]
v_exp_f32 v251, v95
v_add_f32 v242, v242, v250
ds_read_b64_tr_b16 a[180:181], v222 offset:53248
v_mfma_f32_32x32x16_bf16 a[112:127], a[184:187], v[120:123], a[112:127]
v_add_f32 v242, v242, v251
v_cvt_pk_bf16_f32 v119, v250, v251
v_cmp_nge_f32 vcc, s44, v242
ds_read_b64_tr_b16 a[184:185], v223 offset:49152
v_mfma_f32_32x32x16_bf16 a[112:127], a[188:191], v[124:127], a[112:127]
s_cbranch_vccnz L_slow_28
L_back_28:
v_add_f32 v240, v240, v242
ds_read_b64_tr_b16 a[188:189], v223 offset:53248
s_waitcnt lgkmcnt(5)
v_mfma_f32_32x32x16_bf16 v[80:95], a[128:131], v[16:19], v[144:159]
v_exp_f32 v244, v96
v_exp_f32 v245, v97
ds_read_b64_tr_b16 a[162:163], v220 offset:50176
v_mfma_f32_32x32x16_bf16 v[80:95], a[132:135], v[20:23], v[80:95]
v_exp_f32 v246, v98
v_exp_f32 v247, v99
v_add_f32 v243, v244, v245
ds_read_b64_tr_b16 a[166:167], v220 offset:54272
v_mfma_f32_32x32x16_bf16 v[80:95], a[136:139], v[24:27], v[80:95]
v_exp_f32 v248, v100
v_cvt_pk_bf16_f32 v120, v244, v245
v_add_f32 v243, v243, v246
v_add_f32 v243, v243, v247
ds_read_b64_tr_b16 a[170:171], v221 offset:50176
v_mfma_f32_32x32x16_bf16 v[80:95], a[140:143], v[28:31], v[80:95]
v_exp_f32 v249, v101
v_cvt_pk_bf16_f32 v121, v246, v247
v_add_f32 v243, v243, v248
ds_read_b64_tr_b16 a[174:175], v221 offset:54272
v_mfma_f32_32x32x16_bf16 v[80:95], a[144:147], v[32:35], v[80:95]
v_exp_f32 v250, v102
v_add_f32 v243, v243, v249
v_cvt_pk_bf16_f32 v122, v248, v249
ds_read_b64_tr_b16 a[178:179], v222 offset:50176
v_mfma_f32_32x32x16_bf16 v[80:95], a[148:151], v[36:39], v[80:95]
v_exp_f32 v251, v103
v_add_f32 v243, v243, v250
ds_read_b64_tr_b16 a[182:183], v222 offset:54272
v_mfma_f32_32x32x16_bf16 v[80:95], a[152:155], v[40:43], v[80:95]
v_exp_f32 v244, v104
v_add_f32 v243, v243, v251
v_cvt_pk_bf16_f32 v123, v250, v251
ds_read_b64_tr_b16 a[186:187], v223 offset:50176
v_mfma_f32_32x32x16_bf16 v[80:95], a[156:159], v[44:47], v[80:95]
v_exp_f32 v245, v105
v_add_f32 v243, v243, v244
ds_read_b64_tr_b16 a[190:191], v223 offset:54272
s_waitcnt lgkmcnt(5)
v_mfma_f32_32x32x16_bf16 a[0:15], a[160:163], v[112:115], a[0:15]
v_exp_f32 v246, v106
v_add_f32 v243, v243, v245
v_cvt_pk_bf16_f32 v124, v244, v245
v_mfma_f32_32x32x16_bf16 a[0:15], a[164:167], v[116:119], a[0:15]
v_exp_f32 v247, v107
v_add_f32 v243, v243, v246
v_mfma_f32_32x32x16_bf16 a[16:31], a[168:171], v[112:115], a[16:31]
v_exp_f32 v248, v108
v_add_f32 v243, v243, v247
v_cvt_pk_bf16_f32 v125, v246, v247
s_waitcnt lgkmcnt(2)
v_mfma_f32_32x32x16_bf16 a[16:31], a[172:175], v[116:119], a[16:31]
v_exp_f32 v249, v109
v_add_f32 v243, v243, v248
v_mfma_f32_32x32x16_bf16 a[32:47], a[176:179], v[112:115], a[32:47]
v_exp_f32 v250, v110
v_add_f32 v243, v243, v249
v_cvt_pk_bf16_f32 v126, v248, v249
v_mfma_f32_32x32x16_bf16 a[32:47], a[180:183], v[116:119], a[32:47]
v_exp_f32 v251, v111
v_add_f32 v243, v243, v250
s_waitcnt lgkmcnt(0)
v_mfma_f32_32x32x16_bf16 a[48:63], a[184:187], v[112:115], a[48:63]
v_add_f32 v243, v243, v251
v_cvt_pk_bf16_f32 v127, v250, v251
v_cmp_nge_f32 vcc, s44, v243
v_mfma_f32_32x32x16_bf16 a[48:63], a[188:191], v[116:119], a[48:63]
s_cbranch_vccnz L_slow_29
L_back_29:
v_add_f32 v241, v241, v243
v_mfma_f32_32x32x16_bf16 v[96:111], a[128:131], v[48:51], v[160:175]
v_exp_f32 v244, v80
v_exp_f32 v245, v81
v_mfma_f32_32x32x16_bf16 v[96:111], a[132:135], v[52:55], v[96:111]
v_exp_f32 v246, v82
v_exp_f32 v247, v83
v_add_f32 v242, v244, v245
v_mfma_f32_32x32x16_bf16 v[96:111], a[136:139], v[56:59], v[96:111]
v_exp_f32 v248, v84
v_cvt_pk_bf16_f32 v112, v244, v245
v_add_f32 v242, v242, v246
v_add_f32 v242, v242, v247
v_mfma_f32_32x32x16_bf16 v[96:111], a[140:143], v[60:63], v[96:111]
v_exp_f32 v249, v85
v_cvt_pk_bf16_f32 v113, v246, v247
v_add_f32 v242, v242, v248
v_mfma_f32_32x32x16_bf16 v[96:111], a[144:147], v[64:67], v[96:111]
v_exp_f32 v250, v86
v_add_f32 v242, v242, v249
v_cvt_pk_bf16_f32 v114, v248, v249
v_mfma_f32_32x32x16_bf16 v[96:111], a[148:151], v[68:71], v[96:111]
v_exp_f32 v251, v87
v_add_f32 v242, v242, v250
v_mfma_f32_32x32x16_bf16 v[96:111], a[152:155], v[72:75], v[96:111]
v_exp_f32 v244, v88
v_add_f32 v242, v242, v251
v_cvt_pk_bf16_f32 v115, v250, v251
v_mfma_f32_32x32x16_bf16 v[96:111], a[156:159], v[76:79], v[96:111]
v_exp_f32 v245, v89
v_add_f32 v242, v242, v244
v_mfma_f32_32x32x16_bf16 a[64:79], a[160:163], v[120:123], a[64:79]
v_exp_f32 v246, v90
v_add_f32 v242, v242, v245
v_cvt_pk_bf16_f32 v116, v244, v245
ds_read_b64_tr_b16 a[160:161], v220 offset:57344
ds_read_b64_tr_b16 a[162:163], v220 offset:58368
v_mfma_f32_32x32x16_bf16 a[64:79], a[164:167], v[124:127], a[64:79]
v_exp_f32 v247, v91
v_add_f32 v242, v242, v246
ds_read_b64_tr_b16 a[164:165], v220 offset:61440
ds_read_b64_tr_b16 a[166:167], v220 offset:62464
v_mfma_f32_32x32x16_bf16 a[80:95], a[168:171], v[120:123], a[80:95]
v_exp_f32 v248, v92
v_add_f32 v242, v242, v247
v_cvt_pk_bf16_f32 v117, v246, v247
ds_read_b64_tr_b16 a[168:169], v221 offset:57344
ds_read_b64_tr_b16 a[170:171], v221 offset:58368
v_mfma_f32_32x32x16_bf16 a[80:95], a[172:175], v[124:127], a[80:95]
v_exp_f32 v249, v93
v_add_f32 v242, v242, v248
ds_read_b64_tr_b16 a[172:173], v221 offset:61440
ds_read_b64_tr_b16 a[174:175], v221 offset:62464
v_mfma_f32_32x32x16_bf16 a[96:111], a[176:179], v[120:123], a[96:111]
v_exp_f32 v250, v94
v_add_f32 v242, v242, v249
v_cvt_pk_bf16_f32 v118, v248, v249
ds_read_b64_tr_b16 a[176:177], v222 offset:57344
ds_read_b64_tr_b16 a[178:179], v222 offset:58368
v_mfma_f32_32x32x16_bf16 a[96:111], a[180:183], v[124:127], a[96:111]
v_exp_f32 v251, v95
v_add_f32 v242, v242, v250
ds_read_b64_tr_b16 a[180:181], v222 offset:61440
ds_read_b64_tr_b16 a[182:183], v222 offset:62464
v_mfma_f32_32x32x16_bf16 a[112:127], a[184:187], v[120:123], a[112:127]
v_add_f32 v242, v242, v251
v_cvt_pk_bf16_f32 v119, v250, v251
v_cmp_nge_f32 vcc, s44, v242
ds_read_b64_tr_b16 a[184:185], v223 offset:57344
ds_read_b64_tr_b16 a[186:187], v223 offset:58368
v_mfma_f32_32x32x16_bf16 a[112:127], a[188:191], v[124:127], a[112:127]
s_cbranch_vccnz L_slow_30
L_back_30:
v_add_f32 v240, v240, v242
ds_read_b64_tr_b16 a[188:189], v223 offset:61440
ds_read_b64_tr_b16 a[190:191], v223 offset:62464
s_waitcnt lgkmcnt(10)
v_mfma_f32_32x32x16_bf16 a[0:15], a[160:163], v[112:115], a[0:15]
v_exp_f32 v244, v96
v_exp_f32 v245, v97
v_exp_f32 v246, v98
v_exp_f32 v247, v99
v_add_f32 v243, v244, v245
v_exp_f32 v248, v100
v_mfma_f32_32x32x16_bf16 a[0:15], a[164:167], v[116:119], a[0:15]
v_cvt_pk_bf16_f32 v120, v244, v245
v_add_f32 v243, v243, v246
v_add_f32 v243, v243, v247
v_exp_f32 v249, v101
v_cvt_pk_bf16_f32 v121, v246, v247
v_mfma_f32_32x32x16_bf16 a[16:31], a[168:171], v[112:115], a[16:31]
v_add_f32 v243, v243, v248
v_exp_f32 v250, v102
v_add_f32 v243, v243, v249
v_cvt_pk_bf16_f32 v122, v248, v249
v_exp_f32 v251, v103
s_waitcnt lgkmcnt(4)
v_mfma_f32_32x32x16_bf16 a[16:31], a[172:175], v[116:119], a[16:31]
v_add_f32 v243, v243, v250
v_exp_f32 v244, v104
v_add_f32 v243, v243, v251
v_cvt_pk_bf16_f32 v123, v250, v251
v_exp_f32 v245, v105
v_mfma_f32_32x32x16_bf16 a[32:47], a[176:179], v[112:115], a[32:47]
v_add_f32 v243, v243, v244
v_exp_f32 v246, v106
v_add_f32 v243, v243, v245
v_cvt_pk_bf16_f32 v124, v244, v245
v_exp_f32 v247, v107
v_add_f32 v243, v243, v246
v_mfma_f32_32x32x16_bf16 a[32:47], a[180:183], v[116:119], a[32:47]
v_exp_f32 v248, v108
v_add_f32 v243, v243, v247
v_cvt_pk_bf16_f32 v125, v246, v247
v_exp_f32 v249, v109
v_add_f32 v243, v243, v248
s_waitcnt lgkmcnt(0)
v_mfma_f32_32x32x16_bf16 a[48:63], a[184:187], v[112:115], a[48:63]
v_exp_f32 v250, v110
v_add_f32 v243, v243, v249
v_cvt_pk_bf16_f32 v126, v248, v249
v_exp_f32 v251, v111
v_add_f32 v243, v243, v250
v_mfma_f32_32x32x16_bf16 a[48:63], a[188:191], v[116:119], a[48:63]
v_add_f32 v243, v243, v251
v_cvt_pk_bf16_f32 v127, v250, v251
v_cmp_nge_f32 vcc, s44, v243
s_nop 0
s_cbranch_vccnz L_slow_31
L_back_31:
v_add_f32 v241, v241, v243
v_mfma_f32_32x32x16_bf16 a[64:79], a[160:163], v[120:123], a[64:79]
v_mov_b32 v252, v240
s_nop 1
v_permlane32_swap_b32 v252, v240
v_add_f32 v252, v252, v240
v_rcp_f32 v252, v252
v_accvgpr_read_b32 v176, a0
v_accvgpr_read_b32 v177, a1
v_accvgpr_read_b32 v178, a2
v_accvgpr_read_b32 v179, a3
v_accvgpr_read_b32 v180, a4
v_accvgpr_read_b32 v181, a5
v_accvgpr_read_b32 v182, a6
v_accvgpr_read_b32 v183, a7
v_mul_f32 v176, v176, v252
v_mul_f32 v177, v177, v252
v_mul_f32 v178, v178, v252
v_mul_f32 v179, v179, v252
v_mul_f32 v180, v180, v252
v_mul_f32 v181, v181, v252
v_mul_f32 v182, v182, v252
v_mul_f32 v183, v183, v252
v_cvt_pk_bf16_f32 v184, v176, v177
v_cvt_pk_bf16_f32 v185, v178, v179
v_mfma_f32_32x32x16_bf16 a[64:79], a[164:167], v[124:127], a[64:79]
v_cvt_pk_bf16_f32 v186, v180, v181
v_cvt_pk_bf16_f32 v187, v182, v183
s_mov_b32 s35, 0x400000
buffer_store_dwordx4 v[184:187], v239, s[96:99], s35 offen offset:0 sc1
v_accvgpr_read_b32 v188, a8
v_accvgpr_read_b32 v189, a9
v_accvgpr_read_b32 v190, a10
v_accvgpr_read_b32 v191, a11
v_accvgpr_read_b32 v192, a12
v_accvgpr_read_b32 v193, a13
v_accvgpr_read_b32 v194, a14
v_accvgpr_read_b32 v195, a15
v_mul_f32 v188, v188, v252
v_mul_f32 v189, v189, v252
v_mul_f32 v190, v190, v252
v_mul_f32 v191, v191, v252
v_mul_f32 v192, v192, v252
v_mul_f32 v193, v193, v252
v_mul_f32 v194, v194, v252
v_mul_f32 v195, v195, v252
v_cvt_pk_bf16_f32 v196, v188, v189
v_cvt_pk_bf16_f32 v197, v190, v191
v_mfma_f32_32x32x16_bf16 a[80:95], a[168:171], v[120:123], a[80:95]
v_cvt_pk_bf16_f32 v198, v192, v193
v_cvt_pk_bf16_f32 v199, v194, v195
buffer_store_dwordx4 v[196:199], v239, s[96:99], s35 offen offset:1024 sc1
v_accvgpr_read_b32 v176, a16
v_accvgpr_read_b32 v177, a17
v_accvgpr_read_b32 v178, a18
v_accvgpr_read_b32 v179, a19
v_accvgpr_read_b32 v180, a20
v_accvgpr_read_b32 v181, a21
v_accvgpr_read_b32 v182, a22
v_accvgpr_read_b32 v183, a23
v_mul_f32 v176, v176, v252
v_mul_f32 v177, v177, v252
v_mul_f32 v178, v178, v252
v_mul_f32 v179, v179, v252
v_mul_f32 v180, v180, v252
v_mul_f32 v181, v181, v252
v_mul_f32 v182, v182, v252
v_mul_f32 v183, v183, v252
v_cvt_pk_bf16_f32 v184, v176, v177
v_cvt_pk_bf16_f32 v185, v178, v179
v_cvt_pk_bf16_f32 v186, v180, v181
v_mfma_f32_32x32x16_bf16 a[80:95], a[172:175], v[124:127], a[80:95]
v_cvt_pk_bf16_f32 v187, v182, v183
buffer_store_dwordx4 v[184:187], v239, s[96:99], s35 offen offset:2048 sc1
v_accvgpr_read_b32 v188, a24
v_accvgpr_read_b32 v189, a25
v_accvgpr_read_b32 v190, a26
v_accvgpr_read_b32 v191, a27
v_accvgpr_read_b32 v192, a28
v_accvgpr_read_b32 v193, a29
v_accvgpr_read_b32 v194, a30
v_accvgpr_read_b32 v195, a31
v_mul_f32 v188, v188, v252
v_mul_f32 v189, v189, v252
v_mul_f32 v190, v190, v252
v_mul_f32 v191, v191, v252
v_mul_f32 v192, v192, v252
v_mul_f32 v193, v193, v252
v_mul_f32 v194, v194, v252
v_mul_f32 v195, v195, v252
v_cvt_pk_bf16_f32 v196, v188, v189
v_cvt_pk_bf16_f32 v197, v190, v191
v_cvt_pk_bf16_f32 v198, v192, v193
v_mfma_f32_32x32x16_bf16 a[96:111], a[176:179], v[120:123], a[96:111]
v_cvt_pk_bf16_f32 v199, v194, v195
buffer_store_dwordx4 v[196:199], v239, s[96:99], s35 offen offset:3072 sc1
v_accvgpr_read_b32 v176, a32
v_accvgpr_read_b32 v177, a33
v_accvgpr_read_b32 v178, a34
v_accvgpr_read_b32 v179, a35
v_accvgpr_read_b32 v180, a36
v_accvgpr_read_b32 v181, a37
v_accvgpr_read_b32 v182, a38
v_accvgpr_read_b32 v183, a39
v_mul_f32 v176, v176, v252
v_mul_f32 v177, v177, v252
v_mul_f32 v178, v178, v252
v_mul_f32 v179, v179, v252
v_mul_f32 v180, v180, v252
v_mul_f32 v181, v181, v252
v_mul_f32 v182, v182, v252
v_mul_f32 v183, v183, v252
v_cvt_pk_bf16_f32 v184, v176, v177
v_cvt_pk_bf16_f32 v185, v178, v179
v_cvt_pk_bf16_f32 v186, v180, v181
v_cvt_pk_bf16_f32 v187, v182, v183
v_mfma_f32_32x32x16_bf16 a[96:111], a[180:183], v[124:127], a[96:111]
s_mov_b32 s35, 0x401000
buffer_store_dwordx4 v[184:187], v239, s[96:99], s35 offen offset:0 sc1
v_accvgpr_read_b32 v188, a40
v_accvgpr_read_b32 v189, a41
v_accvgpr_read_b32 v190, a42
v_accvgpr_read_b32 v191, a43
v_accvgpr_read_b32 v192, a44
v_accvgpr_read_b32 v193, a45
v_accvgpr_read_b32 v194, a46
v_accvgpr_read_b32 v195, a47
v_mul_f32 v188, v188, v252
v_mul_f32 v189, v189, v252
v_mul_f32 v190, v190, v252
v_mul_f32 v191, v191, v252
v_mul_f32 v192, v192, v252
v_mul_f32 v193, v193, v252
v_mul_f32 v194, v194, v252
v_mul_f32 v195, v195, v252
v_cvt_pk_bf16_f32 v196, v188, v189
v_cvt_pk_bf16_f32 v197, v190, v191
v_cvt_pk_bf16_f32 v198, v192, v193
v_cvt_pk_bf16_f32 v199, v194, v195
v_mfma_f32_32x32x16_bf16 a[112:127], a[184:187], v[120:123], a[112:127]
buffer_store_dwordx4 v[196:199], v239, s[96:99], s35 offen offset:1024 sc1
v_accvgpr_read_b32 v176, a48
v_accvgpr_read_b32 v177, a49
v_accvgpr_read_b32 v178, a50
v_accvgpr_read_b32 v179, a51
v_accvgpr_read_b32 v180, a52
v_accvgpr_read_b32 v181, a53
v_accvgpr_read_b32 v182, a54
v_accvgpr_read_b32 v183, a55
v_mul_f32 v176, v176, v252
v_mul_f32 v177, v177, v252
v_mul_f32 v178, v178, v252
v_mul_f32 v179, v179, v252
v_mul_f32 v180, v180, v252
v_mul_f32 v181, v181, v252
v_mul_f32 v182, v182, v252
v_mul_f32 v183, v183, v252
v_cvt_pk_bf16_f32 v184, v176, v177
v_cvt_pk_bf16_f32 v185, v178, v179
v_cvt_pk_bf16_f32 v186, v180, v181
v_cvt_pk_bf16_f32 v187, v182, v183
buffer_store_dwordx4 v[184:187], v239, s[96:99], s35 offen offset:2048 sc1
v_mfma_f32_32x32x16_bf16 a[112:127], a[188:191], v[124:127], a[112:127]
v_accvgpr_read_b32 v188, a56
v_accvgpr_read_b32 v189, a57
v_accvgpr_read_b32 v190, a58
v_accvgpr_read_b32 v191, a59
v_accvgpr_read_b32 v192, a60
v_accvgpr_read_b32 v193, a61
v_accvgpr_read_b32 v194, a62
v_accvgpr_read_b32 v195, a63
v_mul_f32 v188, v188, v252
v_mul_f32 v189, v189, v252
v_mul_f32 v190, v190, v252
v_mul_f32 v191, v191, v252
v_mul_f32 v192, v192, v252
v_mul_f32 v193, v193, v252
v_mul_f32 v194, v194, v252
v_mul_f32 v195, v195, v252
v_cvt_pk_bf16_f32 v196, v188, v189
v_cvt_pk_bf16_f32 v197, v190, v191
v_cvt_pk_bf16_f32 v198, v192, v193
v_cvt_pk_bf16_f32 v199, v194, v195
buffer_store_dwordx4 v[196:199], v239, s[96:99], s35 offen offset:3072 sc1
v_mov_b32 v252, v241
s_nop 1
v_permlane32_swap_b32 v252, v241
v_add_f32 v252, v252, v241
v_rcp_f32 v252, v252
v_accvgpr_read_b32 v176, a64
v_accvgpr_read_b32 v177, a65
v_accvgpr_read_b32 v178, a66
v_accvgpr_read_b32 v179, a67
v_accvgpr_read_b32 v180, a68
v_accvgpr_read_b32 v181, a69
v_accvgpr_read_b32 v182, a70
v_accvgpr_read_b32 v183, a71
v_pk_mul_f32 v[176:177], v[176:177], v[252:253] op_sel_hi:[1,0]
v_pk_mul_f32 v[178:179], v[178:179], v[252:253] op_sel_hi:[1,0]
v_pk_mul_f32 v[180:181], v[180:181], v[252:253] op_sel_hi:[1,0]
v_pk_mul_f32 v[182:183], v[182:183], v[252:253] op_sel_hi:[1,0]
v_cvt_pk_bf16_f32 v184, v176, v177
v_cvt_pk_bf16_f32 v185, v178, v179
v_cvt_pk_bf16_f32 v186, v180, v181
v_cvt_pk_bf16_f32 v187, v182, v183
s_mov_b32 s35, 0x440000
buffer_store_dwordx4 v[184:187], v239, s[96:99], s35 offen offset:0 sc1
v_accvgpr_read_b32 v188, a72
v_accvgpr_read_b32 v189, a73
v_accvgpr_read_b32 v190, a74
v_accvgpr_read_b32 v191, a75
v_accvgpr_read_b32 v192, a76
v_accvgpr_read_b32 v193, a77
v_accvgpr_read_b32 v194, a78
v_accvgpr_read_b32 v195, a79
v_pk_mul_f32 v[188:189], v[188:189], v[252:253] op_sel_hi:[1,0]
v_pk_mul_f32 v[190:191], v[190:191], v[252:253] op_sel_hi:[1,0]
v_pk_mul_f32 v[192:193], v[192:193], v[252:253] op_sel_hi:[1,0]
v_pk_mul_f32 v[194:195], v[194:195], v[252:253] op_sel_hi:[1,0]
v_cvt_pk_bf16_f32 v196, v188, v189
v_cvt_pk_bf16_f32 v197, v190, v191
v_cvt_pk_bf16_f32 v198, v192, v193
v_cvt_pk_bf16_f32 v199, v194, v195
buffer_store_dwordx4 v[196:199], v239, s[96:99], s35 offen offset:1024 sc1
v_accvgpr_read_b32 v176, a80
v_accvgpr_read_b32 v177, a81
v_accvgpr_read_b32 v178, a82
v_accvgpr_read_b32 v179, a83
v_accvgpr_read_b32 v180, a84
v_accvgpr_read_b32 v181, a85
v_accvgpr_read_b32 v182, a86
v_accvgpr_read_b32 v183, a87
v_pk_mul_f32 v[176:177], v[176:177], v[252:253] op_sel_hi:[1,0]
v_pk_mul_f32 v[178:179], v[178:179], v[252:253] op_sel_hi:[1,0]
v_pk_mul_f32 v[180:181], v[180:181], v[252:253] op_sel_hi:[1,0]
v_pk_mul_f32 v[182:183], v[182:183], v[252:253] op_sel_hi:[1,0]
v_cvt_pk_bf16_f32 v184, v176, v177
v_cvt_pk_bf16_f32 v185, v178, v179
v_cvt_pk_bf16_f32 v186, v180, v181
v_cvt_pk_bf16_f32 v187, v182, v183
buffer_store_dwordx4 v[184:187], v239, s[96:99], s35 offen offset:2048 sc1
v_accvgpr_read_b32 v188, a88
v_accvgpr_read_b32 v189, a89
v_accvgpr_read_b32 v190, a90
v_accvgpr_read_b32 v191, a91
v_accvgpr_read_b32 v192, a92
v_accvgpr_read_b32 v193, a93
v_accvgpr_read_b32 v194, a94
v_accvgpr_read_b32 v195, a95
v_pk_mul_f32 v[188:189], v[188:189], v[252:253] op_sel_hi:[1,0]
v_pk_mul_f32 v[190:191], v[190:191], v[252:253] op_sel_hi:[1,0]
v_pk_mul_f32 v[192:193], v[192:193], v[252:253] op_sel_hi:[1,0]
v_pk_mul_f32 v[194:195], v[194:195], v[252:253] op_sel_hi:[1,0]
v_cvt_pk_bf16_f32 v196, v188, v189
v_cvt_pk_bf16_f32 v197, v190, v191
v_cvt_pk_bf16_f32 v198, v192, v193
v_cvt_pk_bf16_f32 v199, v194, v195
buffer_store_dwordx4 v[196:199], v239, s[96:99], s35 offen offset:3072 sc1
v_accvgpr_read_b32 v176, a96
v_accvgpr_read_b32 v177, a97
v_accvgpr_read_b32 v178, a98
v_accvgpr_read_b32 v179, a99
v_accvgpr_read_b32 v180, a100
v_accvgpr_read_b32 v181, a101
v_accvgpr_read_b32 v182, a102
v_accvgpr_read_b32 v183, a103
v_pk_mul_f32 v[176:177], v[176:177], v[252:253] op_sel_hi:[1,0]
v_pk_mul_f32 v[178:179], v[178:179], v[252:253] op_sel_hi:[1,0]
v_pk_mul_f32 v[180:181], v[180:181], v[252:253] op_sel_hi:[1,0]
v_pk_mul_f32 v[182:183], v[182:183], v[252:253] op_sel_hi:[1,0]
v_cvt_pk_bf16_f32 v184, v176, v177
v_cvt_pk_bf16_f32 v185, v178, v179
v_cvt_pk_bf16_f32 v186, v180, v181
v_cvt_pk_bf16_f32 v187, v182, v183
s_mov_b32 s35, 0x441000
buffer_store_dwordx4 v[184:187], v239, s[96:99], s35 offen offset:0 sc1
v_accvgpr_read_b32 v188, a104
v_accvgpr_read_b32 v189, a105
v_accvgpr_read_b32 v190, a106
v_accvgpr_read_b32 v191, a107
v_accvgpr_read_b32 v192, a108
v_accvgpr_read_b32 v193, a109
v_accvgpr_read_b32 v194, a110
v_accvgpr_read_b32 v195, a111
v_pk_mul_f32 v[188:189], v[188:189], v[252:253] op_sel_hi:[1,0]
v_pk_mul_f32 v[190:191], v[190:191], v[252:253] op_sel_hi:[1,0]
v_pk_mul_f32 v[192:193], v[192:193], v[252:253] op_sel_hi:[1,0]
v_pk_mul_f32 v[194:195], v[194:195], v[252:253] op_sel_hi:[1,0]
v_cvt_pk_bf16_f32 v196, v188, v189
v_cvt_pk_bf16_f32 v197, v190, v191
v_cvt_pk_bf16_f32 v198, v192, v193
v_cvt_pk_bf16_f32 v199, v194, v195
buffer_store_dwordx4 v[196:199], v239, s[96:99], s35 offen offset:1024 sc1
v_accvgpr_read_b32 v176, a112
v_accvgpr_read_b32 v177, a113
v_accvgpr_read_b32 v178, a114
v_accvgpr_read_b32 v179, a115
v_accvgpr_read_b32 v180, a116
v_accvgpr_read_b32 v181, a117
v_accvgpr_read_b32 v182, a118
v_accvgpr_read_b32 v183, a119
v_pk_mul_f32 v[176:177], v[176:177], v[252:253] op_sel_hi:[1,0]
v_pk_mul_f32 v[178:179], v[178:179], v[252:253] op_sel_hi:[1,0]
v_pk_mul_f32 v[180:181], v[180:181], v[252:253] op_sel_hi:[1,0]
v_pk_mul_f32 v[182:183], v[182:183], v[252:253] op_sel_hi:[1,0]
v_cvt_pk_bf16_f32 v184, v176, v177
v_cvt_pk_bf16_f32 v185, v178, v179
v_cvt_pk_bf16_f32 v186, v180, v181
v_cvt_pk_bf16_f32 v187, v182, v183
buffer_store_dwordx4 v[184:187], v239, s[96:99], s35 offen offset:2048 sc1
v_accvgpr_read_b32 v188, a120
v_accvgpr_read_b32 v189, a121
v_accvgpr_read_b32 v190, a122
v_accvgpr_read_b32 v191, a123
v_accvgpr_read_b32 v192, a124
v_accvgpr_read_b32 v193, a125
v_accvgpr_read_b32 v194, a126
v_accvgpr_read_b32 v195, a127
v_pk_mul_f32 v[188:189], v[188:189], v[252:253] op_sel_hi:[1,0]
v_pk_mul_f32 v[190:191], v[190:191], v[252:253] op_sel_hi:[1,0]
v_pk_mul_f32 v[192:193], v[192:193], v[252:253] op_sel_hi:[1,0]
v_pk_mul_f32 v[194:195], v[194:195], v[252:253] op_sel_hi:[1,0]
v_cvt_pk_bf16_f32 v196, v188, v189
v_cvt_pk_bf16_f32 v197, v190, v191
v_cvt_pk_bf16_f32 v198, v192, v193
v_cvt_pk_bf16_f32 v199, v194, v195
buffer_store_dwordx4 v[196:199], v239, s[96:99], s35 offen offset:3072 sc1
s_waitcnt vmcnt(0)
s_barrier
s_cmp_lg_u32 s100, 0
s_cbranch_scc1 L_sig3
s_mov_b64 exec, 1
v_mov_b32 v24, 1
v_mov_b32 v25, 49561600
v_mov_b32 v26, 1
buffer_atomic_add v24, v25, s[96:99], s36 offen sc0
s_waitcnt vmcnt(0)
v_cmp_eq_u32 vcc, 7, v24
v_mov_b32 v27, 0x40000000
s_nop 0
v_cndmask_b32 v25, v27, v25, vcc
v_add_u32 v25, 139264, v25
buffer_store_dword v26, v25, s[96:99], s36 offen sc1
s_mov_b64 exec, -1
L_sig3:
s_load_dwordx2 s[40:41], s[0:1], 0
s_load_dwordx2 s[42:43], s[0:1], 32
s_load_dwordx4 s[44:47], s[0:1], 48
v_lshrrev_b32 v1, 6, v0
v_and_b32 v2, 63, v0
s_bfe_u32 s3, s2, 0x20001
s_and_b32 s5, s2, 1
s_lshl_b32 s5, s5, 2
s_bfe_u32 s6, s2, 0x20003
s_add_u32 s5, s5, s6
s_lshl_b32 s5, s5, 1
s_bfe_u32 s6, s2, 0x10005
s_add_u32 s5, s5, s6
s_lshr_b32 s6, s2, 6
s_lshr_b32 s37, s5, 1
s_lshl_b32 s36, s37, 2
s_add_u32 s36, s36, s3
s_mul_i32 s36, s36, 4352
s_mul_i32 s37, s37, 4352
s_lshl_b32 s35, s5, 2
s_add_u32 s35, s35, s6
s_mul_i32 s29, s100, 5120
s_mul_i32 s31, s3, 1310720
s_mul_i32 s7, s6, 320
s_add_u32 s31, s31, s7
s_mul_i32 s7, s100, 320
v_add_u32 v8, s7, v2
v_add_u32 v9, 0, v8
v_mul_u32_u24 v10, 3277, v9
v_lshrrev_b32 v10, 16, v10
v_mul_u32_u24 v11, 20, v10
v_sub_u32 v11, v9, v11
v_mul_u32_u24 v10, 1280, v10
v_lshl_add_u32 v10, v11, 4, v10
v_subrev_u32 v20, 0, v10
v_add_u32 v9, 64, v8
v_mul_u32_u24 v10, 3277, v9
v_lshrrev_b32 v10, 16, v10
v_mul_u32_u24 v11, 20, v10
v_sub_u32 v11, v9, v11
v_mul_u32_u24 v10, 1280, v10
v_lshl_add_u32 v10, v11, 4, v10
v_subrev_u32 v21, 1024, v10
v_add_u32 v9, 128, v8
v_mul_u32_u24 v10, 3277, v9
v_lshrrev_b32 v10, 16, v10
v_mul_u32_u24 v11, 20, v10
v_sub_u32 v11, v9, v11
v_mul_u32_u24 v10, 1280, v10
v_lshl_add_u32 v10, v11, 4, v10
v_subrev_u32 v22, 2048, v10
v_add_u32 v9, 192, v8
v_mul_u32_u24 v10, 3277, v9
v_lshrrev_b32 v10, 16, v10
v_mul_u32_u24 v11, 20, v10
v_sub_u32 v11, v9, v11
v_mul_u32_u24 v10, 1280, v10
v_lshl_add_u32 v10, v11, 4, v10
v_subrev_u32 v23, 3072, v10
v_add_u32 v9, 256, v8
v_mul_u32_u24 v10, 3277, v9
v_lshrrev_b32 v10, 16, v10
v_mul_u32_u24 v11, 20, v10
v_sub_u32 v11, v9, v11
v_mul_u32_u24 v10, 1280, v10
v_lshl_add_u32 v10, v11, 4, v10
v_subrev_u32 v24, 0, v10
s_waitcnt lgkmcnt(0)
s_mov_b32 s8, s42
s_mov_b32 s9, s43
s_mov_b32 s10, 0x500000
s_mov_b32 s11, 0x20000
s_mov_b32 s24, s40
s_mov_b32 s25, s41
s_mov_b32 s26, 0x280000
s_mov_b32 s27, 0x20000
s_add_u32 s30, s31, 0
s_add_u32 m0, s29, 0
s_nop 0
buffer_load_dwordx4 v20, s[8:11], s30 offen offset:0 lds
buffer_load_dwordx4 v21, s[8:11], s30 offen offset:1024 lds
buffer_load_dwordx4 v22, s[8:11], s30 offen offset:2048 lds
buffer_load_dwordx4 v23, s[8:11], s30 offen offset:3072 lds
s_add_u32 m0, s29, 4096
s_nop 0
buffer_load_dwordx4 v24, s[8:11], s30 offen offset:0 lds
s_add_u32 s30, s31, 81920
s_add_u32 m0, s29, 20480
s_nop 0
buffer_load_dwordx4 v20, s[8:11], s30 offen offset:0 lds
buffer_load_dwordx4 v21, s[8:11], s30 offen offset:1024 lds
buffer_load_dwordx4 v22, s[8:11], s30 offen offset:2048 lds
buffer_load_dwordx4 v23, s[8:11], s30 offen offset:3072 lds
s_add_u32 m0, s29, 24576
s_nop 0
buffer_load_dwordx4 v24, s[8:11], s30 offen offset:0 lds
s_add_u32 s30, s31, 163840
s_add_u32 m0, s29, 40960
s_nop 0
buffer_load_dwordx4 v20, s[8:11], s30 offen offset:0 lds
buffer_load_dwordx4 v21, s[8:11], s30 offen offset:1024 lds
buffer_load_dwordx4 v22, s[8:11], s30 offen offset:2048 lds
buffer_load_dwordx4 v23, s[8:11], s30 offen offset:3072 lds
s_add_u32 m0, s29, 45056
s_nop 0
buffer_load_dwordx4 v24, s[8:11], s30 offen offset:0 lds
s_add_u32 s30, s31, 245760
s_add_u32 m0, s29, 61440
s_nop 0
buffer_load_dwordx4 v20, s[8:11], s30 offen offset:0 lds
buffer_load_dwordx4 v21, s[8:11], s30 offen offset:1024 lds
buffer_load_dwordx4 v22, s[8:11], s30 offen offset:2048 lds
buffer_load_dwordx4 v23, s[8:11], s30 offen offset:3072 lds
s_add_u32 m0, s29, 65536
s_nop 0
buffer_load_dwordx4 v24, s[8:11], s30 offen offset:0 lds
v_lshrrev_b32 v5, 5, v2
v_bfe_u32 v6, v2, 2, 2
v_lshl_add_u32 v8, v5, 3, v6
v_mul_u32_u24 v8, 320, v8
v_bfe_u32 v9, v2, 4, 1
v_lshl_add_u32 v8, v9, 5, v8
v_and_b32 v9, 1, v2
v_lshl_add_u32 v8, v9, 4, v8
v_bfe_u32 v9, v2, 1, 1
v_lshl_add_u32 v26, v9, 3, v8
v_add_u32 v27, 40960, v26
v_add_u32 v28, 81920, v26
v_add_u32 v29, 122880, v26
v_lshlrev_b32 v3, 4, v2
s_lshl_b32 s7, s5, 2
s_add_u32 s7, s7, s100
s_lshl_b32 s7, s7, 8
s_lshl_b32 s4, s3, 6
s_add_u32 s7, s7, s4
s_lshl_b32 s7, s7, 10
v_add_u32 v30, s7, v3
s_lshl_b32 s7, s35, 2
s_add_u32 s4, s7, s100
s_lshl_b32 s4, s4, 2
s_add_u32 s4, s4, s3
s_mul_i32 s4, s4, 10240
s_cmp_eq_u32 s3, s100
s_cselect_b32 s4, 0x40000000, s4
v_add_u32 v31, s4, v3
s_add_u32 s4, s7, s3
s_mul_i32 s4, s4, 40960
s_lshl_b32 s7, s100, 10
s_add_u32 s4, s4, s7
v_add_u32 v35, s4, v3
s_mul_i32 s35, s35, 4352
s_lshl_b32 s7, s100, 11
v_add_u32 v19, s7, v3
s_mov_b32 s48, 0x3200000
s_cmp_eq_u32 s3, 0
s_cselect_b32 s48, 0x40000000, s48
s_mov_b32 s49, 0x3202800
s_cmp_eq_u32 s3, 1
s_cselect_b32 s49, 0x40000000, s49
s_mov_b32 s50, 0x3205000
s_cmp_eq_u32 s3, 2
s_cselect_b32 s50, 0x40000000, s50
s_mov_b32 s51, 0x3207800
s_cmp_eq_u32 s3, 3
s_cselect_b32 s51, 0x40000000, s51
s_lshl_b32 s7, s5, 2
s_add_u32 s7, s7, s3
s_mul_i32 s4, s6, 20
s_lshl_b32 s33, s100, 1
s_add_u32 s4, s4, s33
v_add_u32 v9, s4, v5
v_and_b32 v10, 31, v2
s_lshl_b32 s33, s7, 5
v_add_u32 v36, s33, v10
v_mul_u32_u24 v32, 1280, v36
v_lshl_add_u32 v32, v9, 4, v32
v_lshlrev_b32 v33, 5, v9
s_mul_i32 s33, s7, 40960
s_lshl_b32 s4, s4, 9
s_add_u32 s33, s33, s4
v_add_u32 v34, s33, v3
s_mov_b32 s53, 0x3caaaaab
s_cmp_ge_u32 s100, 2
s_cselect_b32 s52, 0x40000000, 0
s_cselect_b32 s53, 0x3d000000, s53
s_mul_i32 s56, s2, 1214
s_lshr_b32 s56, s56, 16
s_mul_i32 s57, s56, 54
s_sub_u32 s57, s2, s57
s_cmp_ge_u32 s57, 27
s_cselect_b32 s12, s46, s44
s_cselect_b32 s13, s47, s45
s_cselect_b32 s3, 27, 0
s_mov_b32 s14, 0x21c000
s_mov_b32 s15, 0x20000
s_sub_u32 s3, s57, s3
s_lshl_b32 s3, s3, 7
s_mul_i32 s4, s56, 160
s_mul_i32 s7, s100, 40
s_add_u32 s4, s4, s7
v_lshrrev_b32 v14, 3, v2
v_add_u32 v14, s4, v14
v_mul_u32_u24 v15, 3456, v14
v_and_b32 v16, 7, v2
v_lshl_add_u32 v15, v16, 4, v15
v_add_u32 v15, s3, v15
v_lshlrev_b32 v14, 2, v14
s_mov_b32 s4, 7680
s_mov_b32 s54, 5120
s_mov_b32 s55, 10240
v_mov_b32 v38, 49700864
v_add_u32 v38, s36, v38
v_mov_b32 v39, 49491968
v_mov_b32 v40, 1
v_mov_b32 v41, 256
v_cmp_eq_u32 vcc, 0, v2
s_nop 1
v_cndmask_b32 v38, v39, v38, vcc
v_cndmask_b32 v40, v41, v40, vcc
s_mov_b32 s101, 0
L_poll4:
buffer_load_dword v39, v38, s[96:99], 0 offen sc1
s_add_u32 s101, s101, 1
s_waitcnt vmcnt(0)
v_cmp_gt_u32 vcc, v40, v39
s_nop 0
s_cbranch_vccz L_poll4_go
s_sleep 2
s_cmp_lt_u32 s101, 0x20000
s_cbranch_scc1 L_poll4
L_poll4_go:
s_mov_b32 s34, 0x400000
buffer_load_dwordx4 a[0:3], v30, s[96:99], s34 offen offset:0 sc1
buffer_load_dwordx4 a[4:7], v30, s[96:99], s34 offen offset:1024 sc1
buffer_load_dwordx4 a[8:11], v30, s[96:99], s34 offen offset:2048 sc1
buffer_load_dwordx4 a[12:15], v30, s[96:99], s34 offen offset:3072 sc1
s_mov_b32 s34, 0x401000
buffer_load_dwordx4 a[16:19], v30, s[96:99], s34 offen offset:0 sc1
buffer_load_dwordx4 a[20:23], v30, s[96:99], s34 offen offset:1024 sc1
buffer_load_dwordx4 a[24:27], v30, s[96:99], s34 offen offset:2048 sc1
buffer_load_dwordx4 a[28:31], v30, s[96:99], s34 offen offset:3072 sc1
s_mov_b32 s34, 0x402000
buffer_load_dwordx4 a[32:35], v30, s[96:99], s34 offen offset:0 sc1
buffer_load_dwordx4 a[36:39], v30, s[96:99], s34 offen offset:1024 sc1
buffer_load_dwordx4 a[40:43], v30, s[96:99], s34 offen offset:2048 sc1
buffer_load_dwordx4 a[44:47], v30, s[96:99], s34 offen offset:3072 sc1
s_barrier
ds_read_b64_tr_b16 a[128:129], v26 offset:0
ds_read_b64_tr_b16 a[130:131], v26 offset:1280
ds_read_b64_tr_b16 a[132:133], v26 offset:64
ds_read_b64_tr_b16 a[134:135], v26 offset:1344
ds_read_b64_tr_b16 a[136:137], v26 offset:128
ds_read_b64_tr_b16 a[138:139], v26 offset:1408
ds_read_b64_tr_b16 a[140:141], v26 offset:192
ds_read_b64_tr_b16 a[142:143], v26 offset:1472
ds_read_b64_tr_b16 a[144:145], v26 offset:256
ds_read_b64_tr_b16 a[146:147], v26 offset:1536
ds_read_b64_tr_b16 a[148:149], v26 offset:5120
ds_read_b64_tr_b16 a[150:151], v26 offset:6400
ds_read_b64_tr_b16 a[152:153], v26 offset:5184
ds_read_b64_tr_b16 a[154:155], v26 offset:6464
ds_read_b64_tr_b16 a[156:157], v26 offset:5248
ds_read_b64_tr_b16 a[158:159], v26 offset:6528
ds_read_b64_tr_b16 a[160:161], v26 offset:5312
ds_read_b64_tr_b16 a[162:163], v26 offset:6592
ds_read_b64_tr_b16 a[164:165], v26 offset:5376
ds_read_b64_tr_b16 a[166:167], v26 offset:6656
s_waitcnt vmcnt(11) lgkmcnt(15)
v_mfma_f32_32x32x16_bf16 v[96:111], a[128:131], a[0:3], 0
ds_read_b64_tr_b16 a[168:169], v26 offset:10240
ds_read_b64_tr_b16 a[170:171], v26 offset:11520
s_add_u32 s30, s31, 327680
s_add_u32 m0, s29, 81920
s_nop 0
buffer_load_dwordx4 v20, s[8:11], s30 offen offset:0 lds
s_waitcnt lgkmcnt(15)
v_mfma_f32_32x32x16_bf16 v[112:127], a[132:135], a[0:3], 0
ds_read_b64_tr_b16 a[172:173], v26 offset:10304
ds_read_b64_tr_b16 a[174:175], v26 offset:11584
buffer_load_dwordx4 v21, s[8:11], s30 offen offset:1024 lds
s_waitcnt lgkmcnt(15)
v_mfma_f32_32x32x16_bf16 v[128:143], a[136:139], a[0:3], 0
ds_read_b64_tr_b16 a[176:177], v26 offset:10368
ds_read_b64_tr_b16 a[178:179], v26 offset:11648
s_mov_b32 s34, 0x403000
buffer_load_dwordx4 a[48:51], v30, s[96:99], s34 offen offset:0 sc1
buffer_load_dwordx4 v22, s[8:11], s30 offen offset:2048 lds
s_waitcnt lgkmcnt(15)
v_mfma_f32_32x32x16_bf16 v[144:159], a[140:143], a[0:3], 0
ds_read_b64_tr_b16 a[180:181], v26 offset:10432
ds_read_b64_tr_b16 a[182:183], v26 offset:11712
buffer_load_dwordx4 v23, s[8:11], s30 offen offset:3072 lds
s_waitcnt lgkmcnt(15)
v_mfma_f32_32x32x16_bf16 v[160:175], a[144:147], a[0:3], 0
ds_read_b64_tr_b16 a[184:185], v26 offset:10496
ds_read_b64_tr_b16 a[186:187], v26 offset:11776
s_add_u32 m0, s29, 86016
s_nop 0
buffer_load_dwordx4 v24, s[8:11], s30 offen offset:0 lds
s_waitcnt vmcnt(16) lgkmcnt(10)
v_mfma_f32_32x32x16_bf16 v[96:111], a[148:151], a[4:7], v[96:111]
ds_read_b64_tr_b16 a[188:189], v26 offset:15360
ds_read_b64_tr_b16 a[190:191], v26 offset:16640
s_add_u32 s30, s31, 409600
s_add_u32 m0, s29, 102400
s_nop 0
buffer_load_dwordx4 v20, s[8:11], s30 offen offset:0 lds
v_mfma_f32_32x32x16_bf16 v[112:127], a[152:155], a[4:7], v[112:127]
ds_read_b64_tr_b16 a[192:193], v26 offset:15424
ds_read_b64_tr_b16 a[194:195], v26 offset:16704
buffer_load_dwordx4 v21, s[8:11], s30 offen offset:1024 lds
v_mfma_f32_32x32x16_bf16 v[128:143], a[156:159], a[4:7], v[128:143]
ds_read_b64_tr_b16 a[196:197], v26 offset:15488
ds_read_b64_tr_b16 a[198:199], v26 offset:16768
buffer_load_dwordx4 a[52:55], v30, s[96:99], s34 offen offset:1024 sc1
buffer_load_dwordx4 v22, s[8:11], s30 offen offset:2048 lds
v_mfma_f32_32x32x16_bf16 v[144:159], a[160:163], a[4:7], v[144:159]
ds_read_b64_tr_b16 a[200:201], v26 offset:15552
ds_read_b64_tr_b16 a[202:203], v26 offset:16832
buffer_load_dwordx4 v23, s[8:11], s30 offen offset:3072 lds
v_mfma_f32_32x32x16_bf16 v[160:175], a[164:167], a[4:7], v[160:175]
ds_read_b64_tr_b16 a[204:205], v26 offset:15616
ds_read_b64_tr_b16 a[206:207], v26 offset:16896
s_add_u32 m0, s29, 106496
s_nop 0
buffer_load_dwordx4 v24, s[8:11], s30 offen offset:0 lds
s_waitcnt vmcnt(21) lgkmcnt(10)
v_mfma_f32_32x32x16_bf16 v[96:111], a[168:171], a[8:11], v[96:111]
ds_read_b64_tr_b16 a[128:129], v26 offset:20480
ds_read_b64_tr_b16 a[130:131], v26 offset:21760
s_mov_b32 s33, 0
buffer_load_dwordx4 v[176:179], v15, s[12:15], s33 offen
v_mfma_f32_32x32x16_bf16 v[112:127], a[172:175], a[8:11], v[112:127]
ds_read_b64_tr_b16 a[132:133], v26 offset:20544
ds_read_b64_tr_b16 a[134:135], v26 offset:21824
buffer_load_dword v4, v14, s[96:99], s55 offen offset:0 sc1
v_mfma_f32_32x32x16_bf16 v[128:143], a[176:179], a[8:11], v[128:143]
ds_read_b64_tr_b16 a[136:137], v26 offset:20608
ds_read_b64_tr_b16 a[138:139], v26 offset:21888
buffer_load_dwordx4 a[56:59], v30, s[96:99], s34 offen offset:2048 sc1
buffer_load_dword v9, v14, s[96:99], s4 offen offset:0 sc1
v_mfma_f32_32x32x16_bf16 v[144:159], a[180:183], a[8:11], v[144:159]
ds_read_b64_tr_b16 a[140:141], v26 offset:20672
ds_read_b64_tr_b16 a[142:143], v26 offset:21952
s_mov_b32 s33, 27648
buffer_load_dwordx4 v[180:183], v15, s[12:15], s33 offen
v_mfma_f32_32x32x16_bf16 v[160:175], a[184:187], a[8:11], v[160:175]
ds_read_b64_tr_b16 a[144:145], v26 offset:20736
ds_read_b64_tr_b16 a[146:147], v26 offset:22016
buffer_load_dword v5, v14, s[96:99], s55 offen offset:32 sc1
s_waitcnt vmcnt(26) lgkmcnt(10)
v_mfma_f32_32x32x16_bf16 v[96:111], a[188:191], a[12:15], v[96:111]
ds_read_b64_tr_b16 a[148:149], v26 offset:25600
ds_read_b64_tr_b16 a[150:151], v26 offset:26880
buffer_load_dword v10, v14, s[96:99], s4 offen offset:32 sc1
v_mfma_f32_32x32x16_bf16 v[112:127], a[192:195], a[12:15], v[112:127]
ds_read_b64_tr_b16 a[152:153], v26 offset:25664
ds_read_b64_tr_b16 a[154:155], v26 offset:26944
s_mov_b32 s33, 55296
buffer_load_dwordx4 v[184:187], v15, s[12:15], s33 offen
v_mfma_f32_32x32x16_bf16 v[128:143], a[196:199], a[12:15], v[128:143]
ds_read_b64_tr_b16 a[156:157], v26 offset:25728
ds_read_b64_tr_b16 a[158:159], v26 offset:27008
buffer_load_dwordx4 a[60:63], v30, s[96:99], s34 offen offset:3072 sc1
buffer_load_dword v6, v14, s[96:99], s55 offen offset:64 sc1
v_mfma_f32_32x32x16_bf16 v[144:159], a[200:203], a[12:15], v[144:159]
ds_read_b64_tr_b16 a[160:161], v26 offset:25792
ds_read_b64_tr_b16 a[162:163], v26 offset:27072
buffer_load_dword v11, v14, s[96:99], s4 offen offset:64 sc1
v_mfma_f32_32x32x16_bf16 v[160:175], a[204:207], a[12:15], v[160:175]
ds_read_b64_tr_b16 a[164:165], v26 offset:25856
ds_read_b64_tr_b16 a[166:167], v26 offset:27136
s_mov_b32 s33, 82944
buffer_load_dwordx4 v[188:191], v15, s[12:15], s33 offen
s_waitcnt vmcnt(31) lgkmcnt(10)
v_mfma_f32_32x32x16_bf16 v[96:111], a[128:131], a[16:19], v[96:111]
ds_read_b64_tr_b16 a[168:169], v26 offset:30720
ds_read_b64_tr_b16 a[170:171], v26 offset:32000
buffer_load_dword v7, v14, s[96:99], s55 offen offset:96 sc1
v_mfma_f32_32x32x16_bf16 v[112:127], a[132:135], a[16:19], v[112:127]
ds_read_b64_tr_b16 a[172:173], v26 offset:30784
ds_read_b64_tr_b16 a[174:175], v26 offset:32064
buffer_load_dword v12, v14, s[96:99], s4 offen offset:96 sc1
v_mfma_f32_32x32x16_bf16 v[128:143], a[136:139], a[16:19], v[128:143]
ds_read_b64_tr_b16 a[176:177], v26 offset:30848
ds_read_b64_tr_b16 a[178:179], v26 offset:32128
s_mov_b32 s34, 0x404000
buffer_load_dwordx4 a[64:67], v30, s[96:99], s34 offen offset:0 sc1
s_mov_b32 s33, 110592
buffer_load_dwordx4 v[192:195], v15, s[12:15], s33 offen
v_mfma_f32_32x32x16_bf16 v[144:159], a[140:143], a[16:19], v[144:159]
ds_read_b64_tr_b16 a[180:181], v26 offset:30912
ds_read_b64_tr_b16 a[182:183], v26 offset:32192
buffer_load_dword v8, v14, s[96:99], s55 offen offset:128 sc1
v_mfma_f32_32x32x16_bf16 v[160:175], a[144:147], a[16:19], v[160:175]
ds_read_b64_tr_b16 a[184:185], v26 offset:30976
ds_read_b64_tr_b16 a[186:187], v26 offset:32256
buffer_load_dword v13, v14, s[96:99], s4 offen offset:128 sc1
s_waitcnt vmcnt(36) lgkmcnt(10)
v_mfma_f32_32x32x16_bf16 v[96:111], a[148:151], a[20:23], v[96:111]
ds_read_b64_tr_b16 a[188:189], v26 offset:35840
ds_read_b64_tr_b16 a[190:191], v26 offset:37120
s_add_u32 s30, s31, 491520
s_add_u32 m0, s29, 122880
s_nop 0
buffer_load_dwordx4 v20, s[8:11], s30 offen offset:0 lds
v_mfma_f32_32x32x16_bf16 v[112:127], a[152:155], a[20:23], v[112:127]
ds_read_b64_tr_b16 a[192:193], v26 offset:35904
ds_read_b64_tr_b16 a[194:195], v26 offset:37184
buffer_load_dwordx4 v21, s[8:11], s30 offen offset:1024 lds
v_mfma_f32_32x32x16_bf16 v[128:143], a[156:159], a[20:23], v[128:143]
ds_read_b64_tr_b16 a[196:197], v26 offset:35968
ds_read_b64_tr_b16 a[198:199], v26 offset:37248
buffer_load_dwordx4 a[68:71], v30, s[96:99], s34 offen offset:1024 sc1
buffer_load_dwordx4 v22, s[8:11], s30 offen offset:2048 lds
v_mfma_f32_32x32x16_bf16 v[144:159], a[160:163], a[20:23], v[144:159]
ds_read_b64_tr_b16 a[200:201], v26 offset:36032
ds_read_b64_tr_b16 a[202:203], v26 offset:37312
buffer_load_dwordx4 v23, s[8:11], s30 offen offset:3072 lds
v_mfma_f32_32x32x16_bf16 v[160:175], a[164:167], a[20:23], v[160:175]
ds_read_b64_tr_b16 a[204:205], v26 offset:36096
ds_read_b64_tr_b16 a[206:207], v26 offset:37376
s_add_u32 m0, s29, 126976
s_nop 0
buffer_load_dwordx4 v24, s[8:11], s30 offen offset:0 lds
s_waitcnt vmcnt(41) lgkmcnt(10)
v_mfma_f32_32x32x16_bf16 v[96:111], a[168:171], a[24:27], v[96:111]
ds_read_b64_tr_b16 a[128:129], v27 offset:0
ds_read_b64_tr_b16 a[130:131], v27 offset:1280
s_add_u32 s30, s31, 573440
s_add_u32 m0, s29, 143360
s_nop 0
buffer_load_dwordx4 v20, s[8:11], s30 offen offset:0 lds
v_mfma_f32_32x32x16_bf16 v[112:127], a[172:175], a[24:27], v[112:127]
ds_read_b64_tr_b16 a[132:133], v27 offset:64
ds_read_b64_tr_b16 a[134:135], v27 offset:1344
buffer_load_dwordx4 v21, s[8:11], s30 offen offset:1024 lds
v_mfma_f32_32x32x16_bf16 v[128:143], a[176:179], a[24:27], v[128:143]
ds_read_b64_tr_b16 a[136:137], v27 offset:128
ds_read_b64_tr_b16 a[138:139], v27 offset:1408
buffer_load_dwordx4 a[72:75], v30, s[96:99], s34 offen offset:2048 sc1
buffer_load_dwordx4 v22, s[8:11], s30 offen offset:2048 lds
v_mfma_f32_32x32x16_bf16 v[144:159], a[180:183], a[24:27], v[144:159]
ds_read_b64_tr_b16 a[140:141], v27 offset:192
ds_read_b64_tr_b16 a[142:143], v27 offset:1472
buffer_load_dwordx4 v23, s[8:11], s30 offen offset:3072 lds
v_mfma_f32_32x32x16_bf16 v[160:175], a[184:187], a[24:27], v[160:175]
ds_read_b64_tr_b16 a[144:145], v27 offset:256
ds_read_b64_tr_b16 a[146:147], v27 offset:1536
s_add_u32 m0, s29, 147456
s_nop 0
buffer_load_dwordx4 v24, s[8:11], s30 offen offset:0 lds
s_waitcnt vmcnt(46) lgkmcnt(10)
v_mfma_f32_32x32x16_bf16 v[96:111], a[188:191], a[28:31], v[96:111]
ds_read_b64_tr_b16 a[148:149], v27 offset:5120
ds_read_b64_tr_b16 a[150:151], v27 offset:6400
v_mfma_f32_32x32x16_bf16 v[112:127], a[192:195], a[28:31], v[112:127]
ds_read_b64_tr_b16 a[152:153], v27 offset:5184
ds_read_b64_tr_b16 a[154:155], v27 offset:6464
v_mfma_f32_32x32x16_bf16 v[128:143], a[196:199], a[28:31], v[128:143]
ds_read_b64_tr_b16 a[156:157], v27 offset:5248
ds_read_b64_tr_b16 a[158:159], v27 offset:6528
buffer_load_dwordx4 a[76:79], v30, s[96:99], s34 offen offset:3072 sc1
v_mfma_f32_32x32x16_bf16 v[144:159], a[200:203], a[28:31], v[144:159]
ds_read_b64_tr_b16 a[160:161], v27 offset:5312
ds_read_b64_tr_b16 a[162:163], v27 offset:6592
v_mfma_f32_32x32x16_bf16 v[160:175], a[204:207], a[28:31], v[160:175]
ds_read_b64_tr_b16 a[164:165], v27 offset:5376
ds_read_b64_tr_b16 a[166:167], v27 offset:6656
s_waitcnt vmcnt(46) lgkmcnt(10)
v_mfma_f32_32x32x16_bf16 v[96:111], a[128:131], a[32:35], v[96:111]
ds_read_b64_tr_b16 a[168:169], v27 offset:10240
ds_read_b64_tr_b16 a[170:171], v27 offset:11520
v_mfma_f32_32x32x16_bf16 v[112:127], a[132:135], a[32:35], v[112:127]
ds_read_b64_tr_b16 a[172:173], v27 offset:10304
ds_read_b64_tr_b16 a[174:175], v27 offset:11584
v_mfma_f32_32x32x16_bf16 v[128:143], a[136:139], a[32:35], v[128:143]
ds_read_b64_tr_b16 a[176:177], v27 offset:10368
ds_read_b64_tr_b16 a[178:179], v27 offset:11648
s_mov_b32 s34, 0x405000
buffer_load_dwordx4 a[80:83], v30, s[96:99], s34 offen offset:0 sc1
v_mfma_f32_32x32x16_bf16 v[144:159], a[140:143], a[32:35], v[144:159]
ds_read_b64_tr_b16 a[180:181], v27 offset:10432
ds_read_b64_tr_b16 a[182:183], v27 offset:11712
v_mfma_f32_32x32x16_bf16 v[160:175], a[144:147], a[32:35], v[160:175]
ds_read_b64_tr_b16 a[184:185], v27 offset:10496
ds_read_b64_tr_b16 a[186:187], v27 offset:11776
s_waitcnt vmcnt(46) lgkmcnt(10)
v_mfma_f32_32x32x16_bf16 v[96:111], a[148:151], a[36:39], v[96:111]
s_waitcnt vmcnt(38)
s_barrier
ds_read_b64_tr_b16 a[188:189], v27 offset:15360
ds_read_b64_tr_b16 a[190:191], v27 offset:16640
v_mfma_f32_32x32x16_bf16 v[112:127], a[152:155], a[36:39], v[112:127]
ds_read_b64_tr_b16 a[192:193], v27 offset:15424
ds_read_b64_tr_b16 a[194:195], v27 offset:16704
s_add_u32 s30, s31, 655360
s_add_u32 m0, s29, 0
s_nop 0
buffer_load_dwordx4 v20, s[8:11], s30 offen offset:0 lds
v_mfma_f32_32x32x16_bf16 v[128:143], a[156:159], a[36:39], v[128:143]
ds_read_b64_tr_b16 a[196:197], v27 offset:15488
ds_read_b64_tr_b16 a[198:199], v27 offset:16768
buffer_load_dwordx4 a[84:87], v30, s[96:99], s34 offen offset:1024 sc1
buffer_load_dwordx4 v21, s[8:11], s30 offen offset:1024 lds
v_mfma_f32_32x32x16_bf16 v[144:159], a[160:163], a[36:39], v[144:159]
ds_read_b64_tr_b16 a[200:201], v27 offset:15552
ds_read_b64_tr_b16 a[202:203], v27 offset:16832
buffer_load_dwordx4 v22, s[8:11], s30 offen offset:2048 lds
v_mfma_f32_32x32x16_bf16 v[160:175], a[164:167], a[36:39], v[160:175]
ds_read_b64_tr_b16 a[204:205], v27 offset:15616
ds_read_b64_tr_b16 a[206:207], v27 offset:16896
buffer_load_dwordx4 v23, s[8:11], s30 offen offset:3072 lds
s_waitcnt lgkmcnt(10)
v_mfma_f32_32x32x16_bf16 v[96:111], a[168:171], a[40:43], v[96:111]
ds_read_b64_tr_b16 a[128:129], v27 offset:20480
ds_read_b64_tr_b16 a[130:131], v27 offset:21760
s_add_u32 m0, s29, 4096
s_nop 0
buffer_load_dwordx4 v24, s[8:11], s30 offen offset:0 lds
v_mfma_f32_32x32x16_bf16 v[112:127], a[172:175], a[40:43], v[112:127]
ds_read_b64_tr_b16 a[132:133], v27 offset:20544
ds_read_b64_tr_b16 a[134:135], v27 offset:21824
s_add_u32 s30, s31, 737280
s_add_u32 m0, s29, 20480
s_nop 0
buffer_load_dwordx4 v20, s[8:11], s30 offen offset:0 lds
v_mfma_f32_32x32x16_bf16 v[128:143], a[176:179], a[40:43], v[128:143]
ds_read_b64_tr_b16 a[136:137], v27 offset:20608
ds_read_b64_tr_b16 a[138:139], v27 offset:21888
buffer_load_dwordx4 a[88:91], v30, s[96:99], s34 offen offset:2048 sc1
buffer_load_dwordx4 v21, s[8:11], s30 offen offset:1024 lds
v_mfma_f32_32x32x16_bf16 v[144:159], a[180:183], a[40:43], v[144:159]
ds_read_b64_tr_b16 a[140:141], v27 offset:20672
ds_read_b64_tr_b16 a[142:143], v27 offset:21952
buffer_load_dwordx4 v22, s[8:11], s30 offen offset:2048 lds
v_mfma_f32_32x32x16_bf16 v[160:175], a[184:187], a[40:43], v[160:175]
ds_read_b64_tr_b16 a[144:145], v27 offset:20736
ds_read_b64_tr_b16 a[146:147], v27 offset:22016
buffer_load_dwordx4 v23, s[8:11], s30 offen offset:3072 lds
s_waitcnt lgkmcnt(10)
v_mfma_f32_32x32x16_bf16 v[96:111], a[188:191], a[44:47], v[96:111]
ds_read_b64_tr_b16 a[148:149], v27 offset:25600
ds_read_b64_tr_b16 a[150:151], v27 offset:26880
s_add_u32 m0, s29, 24576
s_nop 0
buffer_load_dwordx4 v24, s[8:11], s30 offen offset:0 lds
v_mfma_f32_32x32x16_bf16 v[112:127], a[192:195], a[44:47], v[112:127]
ds_read_b64_tr_b16 a[152:153], v27 offset:25664
ds_read_b64_tr_b16 a[154:155], v27 offset:26944
v_mfma_f32_32x32x16_bf16 v[128:143], a[196:199], a[44:47], v[128:143]
ds_read_b64_tr_b16 a[156:157], v27 offset:25728
ds_read_b64_tr_b16 a[158:159], v27 offset:27008
buffer_load_dwordx4 a[92:95], v30, s[96:99], s34 offen offset:3072 sc1
v_mfma_f32_32x32x16_bf16 v[144:159], a[200:203], a[44:47], v[144:159]
ds_read_b64_tr_b16 a[160:161], v27 offset:25792
ds_read_b64_tr_b16 a[162:163], v27 offset:27072
v_mfma_f32_32x32x16_bf16 v[160:175], a[204:207], a[44:47], v[160:175]
ds_read_b64_tr_b16 a[164:165], v27 offset:25856
ds_read_b64_tr_b16 a[166:167], v27 offset:27136
s_waitcnt lgkmcnt(10)
v_mfma_f32_32x32x16_bf16 v[96:111], a[128:131], a[48:51], v[96:111]
ds_read_b64_tr_b16 a[168:169], v27 offset:30720
ds_read_b64_tr_b16 a[170:171], v27 offset:32000
v_mfma_f32_32x32x16_bf16 v[112:127], a[132:135], a[48:51], v[112:127]
ds_read_b64_tr_b16 a[172:173], v27 offset:30784
ds_read_b64_tr_b16 a[174:175], v27 offset:32064
v_mfma_f32_32x32x16_bf16 v[128:143], a[136:139], a[48:51], v[128:143]
ds_read_b64_tr_b16 a[176:177], v27 offset:30848
ds_read_b64_tr_b16 a[178:179], v27 offset:32128
s_mov_b32 s34, 0x406000
buffer_load_dwordx4 a[96:99], v30, s[96:99], s34 offen offset:0 sc1
v_mfma_f32_32x32x16_bf16 v[144:159], a[140:143], a[48:51], v[144:159]
ds_read_b64_tr_b16 a[180:181], v27 offset:30912
ds_read_b64_tr_b16 a[182:183], v27 offset:32192
v_mfma_f32_32x32x16_bf16 v[160:175], a[144:147], a[48:51], v[160:175]
ds_read_b64_tr_b16 a[184:185], v27 offset:30976
ds_read_b64_tr_b16 a[186:187], v27 offset:32256
s_waitcnt vmcnt(49) lgkmcnt(10)
v_mfma_f32_32x32x16_bf16 v[96:111], a[148:151], a[52:55], v[96:111]
ds_read_b64_tr_b16 a[188:189], v27 offset:35840
ds_read_b64_tr_b16 a[190:191], v27 offset:37120
v_mfma_f32_32x32x16_bf16 v[112:127], a[152:155], a[52:55], v[112:127]
ds_read_b64_tr_b16 a[192:193], v27 offset:35904
ds_read_b64_tr_b16 a[194:195], v27 offset:37184
v_mfma_f32_32x32x16_bf16 v[128:143], a[156:159], a[52:55], v[128:143]
ds_read_b64_tr_b16 a[196:197], v27 offset:35968
ds_read_b64_tr_b16 a[198:199], v27 offset:37248
buffer_load_dwordx4 a[100:103], v30, s[96:99], s34 offen offset:1024 sc1
v_mfma_f32_32x32x16_bf16 v[144:159], a[160:163], a[52:55], v[144:159]
ds_read_b64_tr_b16 a[200:201], v27 offset:36032
ds_read_b64_tr_b16 a[202:203], v27 offset:37312
v_mfma_f32_32x32x16_bf16 v[160:175], a[164:167], a[52:55], v[160:175]
ds_read_b64_tr_b16 a[204:205], v27 offset:36096
ds_read_b64_tr_b16 a[206:207], v27 offset:37376
s_waitcnt vmcnt(44) lgkmcnt(10)
v_mfma_f32_32x32x16_bf16 v[96:111], a[168:171], a[56:59], v[96:111]
ds_read_b64_tr_b16 a[128:129], v28 offset:0
ds_read_b64_tr_b16 a[130:131], v28 offset:1280
v_mfma_f32_32x32x16_bf16 v[112:127], a[172:175], a[56:59], v[112:127]
ds_read_b64_tr_b16 a[132:133], v28 offset:64
ds_read_b64_tr_b16 a[134:135], v28 offset:1344
v_mfma_f32_32x32x16_bf16 v[128:143], a[176:179], a[56:59], v[128:143]
ds_read_b64_tr_b16 a[136:137], v28 offset:128
ds_read_b64_tr_b16 a[138:139], v28 offset:1408
buffer_load_dwordx4 a[104:107], v30, s[96:99], s34 offen offset:2048 sc1
v_mfma_f32_32x32x16_bf16 v[144:159], a[180:183], a[56:59], v[144:159]
ds_read_b64_tr_b16 a[140:141], v28 offset:192
ds_read_b64_tr_b16 a[142:143], v28 offset:1472
v_mfma_f32_32x32x16_bf16 v[160:175], a[184:187], a[56:59], v[160:175]
ds_read_b64_tr_b16 a[144:145], v28 offset:256
ds_read_b64_tr_b16 a[146:147], v28 offset:1536
s_waitcnt vmcnt(39) lgkmcnt(10)
v_mfma_f32_32x32x16_bf16 v[96:111], a[188:191], a[60:63], v[96:111]
ds_read_b64_tr_b16 a[148:149], v28 offset:5120
ds_read_b64_tr_b16 a[150:151], v28 offset:6400
v_add_f32 v4, 1.0, v4
v_cvt_pk_bf16_f32 v4, v4, v4
v_and_b32 v4, 0xffff0000, v4
v_mfma_f32_32x32x16_bf16 v[112:127], a[192:195], a[60:63], v[112:127]
ds_read_b64_tr_b16 a[152:153], v28 offset:5184
ds_read_b64_tr_b16 a[154:155], v28 offset:6464
v_lshlrev_b32 v17, 16, v176
v_and_b32 v18, 0xffff0000, v176
v_mfma_f32_32x32x16_bf16 v[128:143], a[196:199], a[60:63], v[128:143]
ds_read_b64_tr_b16 a[156:157], v28 offset:5248
ds_read_b64_tr_b16 a[158:159], v28 offset:6528
buffer_load_dwordx4 a[108:111], v30, s[96:99], s34 offen offset:3072 sc1
v_mul_f32 v236, v17, v4
v_mul_f32 v237, v18, v4
v_mfma_f32_32x32x16_bf16 v[144:159], a[200:203], a[60:63], v[144:159]
ds_read_b64_tr_b16 a[160:161], v28 offset:5312
ds_read_b64_tr_b16 a[162:163], v28 offset:6592
v_mul_f32 v244, v17, v9
v_mul_f32 v245, v18, v9
v_mfma_f32_32x32x16_bf16 v[160:175], a[204:207], a[60:63], v[160:175]
ds_read_b64_tr_b16 a[164:165], v28 offset:5376
ds_read_b64_tr_b16 a[166:167], v28 offset:6656
v_lshlrev_b32 v17, 16, v177
v_and_b32 v18, 0xffff0000, v177
s_waitcnt vmcnt(34) lgkmcnt(10)
v_mfma_f32_32x32x16_bf16 v[96:111], a[128:131], a[64:67], v[96:111]
ds_read_b64_tr_b16 a[168:169], v28 offset:10240
ds_read_b64_tr_b16 a[170:171], v28 offset:11520
v_mul_f32 v238, v17, v4
v_mul_f32 v239, v18, v4
v_mfma_f32_32x32x16_bf16 v[112:127], a[132:135], a[64:67], v[112:127]
ds_read_b64_tr_b16 a[172:173], v28 offset:10304
ds_read_b64_tr_b16 a[174:175], v28 offset:11584
v_mul_f32 v246, v17, v9
v_mul_f32 v247, v18, v9
v_mfma_f32_32x32x16_bf16 v[128:143], a[136:139], a[64:67], v[128:143]
ds_read_b64_tr_b16 a[176:177], v28 offset:10368
ds_read_b64_tr_b16 a[178:179], v28 offset:11648
s_mov_b32 s34, 0x407000
buffer_load_dwordx4 a[112:115], v30, s[96:99], s34 offen offset:0 sc1
v_lshlrev_b32 v17, 16, v178
v_and_b32 v18, 0xffff0000, v178
v_mfma_f32_32x32x16_bf16 v[144:159], a[140:143], a[64:67], v[144:159]
ds_read_b64_tr_b16 a[180:181], v28 offset:10432
ds_read_b64_tr_b16 a[182:183], v28 offset:11712
v_mul_f32 v240, v17, v4
v_mul_f32 v241, v18, v4
v_mfma_f32_32x32x16_bf16 v[160:175], a[144:147], a[64:67], v[160:175]
ds_read_b64_tr_b16 a[184:185], v28 offset:10496
ds_read_b64_tr_b16 a[186:187], v28 offset:11776
v_mul_f32 v248, v17, v9
v_mul_f32 v249, v18, v9
s_waitcnt vmcnt(29) lgkmcnt(10)
v_mfma_f32_32x32x16_bf16 v[96:111], a[148:151], a[68:71], v[96:111]
s_waitcnt vmcnt(26)
s_barrier
ds_read_b64_tr_b16 a[188:189], v28 offset:15360
ds_read_b64_tr_b16 a[190:191], v28 offset:16640
v_lshlrev_b32 v17, 16, v179
v_and_b32 v18, 0xffff0000, v179
v_mfma_f32_32x32x16_bf16 v[112:127], a[152:155], a[68:71], v[112:127]
ds_read_b64_tr_b16 a[192:193], v28 offset:15424
ds_read_b64_tr_b16 a[194:195], v28 offset:16704
v_mul_f32 v242, v17, v4
v_mul_f32 v243, v18, v4
s_add_u32 s30, s31, 819200
s_add_u32 m0, s29, 40960
s_nop 0
buffer_load_dwordx4 v20, s[8:11], s30 offen offset:0 lds
v_mfma_f32_32x32x16_bf16 v[128:143], a[156:159], a[68:71], v[128:143]
ds_read_b64_tr_b16 a[196:197], v28 offset:15488
ds_read_b64_tr_b16 a[198:199], v28 offset:16768
buffer_load_dwordx4 a[116:119], v30, s[96:99], s34 offen offset:1024 sc1
v_mul_f32 v250, v17, v9
v_mul_f32 v251, v18, v9
buffer_load_dwordx4 v21, s[8:11], s30 offen offset:1024 lds
v_mfma_f32_32x32x16_bf16 v[144:159], a[160:163], a[68:71], v[144:159]
ds_read_b64_tr_b16 a[200:201], v28 offset:15552
ds_read_b64_tr_b16 a[202:203], v28 offset:16832
v_add_f32 v5, 1.0, v5
v_cvt_pk_bf16_f32 v5, v5, v5
buffer_load_dwordx4 v22, s[8:11], s30 offen offset:2048 lds
v_mfma_f32_32x32x16_bf16 v[160:175], a[164:167], a[68:71], v[160:175]
ds_read_b64_tr_b16 a[204:205], v28 offset:15616
ds_read_b64_tr_b16 a[206:207], v28 offset:16896
v_and_b32 v5, 0xffff0000, v5
v_lshlrev_b32 v17, 16, v180
buffer_load_dwordx4 v23, s[8:11], s30 offen offset:3072 lds
s_waitcnt vmcnt(28) lgkmcnt(10)
v_mfma_f32_32x32x16_bf16 v[96:111], a[168:171], a[72:75], v[96:111]
ds_read_b64_tr_b16 a[128:129], v28 offset:20480
ds_read_b64_tr_b16 a[130:131], v28 offset:21760
v_and_b32 v18, 0xffff0000, v180
v_fmac_f32 v236, v17, v5
v_fmac_f32 v237, v18, v5
s_add_u32 m0, s29, 45056
s_nop 0
buffer_load_dwordx4 v24, s[8:11], s30 offen offset:0 lds
v_mfma_f32_32x32x16_bf16 v[112:127], a[172:175], a[72:75], v[112:127]
ds_read_b64_tr_b16 a[132:133], v28 offset:20544
ds_read_b64_tr_b16 a[134:135], v28 offset:21824
v_fmac_f32 v244, v17, v10
v_fmac_f32 v245, v18, v10
s_add_u32 s30, s31, 901120
s_add_u32 m0, s29, 61440
s_nop 0
buffer_load_dwordx4 v20, s[8:11], s30 offen offset:0 lds
v_mfma_f32_32x32x16_bf16 v[128:143], a[176:179], a[72:75], v[128:143]
ds_read_b64_tr_b16 a[136:137], v28 offset:20608
ds_read_b64_tr_b16 a[138:139], v28 offset:21888
buffer_load_dwordx4 a[120:123], v30, s[96:99], s34 offen offset:2048 sc1
v_lshlrev_b32 v17, 16, v181
v_and_b32 v18, 0xffff0000, v181
buffer_load_dwordx4 v21, s[8:11], s30 offen offset:1024 lds
v_mfma_f32_32x32x16_bf16 v[144:159], a[180:183], a[72:75], v[144:159]
ds_read_b64_tr_b16 a[140:141], v28 offset:20672
ds_read_b64_tr_b16 a[142:143], v28 offset:21952
v_fmac_f32 v238, v17, v5
v_fmac_f32 v239, v18, v5
buffer_load_dwordx4 v22, s[8:11], s30 offen offset:2048 lds
v_mfma_f32_32x32x16_bf16 v[160:175], a[184:187], a[72:75], v[160:175]
ds_read_b64_tr_b16 a[144:145], v28 offset:20736
ds_read_b64_tr_b16 a[146:147], v28 offset:22016
v_fmac_f32 v246, v17, v10
v_fmac_f32 v247, v18, v10
buffer_load_dwordx4 v23, s[8:11], s30 offen offset:3072 lds
s_waitcnt vmcnt(30) lgkmcnt(10)
v_mfma_f32_32x32x16_bf16 v[96:111], a[188:191], a[76:79], v[96:111]
ds_read_b64_tr_b16 a[148:149], v28 offset:25600
ds_read_b64_tr_b16 a[150:151], v28 offset:26880
v_lshlrev_b32 v17, 16, v182
v_and_b32 v18, 0xffff0000, v182
s_add_u32 m0, s29, 65536
s_nop 0
buffer_load_dwordx4 v24, s[8:11], s30 offen offset:0 lds
v_mfma_f32_32x32x16_bf16 v[112:127], a[192:195], a[76:79], v[112:127]
ds_read_b64_tr_b16 a[152:153], v28 offset:25664
ds_read_b64_tr_b16 a[154:155], v28 offset:26944
v_fmac_f32 v240, v17, v5
v_fmac_f32 v241, v18, v5
v_mfma_f32_32x32x16_bf16 v[128:143], a[196:199], a[76:79], v[128:143]
ds_read_b64_tr_b16 a[156:157], v28 offset:25728
ds_read_b64_tr_b16 a[158:159], v28 offset:27008
buffer_load_dwordx4 a[124:127], v30, s[96:99], s34 offen offset:3072 sc1
v_fmac_f32 v248, v17, v10
v_fmac_f32 v249, v18, v10
v_mfma_f32_32x32x16_bf16 v[144:159], a[200:203], a[76:79], v[144:159]
ds_read_b64_tr_b16 a[160:161], v28 offset:25792
ds_read_b64_tr_b16 a[162:163], v28 offset:27072
v_lshlrev_b32 v17, 16, v183
v_and_b32 v18, 0xffff0000, v183
v_mfma_f32_32x32x16_bf16 v[160:175], a[204:207], a[76:79], v[160:175]
ds_read_b64_tr_b16 a[164:165], v28 offset:25856
ds_read_b64_tr_b16 a[166:167], v28 offset:27136
v_fmac_f32 v242, v17, v5
v_fmac_f32 v243, v18, v5
s_waitcnt vmcnt(31) lgkmcnt(10)
v_mfma_f32_32x32x16_bf16 v[96:111], a[128:131], a[80:83], v[96:111]
ds_read_b64_tr_b16 a[168:169], v28 offset:30720
ds_read_b64_tr_b16 a[170:171], v28 offset:32000
v_fmac_f32 v250, v17, v10
v_fmac_f32 v251, v18, v10
v_mfma_f32_32x32x16_bf16 v[112:127], a[132:135], a[80:83], v[112:127]
ds_read_b64_tr_b16 a[172:173], v28 offset:30784
ds_read_b64_tr_b16 a[174:175], v28 offset:32064
v_add_f32 v6, 1.0, v6
v_cvt_pk_bf16_f32 v6, v6, v6
v_mfma_f32_32x32x16_bf16 v[128:143], a[136:139], a[80:83], v[128:143]
ds_read_b64_tr_b16 a[176:177], v28 offset:30848
ds_read_b64_tr_b16 a[178:179], v28 offset:32128
s_mov_b32 s34, 0x408000
buffer_load_dwordx4 a[0:3], v30, s[96:99], s34 offen offset:0 sc1
v_and_b32 v6, 0xffff0000, v6
v_lshlrev_b32 v17, 16, v184
v_mfma_f32_32x32x16_bf16 v[144:159], a[140:143], a[80:83], v[144:159]
ds_read_b64_tr_b16 a[180:181], v28 offset:30912
ds_read_b64_tr_b16 a[182:183], v28 offset:32192
v_and_b32 v18, 0xffff0000, v184
v_fmac_f32 v236, v17, v6
v_mfma_f32_32x32x16_bf16 v[160:175], a[144:147], a[80:83], v[160:175]
ds_read_b64_tr_b16 a[184:185], v28 offset:30976
ds_read_b64_tr_b16 a[186:187], v28 offset:32256
v_fmac_f32 v237, v18, v6
v_fmac_f32 v244, v17, v11
s_waitcnt vmcnt(30) lgkmcnt(10)
v_mfma_f32_32x32x16_bf16 v[96:111], a[148:151], a[84:87], v[96:111]
ds_read_b64_tr_b16 a[188:189], v28 offset:35840
ds_read_b64_tr_b16 a[190:191], v28 offset:37120
v_fmac_f32 v245, v18, v11
v_lshlrev_b32 v17, 16, v185
v_and_b32 v18, 0xffff0000, v185
v_mfma_f32_32x32x16_bf16 v[112:127], a[152:155], a[84:87], v[112:127]
ds_read_b64_tr_b16 a[192:193], v28 offset:35904
ds_read_b64_tr_b16 a[194:195], v28 offset:37184
v_fmac_f32 v238, v17, v6
v_fmac_f32 v239, v18, v6
v_mfma_f32_32x32x16_bf16 v[128:143], a[156:159], a[84:87], v[128:143]
ds_read_b64_tr_b16 a[196:197], v28 offset:35968
ds_read_b64_tr_b16 a[198:199], v28 offset:37248
buffer_load_dwordx4 a[4:7], v30, s[96:99], s34 offen offset:1024 sc1
v_fmac_f32 v246, v17, v11
v_fmac_f32 v247, v18, v11
v_mfma_f32_32x32x16_bf16 v[144:159], a[160:163], a[84:87], v[144:159]
ds_read_b64_tr_b16 a[200:201], v28 offset:36032
ds_read_b64_tr_b16 a[202:203], v28 offset:37312
v_lshlrev_b32 v17, 16, v186
v_and_b32 v18, 0xffff0000, v186
v_mfma_f32_32x32x16_bf16 v[160:175], a[164:167], a[84:87], v[160:175]
ds_read_b64_tr_b16 a[204:205], v28 offset:36096
ds_read_b64_tr_b16 a[206:207], v28 offset:37376
v_fmac_f32 v240, v17, v6
v_fmac_f32 v241, v18, v6
s_waitcnt vmcnt(25) lgkmcnt(10)
v_mfma_f32_32x32x16_bf16 v[96:111], a[168:171], a[88:91], v[96:111]
ds_read_b64_tr_b16 a[128:129], v29 offset:0
ds_read_b64_tr_b16 a[130:131], v29 offset:1280
v_fmac_f32 v248, v17, v11
v_fmac_f32 v249, v18, v11
v_mfma_f32_32x32x16_bf16 v[112:127], a[172:175], a[88:91], v[112:127]
ds_read_b64_tr_b16 a[132:133], v29 offset:64
ds_read_b64_tr_b16 a[134:135], v29 offset:1344
v_lshlrev_b32 v17, 16, v187
v_and_b32 v18, 0xffff0000, v187
v_mfma_f32_32x32x16_bf16 v[128:143], a[176:179], a[88:91], v[128:143]
ds_read_b64_tr_b16 a[136:137], v29 offset:128
ds_read_b64_tr_b16 a[138:139], v29 offset:1408
buffer_load_dwordx4 a[8:11], v30, s[96:99], s34 offen offset:2048 sc1
v_fmac_f32 v242, v17, v6
v_fmac_f32 v243, v18, v6
v_mfma_f32_32x32x16_bf16 v[144:159], a[180:183], a[88:91], v[144:159]
ds_read_b64_tr_b16 a[140:141], v29 offset:192
ds_read_b64_tr_b16 a[142:143], v29 offset:1472
v_fmac_f32 v250, v17, v11
v_fmac_f32 v251, v18, v11
v_mfma_f32_32x32x16_bf16 v[160:175], a[184:187], a[88:91], v[160:175]
ds_read_b64_tr_b16 a[144:145], v29 offset:256
ds_read_b64_tr_b16 a[146:147], v29 offset:1536
v_add_f32 v7, 1.0, v7
v_cvt_pk_bf16_f32 v7, v7, v7
s_waitcnt vmcnt(21) lgkmcnt(10)
v_mfma_f32_32x32x16_bf16 v[96:111], a[188:191], a[92:95], v[96:111]
ds_read_b64_tr_b16 a[148:149], v29 offset:5120
ds_read_b64_tr_b16 a[150:151], v29 offset:6400
v_and_b32 v7, 0xffff0000, v7
v_lshlrev_b32 v17, 16, v188
v_mfma_f32_32x32x16_bf16 v[112:127], a[192:195], a[92:95], v[112:127]
ds_read_b64_tr_b16 a[152:153], v29 offset:5184
ds_read_b64_tr_b16 a[154:155], v29 offset:6464
v_and_b32 v18, 0xffff0000, v188
v_fmac_f32 v236, v17, v7
v_mfma_f32_32x32x16_bf16 v[128:143], a[196:199], a[92:95], v[128:143]
ds_read_b64_tr_b16 a[156:157], v29 offset:5248
ds_read_b64_tr_b16 a[158:159], v29 offset:6528
buffer_load_dwordx4 a[12:15], v30, s[96:99], s34 offen offset:3072 sc1
v_fmac_f32 v237, v18, v7
v_fmac_f32 v244, v17, v12
v_mfma_f32_32x32x16_bf16 v[144:159], a[200:203], a[92:95], v[144:159]
ds_read_b64_tr_b16 a[160:161], v29 offset:5312
ds_read_b64_tr_b16 a[162:163], v29 offset:6592
v_fmac_f32 v245, v18, v12
v_lshlrev_b32 v17, 16, v189
v_mfma_f32_32x32x16_bf16 v[160:175], a[204:207], a[92:95], v[160:175]
ds_read_b64_tr_b16 a[164:165], v29 offset:5376
ds_read_b64_tr_b16 a[166:167], v29 offset:6656
v_and_b32 v18, 0xffff0000, v189
v_fmac_f32 v238, v17, v7
s_waitcnt vmcnt(21) lgkmcnt(10)
v_mfma_f32_32x32x16_bf16 v[96:111], a[128:131], a[96:99], v[96:111]
ds_read_b64_tr_b16 a[168:169], v29 offset:10240
ds_read_b64_tr_b16 a[170:171], v29 offset:11520
v_fmac_f32 v239, v18, v7
v_fmac_f32 v246, v17, v12
v_fmac_f32 v247, v18, v12
v_mfma_f32_32x32x16_bf16 v[112:127], a[132:135], a[96:99], v[112:127]
ds_read_b64_tr_b16 a[172:173], v29 offset:10304
ds_read_b64_tr_b16 a[174:175], v29 offset:11584
v_lshlrev_b32 v17, 16, v190
v_and_b32 v18, 0xffff0000, v190
v_mfma_f32_32x32x16_bf16 v[128:143], a[136:139], a[96:99], v[128:143]
ds_read_b64_tr_b16 a[176:177], v29 offset:10368
ds_read_b64_tr_b16 a[178:179], v29 offset:11648
s_mov_b32 s34, 0x409000
buffer_load_dwordx4 a[16:19], v30, s[96:99], s34 offen offset:0 sc1
v_fmac_f32 v240, v17, v7
v_fmac_f32 v241, v18, v7
v_mfma_f32_32x32x16_bf16 v[144:159], a[140:143], a[96:99], v[144:159]
ds_read_b64_tr_b16 a[180:181], v29 offset:10432
ds_read_b64_tr_b16 a[182:183], v29 offset:11712
v_fmac_f32 v248, v17, v12
v_fmac_f32 v249, v18, v12
v_mfma_f32_32x32x16_bf16 v[160:175], a[144:147], a[96:99], v[160:175]
ds_read_b64_tr_b16 a[184:185], v29 offset:10496
ds_read_b64_tr_b16 a[186:187], v29 offset:11776
v_lshlrev_b32 v17, 16, v191
v_and_b32 v18, 0xffff0000, v191
s_waitcnt vmcnt(21) lgkmcnt(10)
v_mfma_f32_32x32x16_bf16 v[96:111], a[148:151], a[100:103], v[96:111]
s_barrier
ds_read_b64_tr_b16 a[188:189], v29 offset:15360
ds_read_b64_tr_b16 a[190:191], v29 offset:16640
v_fmac_f32 v242, v17, v7
v_fmac_f32 v243, v18, v7
v_mfma_f32_32x32x16_bf16 v[112:127], a[152:155], a[100:103], v[112:127]
ds_read_b64_tr_b16 a[192:193], v29 offset:15424
ds_read_b64_tr_b16 a[194:195], v29 offset:16704
v_fmac_f32 v250, v17, v12
v_fmac_f32 v251, v18, v12
s_add_u32 s30, s31, 983040
s_add_u32 m0, s29, 81920
s_nop 0
buffer_load_dwordx4 v20, s[8:11], s30 offen offset:0 lds
v_mfma_f32_32x32x16_bf16 v[128:143], a[156:159], a[100:103], v[128:143]
ds_read_b64_tr_b16 a[196:197], v29 offset:15488
ds_read_b64_tr_b16 a[198:199], v29 offset:16768
buffer_load_dwordx4 a[20:23], v30, s[96:99], s34 offen offset:1024 sc1
v_add_f32 v8, 1.0, v8
v_cvt_pk_bf16_f32 v8, v8, v8
buffer_load_dwordx4 v21, s[8:11], s30 offen offset:1024 lds
v_mfma_f32_32x32x16_bf16 v[144:159], a[160:163], a[100:103], v[144:159]
ds_read_b64_tr_b16 a[200:201], v29 offset:15552
ds_read_b64_tr_b16 a[202:203], v29 offset:16832
v_and_b32 v8, 0xffff0000, v8
v_lshlrev_b32 v17, 16, v192
buffer_load_dwordx4 v22, s[8:11], s30 offen offset:2048 lds
v_mfma_f32_32x32x16_bf16 v[160:175], a[164:167], a[100:103], v[160:175]
ds_read_b64_tr_b16 a[204:205], v29 offset:15616
ds_read_b64_tr_b16 a[206:207], v29 offset:16896
v_and_b32 v18, 0xffff0000, v192
v_fmac_f32 v236, v17, v8
buffer_load_dwordx4 v23, s[8:11], s30 offen offset:3072 lds
s_waitcnt vmcnt(25) lgkmcnt(10)
v_mfma_f32_32x32x16_bf16 v[96:111], a[168:171], a[104:107], v[96:111]
ds_read_b64_tr_b16 a[128:129], v29 offset:20480
ds_read_b64_tr_b16 a[130:131], v29 offset:21760
v_fmac_f32 v237, v18, v8
v_fmac_f32 v244, v17, v13
s_add_u32 m0, s29, 86016
s_nop 0
buffer_load_dwordx4 v24, s[8:11], s30 offen offset:0 lds
v_mfma_f32_32x32x16_bf16 v[112:127], a[172:175], a[104:107], v[112:127]
ds_read_b64_tr_b16 a[132:133], v29 offset:20544
ds_read_b64_tr_b16 a[134:135], v29 offset:21824
v_fmac_f32 v245, v18, v13
v_lshlrev_b32 v17, 16, v193
s_add_u32 s30, s31, 1064960
s_add_u32 m0, s29, 102400
s_nop 0
buffer_load_dwordx4 v20, s[8:11], s30 offen offset:0 lds
v_mfma_f32_32x32x16_bf16 v[128:143], a[176:179], a[104:107], v[128:143]
ds_read_b64_tr_b16 a[136:137], v29 offset:20608
ds_read_b64_tr_b16 a[138:139], v29 offset:21888
buffer_load_dwordx4 a[24:27], v30, s[96:99], s34 offen offset:2048 sc1
v_and_b32 v18, 0xffff0000, v193
v_fmac_f32 v238, v17, v8
buffer_load_dwordx4 v21, s[8:11], s30 offen offset:1024 lds
v_mfma_f32_32x32x16_bf16 v[144:159], a[180:183], a[104:107], v[144:159]
ds_read_b64_tr_b16 a[140:141], v29 offset:20672
ds_read_b64_tr_b16 a[142:143], v29 offset:21952
v_fmac_f32 v239, v18, v8
v_fmac_f32 v246, v17, v13
buffer_load_dwordx4 v22, s[8:11], s30 offen offset:2048 lds
v_mfma_f32_32x32x16_bf16 v[160:175], a[184:187], a[104:107], v[160:175]
ds_read_b64_tr_b16 a[144:145], v29 offset:20736
ds_read_b64_tr_b16 a[146:147], v29 offset:22016
v_fmac_f32 v247, v18, v13
v_lshlrev_b32 v17, 16, v194
buffer_load_dwordx4 v23, s[8:11], s30 offen offset:3072 lds
s_waitcnt vmcnt(30) lgkmcnt(10)
v_mfma_f32_32x32x16_bf16 v[96:111], a[188:191], a[108:111], v[96:111]
ds_read_b64_tr_b16 a[148:149], v29 offset:25600
ds_read_b64_tr_b16 a[150:151], v29 offset:26880
v_and_b32 v18, 0xffff0000, v194
v_fmac_f32 v240, v17, v8
v_fmac_f32 v241, v18, v8
s_add_u32 m0, s29, 106496
s_nop 0
buffer_load_dwordx4 v24, s[8:11], s30 offen offset:0 lds
v_mfma_f32_32x32x16_bf16 v[112:127], a[192:195], a[108:111], v[112:127]
ds_read_b64_tr_b16 a[152:153], v29 offset:25664
ds_read_b64_tr_b16 a[154:155], v29 offset:26944
v_fmac_f32 v248, v17, v13
v_fmac_f32 v249, v18, v13
v_mfma_f32_32x32x16_bf16 v[128:143], a[196:199], a[108:111], v[128:143]
ds_read_b64_tr_b16 a[156:157], v29 offset:25728
ds_read_b64_tr_b16 a[158:159], v29 offset:27008
buffer_load_dwordx4 a[28:31], v30, s[96:99], s34 offen offset:3072 sc1
v_lshlrev_b32 v17, 16, v195
v_and_b32 v18, 0xffff0000, v195
v_mfma_f32_32x32x16_bf16 v[144:159], a[200:203], a[108:111], v[144:159]
ds_read_b64_tr_b16 a[160:161], v29 offset:25792
ds_read_b64_tr_b16 a[162:163], v29 offset:27072
v_fmac_f32 v242, v17, v8
v_fmac_f32 v243, v18, v8
v_mfma_f32_32x32x16_bf16 v[160:175], a[204:207], a[108:111], v[160:175]
ds_read_b64_tr_b16 a[164:165], v29 offset:25856
ds_read_b64_tr_b16 a[166:167], v29 offset:27136
v_fmac_f32 v250, v17, v13
v_fmac_f32 v251, v18, v13
s_waitcnt vmcnt(31) lgkmcnt(10)
v_mfma_f32_32x32x16_bf16 v[96:111], a[128:131], a[112:115], v[96:111]
ds_read_b64_tr_b16 a[168:169], v29 offset:30720
ds_read_b64_tr_b16 a[170:171], v29 offset:32000
v_add_f32_dpp v236, v236, v236 row_ror:8 row_mask:0xf bank_mask:0xf
v_add_f32_dpp v237, v237, v237 row_ror:8 row_mask:0xf bank_mask:0xf
v_mfma_f32_32x32x16_bf16 v[112:127], a[132:135], a[112:115], v[112:127]
ds_read_b64_tr_b16 a[172:173], v29 offset:30784
ds_read_b64_tr_b16 a[174:175], v29 offset:32064
v_add_f32_dpp v238, v238, v238 row_ror:8 row_mask:0xf bank_mask:0xf
v_add_f32_dpp v239, v239, v239 row_ror:8 row_mask:0xf bank_mask:0xf
v_mfma_f32_32x32x16_bf16 v[128:143], a[136:139], a[112:115], v[128:143]
ds_read_b64_tr_b16 a[176:177], v29 offset:30848
ds_read_b64_tr_b16 a[178:179], v29 offset:32128
s_mov_b32 s34, 0x40a000
buffer_load_dwordx4 a[32:35], v30, s[96:99], s34 offen offset:0 sc1
v_add_f32_dpp v240, v240, v240 row_ror:8 row_mask:0xf bank_mask:0xf
v_add_f32_dpp v241, v241, v241 row_ror:8 row_mask:0xf bank_mask:0xf
v_mfma_f32_32x32x16_bf16 v[144:159], a[140:143], a[112:115], v[144:159]
ds_read_b64_tr_b16 a[180:181], v29 offset:30912
ds_read_b64_tr_b16 a[182:183], v29 offset:32192
v_add_f32_dpp v242, v242, v242 row_ror:8 row_mask:0xf bank_mask:0xf
v_add_f32_dpp v243, v243, v243 row_ror:8 row_mask:0xf bank_mask:0xf
v_mfma_f32_32x32x16_bf16 v[160:175], a[144:147], a[112:115], v[160:175]
ds_read_b64_tr_b16 a[184:185], v29 offset:30976
ds_read_b64_tr_b16 a[186:187], v29 offset:32256
v_add_f32_dpp v244, v244, v244 row_ror:8 row_mask:0xf bank_mask:0xf
v_add_f32_dpp v245, v245, v245 row_ror:8 row_mask:0xf bank_mask:0xf
s_waitcnt vmcnt(30) lgkmcnt(10)
v_mfma_f32_32x32x16_bf16 v[96:111], a[148:151], a[116:119], v[96:111]
ds_read_b64_tr_b16 a[188:189], v29 offset:35840
ds_read_b64_tr_b16 a[190:191], v29 offset:37120
v_add_f32_dpp v246, v246, v246 row_ror:8 row_mask:0xf bank_mask:0xf
v_add_f32_dpp v247, v247, v247 row_ror:8 row_mask:0xf bank_mask:0xf
v_mfma_f32_32x32x16_bf16 v[112:127], a[152:155], a[116:119], v[112:127]
ds_read_b64_tr_b16 a[192:193], v29 offset:35904
ds_read_b64_tr_b16 a[194:195], v29 offset:37184
v_add_f32_dpp v248, v248, v248 row_ror:8 row_mask:0xf bank_mask:0xf
v_add_f32_dpp v249, v249, v249 row_ror:8 row_mask:0xf bank_mask:0xf
v_mfma_f32_32x32x16_bf16 v[128:143], a[156:159], a[116:119], v[128:143]
ds_read_b64_tr_b16 a[196:197], v29 offset:35968
ds_read_b64_tr_b16 a[198:199], v29 offset:37248
buffer_load_dwordx4 a[36:39], v30, s[96:99], s34 offen offset:1024 sc1
v_add_f32_dpp v250, v250, v250 row_ror:8 row_mask:0xf bank_mask:0xf
v_add_f32_dpp v251, v251, v251 row_ror:8 row_mask:0xf bank_mask:0xf
v_mfma_f32_32x32x16_bf16 v[144:159], a[160:163], a[116:119], v[144:159]
ds_read_b64_tr_b16 a[200:201], v29 offset:36032
ds_read_b64_tr_b16 a[202:203], v29 offset:37312
v_mov_b32 v176, v236
v_mov_b32 v177, v237
v_mfma_f32_32x32x16_bf16 v[160:175], a[164:167], a[116:119], v[160:175]
ds_read_b64_tr_b16 a[204:205], v29 offset:36096
ds_read_b64_tr_b16 a[206:207], v29 offset:37376
v_mov_b32 v178, v238
v_mov_b32 v179, v239
s_waitcnt vmcnt(25) lgkmcnt(10)
v_mfma_f32_32x32x16_bf16 v[96:111], a[168:171], a[120:123], v[96:111]
ds_read_b64_tr_b16 a[128:129], v26 offset:0
ds_read_b64_tr_b16 a[130:131], v26 offset:1280
v_mov_b32 v180, v240
v_mov_b32 v181, v241
v_mov_b32 v182, v242
v_mfma_f32_32x32x16_bf16 v[112:127], a[172:175], a[120:123], v[112:127]
ds_read_b64_tr_b16 a[132:133], v26 offset:64
ds_read_b64_tr_b16 a[134:135], v26 offset:1344
v_mov_b32 v183, v243
v_mov_b32 v184, v244
v_mfma_f32_32x32x16_bf16 v[128:143], a[176:179], a[120:123], v[128:143]
ds_read_b64_tr_b16 a[136:137], v26 offset:128
ds_read_b64_tr_b16 a[138:139], v26 offset:1408
buffer_load_dwordx4 a[40:43], v30, s[96:99], s34 offen offset:2048 sc1
v_mov_b32 v185, v245
v_mov_b32 v186, v246
v_mfma_f32_32x32x16_bf16 v[144:159], a[180:183], a[120:123], v[144:159]
ds_read_b64_tr_b16 a[140:141], v26 offset:192
ds_read_b64_tr_b16 a[142:143], v26 offset:1472
v_mov_b32 v187, v247
v_mov_b32 v188, v248
v_mfma_f32_32x32x16_bf16 v[160:175], a[184:187], a[120:123], v[160:175]
ds_read_b64_tr_b16 a[144:145], v26 offset:256
ds_read_b64_tr_b16 a[146:147], v26 offset:1536
v_mov_b32 v189, v249
v_mov_b32 v190, v250
s_waitcnt vmcnt(21) lgkmcnt(10)
v_mfma_f32_32x32x16_bf16 v[96:111], a[188:191], a[124:127], v[96:111]
ds_read_b64_tr_b16 a[148:149], v26 offset:5120
ds_read_b64_tr_b16 a[150:151], v26 offset:6400
v_mov_b32 v191, v251
v_permlane16_swap_b32 v176, v236
v_mfma_f32_32x32x16_bf16 v[112:127], a[192:195], a[124:127], v[112:127]
ds_read_b64_tr_b16 a[152:153], v26 offset:5184
ds_read_b64_tr_b16 a[154:155], v26 offset:6464
v_permlane16_swap_b32 v177, v237
v_permlane16_swap_b32 v178, v238
v_mfma_f32_32x32x16_bf16 v[128:143], a[196:199], a[124:127], v[128:143]
ds_read_b64_tr_b16 a[156:157], v26 offset:5248
ds_read_b64_tr_b16 a[158:159], v26 offset:6528
buffer_load_dwordx4 a[44:47], v30, s[96:99], s34 offen offset:3072 sc1
v_permlane16_swap_b32 v179, v239
v_permlane16_swap_b32 v180, v240
v_mfma_f32_32x32x16_bf16 v[144:159], a[200:203], a[124:127], v[144:159]
ds_read_b64_tr_b16 a[160:161], v26 offset:5312
ds_read_b64_tr_b16 a[162:163], v26 offset:6592
v_permlane16_swap_b32 v181, v241
v_permlane16_swap_b32 v182, v242
v_mfma_f32_32x32x16_bf16 v[160:175], a[204:207], a[124:127], v[160:175]
ds_read_b64_tr_b16 a[164:165], v26 offset:5376
ds_read_b64_tr_b16 a[166:167], v26 offset:6656
v_permlane16_swap_b32 v183, v243
v_permlane16_swap_b32 v184, v244
s_waitcnt vmcnt(21) lgkmcnt(10)
v_mfma_f32_32x32x16_bf16 v[96:111], a[128:131], a[0:3], v[96:111]
ds_read_b64_tr_b16 a[168:169], v26 offset:10240
ds_read_b64_tr_b16 a[170:171], v26 offset:11520
v_permlane16_swap_b32 v185, v245
v_permlane16_swap_b32 v186, v246
v_mfma_f32_32x32x16_bf16 v[112:127], a[132:135], a[0:3], v[112:127]
ds_read_b64_tr_b16 a[172:173], v26 offset:10304
ds_read_b64_tr_b16 a[174:175], v26 offset:11584
v_permlane16_swap_b32 v187, v247
v_permlane16_swap_b32 v188, v248
v_mfma_f32_32x32x16_bf16 v[128:143], a[136:139], a[0:3], v[128:143]
ds_read_b64_tr_b16 a[176:177], v26 offset:10368
ds_read_b64_tr_b16 a[178:179], v26 offset:11648
s_mov_b32 s34, 0x40b000
buffer_load_dwordx4 a[48:51], v30, s[96:99], s34 offen offset:0 sc1
v_permlane16_swap_b32 v189, v249
v_permlane16_swap_b32 v190, v250
v_mfma_f32_32x32x16_bf16 v[144:159], a[140:143], a[0:3], v[144:159]
ds_read_b64_tr_b16 a[180:181], v26 offset:10432
ds_read_b64_tr_b16 a[182:183], v26 offset:11712
v_permlane16_swap_b32 v191, v251
v_add_f32 v236, v236, v176
v_mfma_f32_32x32x16_bf16 v[160:175], a[144:147], a[0:3], v[160:175]
ds_read_b64_tr_b16 a[184:185], v26 offset:10496
ds_read_b64_tr_b16 a[186:187], v26 offset:11776
v_add_f32 v237, v237, v177
v_add_f32 v238, v238, v178
s_waitcnt vmcnt(21) lgkmcnt(10)
v_mfma_f32_32x32x16_bf16 v[96:111], a[148:151], a[4:7], v[96:111]
s_barrier
ds_read_b64_tr_b16 a[188:189], v26 offset:15360
ds_read_b64_tr_b16 a[190:191], v26 offset:16640
v_add_f32 v239, v239, v179
v_add_f32 v240, v240, v180
v_add_f32 v241, v241, v181
v_mfma_f32_32x32x16_bf16 v[112:127], a[152:155], a[4:7], v[112:127]
ds_read_b64_tr_b16 a[192:193], v26 offset:15424
ds_read_b64_tr_b16 a[194:195], v26 offset:16704
v_add_f32 v242, v242, v182
v_add_f32 v243, v243, v183
s_add_u32 s30, s31, 1146880
s_add_u32 m0, s29, 122880
s_nop 0
buffer_load_dwordx4 v20, s[8:11], s30 offen offset:0 lds
v_mfma_f32_32x32x16_bf16 v[128:143], a[156:159], a[4:7], v[128:143]
ds_read_b64_tr_b16 a[196:197], v26 offset:15488
ds_read_b64_tr_b16 a[198:199], v26 offset:16768
buffer_load_dwordx4 a[52:55], v30, s[96:99], s34 offen offset:1024 sc1
v_add_f32 v244, v244, v184
v_add_f32 v245, v245, v185
buffer_load_dwordx4 v21, s[8:11], s30 offen offset:1024 lds
v_mfma_f32_32x32x16_bf16 v[144:159], a[160:163], a[4:7], v[144:159]
ds_read_b64_tr_b16 a[200:201], v26 offset:15552
ds_read_b64_tr_b16 a[202:203], v26 offset:16832
v_add_f32 v246, v246, v186
v_add_f32 v247, v247, v187
buffer_load_dwordx4 v22, s[8:11], s30 offen offset:2048 lds
v_mfma_f32_32x32x16_bf16 v[160:175], a[164:167], a[4:7], v[160:175]
ds_read_b64_tr_b16 a[204:205], v26 offset:15616
ds_read_b64_tr_b16 a[206:207], v26 offset:16896
v_add_f32 v248, v248, v188
v_add_f32 v249, v249, v189
buffer_load_dwordx4 v23, s[8:11], s30 offen offset:3072 lds
s_waitcnt vmcnt(25) lgkmcnt(10)
v_mfma_f32_32x32x16_bf16 v[96:111], a[168:171], a[8:11], v[96:111]
ds_read_b64_tr_b16 a[128:129], v26 offset:20480
ds_read_b64_tr_b16 a[130:131], v26 offset:21760
v_add_f32 v250, v250, v190
v_add_f32 v251, v251, v191
s_add_u32 m0, s29, 126976
s_nop 0
buffer_load_dwordx4 v24, s[8:11], s30 offen offset:0 lds
v_mfma_f32_32x32x16_bf16 v[112:127], a[172:175], a[8:11], v[112:127]
ds_read_b64_tr_b16 a[132:133], v26 offset:20544
ds_read_b64_tr_b16 a[134:135], v26 offset:21824
v_mov_b32 v176, v236
v_mov_b32 v177, v237
s_add_u32 s30, s31, 1228800
s_add_u32 m0, s29, 143360
s_nop 0
buffer_load_dwordx4 v20, s[8:11], s30 offen offset:0 lds
v_mfma_f32_32x32x16_bf16 v[128:143], a[176:179], a[8:11], v[128:143]
ds_read_b64_tr_b16 a[136:137], v26 offset:20608
ds_read_b64_tr_b16 a[138:139], v26 offset:21888
buffer_load_dwordx4 a[56:59], v30, s[96:99], s34 offen offset:2048 sc1
v_mov_b32 v178, v238
v_mov_b32 v179, v239
buffer_load_dwordx4 v21, s[8:11], s30 offen offset:1024 lds
v_mfma_f32_32x32x16_bf16 v[144:159], a[180:183], a[8:11], v[144:159]
ds_read_b64_tr_b16 a[140:141], v26 offset:20672
ds_read_b64_tr_b16 a[142:143], v26 offset:21952
v_mov_b32 v180, v240
v_mov_b32 v181, v241
buffer_load_dwordx4 v22, s[8:11], s30 offen offset:2048 lds
v_mfma_f32_32x32x16_bf16 v[160:175], a[184:187], a[8:11], v[160:175]
ds_read_b64_tr_b16 a[144:145], v26 offset:20736
ds_read_b64_tr_b16 a[146:147], v26 offset:22016
v_mov_b32 v182, v242
v_mov_b32 v183, v243
buffer_load_dwordx4 v23, s[8:11], s30 offen offset:3072 lds
s_waitcnt vmcnt(30) lgkmcnt(10)
v_mfma_f32_32x32x16_bf16 v[96:111], a[188:191], a[12:15], v[96:111]
ds_read_b64_tr_b16 a[148:149], v26 offset:25600
ds_read_b64_tr_b16 a[150:151], v26 offset:26880
v_mov_b32 v184, v244
v_mov_b32 v185, v245
s_add_u32 m0, s29, 147456
s_nop 0
buffer_load_dwordx4 v24, s[8:11], s30 offen offset:0 lds
v_mfma_f32_32x32x16_bf16 v[112:127], a[192:195], a[12:15], v[112:127]
ds_read_b64_tr_b16 a[152:153], v26 offset:25664
ds_read_b64_tr_b16 a[154:155], v26 offset:26944
v_mov_b32 v186, v246
v_mov_b32 v187, v247
v_mfma_f32_32x32x16_bf16 v[128:143], a[196:199], a[12:15], v[128:143]
ds_read_b64_tr_b16 a[156:157], v26 offset:25728
ds_read_b64_tr_b16 a[158:159], v26 offset:27008
buffer_load_dwordx4 a[60:63], v30, s[96:99], s34 offen offset:3072 sc1
v_mov_b32 v188, v248
v_mov_b32 v189, v249
v_mfma_f32_32x32x16_bf16 v[144:159], a[200:203], a[12:15], v[144:159]
ds_read_b64_tr_b16 a[160:161], v26 offset:25792
ds_read_b64_tr_b16 a[162:163], v26 offset:27072
v_mov_b32 v190, v250
v_mov_b32 v191, v251
v_mfma_f32_32x32x16_bf16 v[160:175], a[204:207], a[12:15], v[160:175]
ds_read_b64_tr_b16 a[164:165], v26 offset:25856
ds_read_b64_tr_b16 a[166:167], v26 offset:27136
v_permlane32_swap_b32 v176, v236
v_permlane32_swap_b32 v177, v237
s_waitcnt vmcnt(31) lgkmcnt(10)
v_mfma_f32_32x32x16_bf16 v[96:111], a[128:131], a[16:19], v[96:111]
ds_read_b64_tr_b16 a[168:169], v26 offset:30720
ds_read_b64_tr_b16 a[170:171], v26 offset:32000
v_permlane32_swap_b32 v178, v238
v_permlane32_swap_b32 v179, v239
v_permlane32_swap_b32 v180, v240
v_mfma_f32_32x32x16_bf16 v[112:127], a[132:135], a[16:19], v[112:127]
ds_read_b64_tr_b16 a[172:173], v26 offset:30784
ds_read_b64_tr_b16 a[174:175], v26 offset:32064
v_permlane32_swap_b32 v181, v241
v_permlane32_swap_b32 v182, v242
v_mfma_f32_32x32x16_bf16 v[128:143], a[136:139], a[16:19], v[128:143]
ds_read_b64_tr_b16 a[176:177], v26 offset:30848
ds_read_b64_tr_b16 a[178:179], v26 offset:32128
s_mov_b32 s34, 0x40c000
buffer_load_dwordx4 a[64:67], v30, s[96:99], s34 offen offset:0 sc1
v_permlane32_swap_b32 v183, v243
v_permlane32_swap_b32 v184, v244
v_mfma_f32_32x32x16_bf16 v[144:159], a[140:143], a[16:19], v[144:159]
ds_read_b64_tr_b16 a[180:181], v26 offset:30912
ds_read_b64_tr_b16 a[182:183], v26 offset:32192
v_permlane32_swap_b32 v185, v245
v_permlane32_swap_b32 v186, v246
v_mfma_f32_32x32x16_bf16 v[160:175], a[144:147], a[16:19], v[160:175]
ds_read_b64_tr_b16 a[184:185], v26 offset:30976
ds_read_b64_tr_b16 a[186:187], v26 offset:32256
v_permlane32_swap_b32 v187, v247
v_permlane32_swap_b32 v188, v248
s_waitcnt vmcnt(30) lgkmcnt(10)
v_mfma_f32_32x32x16_bf16 v[96:111], a[148:151], a[20:23], v[96:111]
ds_read_b64_tr_b16 a[188:189], v26 offset:35840
ds_read_b64_tr_b16 a[190:191], v26 offset:37120
v_permlane32_swap_b32 v189, v249
v_permlane32_swap_b32 v190, v250
v_mfma_f32_32x32x16_bf16 v[112:127], a[152:155], a[20:23], v[112:127]
ds_read_b64_tr_b16 a[192:193], v26 offset:35904
ds_read_b64_tr_b16 a[194:195], v26 offset:37184
v_permlane32_swap_b32 v191, v251
v_add_f32 v236, v236, v176
v_mfma_f32_32x32x16_bf16 v[128:143], a[156:159], a[20:23], v[128:143]
ds_read_b64_tr_b16 a[196:197], v26 offset:35968
ds_read_b64_tr_b16 a[198:199], v26 offset:37248
buffer_load_dwordx4 a[68:71], v30, s[96:99], s34 offen offset:1024 sc1
v_add_f32 v237, v237, v177
v_add_f32 v238, v238, v178
v_mfma_f32_32x32x16_bf16 v[144:159], a[160:163], a[20:23], v[144:159]
ds_read_b64_tr_b16 a[200:201], v26 offset:36032
ds_read_b64_tr_b16 a[202:203], v26 offset:37312
v_add_f32 v239, v239, v179
v_add_f32 v240, v240, v180
v_mfma_f32_32x32x16_bf16 v[160:175], a[164:167], a[20:23], v[160:175]
ds_read_b64_tr_b16 a[204:205], v26 offset:36096
ds_read_b64_tr_b16 a[206:207], v26 offset:37376
v_add_f32 v241, v241, v181
v_add_f32 v242, v242, v182
s_waitcnt vmcnt(25) lgkmcnt(10)
v_mfma_f32_32x32x16_bf16 v[96:111], a[168:171], a[24:27], v[96:111]
ds_read_b64_tr_b16 a[128:129], v27 offset:0
ds_read_b64_tr_b16 a[130:131], v27 offset:1280
v_add_f32 v243, v243, v183
v_add_f32 v244, v244, v184
v_mfma_f32_32x32x16_bf16 v[112:127], a[172:175], a[24:27], v[112:127]
ds_read_b64_tr_b16 a[132:133], v27 offset:64
ds_read_b64_tr_b16 a[134:135], v27 offset:1344
v_add_f32 v245, v245, v185
v_add_f32 v246, v246, v186
v_mfma_f32_32x32x16_bf16 v[128:143], a[176:179], a[24:27], v[128:143]
ds_read_b64_tr_b16 a[136:137], v27 offset:128
ds_read_b64_tr_b16 a[138:139], v27 offset:1408
buffer_load_dwordx4 a[72:75], v30, s[96:99], s34 offen offset:2048 sc1
v_add_f32 v247, v247, v187
v_add_f32 v248, v248, v188
v_mfma_f32_32x32x16_bf16 v[144:159], a[180:183], a[24:27], v[144:159]
ds_read_b64_tr_b16 a[140:141], v27 offset:192
ds_read_b64_tr_b16 a[142:143], v27 offset:1472
v_add_f32 v249, v249, v189
v_add_f32 v250, v250, v190
v_mfma_f32_32x32x16_bf16 v[160:175], a[184:187], a[24:27], v[160:175]
ds_read_b64_tr_b16 a[144:145], v27 offset:256
ds_read_b64_tr_b16 a[146:147], v27 offset:1536
v_add_f32 v251, v251, v191
s_lshl_b32 s7, s56, 2
s_add_u32 s7, s7, s100
s_mul_i32 s7, s7, 27648
s_lshl_b32 s3, s57, 8
s_add_u32 s7, s7, s3
s_add_u32 s7, s7, 0x2e00000
s_cmp_ge_u32 s56, 4
s_cselect_b32 s7, 0x40000000, s7
s_add_u32 s3, s7, 13824
v_lshlrev_b32 v4, 5, v16
s_mov_b64 exec, 0xff
buffer_store_dwordx4 v[236:239], v4, s[96:99], s7 offen sc1
buffer_store_dwordx4 v[240:243], v4, s[96:99], s7 offen offset:16 sc1
buffer_store_dwordx4 v[244:247], v4, s[96:99], s3 offen sc1
buffer_store_dwordx4 v[248:251], v4, s[96:99], s3 offen offset:16 sc1
s_mov_b64 exec, -1
s_waitcnt vmcnt(25) lgkmcnt(10)
v_mfma_f32_32x32x16_bf16 v[96:111], a[188:191], a[28:31], v[96:111]
ds_read_b64_tr_b16 a[148:149], v27 offset:5120
ds_read_b64_tr_b16 a[150:151], v27 offset:6400
v_mfma_f32_32x32x16_bf16 v[112:127], a[192:195], a[28:31], v[112:127]
ds_read_b64_tr_b16 a[152:153], v27 offset:5184
ds_read_b64_tr_b16 a[154:155], v27 offset:6464
v_mfma_f32_32x32x16_bf16 v[128:143], a[196:199], a[28:31], v[128:143]
ds_read_b64_tr_b16 a[156:157], v27 offset:5248
ds_read_b64_tr_b16 a[158:159], v27 offset:6528
buffer_load_dwordx4 a[76:79], v30, s[96:99], s34 offen offset:3072 sc1
v_mfma_f32_32x32x16_bf16 v[144:159], a[200:203], a[28:31], v[144:159]
ds_read_b64_tr_b16 a[160:161], v27 offset:5312
ds_read_b64_tr_b16 a[162:163], v27 offset:6592
v_mfma_f32_32x32x16_bf16 v[160:175], a[204:207], a[28:31], v[160:175]
ds_read_b64_tr_b16 a[164:165], v27 offset:5376
ds_read_b64_tr_b16 a[166:167], v27 offset:6656
s_waitcnt vmcnt(25) lgkmcnt(10)
v_mfma_f32_32x32x16_bf16 v[96:111], a[128:131], a[32:35], v[96:111]
ds_read_b64_tr_b16 a[168:169], v27 offset:10240
ds_read_b64_tr_b16 a[170:171], v27 offset:11520
v_mfma_f32_32x32x16_bf16 v[112:127], a[132:135], a[32:35], v[112:127]
ds_read_b64_tr_b16 a[172:173], v27 offset:10304
ds_read_b64_tr_b16 a[174:175], v27 offset:11584
v_mfma_f32_32x32x16_bf16 v[128:143], a[136:139], a[32:35], v[128:143]
ds_read_b64_tr_b16 a[176:177], v27 offset:10368
ds_read_b64_tr_b16 a[178:179], v27 offset:11648
s_mov_b32 s34, 0x40d000
buffer_load_dwordx4 a[80:83], v30, s[96:99], s34 offen offset:0 sc1
v_mfma_f32_32x32x16_bf16 v[144:159], a[140:143], a[32:35], v[144:159]
ds_read_b64_tr_b16 a[180:181], v27 offset:10432
ds_read_b64_tr_b16 a[182:183], v27 offset:11712
v_mfma_f32_32x32x16_bf16 v[160:175], a[144:147], a[32:35], v[160:175]
ds_read_b64_tr_b16 a[184:185], v27 offset:10496
ds_read_b64_tr_b16 a[186:187], v27 offset:11776
s_waitcnt vmcnt(25) lgkmcnt(10)
v_mfma_f32_32x32x16_bf16 v[96:111], a[148:151], a[36:39], v[96:111]
s_barrier
ds_read_b64_tr_b16 a[188:189], v27 offset:15360
ds_read_b64_tr_b16 a[190:191], v27 offset:16640
v_mfma_f32_32x32x16_bf16 v[112:127], a[152:155], a[36:39], v[112:127]
ds_read_b64_tr_b16 a[192:193], v27 offset:15424
ds_read_b64_tr_b16 a[194:195], v27 offset:16704
s_bfe_u32 s32, s2, 0x20001
s_mul_i32 s32, s32, 7
s_lshr_b32 s33, s2, 5
s_add_u32 s32, s32, s33
s_lshl_b32 s31, s32, 7
s_cmp_ge_u32 s33, 7
s_cselect_b32 s31, 0x40000000, s31
s_cmp_ge_u32 s32, 27
s_cselect_b32 s31, 0x40000000, s31
s_lshl_b32 s29, s100, 11
s_mov_b32 s8, s44
s_mov_b32 s9, s45
s_mov_b32 s10, 0x21c000
s_mov_b32 s11, 0x20000
s_mov_b32 s12, s46
s_mov_b32 s13, s47
s_mov_b32 s14, 0x21c000
s_mov_b32 s15, 0x20000
v_mfma_f32_32x32x16_bf16 v[128:143], a[156:159], a[36:39], v[128:143]
ds_read_b64_tr_b16 a[196:197], v27 offset:15488
ds_read_b64_tr_b16 a[198:199], v27 offset:16768
buffer_load_dwordx4 a[84:87], v30, s[96:99], s34 offen offset:1024 sc1
v_mfma_f32_32x32x16_bf16 v[144:159], a[160:163], a[36:39], v[144:159]
ds_read_b64_tr_b16 a[200:201], v27 offset:15552
ds_read_b64_tr_b16 a[202:203], v27 offset:16832
v_mfma_f32_32x32x16_bf16 v[160:175], a[164:167], a[36:39], v[160:175]
ds_read_b64_tr_b16 a[204:205], v27 offset:15616
ds_read_b64_tr_b16 a[206:207], v27 offset:16896
s_waitcnt vmcnt(25) lgkmcnt(10)
v_mfma_f32_32x32x16_bf16 v[96:111], a[168:171], a[40:43], v[96:111]
ds_read_b64_tr_b16 a[128:129], v27 offset:20480
ds_read_b64_tr_b16 a[130:131], v27 offset:21760
v_bfe_u32 v14, v2, 4, 1
v_mfma_f32_32x32x16_bf16 v[112:127], a[172:175], a[40:43], v[112:127]
ds_read_b64_tr_b16 a[132:133], v27 offset:20544
ds_read_b64_tr_b16 a[134:135], v27 offset:21824
v_mfma_f32_32x32x16_bf16 v[128:143], a[176:179], a[40:43], v[128:143]
ds_read_b64_tr_b16 a[136:137], v27 offset:20608
ds_read_b64_tr_b16 a[138:139], v27 offset:21888
buffer_load_dwordx4 a[88:91], v30, s[96:99], s34 offen offset:2048 sc1
v_lshlrev_b32 v14, 2, v14
v_mfma_f32_32x32x16_bf16 v[144:159], a[180:183], a[40:43], v[144:159]
ds_read_b64_tr_b16 a[140:141], v27 offset:20672
ds_read_b64_tr_b16 a[142:143], v27 offset:21952
v_mfma_f32_32x32x16_bf16 v[160:175], a[184:187], a[40:43], v[160:175]
ds_read_b64_tr_b16 a[144:145], v27 offset:20736
ds_read_b64_tr_b16 a[146:147], v27 offset:22016
s_waitcnt vmcnt(25) lgkmcnt(10)
v_mfma_f32_32x32x16_bf16 v[96:111], a[188:191], a[44:47], v[96:111]
ds_read_b64_tr_b16 a[148:149], v27 offset:25600
ds_read_b64_tr_b16 a[150:151], v27 offset:26880
v_and_b32 v15, 7, v2
v_mfma_f32_32x32x16_bf16 v[112:127], a[192:195], a[44:47], v[112:127]
ds_read_b64_tr_b16 a[152:153], v27 offset:25664
ds_read_b64_tr_b16 a[154:155], v27 offset:26944
v_mfma_f32_32x32x16_bf16 v[128:143], a[196:199], a[44:47], v[128:143]
ds_read_b64_tr_b16 a[156:157], v27 offset:25728
ds_read_b64_tr_b16 a[158:159], v27 offset:27008
buffer_load_dwordx4 a[92:95], v30, s[96:99], s34 offen offset:3072 sc1
v_xor_b32 v14, v14, v15
v_mfma_f32_32x32x16_bf16 v[144:159], a[200:203], a[44:47], v[144:159]
ds_read_b64_tr_b16 a[160:161], v27 offset:25792
ds_read_b64_tr_b16 a[162:163], v27 offset:27072
v_mfma_f32_32x32x16_bf16 v[160:175], a[204:207], a[44:47], v[160:175]
ds_read_b64_tr_b16 a[164:165], v27 offset:25856
ds_read_b64_tr_b16 a[166:167], v27 offset:27136
s_waitcnt vmcnt(25) lgkmcnt(10)
v_mfma_f32_32x32x16_bf16 v[96:111], a[128:131], a[48:51], v[96:111]
ds_read_b64_tr_b16 a[168:169], v27 offset:30720
ds_read_b64_tr_b16 a[170:171], v27 offset:32000
v_lshlrev_b32 v14, 4, v14
v_mfma_f32_32x32x16_bf16 v[112:127], a[132:135], a[48:51], v[112:127]
ds_read_b64_tr_b16 a[172:173], v27 offset:30784
ds_read_b64_tr_b16 a[174:175], v27 offset:32064
v_mfma_f32_32x32x16_bf16 v[128:143], a[136:139], a[48:51], v[128:143]
ds_read_b64_tr_b16 a[176:177], v27 offset:30848
ds_read_b64_tr_b16 a[178:179], v27 offset:32128
s_mov_b32 s34, 0x40e000
buffer_load_dwordx4 a[96:99], v30, s[96:99], s34 offen offset:0 sc1
v_lshrrev_b32 v15, 3, v2
v_mfma_f32_32x32x16_bf16 v[144:159], a[140:143], a[48:51], v[144:159]
ds_read_b64_tr_b16 a[180:181], v27 offset:30912
ds_read_b64_tr_b16 a[182:183], v27 offset:32192
v_mfma_f32_32x32x16_bf16 v[160:175], a[144:147], a[48:51], v[160:175]
ds_read_b64_tr_b16 a[184:185], v27 offset:30976
ds_read_b64_tr_b16 a[186:187], v27 offset:32256
s_waitcnt vmcnt(24) lgkmcnt(10)
v_mfma_f32_32x32x16_bf16 v[96:111], a[148:151], a[52:55], v[96:111]
ds_read_b64_tr_b16 a[188:189], v27 offset:35840
ds_read_b64_tr_b16 a[190:191], v27 offset:37120
v_lshl_add_u32 v15, v1, 4, v15
v_mfma_f32_32x32x16_bf16 v[112:127], a[152:155], a[52:55], v[112:127]
ds_read_b64_tr_b16 a[192:193], v27 offset:35904
ds_read_b64_tr_b16 a[194:195], v27 offset:37184
v_mfma_f32_32x32x16_bf16 v[128:143], a[156:159], a[52:55], v[128:143]
ds_read_b64_tr_b16 a[196:197], v27 offset:35968
ds_read_b64_tr_b16 a[198:199], v27 offset:37248
buffer_load_dwordx4 a[100:103], v30, s[96:99], s34 offen offset:1024 sc1
v_mul_u32_u24 v15, 3456, v15
v_mfma_f32_32x32x16_bf16 v[144:159], a[160:163], a[52:55], v[144:159]
ds_read_b64_tr_b16 a[200:201], v27 offset:36032
ds_read_b64_tr_b16 a[202:203], v27 offset:37312
v_mfma_f32_32x32x16_bf16 v[160:175], a[164:167], a[52:55], v[160:175]
ds_read_b64_tr_b16 a[204:205], v27 offset:36096
ds_read_b64_tr_b16 a[206:207], v27 offset:37376
s_waitcnt vmcnt(19) lgkmcnt(10)
v_mfma_f32_32x32x16_bf16 v[96:111], a[168:171], a[56:59], v[96:111]
ds_read_b64_tr_b16 a[128:129], v28 offset:0
ds_read_b64_tr_b16 a[130:131], v28 offset:1280
v_add_u32 v16, v15, v14
v_mfma_f32_32x32x16_bf16 v[112:127], a[172:175], a[56:59], v[112:127]
ds_read_b64_tr_b16 a[132:133], v28 offset:64
ds_read_b64_tr_b16 a[134:135], v28 offset:1344
v_mfma_f32_32x32x16_bf16 v[128:143], a[176:179], a[56:59], v[128:143]
ds_read_b64_tr_b16 a[136:137], v28 offset:128
ds_read_b64_tr_b16 a[138:139], v28 offset:1408
buffer_load_dwordx4 a[104:107], v30, s[96:99], s34 offen offset:2048 sc1
v_add_u32 v17, 26624, v16
v_mfma_f32_32x32x16_bf16 v[144:159], a[180:183], a[56:59], v[144:159]
ds_read_b64_tr_b16 a[140:141], v28 offset:192
ds_read_b64_tr_b16 a[142:143], v28 offset:1472
v_mfma_f32_32x32x16_bf16 v[160:175], a[184:187], a[56:59], v[160:175]
ds_read_b64_tr_b16 a[144:145], v28 offset:256
ds_read_b64_tr_b16 a[146:147], v28 offset:1536
s_waitcnt vmcnt(15) lgkmcnt(10)
v_mfma_f32_32x32x16_bf16 v[96:111], a[188:191], a[60:63], v[96:111]
ds_read_b64_tr_b16 a[148:149], v28 offset:5120
ds_read_b64_tr_b16 a[150:151], v28 offset:6400
v_mfma_f32_32x32x16_bf16 v[112:127], a[192:195], a[60:63], v[112:127]
ds_read_b64_tr_b16 a[152:153], v28 offset:5184
ds_read_b64_tr_b16 a[154:155], v28 offset:6464
v_mfma_f32_32x32x16_bf16 v[128:143], a[196:199], a[60:63], v[128:143]
ds_read_b64_tr_b16 a[156:157], v28 offset:5248
ds_read_b64_tr_b16 a[158:159], v28 offset:6528
buffer_load_dwordx4 a[108:111], v30, s[96:99], s34 offen offset:3072 sc1
v_mfma_f32_32x32x16_bf16 v[144:159], a[200:203], a[60:63], v[144:159]
ds_read_b64_tr_b16 a[160:161], v28 offset:5312
ds_read_b64_tr_b16 a[162:163], v28 offset:6592
v_mfma_f32_32x32x16_bf16 v[160:175], a[204:207], a[60:63], v[160:175]
ds_read_b64_tr_b16 a[164:165], v28 offset:5376
ds_read_b64_tr_b16 a[166:167], v28 offset:6656
s_waitcnt vmcnt(15) lgkmcnt(10)
v_mfma_f32_32x32x16_bf16 v[96:111], a[128:131], a[64:67], v[96:111]
ds_read_b64_tr_b16 a[168:169], v28 offset:10240
ds_read_b64_tr_b16 a[170:171], v28 offset:11520
v_mfma_f32_32x32x16_bf16 v[112:127], a[132:135], a[64:67], v[112:127]
ds_read_b64_tr_b16 a[172:173], v28 offset:10304
ds_read_b64_tr_b16 a[174:175], v28 offset:11584
v_mfma_f32_32x32x16_bf16 v[128:143], a[136:139], a[64:67], v[128:143]
ds_read_b64_tr_b16 a[176:177], v28 offset:10368
ds_read_b64_tr_b16 a[178:179], v28 offset:11648
s_mov_b32 s34, 0x40f000
buffer_load_dwordx4 a[112:115], v30, s[96:99], s34 offen offset:0 sc1
v_mfma_f32_32x32x16_bf16 v[144:159], a[140:143], a[64:67], v[144:159]
ds_read_b64_tr_b16 a[180:181], v28 offset:10432
ds_read_b64_tr_b16 a[182:183], v28 offset:11712
v_mfma_f32_32x32x16_bf16 v[160:175], a[144:147], a[64:67], v[160:175]
ds_read_b64_tr_b16 a[184:185], v28 offset:10496
ds_read_b64_tr_b16 a[186:187], v28 offset:11776
s_waitcnt vmcnt(15) lgkmcnt(10)
v_mfma_f32_32x32x16_bf16 v[96:111], a[148:151], a[68:71], v[96:111]
s_waitcnt vmcnt(10)
s_barrier
ds_read_b64_tr_b16 a[188:189], v28 offset:15360
ds_read_b64_tr_b16 a[190:191], v28 offset:16640
v_mfma_f32_32x32x16_bf16 v[112:127], a[152:155], a[68:71], v[112:127]
v_cmp_eq_u32 vcc, 0, v0
v_mov_b32 v38, 1
v_mov_b32 v39, 0x40000000
v_mov_b32 v40, 49496320
v_cndmask_b32 v39, v39, v40, vcc
buffer_atomic_add v38, v39, s[96:99], 0 offen
ds_read_b64_tr_b16 a[192:193], v28 offset:15424
ds_read_b64_tr_b16 a[194:195], v28 offset:16704
v_mfma_f32_32x32x16_bf16 v[128:143], a[156:159], a[68:71], v[128:143]
ds_read_b64_tr_b16 a[196:197], v28 offset:15488
ds_read_b64_tr_b16 a[198:199], v28 offset:16768
buffer_load_dwordx4 a[116:119], v30, s[96:99], s34 offen offset:1024 sc1
s_add_u32 s30, s31, 442368
s_add_u32 m0, s29, 32768
s_nop 0
buffer_load_dwordx4 v16, s[8:11], s30 offen offset:0 lds
v_mfma_f32_32x32x16_bf16 v[144:159], a[160:163], a[68:71], v[144:159]
ds_read_b64_tr_b16 a[200:201], v28 offset:15552
ds_read_b64_tr_b16 a[202:203], v28 offset:16832
buffer_load_dwordx4 v17, s[8:11], s30 offen offset:1024 lds
v_mfma_f32_32x32x16_bf16 v[160:175], a[164:167], a[68:71], v[160:175]
ds_read_b64_tr_b16 a[204:205], v28 offset:15616
ds_read_b64_tr_b16 a[206:207], v28 offset:16896
s_add_u32 m0, s29, 40960
s_nop 0
buffer_load_dwordx4 v16, s[12:15], s30 offen offset:0 lds
s_waitcnt lgkmcnt(10)
v_mfma_f32_32x32x16_bf16 v[96:111], a[168:171], a[72:75], v[96:111]
ds_read_b64_tr_b16 a[128:129], v28 offset:20480
ds_read_b64_tr_b16 a[130:131], v28 offset:21760
buffer_load_dwordx4 v17, s[12:15], s30 offen offset:1024 lds
v_mfma_f32_32x32x16_bf16 v[112:127], a[172:175], a[72:75], v[112:127]
ds_read_b64_tr_b16 a[132:133], v28 offset:20544
ds_read_b64_tr_b16 a[134:135], v28 offset:21824
s_add_u32 s30, s31, 663552
s_add_u32 m0, s29, 49152
s_nop 0
buffer_load_dwordx4 v16, s[8:11], s30 offen offset:0 lds
v_mfma_f32_32x32x16_bf16 v[128:143], a[176:179], a[72:75], v[128:143]
ds_read_b64_tr_b16 a[136:137], v28 offset:20608
ds_read_b64_tr_b16 a[138:139], v28 offset:21888
buffer_load_dwordx4 a[120:123], v30, s[96:99], s34 offen offset:2048 sc1
buffer_load_dwordx4 v17, s[8:11], s30 offen offset:1024 lds
v_mfma_f32_32x32x16_bf16 v[144:159], a[180:183], a[72:75], v[144:159]
ds_read_b64_tr_b16 a[140:141], v28 offset:20672
ds_read_b64_tr_b16 a[142:143], v28 offset:21952
s_add_u32 m0, s29, 57344
s_nop 0
buffer_load_dwordx4 v16, s[12:15], s30 offen offset:0 lds
v_mfma_f32_32x32x16_bf16 v[160:175], a[184:187], a[72:75], v[160:175]
ds_read_b64_tr_b16 a[144:145], v28 offset:20736
ds_read_b64_tr_b16 a[146:147], v28 offset:22016
buffer_load_dwordx4 v17, s[12:15], s30 offen offset:1024 lds
s_waitcnt vmcnt(20) lgkmcnt(10)
v_mfma_f32_32x32x16_bf16 v[96:111], a[188:191], a[76:79], v[96:111]
ds_read_b64_tr_b16 a[148:149], v28 offset:25600
ds_read_b64_tr_b16 a[150:151], v28 offset:26880
s_add_u32 s30, s31, 884736
s_add_u32 m0, s29, 65536
s_nop 0
buffer_load_dwordx4 v16, s[8:11], s30 offen offset:0 lds
v_mfma_f32_32x32x16_bf16 v[112:127], a[192:195], a[76:79], v[112:127]
ds_read_b64_tr_b16 a[152:153], v28 offset:25664
ds_read_b64_tr_b16 a[154:155], v28 offset:26944
buffer_load_dwordx4 v17, s[8:11], s30 offen offset:1024 lds
v_mfma_f32_32x32x16_bf16 v[128:143], a[196:199], a[76:79], v[128:143]
ds_read_b64_tr_b16 a[156:157], v28 offset:25728
ds_read_b64_tr_b16 a[158:159], v28 offset:27008
buffer_load_dwordx4 a[124:127], v30, s[96:99], s34 offen offset:3072 sc1
s_add_u32 m0, s29, 73728
s_nop 0
buffer_load_dwordx4 v16, s[12:15], s30 offen offset:0 lds
v_mfma_f32_32x32x16_bf16 v[144:159], a[200:203], a[76:79], v[144:159]
ds_read_b64_tr_b16 a[160:161], v28 offset:25792
ds_read_b64_tr_b16 a[162:163], v28 offset:27072
buffer_load_dwordx4 v17, s[12:15], s30 offen offset:1024 lds
v_mfma_f32_32x32x16_bf16 v[160:175], a[204:207], a[76:79], v[160:175]
ds_read_b64_tr_b16 a[164:165], v28 offset:25856
ds_read_b64_tr_b16 a[166:167], v28 offset:27136
s_waitcnt vmcnt(24) lgkmcnt(10)
v_mfma_f32_32x32x16_bf16 v[96:111], a[128:131], a[80:83], v[96:111]
ds_read_b64_tr_b16 a[168:169], v28 offset:30720
ds_read_b64_tr_b16 a[170:171], v28 offset:32000
v_mfma_f32_32x32x16_bf16 v[112:127], a[132:135], a[80:83], v[112:127]
ds_read_b64_tr_b16 a[172:173], v28 offset:30784
ds_read_b64_tr_b16 a[174:175], v28 offset:32064
v_mfma_f32_32x32x16_bf16 v[128:143], a[136:139], a[80:83], v[128:143]
ds_read_b64_tr_b16 a[176:177], v28 offset:30848
ds_read_b64_tr_b16 a[178:179], v28 offset:32128
v_mfma_f32_32x32x16_bf16 v[144:159], a[140:143], a[80:83], v[144:159]
ds_read_b64_tr_b16 a[180:181], v28 offset:30912
ds_read_b64_tr_b16 a[182:183], v28 offset:32192
v_mfma_f32_32x32x16_bf16 v[160:175], a[144:147], a[80:83], v[160:175]
ds_read_b64_tr_b16 a[184:185], v28 offset:30976
ds_read_b64_tr_b16 a[186:187], v28 offset:32256
s_waitcnt vmcnt(23) lgkmcnt(10)
v_mfma_f32_32x32x16_bf16 v[96:111], a[148:151], a[84:87], v[96:111]
ds_read_b64_tr_b16 a[188:189], v28 offset:35840
ds_read_b64_tr_b16 a[190:191], v28 offset:37120
v_mfma_f32_32x32x16_bf16 v[112:127], a[152:155], a[84:87], v[112:127]
ds_read_b64_tr_b16 a[192:193], v28 offset:35904
ds_read_b64_tr_b16 a[194:195], v28 offset:37184
v_mfma_f32_32x32x16_bf16 v[128:143], a[156:159], a[84:87], v[128:143]
ds_read_b64_tr_b16 a[196:197], v28 offset:35968
ds_read_b64_tr_b16 a[198:199], v28 offset:37248
v_mfma_f32_32x32x16_bf16 v[144:159], a[160:163], a[84:87], v[144:159]
ds_read_b64_tr_b16 a[200:201], v28 offset:36032
ds_read_b64_tr_b16 a[202:203], v28 offset:37312
v_mfma_f32_32x32x16_bf16 v[160:175], a[164:167], a[84:87], v[160:175]
ds_read_b64_tr_b16 a[204:205], v28 offset:36096
ds_read_b64_tr_b16 a[206:207], v28 offset:37376
s_waitcnt vmcnt(22) lgkmcnt(10)
v_mfma_f32_32x32x16_bf16 v[96:111], a[168:171], a[88:91], v[96:111]
ds_read_b64_tr_b16 a[128:129], v29 offset:0
ds_read_b64_tr_b16 a[130:131], v29 offset:1280
v_mfma_f32_32x32x16_bf16 v[112:127], a[172:175], a[88:91], v[112:127]
ds_read_b64_tr_b16 a[132:133], v29 offset:64
ds_read_b64_tr_b16 a[134:135], v29 offset:1344
v_mfma_f32_32x32x16_bf16 v[128:143], a[176:179], a[88:91], v[128:143]
ds_read_b64_tr_b16 a[136:137], v29 offset:128
ds_read_b64_tr_b16 a[138:139], v29 offset:1408
v_mfma_f32_32x32x16_bf16 v[144:159], a[180:183], a[88:91], v[144:159]
ds_read_b64_tr_b16 a[140:141], v29 offset:192
ds_read_b64_tr_b16 a[142:143], v29 offset:1472
v_mfma_f32_32x32x16_bf16 v[160:175], a[184:187], a[88:91], v[160:175]
ds_read_b64_tr_b16 a[144:145], v29 offset:256
ds_read_b64_tr_b16 a[146:147], v29 offset:1536
s_waitcnt vmcnt(21) lgkmcnt(10)
v_mfma_f32_32x32x16_bf16 v[96:111], a[188:191], a[92:95], v[96:111]
ds_read_b64_tr_b16 a[148:149], v29 offset:5120
ds_read_b64_tr_b16 a[150:151], v29 offset:6400
v_mfma_f32_32x32x16_bf16 v[112:127], a[192:195], a[92:95], v[112:127]
ds_read_b64_tr_b16 a[152:153], v29 offset:5184
ds_read_b64_tr_b16 a[154:155], v29 offset:6464
v_mfma_f32_32x32x16_bf16 v[128:143], a[196:199], a[92:95], v[128:143]
ds_read_b64_tr_b16 a[156:157], v29 offset:5248
ds_read_b64_tr_b16 a[158:159], v29 offset:6528
v_mfma_f32_32x32x16_bf16 v[144:159], a[200:203], a[92:95], v[144:159]
ds_read_b64_tr_b16 a[160:161], v29 offset:5312
ds_read_b64_tr_b16 a[162:163], v29 offset:6592
v_mfma_f32_32x32x16_bf16 v[160:175], a[204:207], a[92:95], v[160:175]
ds_read_b64_tr_b16 a[164:165], v29 offset:5376
ds_read_b64_tr_b16 a[166:167], v29 offset:6656
s_waitcnt vmcnt(20) lgkmcnt(10)
v_mfma_f32_32x32x16_bf16 v[96:111], a[128:131], a[96:99], v[96:111]
ds_read_b64_tr_b16 a[168:169], v29 offset:10240
ds_read_b64_tr_b16 a[170:171], v29 offset:11520
v_mfma_f32_32x32x16_bf16 v[112:127], a[132:135], a[96:99], v[112:127]
ds_read_b64_tr_b16 a[172:173], v29 offset:10304
ds_read_b64_tr_b16 a[174:175], v29 offset:11584
v_mfma_f32_32x32x16_bf16 v[128:143], a[136:139], a[96:99], v[128:143]
ds_read_b64_tr_b16 a[176:177], v29 offset:10368
ds_read_b64_tr_b16 a[178:179], v29 offset:11648
v_mfma_f32_32x32x16_bf16 v[144:159], a[140:143], a[96:99], v[144:159]
ds_read_b64_tr_b16 a[180:181], v29 offset:10432
ds_read_b64_tr_b16 a[182:183], v29 offset:11712
v_mfma_f32_32x32x16_bf16 v[160:175], a[144:147], a[96:99], v[160:175]
ds_read_b64_tr_b16 a[184:185], v29 offset:10496
ds_read_b64_tr_b16 a[186:187], v29 offset:11776
s_waitcnt vmcnt(19) lgkmcnt(10)
v_mfma_f32_32x32x16_bf16 v[96:111], a[148:151], a[100:103], v[96:111]
s_barrier
ds_read_b64_tr_b16 a[188:189], v29 offset:15360
ds_read_b64_tr_b16 a[190:191], v29 offset:16640
v_mfma_f32_32x32x16_bf16 v[112:127], a[152:155], a[100:103], v[112:127]
ds_read_b64_tr_b16 a[192:193], v29 offset:15424
ds_read_b64_tr_b16 a[194:195], v29 offset:16704
v_mfma_f32_32x32x16_bf16 v[128:143], a[156:159], a[100:103], v[128:143]
ds_read_b64_tr_b16 a[196:197], v29 offset:15488
ds_read_b64_tr_b16 a[198:199], v29 offset:16768
s_add_u32 s30, s31, 1105920
s_add_u32 m0, s29, 81920
s_nop 0
buffer_load_dwordx4 v16, s[8:11], s30 offen offset:0 lds
v_mfma_f32_32x32x16_bf16 v[144:159], a[160:163], a[100:103], v[144:159]
ds_read_b64_tr_b16 a[200:201], v29 offset:15552
ds_read_b64_tr_b16 a[202:203], v29 offset:16832
buffer_load_dwordx4 v17, s[8:11], s30 offen offset:1024 lds
v_mfma_f32_32x32x16_bf16 v[160:175], a[164:167], a[100:103], v[160:175]
ds_read_b64_tr_b16 a[204:205], v29 offset:15616
ds_read_b64_tr_b16 a[206:207], v29 offset:16896
s_add_u32 m0, s29, 90112
s_nop 0
buffer_load_dwordx4 v16, s[12:15], s30 offen offset:0 lds
s_waitcnt vmcnt(21) lgkmcnt(10)
v_mfma_f32_32x32x16_bf16 v[96:111], a[168:171], a[104:107], v[96:111]
ds_read_b64_tr_b16 a[128:129], v29 offset:20480
ds_read_b64_tr_b16 a[130:131], v29 offset:21760
buffer_load_dwordx4 v17, s[12:15], s30 offen offset:1024 lds
v_mfma_f32_32x32x16_bf16 v[112:127], a[172:175], a[104:107], v[112:127]
ds_read_b64_tr_b16 a[132:133], v29 offset:20544
ds_read_b64_tr_b16 a[134:135], v29 offset:21824
s_add_u32 s30, s31, 1327104
s_add_u32 m0, s29, 98304
s_nop 0
buffer_load_dwordx4 v16, s[8:11], s30 offen offset:0 lds
v_mfma_f32_32x32x16_bf16 v[128:143], a[176:179], a[104:107], v[128:143]
ds_read_b64_tr_b16 a[136:137], v29 offset:20608
ds_read_b64_tr_b16 a[138:139], v29 offset:21888
buffer_load_dwordx4 v17, s[8:11], s30 offen offset:1024 lds
v_mfma_f32_32x32x16_bf16 v[144:159], a[180:183], a[104:107], v[144:159]
ds_read_b64_tr_b16 a[140:141], v29 offset:20672
ds_read_b64_tr_b16 a[142:143], v29 offset:21952
s_add_u32 m0, s29, 106496
s_nop 0
buffer_load_dwordx4 v16, s[12:15], s30 offen offset:0 lds
v_mfma_f32_32x32x16_bf16 v[160:175], a[184:187], a[104:107], v[160:175]
ds_read_b64_tr_b16 a[144:145], v29 offset:20736
ds_read_b64_tr_b16 a[146:147], v29 offset:22016
buffer_load_dwordx4 v17, s[12:15], s30 offen offset:1024 lds
s_waitcnt vmcnt(25) lgkmcnt(10)
v_mfma_f32_32x32x16_bf16 v[96:111], a[188:191], a[108:111], v[96:111]
ds_read_b64_tr_b16 a[148:149], v29 offset:25600
ds_read_b64_tr_b16 a[150:151], v29 offset:26880
buffer_load_dwordx4 v[224:227], v32, s[24:27], 0 offen offset:0
v_mfma_f32_32x32x16_bf16 v[112:127], a[192:195], a[108:111], v[112:127]
ds_read_b64_tr_b16 a[152:153], v29 offset:25664
ds_read_b64_tr_b16 a[154:155], v29 offset:26944
buffer_load_dwordx4 v[48:51], v33, s[96:99], s54 offen offset:0 sc1
v_mfma_f32_32x32x16_bf16 v[128:143], a[196:199], a[108:111], v[128:143]
ds_read_b64_tr_b16 a[156:157], v29 offset:25728
ds_read_b64_tr_b16 a[158:159], v29 offset:27008
buffer_load_dwordx4 v[72:75], v33, s[96:99], s55 offen offset:0 sc1
v_mfma_f32_32x32x16_bf16 v[144:159], a[200:203], a[108:111], v[144:159]
ds_read_b64_tr_b16 a[160:161], v29 offset:25792
ds_read_b64_tr_b16 a[162:163], v29 offset:27072
buffer_load_dwordx4 v[52:55], v33, s[96:99], s54 offen offset:16 sc1
v_mfma_f32_32x32x16_bf16 v[160:175], a[204:207], a[108:111], v[160:175]
ds_read_b64_tr_b16 a[164:165], v29 offset:25856
ds_read_b64_tr_b16 a[166:167], v29 offset:27136
buffer_load_dwordx4 v[76:79], v33, s[96:99], s55 offen offset:16 sc1
s_waitcnt vmcnt(29) lgkmcnt(10)
v_mfma_f32_32x32x16_bf16 v[96:111], a[128:131], a[112:115], v[96:111]
ds_read_b64_tr_b16 a[168:169], v29 offset:30720
ds_read_b64_tr_b16 a[170:171], v29 offset:32000
buffer_load_dwordx4 v[228:231], v32, s[24:27], 0 offen offset:128
v_mfma_f32_32x32x16_bf16 v[112:127], a[132:135], a[112:115], v[112:127]
ds_read_b64_tr_b16 a[172:173], v29 offset:30784
ds_read_b64_tr_b16 a[174:175], v29 offset:32064
buffer_load_dwordx4 v[56:59], v33, s[96:99], s54 offen offset:256 sc1
v_mfma_f32_32x32x16_bf16 v[128:143], a[136:139], a[112:115], v[128:143]
ds_read_b64_tr_b16 a[176:177], v29 offset:30848
ds_read_b64_tr_b16 a[178:179], v29 offset:32128
buffer_load_dwordx4 v[80:83], v33, s[96:99], s55 offen offset:256 sc1
v_mfma_f32_32x32x16_bf16 v[144:159], a[140:143], a[112:115], v[144:159]
ds_read_b64_tr_b16 a[180:181], v29 offset:30912
ds_read_b64_tr_b16 a[182:183], v29 offset:32192
buffer_load_dwordx4 v[60:63], v33, s[96:99], s54 offen offset:272 sc1
v_mfma_f32_32x32x16_bf16 v[160:175], a[144:147], a[112:115], v[160:175]
ds_read_b64_tr_b16 a[184:185], v29 offset:30976
ds_read_b64_tr_b16 a[186:187], v29 offset:32256
buffer_load_dwordx4 v[84:87], v33, s[96:99], s55 offen offset:272 sc1
s_waitcnt vmcnt(32) lgkmcnt(10)
v_mfma_f32_32x32x16_bf16 v[96:111], a[148:151], a[116:119], v[96:111]
ds_read_b64_tr_b16 a[188:189], v29 offset:35840
ds_read_b64_tr_b16 a[190:191], v29 offset:37120
buffer_load_dwordx4 v[232:235], v32, s[24:27], s52 offen offset:256
v_mfma_f32_32x32x16_bf16 v[112:127], a[152:155], a[116:119], v[112:127]
ds_read_b64_tr_b16 a[192:193], v29 offset:35904
ds_read_b64_tr_b16 a[194:195], v29 offset:37184
buffer_load_dwordx4 v[64:67], v33, s[96:99], s54 offen offset:512 sc1
v_mfma_f32_32x32x16_bf16 v[128:143], a[156:159], a[116:119], v[128:143]
ds_read_b64_tr_b16 a[196:197], v29 offset:35968
ds_read_b64_tr_b16 a[198:199], v29 offset:37248
buffer_load_dwordx4 v[88:91], v33, s[96:99], s55 offen offset:512 sc1
v_mfma_f32_32x32x16_bf16 v[144:159], a[160:163], a[116:119], v[144:159]
ds_read_b64_tr_b16 a[200:201], v29 offset:36032
ds_read_b64_tr_b16 a[202:203], v29 offset:37312
buffer_load_dwordx4 v[68:71], v33, s[96:99], s54 offen offset:528 sc1
v_mfma_f32_32x32x16_bf16 v[160:175], a[164:167], a[116:119], v[160:175]
ds_read_b64_tr_b16 a[204:205], v29 offset:36096
ds_read_b64_tr_b16 a[206:207], v29 offset:37376
buffer_load_dwordx4 v[92:95], v33, s[96:99], s55 offen offset:528 sc1
s_waitcnt vmcnt(31) lgkmcnt(10)
v_mfma_f32_32x32x16_bf16 v[96:111], a[168:171], a[120:123], v[96:111]
v_lshlrev_b32 v42, 2, v36
s_mov_b32 s33, 0x8000
buffer_load_dword v37, v42, s[96:99], s33 offen sc1
v_mfma_f32_32x32x16_bf16 v[112:127], a[172:175], a[120:123], v[112:127]
v_mfma_f32_32x32x16_bf16 v[128:143], a[176:179], a[120:123], v[128:143]
v_mfma_f32_32x32x16_bf16 v[144:159], a[180:183], a[120:123], v[144:159]
v_mfma_f32_32x32x16_bf16 v[160:175], a[184:187], a[120:123], v[160:175]
s_waitcnt vmcnt(26) lgkmcnt(0)
v_mfma_f32_32x32x16_bf16 v[96:111], a[188:191], a[124:127], v[96:111]
v_mfma_f32_32x32x16_bf16 v[112:127], a[192:195], a[124:127], v[112:127]
v_mfma_f32_32x32x16_bf16 v[128:143], a[196:199], a[124:127], v[128:143]
v_mfma_f32_32x32x16_bf16 v[144:159], a[200:203], a[124:127], v[144:159]
v_mfma_f32_32x32x16_bf16 v[160:175], a[204:207], a[124:127], v[160:175]
s_nop 7
v_cvt_pk_bf16_f32 v176, v96, v97
v_cvt_pk_bf16_f32 v177, v98, v99
v_cvt_pk_bf16_f32 v178, v100, v101
v_cvt_pk_bf16_f32 v179, v102, v103
s_mov_b32 s34, 0x3200000
buffer_store_dwordx4 v[176:179], v31, s[96:99], s34 offen offset:0 sc1
v_cvt_pk_bf16_f32 v180, v104, v105
v_cvt_pk_bf16_f32 v181, v106, v107
v_cvt_pk_bf16_f32 v182, v108, v109
v_cvt_pk_bf16_f32 v183, v110, v111
buffer_store_dwordx4 v[180:183], v31, s[96:99], s34 offen offset:1024 sc1
v_cvt_pk_bf16_f32 v184, v112, v113
v_cvt_pk_bf16_f32 v185, v114, v115
v_cvt_pk_bf16_f32 v186, v116, v117
v_cvt_pk_bf16_f32 v187, v118, v119
buffer_store_dwordx4 v[184:187], v31, s[96:99], s34 offen offset:2048 sc1
v_cvt_pk_bf16_f32 v188, v120, v121
v_cvt_pk_bf16_f32 v189, v122, v123
v_cvt_pk_bf16_f32 v190, v124, v125
v_cvt_pk_bf16_f32 v191, v126, v127
buffer_store_dwordx4 v[188:191], v31, s[96:99], s34 offen offset:3072 sc1
v_cvt_pk_bf16_f32 v192, v128, v129
v_cvt_pk_bf16_f32 v193, v130, v131
v_cvt_pk_bf16_f32 v194, v132, v133
v_cvt_pk_bf16_f32 v195, v134, v135
s_mov_b32 s34, 0x3201000
buffer_store_dwordx4 v[192:195], v31, s[96:99], s34 offen offset:0 sc1
v_cvt_pk_bf16_f32 v196, v136, v137
v_cvt_pk_bf16_f32 v197, v138, v139
v_cvt_pk_bf16_f32 v198, v140, v141
v_cvt_pk_bf16_f32 v199, v142, v143
buffer_store_dwordx4 v[196:199], v31, s[96:99], s34 offen offset:1024 sc1
v_cvt_pk_bf16_f32 v200, v144, v145
v_cvt_pk_bf16_f32 v201, v146, v147
v_cvt_pk_bf16_f32 v202, v148, v149
v_cvt_pk_bf16_f32 v203, v150, v151
buffer_store_dwordx4 v[200:203], v31, s[96:99], s34 offen offset:2048 sc1
v_cvt_pk_bf16_f32 v204, v152, v153
v_cvt_pk_bf16_f32 v205, v154, v155
v_cvt_pk_bf16_f32 v206, v156, v157
v_cvt_pk_bf16_f32 v207, v158, v159
buffer_store_dwordx4 v[204:207], v31, s[96:99], s34 offen offset:3072 sc1
v_cvt_pk_bf16_f32 v208, v160, v161
v_cvt_pk_bf16_f32 v209, v162, v163
v_cvt_pk_bf16_f32 v210, v164, v165
v_cvt_pk_bf16_f32 v211, v166, v167
s_mov_b32 s34, 0x3202000
buffer_store_dwordx4 v[208:211], v31, s[96:99], s34 offen offset:0 sc1
v_cvt_pk_bf16_f32 v212, v168, v169
v_cvt_pk_bf16_f32 v213, v170, v171
v_cvt_pk_bf16_f32 v214, v172, v173
v_cvt_pk_bf16_f32 v215, v174, v175
buffer_store_dwordx4 v[212:215], v31, s[96:99], s34 offen offset:1024 sc1
s_barrier
s_bfe_u32 s3, s2, 0x20001
s_cmp_lg_u32 s3, s100
s_cbranch_scc1 L_noself
ds_write_b128 v3, v[96:99] offset:0
ds_write_b128 v3, v[100:103] offset:1024
ds_write_b128 v3, v[104:107] offset:2048
ds_write_b128 v3, v[108:111] offset:3072
ds_write_b128 v3, v[112:115] offset:4096
ds_write_b128 v3, v[116:119] offset:5120
ds_write_b128 v3, v[120:123] offset:6144
ds_write_b128 v3, v[124:127] offset:7168
ds_write_b128 v3, v[128:131] offset:8192
ds_write_b128 v3, v[132:135] offset:9216
ds_write_b128 v3, v[136:139] offset:10240
ds_write_b128 v3, v[140:143] offset:11264
ds_write_b128 v3, v[144:147] offset:12288
ds_write_b128 v3, v[148:151] offset:13312
ds_write_b128 v3, v[152:155] offset:14336
ds_write_b128 v3, v[156:159] offset:15360
ds_write_b128 v3, v[160:163] offset:16384
ds_write_b128 v3, v[164:167] offset:17408
ds_write_b128 v3, v[168:171] offset:18432
ds_write_b128 v3, v[172:175] offset:19456
L_noself:
s_waitcnt lgkmcnt(0)
s_waitcnt vmcnt(0)
s_barrier
s_cmp_lg_u32 s100, 0
s_cbranch_scc1 L_sig5
s_mov_b64 exec, 1
v_mov_b32 v38, 1
v_mov_b32 v39, 49840128
buffer_atomic_add v38, v39, s[96:99], s35 offen
s_mov_b64 exec, -1
L_sig5:
ds_read_b128 v[96:99], v19 offset:0
ds_read_b128 v[100:103], v19 offset:1024
ds_read_b128 v[104:107], v19 offset:8192
ds_read_b128 v[108:111], v19 offset:9216
ds_read_b128 v[112:115], v19 offset:16384
ds_read_b128 v[116:119], v19 offset:17408
v_lshrrev_b32 v8, 7, v0
v_mul_u32_u24 v8, 3456, v8
v_and_b32 v9, 1, v1
v_mul_u32_u24 v9, 1728, v9
v_add3_u32 v8, v8, v9, v2
v_lshlrev_b32 v8, 2, v8
s_lshl_b32 s3, s31, 1
v_add_u32 v8, s3, v8
v_mov_b32 v38, 49496320
s_mov_b32 s101, 0
L_poll6:
buffer_load_dword v39, v38, s[96:99], 0 offen sc1
s_add_u32 s101, s101, 1
s_waitcnt vmcnt(0)
v_cmp_gt_u32 vcc, 256, v39
s_nop 0
s_cbranch_vccz L_poll6_go
s_sleep 2
s_cmp_lt_u32 s101, 0x20000
s_cbranch_scc1 L_poll6
L_poll6_go:
s_mov_b32 s33, 0x2e00000
buffer_load_dword v176, v8, s[96:99], s33 offen sc1
s_mov_b32 s33, 0x2e06c00
buffer_load_dword v177, v8, s[96:99], s33 offen sc1
s_mov_b32 s33, 0x2e0d800
buffer_load_dword v178, v8, s[96:99], s33 offen sc1
s_mov_b32 s33, 0x2e14400
buffer_load_dword v179, v8, s[96:99], s33 offen sc1
s_mov_b32 s33, 0x2e1b000
buffer_load_dword v180, v8, s[96:99], s33 offen sc1
s_mov_b32 s33, 0x2e21c00
buffer_load_dword v181, v8, s[96:99], s33 offen sc1
s_mov_b32 s33, 0x2e28800
buffer_load_dword v182, v8, s[96:99], s33 offen sc1
s_mov_b32 s33, 0x2e2f400
buffer_load_dword v183, v8, s[96:99], s33 offen sc1
s_mov_b32 s33, 0x2e36000
buffer_load_dword v184, v8, s[96:99], s33 offen sc1
s_mov_b32 s33, 0x2e3cc00
buffer_load_dword v185, v8, s[96:99], s33 offen sc1
s_mov_b32 s33, 0x2e43800
buffer_load_dword v186, v8, s[96:99], s33 offen sc1
s_mov_b32 s33, 0x2e4a400
buffer_load_dword v187, v8, s[96:99], s33 offen sc1
s_mov_b32 s33, 0x2e51000
buffer_load_dword v188, v8, s[96:99], s33 offen sc1
s_mov_b32 s33, 0x2e57c00
buffer_load_dword v189, v8, s[96:99], s33 offen sc1
s_mov_b32 s33, 0x2e5e800
buffer_load_dword v190, v8, s[96:99], s33 offen sc1
s_mov_b32 s33, 0x2e65400
buffer_load_dword v191, v8, s[96:99], s33 offen sc1
s_add_u32 s30, s31, 1548288
s_add_u32 m0, s29, 114688
s_nop 0
buffer_load_dwordx4 v16, s[8:11], s30 offen offset:0 lds
buffer_load_dwordx4 v17, s[8:11], s30 offen offset:1024 lds
s_add_u32 m0, s29, 122880
s_nop 0
buffer_load_dwordx4 v16, s[12:15], s30 offen offset:0 lds
buffer_load_dwordx4 v17, s[12:15], s30 offen offset:1024 lds
s_add_u32 s30, s31, 1769472
s_add_u32 m0, s29, 131072
s_nop 0
buffer_load_dwordx4 v16, s[8:11], s30 offen offset:0 lds
buffer_load_dwordx4 v17, s[8:11], s30 offen offset:1024 lds
s_add_u32 m0, s29, 139264
s_nop 0
buffer_load_dwordx4 v16, s[12:15], s30 offen offset:0 lds
buffer_load_dwordx4 v17, s[12:15], s30 offen offset:1024 lds
s_add_u32 s30, s31, 1990656
s_add_u32 m0, s29, 147456
s_nop 0
buffer_load_dwordx4 v16, s[8:11], s30 offen offset:0 lds
buffer_load_dwordx4 v17, s[8:11], s30 offen offset:1024 lds
s_add_u32 m0, s29, 155648
s_nop 0
buffer_load_dwordx4 v16, s[12:15], s30 offen offset:0 lds
buffer_load_dwordx4 v17, s[12:15], s30 offen offset:1024 lds
s_waitcnt vmcnt(26)
v_add_f32 v176, v176, v177
s_waitcnt vmcnt(25)
v_add_f32 v176, v176, v178
s_waitcnt vmcnt(24)
v_add_f32 v176, v176, v179
s_waitcnt vmcnt(23)
v_add_f32 v176, v176, v180
s_waitcnt vmcnt(22)
v_add_f32 v176, v176, v181
s_waitcnt vmcnt(21)
v_add_f32 v176, v176, v182
s_waitcnt vmcnt(20)
v_add_f32 v176, v176, v183
s_waitcnt vmcnt(19)
v_add_f32 v176, v176, v184
s_waitcnt vmcnt(18)
v_add_f32 v176, v176, v185
s_waitcnt vmcnt(17)
v_add_f32 v176, v176, v186
s_waitcnt vmcnt(16)
v_add_f32 v176, v176, v187
s_waitcnt vmcnt(15)
v_add_f32 v176, v176, v188
s_waitcnt vmcnt(14)
v_add_f32 v176, v176, v189
s_waitcnt vmcnt(13)
v_add_f32 v176, v176, v190
s_waitcnt vmcnt(12)
v_add_f32 v176, v176, v191
v_mov_b32 v41, v176
v_add_f32 v72, 1.0, v72
v_add_f32 v73, 1.0, v73
v_add_f32 v74, 1.0, v74
v_add_f32 v75, 1.0, v75
v_add_f32 v76, 1.0, v76
v_add_f32 v77, 1.0, v77
v_add_f32 v78, 1.0, v78
v_add_f32 v79, 1.0, v79
v_add_f32 v80, 1.0, v80
v_add_f32 v81, 1.0, v81
v_add_f32 v82, 1.0, v82
v_add_f32 v83, 1.0, v83
v_add_f32 v84, 1.0, v84
v_add_f32 v85, 1.0, v85
v_add_f32 v86, 1.0, v86
v_add_f32 v87, 1.0, v87
v_add_f32 v88, 1.0, v88
v_add_f32 v89, 1.0, v89
v_add_f32 v90, 1.0, v90
v_add_f32 v91, 1.0, v91
v_add_f32 v92, 1.0, v92
v_add_f32 v93, 1.0, v93
v_add_f32 v94, 1.0, v94
v_add_f32 v95, 1.0, v95
v_cvt_pk_bf16_f32 v5, v72, v73
v_lshlrev_b32 v72, 16, v5
v_and_b32 v73, 0xffff0000, v5
v_cvt_pk_bf16_f32 v5, v74, v75
v_lshlrev_b32 v74, 16, v5
v_and_b32 v75, 0xffff0000, v5
v_cvt_pk_bf16_f32 v5, v76, v77
v_lshlrev_b32 v76, 16, v5
v_and_b32 v77, 0xffff0000, v5
v_cvt_pk_bf16_f32 v5, v78, v79
v_lshlrev_b32 v78, 16, v5
v_and_b32 v79, 0xffff0000, v5
v_cvt_pk_bf16_f32 v5, v80, v81
v_lshlrev_b32 v80, 16, v5
v_and_b32 v81, 0xffff0000, v5
v_cvt_pk_bf16_f32 v5, v82, v83
v_lshlrev_b32 v82, 16, v5
v_and_b32 v83, 0xffff0000, v5
v_cvt_pk_bf16_f32 v5, v84, v85
v_lshlrev_b32 v84, 16, v5
v_and_b32 v85, 0xffff0000, v5
v_cvt_pk_bf16_f32 v5, v86, v87
v_lshlrev_b32 v86, 16, v5
v_and_b32 v87, 0xffff0000, v5
v_cvt_pk_bf16_f32 v5, v88, v89
v_lshlrev_b32 v88, 16, v5
v_and_b32 v89, 0xffff0000, v5
v_cvt_pk_bf16_f32 v5, v90, v91
v_lshlrev_b32 v90, 16, v5
v_and_b32 v91, 0xffff0000, v5
v_cvt_pk_bf16_f32 v5, v92, v93
v_lshlrev_b32 v92, 16, v5
v_and_b32 v93, 0xffff0000, v5
v_cvt_pk_bf16_f32 v5, v94, v95
v_lshlrev_b32 v94, 16, v5
v_and_b32 v95, 0xffff0000, v5
v_add_u32 v40, s52, v35
v_add_u32 v40, 8192, v40
v_mov_b32 v38, 49840128
s_mov_b32 s101, 0
L_poll7:
buffer_load_dword v39, v38, s[96:99], s35 offen sc1
s_add_u32 s101, s101, 1
s_waitcnt vmcnt(0)
v_cmp_gt_u32 vcc, 4, v39
s_nop 0
s_cbranch_vccz L_poll7_go
s_sleep 2
s_cmp_lt_u32 s101, 0x20000
s_cbranch_scc1 L_poll7
L_poll7_go:
s_waitcnt lgkmcnt(0)
buffer_load_dwordx4 v[128:131], v35, s[96:99], s48 offen sc1
buffer_load_dwordx4 v[132:135], v35, s[96:99], s49 offen sc1
buffer_load_dwordx4 v[136:139], v35, s[96:99], s50 offen sc1
buffer_load_dwordx4 v[140:143], v35, s[96:99], s51 offen sc1
v_add_u32 v35, 4096, v35
buffer_load_dwordx4 v[144:147], v35, s[96:99], s48 offen sc1
buffer_load_dwordx4 v[148:151], v35, s[96:99], s49 offen sc1
buffer_load_dwordx4 v[152:155], v35, s[96:99], s50 offen sc1
buffer_load_dwordx4 v[156:159], v35, s[96:99], s51 offen sc1
buffer_load_dwordx4 v[160:163], v40, s[96:99], s48 offen sc1
buffer_load_dwordx4 v[164:167], v40, s[96:99], s49 offen sc1
buffer_load_dwordx4 v[168:171], v40, s[96:99], s50 offen sc1
buffer_load_dwordx4 v[172:175], v40, s[96:99], s51 offen sc1
s_cmp_ge_u32 s100, 2
s_cselect_b32 s7, 0, -1
v_and_b32 v112, s7, v112
v_and_b32 v113, s7, v113
v_and_b32 v114, s7, v114
v_and_b32 v115, s7, v115
v_and_b32 v116, s7, v116
v_and_b32 v117, s7, v117
v_and_b32 v118, s7, v118
v_and_b32 v119, s7, v119
s_waitcnt vmcnt(11)
v_lshlrev_b32 v5, 16, v128
v_and_b32 v6, 0xffff0000, v128
v_add_f32 v96, v96, v5
v_add_f32 v97, v97, v6
v_lshlrev_b32 v5, 16, v129
v_and_b32 v6, 0xffff0000, v129
v_add_f32 v98, v98, v5
v_add_f32 v99, v99, v6
v_lshlrev_b32 v5, 16, v130
v_and_b32 v6, 0xffff0000, v130
v_add_f32 v100, v100, v5
v_add_f32 v101, v101, v6
v_lshlrev_b32 v5, 16, v131
v_and_b32 v6, 0xffff0000, v131
v_add_f32 v102, v102, v5
v_add_f32 v103, v103, v6
s_waitcnt vmcnt(10)
v_lshlrev_b32 v5, 16, v132
v_and_b32 v6, 0xffff0000, v132
v_add_f32 v96, v96, v5
v_add_f32 v97, v97, v6
v_lshlrev_b32 v5, 16, v133
v_and_b32 v6, 0xffff0000, v133
v_add_f32 v98, v98, v5
v_add_f32 v99, v99, v6
v_lshlrev_b32 v5, 16, v134
v_and_b32 v6, 0xffff0000, v134
v_add_f32 v100, v100, v5
v_add_f32 v101, v101, v6
v_lshlrev_b32 v5, 16, v135
v_and_b32 v6, 0xffff0000, v135
v_add_f32 v102, v102, v5
v_add_f32 v103, v103, v6
s_waitcnt vmcnt(9)
v_lshlrev_b32 v5, 16, v136
v_and_b32 v6, 0xffff0000, v136
v_add_f32 v96, v96, v5
v_add_f32 v97, v97, v6
v_lshlrev_b32 v5, 16, v137
v_and_b32 v6, 0xffff0000, v137
v_add_f32 v98, v98, v5
v_add_f32 v99, v99, v6
v_lshlrev_b32 v5, 16, v138
v_and_b32 v6, 0xffff0000, v138
v_add_f32 v100, v100, v5
v_add_f32 v101, v101, v6
v_lshlrev_b32 v5, 16, v139
v_and_b32 v6, 0xffff0000, v139
v_add_f32 v102, v102, v5
v_add_f32 v103, v103, v6
s_waitcnt vmcnt(8)
v_lshlrev_b32 v5, 16, v140
v_and_b32 v6, 0xffff0000, v140
v_add_f32 v96, v96, v5
v_add_f32 v97, v97, v6
v_lshlrev_b32 v5, 16, v141
v_and_b32 v6, 0xffff0000, v141
v_add_f32 v98, v98, v5
v_add_f32 v99, v99, v6
v_lshlrev_b32 v5, 16, v142
v_and_b32 v6, 0xffff0000, v142
v_add_f32 v100, v100, v5
v_add_f32 v101, v101, v6
v_lshlrev_b32 v5, 16, v143
v_and_b32 v6, 0xffff0000, v143
v_add_f32 v102, v102, v5
v_add_f32 v103, v103, v6
v_lshlrev_b32 v5, 16, v224
v_fma_f32 v96, v96, v48, v5
v_and_b32 v5, 0xffff0000, v224
v_fma_f32 v97, v97, v49, v5
v_lshlrev_b32 v5, 16, v225
v_fma_f32 v98, v98, v50, v5
v_and_b32 v5, 0xffff0000, v225
v_fma_f32 v99, v99, v51, v5
v_lshlrev_b32 v5, 16, v226
v_fma_f32 v100, v100, v52, v5
v_and_b32 v5, 0xffff0000, v226
v_fma_f32 v101, v101, v53, v5
v_lshlrev_b32 v5, 16, v227
v_fma_f32 v102, v102, v54, v5
v_and_b32 v5, 0xffff0000, v227
v_fma_f32 v103, v103, v55, v5
v_cvt_pk_bf16_f32 v200, v96, v97
v_cvt_pk_bf16_f32 v201, v98, v99
v_cvt_pk_bf16_f32 v202, v100, v101
v_cvt_pk_bf16_f32 v203, v102, v103
v_lshlrev_b32 v96, 16, v200
v_and_b32 v97, 0xffff0000, v200
v_lshlrev_b32 v98, 16, v201
v_and_b32 v99, 0xffff0000, v201
v_lshlrev_b32 v100, 16, v202
v_and_b32 v101, 0xffff0000, v202
v_lshlrev_b32 v102, 16, v203
v_and_b32 v103, 0xffff0000, v203
v_sub_f32 v96, v96, v37
v_sub_f32 v97, v97, v37
v_sub_f32 v98, v98, v37
v_sub_f32 v99, v99, v37
v_sub_f32 v100, v100, v37
v_sub_f32 v101, v101, v37
v_sub_f32 v102, v102, v37
v_sub_f32 v103, v103, v37
v_mul_f32 v72, v72, v96
v_mul_f32 v73, v73, v97
v_mul_f32 v74, v74, v98
v_mul_f32 v75, v75, v99
v_mul_f32 v76, v76, v100
v_mul_f32 v77, v77, v101
v_mul_f32 v78, v78, v102
v_mul_f32 v79, v79, v103
v_cvt_pk_bf16_f32 v204, v72, v73
v_cvt_pk_bf16_f32 v205, v74, v75
v_cvt_pk_bf16_f32 v206, v76, v77
v_cvt_pk_bf16_f32 v207, v78, v79
s_mov_b32 s34, 0x2000000
buffer_store_dwordx4 v[204:207], v34, s[96:99], s34 offen sc1
s_mov_b32 s34, 0x1400000
buffer_store_dwordx4 v[200:203], v34, s[96:99], s34 offen sc1
s_waitcnt vmcnt(9)
v_lshlrev_b32 v5, 16, v144
v_and_b32 v6, 0xffff0000, v144
v_add_f32 v104, v104, v5
v_add_f32 v105, v105, v6
v_lshlrev_b32 v5, 16, v145
v_and_b32 v6, 0xffff0000, v145
v_add_f32 v106, v106, v5
v_add_f32 v107, v107, v6
v_lshlrev_b32 v5, 16, v146
v_and_b32 v6, 0xffff0000, v146
v_add_f32 v108, v108, v5
v_add_f32 v109, v109, v6
v_lshlrev_b32 v5, 16, v147
v_and_b32 v6, 0xffff0000, v147
v_add_f32 v110, v110, v5
v_add_f32 v111, v111, v6
s_waitcnt vmcnt(8)
v_lshlrev_b32 v5, 16, v148
v_and_b32 v6, 0xffff0000, v148
v_add_f32 v104, v104, v5
v_add_f32 v105, v105, v6
v_lshlrev_b32 v5, 16, v149
v_and_b32 v6, 0xffff0000, v149
v_add_f32 v106, v106, v5
v_add_f32 v107, v107, v6
v_lshlrev_b32 v5, 16, v150
v_and_b32 v6, 0xffff0000, v150
v_add_f32 v108, v108, v5
v_add_f32 v109, v109, v6
v_lshlrev_b32 v5, 16, v151
v_and_b32 v6, 0xffff0000, v151
v_add_f32 v110, v110, v5
v_add_f32 v111, v111, v6
s_waitcnt vmcnt(7)
v_lshlrev_b32 v5, 16, v152
v_and_b32 v6, 0xffff0000, v152
v_add_f32 v104, v104, v5
v_add_f32 v105, v105, v6
v_lshlrev_b32 v5, 16, v153
v_and_b32 v6, 0xffff0000, v153
v_add_f32 v106, v106, v5
v_add_f32 v107, v107, v6
v_lshlrev_b32 v5, 16, v154
v_and_b32 v6, 0xffff0000, v154
v_add_f32 v108, v108, v5
v_add_f32 v109, v109, v6
v_lshlrev_b32 v5, 16, v155
v_and_b32 v6, 0xffff0000, v155
v_add_f32 v110, v110, v5
v_add_f32 v111, v111, v6
s_waitcnt vmcnt(6)
v_lshlrev_b32 v5, 16, v156
v_and_b32 v6, 0xffff0000, v156
v_add_f32 v104, v104, v5
v_add_f32 v105, v105, v6
v_lshlrev_b32 v5, 16, v157
v_and_b32 v6, 0xffff0000, v157
v_add_f32 v106, v106, v5
v_add_f32 v107, v107, v6
v_lshlrev_b32 v5, 16, v158
v_and_b32 v6, 0xffff0000, v158
v_add_f32 v108, v108, v5
v_add_f32 v109, v109, v6
v_lshlrev_b32 v5, 16, v159
v_and_b32 v6, 0xffff0000, v159
v_add_f32 v110, v110, v5
v_add_f32 v111, v111, v6
v_lshlrev_b32 v5, 16, v228
v_fma_f32 v104, v104, v56, v5
v_and_b32 v5, 0xffff0000, v228
v_fma_f32 v105, v105, v57, v5
v_lshlrev_b32 v5, 16, v229
v_fma_f32 v106, v106, v58, v5
v_and_b32 v5, 0xffff0000, v229
v_fma_f32 v107, v107, v59, v5
v_lshlrev_b32 v5, 16, v230
v_fma_f32 v108, v108, v60, v5
v_and_b32 v5, 0xffff0000, v230
v_fma_f32 v109, v109, v61, v5
v_lshlrev_b32 v5, 16, v231
v_fma_f32 v110, v110, v62, v5
v_and_b32 v5, 0xffff0000, v231
v_fma_f32 v111, v111, v63, v5
v_cvt_pk_bf16_f32 v208, v104, v105
v_cvt_pk_bf16_f32 v209, v106, v107
v_cvt_pk_bf16_f32 v210, v108, v109
v_cvt_pk_bf16_f32 v211, v110, v111
v_lshlrev_b32 v104, 16, v208
v_and_b32 v105, 0xffff0000, v208
v_lshlrev_b32 v106, 16, v209
v_and_b32 v107, 0xffff0000, v209
v_lshlrev_b32 v108, 16, v210
v_and_b32 v109, 0xffff0000, v210
v_lshlrev_b32 v110, 16, v211
v_and_b32 v111, 0xffff0000, v211
v_sub_f32 v104, v104, v37
v_sub_f32 v105, v105, v37
v_sub_f32 v106, v106, v37
v_sub_f32 v107, v107, v37
v_sub_f32 v108, v108, v37
v_sub_f32 v109, v109, v37
v_sub_f32 v110, v110, v37
v_sub_f32 v111, v111, v37
v_mul_f32 v80, v80, v104
v_mul_f32 v81, v81, v105
v_mul_f32 v82, v82, v106
v_mul_f32 v83, v83, v107
v_mul_f32 v84, v84, v108
v_mul_f32 v85, v85, v109
v_mul_f32 v86, v86, v110
v_mul_f32 v87, v87, v111
v_cvt_pk_bf16_f32 v212, v80, v81
v_cvt_pk_bf16_f32 v213, v82, v83
v_cvt_pk_bf16_f32 v214, v84, v85
v_cvt_pk_bf16_f32 v215, v86, v87
s_mov_b32 s34, 0x2001000
buffer_store_dwordx4 v[212:215], v34, s[96:99], s34 offen sc1
s_mov_b32 s34, 0x1401000
buffer_store_dwordx4 v[208:211], v34, s[96:99], s34 offen sc1
s_waitcnt vmcnt(7)
v_lshlrev_b32 v5, 16, v160
v_and_b32 v6, 0xffff0000, v160
v_add_f32 v112, v112, v5
v_add_f32 v113, v113, v6
v_lshlrev_b32 v5, 16, v161
v_and_b32 v6, 0xffff0000, v161
v_add_f32 v114, v114, v5
v_add_f32 v115, v115, v6
v_lshlrev_b32 v5, 16, v162
v_and_b32 v6, 0xffff0000, v162
v_add_f32 v116, v116, v5
v_add_f32 v117, v117, v6
v_lshlrev_b32 v5, 16, v163
v_and_b32 v6, 0xffff0000, v163
v_add_f32 v118, v118, v5
v_add_f32 v119, v119, v6
s_waitcnt vmcnt(6)
v_lshlrev_b32 v5, 16, v164
v_and_b32 v6, 0xffff0000, v164
v_add_f32 v112, v112, v5
v_add_f32 v113, v113, v6
v_lshlrev_b32 v5, 16, v165
v_and_b32 v6, 0xffff0000, v165
v_add_f32 v114, v114, v5
v_add_f32 v115, v115, v6
v_lshlrev_b32 v5, 16, v166
v_and_b32 v6, 0xffff0000, v166
v_add_f32 v116, v116, v5
v_add_f32 v117, v117, v6
v_lshlrev_b32 v5, 16, v167
v_and_b32 v6, 0xffff0000, v167
v_add_f32 v118, v118, v5
v_add_f32 v119, v119, v6
s_waitcnt vmcnt(5)
v_lshlrev_b32 v5, 16, v168
v_and_b32 v6, 0xffff0000, v168
v_add_f32 v112, v112, v5
v_add_f32 v113, v113, v6
v_lshlrev_b32 v5, 16, v169
v_and_b32 v6, 0xffff0000, v169
v_add_f32 v114, v114, v5
v_add_f32 v115, v115, v6
v_lshlrev_b32 v5, 16, v170
v_and_b32 v6, 0xffff0000, v170
v_add_f32 v116, v116, v5
v_add_f32 v117, v117, v6
v_lshlrev_b32 v5, 16, v171
v_and_b32 v6, 0xffff0000, v171
v_add_f32 v118, v118, v5
v_add_f32 v119, v119, v6
s_waitcnt vmcnt(4)
v_lshlrev_b32 v5, 16, v172
v_and_b32 v6, 0xffff0000, v172
v_add_f32 v112, v112, v5
v_add_f32 v113, v113, v6
v_lshlrev_b32 v5, 16, v173
v_and_b32 v6, 0xffff0000, v173
v_add_f32 v114, v114, v5
v_add_f32 v115, v115, v6
v_lshlrev_b32 v5, 16, v174
v_and_b32 v6, 0xffff0000, v174
v_add_f32 v116, v116, v5
v_add_f32 v117, v117, v6
v_lshlrev_b32 v5, 16, v175
v_and_b32 v6, 0xffff0000, v175
v_add_f32 v118, v118, v5
v_add_f32 v119, v119, v6
v_lshlrev_b32 v5, 16, v232
v_fma_f32 v112, v112, v64, v5
v_and_b32 v5, 0xffff0000, v232
v_fma_f32 v113, v113, v65, v5
v_lshlrev_b32 v5, 16, v233
v_fma_f32 v114, v114, v66, v5
v_and_b32 v5, 0xffff0000, v233
v_fma_f32 v115, v115, v67, v5
v_lshlrev_b32 v5, 16, v234
v_fma_f32 v116, v116, v68, v5
v_and_b32 v5, 0xffff0000, v234
v_fma_f32 v117, v117, v69, v5
v_lshlrev_b32 v5, 16, v235
v_fma_f32 v118, v118, v70, v5
v_and_b32 v5, 0xffff0000, v235
v_fma_f32 v119, v119, v71, v5
v_cvt_pk_bf16_f32 v216, v112, v113
v_cvt_pk_bf16_f32 v217, v114, v115
v_cvt_pk_bf16_f32 v218, v116, v117
v_cvt_pk_bf16_f32 v219, v118, v119
v_lshlrev_b32 v112, 16, v216
v_and_b32 v113, 0xffff0000, v216
v_lshlrev_b32 v114, 16, v217
v_and_b32 v115, 0xffff0000, v217
v_lshlrev_b32 v116, 16, v218
v_and_b32 v117, 0xffff0000, v218
v_lshlrev_b32 v118, 16, v219
v_and_b32 v119, 0xffff0000, v219
v_sub_f32 v112, v112, v37
v_and_b32 v112, s7, v112
v_sub_f32 v113, v113, v37
v_and_b32 v113, s7, v113
v_sub_f32 v114, v114, v37
v_and_b32 v114, s7, v114
v_sub_f32 v115, v115, v37
v_and_b32 v115, s7, v115
v_sub_f32 v116, v116, v37
v_and_b32 v116, s7, v116
v_sub_f32 v117, v117, v37
v_and_b32 v117, s7, v117
v_sub_f32 v118, v118, v37
v_and_b32 v118, s7, v118
v_sub_f32 v119, v119, v37
v_and_b32 v119, s7, v119
v_mul_f32 v88, v88, v112
v_mul_f32 v89, v89, v113
v_mul_f32 v90, v90, v114
v_mul_f32 v91, v91, v115
v_mul_f32 v92, v92, v116
v_mul_f32 v93, v93, v117
v_mul_f32 v94, v94, v118
v_mul_f32 v95, v95, v119
v_cvt_pk_bf16_f32 v220, v88, v89
v_cvt_pk_bf16_f32 v221, v90, v91
v_cvt_pk_bf16_f32 v222, v92, v93
v_cvt_pk_bf16_f32 v223, v94, v95
s_add_u32 s34, s52, 0x2002000
buffer_store_dwordx4 v[220:223], v34, s[96:99], s34 offen sc1
s_add_u32 s34, s52, 0x1402000
buffer_store_dwordx4 v[216:219], v34, s[96:99], s34 offen sc1
v_add_f32 v5, v96, v97
v_add_f32 v5, v5, v98
v_add_f32 v5, v5, v99
v_add_f32 v5, v5, v100
v_add_f32 v5, v5, v101
v_add_f32 v5, v5, v102
v_add_f32 v5, v5, v103
v_add_f32 v5, v5, v104
v_add_f32 v5, v5, v105
v_add_f32 v5, v5, v106
v_add_f32 v5, v5, v107
v_add_f32 v5, v5, v108
v_add_f32 v5, v5, v109
v_add_f32 v5, v5, v110
v_add_f32 v5, v5, v111
v_add_f32 v5, v5, v112
v_add_f32 v5, v5, v113
v_add_f32 v5, v5, v114
v_add_f32 v5, v5, v115
v_add_f32 v5, v5, v116
v_add_f32 v5, v5, v117
v_add_f32 v5, v5, v118
v_add_f32 v5, v5, v119
v_mov_b32 v6, v5
s_nop 1
v_permlane32_swap_b32 v6, v5
v_add_f32 v5, v5, v6
v_mul_f32 v5, s53, v5
v_sub_f32 v7, v112, v5
v_mul_f32 v6, v7, v7
v_sub_f32 v7, v113, v5
v_fmac_f32 v6, v7, v7
v_sub_f32 v7, v114, v5
v_fmac_f32 v6, v7, v7
v_sub_f32 v7, v115, v5
v_fmac_f32 v6, v7, v7
v_sub_f32 v7, v116, v5
v_fmac_f32 v6, v7, v7
v_sub_f32 v7, v117, v5
v_fmac_f32 v6, v7, v7
v_sub_f32 v7, v118, v5
v_fmac_f32 v6, v7, v7
v_sub_f32 v7, v119, v5
v_fmac_f32 v6, v7, v7
s_cmp_ge_u32 s100, 2
s_cselect_b32 s7, 0, 1.0
v_mul_f32 v6, s7, v6
v_sub_f32 v7, v96, v5
v_fmac_f32 v6, v7, v7
v_sub_f32 v7, v97, v5
v_fmac_f32 v6, v7, v7
v_sub_f32 v7, v98, v5
v_fmac_f32 v6, v7, v7
v_sub_f32 v7, v99, v5
v_fmac_f32 v6, v7, v7
v_sub_f32 v7, v100, v5
v_fmac_f32 v6, v7, v7
v_sub_f32 v7, v101, v5
v_fmac_f32 v6, v7, v7
v_sub_f32 v7, v102, v5
v_fmac_f32 v6, v7, v7
v_sub_f32 v7, v103, v5
v_fmac_f32 v6, v7, v7
v_sub_f32 v7, v104, v5
v_fmac_f32 v6, v7, v7
v_sub_f32 v7, v105, v5
v_fmac_f32 v6, v7, v7
v_sub_f32 v7, v106, v5
v_fmac_f32 v6, v7, v7
v_sub_f32 v7, v107, v5
v_fmac_f32 v6, v7, v7
v_sub_f32 v7, v108, v5
v_fmac_f32 v6, v7, v7
v_sub_f32 v7, v109, v5
v_fmac_f32 v6, v7, v7
v_sub_f32 v7, v110, v5
v_fmac_f32 v6, v7, v7
v_sub_f32 v7, v111, v5
v_fmac_f32 v6, v7, v7
v_mov_b32 v7, v6
s_nop 1
v_permlane32_swap_b32 v7, v6
v_mov_b32 v4, v5
v_add_f32 v5, v6, v7
v_lshlrev_b32 v3, 3, v36
s_lshl_b32 s7, s6, 2
s_add_u32 s7, s7, s100
s_lshl_b32 s7, s7, 14
s_add_u32 s7, s7, 0x1700000
s_mov_b64 exec, 0xffffffff
buffer_store_dwordx2 v[4:5], v3, s[96:99], s7 offen sc1
s_mov_b64 exec, -1
s_waitcnt vmcnt(0)
s_barrier
s_cmp_lg_u32 s100, 0
s_cbranch_scc1 L_sig8
s_mov_b64 exec, 1
v_mov_b32 v8, 1
v_mov_b32 v9, 49352704
v_mov_b32 v10, 1
buffer_atomic_add v8, v9, s[96:99], s37 offen sc0
s_waitcnt vmcnt(0)
v_cmp_eq_u32 vcc, 31, v8
v_mov_b32 v11, 0x40000000
s_nop 0
v_cndmask_b32 v9, v11, v9, vcc
v_add_u32 v9, 34816, v9
buffer_store_dword v10, v9, s[96:99], s37 offen sc1
s_mov_b64 exec, -1
L_sig8:
s_bfe_u32 s40, s2, 0x10001
s_lshl_b32 s40, s40, 2
s_bfe_u32 s41, s2, 0x20005
s_add_u32 s40, s40, s41
s_mul_i32 s40, s40, 54
s_mul_i32 s41, s100, 14
s_add_u32 s40, s40, s41
s_cmp_eq_u32 s100, 3
s_cselect_b32 s41, 1, 0
s_sub_u32 s40, s40, s41
s_mul_i32 s40, s40, 5120
v_lshlrev_b32 v232, 4, v2
v_add_u32 v232, s40, v232
v_add_u32 v233, 4096, v232
s_cmp_ge_u32 s100, 2
s_cselect_b32 s39, 0x40000000, 0
s_mul_i32 s28, s100, 20480
s_add_u32 s28, s28, 16384
s_mul_i32 s38, s100, 10240
s_add_u32 s38, s38, 98304
s_and_b32 s3, s2, 7
s_lshr_b32 s4, s2, 3
s_and_b32 s5, s3, 1
s_lshl_b32 s5, s5, 2
s_and_b32 s6, s4, 3
s_add_u32 s5, s5, s6
s_lshr_b32 s3, s3, 1
s_mul_i32 s3, s3, 7
s_lshr_b32 s4, s4, 2
s_add_u32 s6, s3, s4
s_cmp_ge_u32 s4, 7
s_cbranch_scc1 L_ffn1_skip
s_cmp_ge_u32 s6, 27
s_cbranch_scc1 L_ffn1_skip
v_lshrrev_b32 v3, 4, v2
v_and_b32 v4, 15, v2
v_lshrrev_b32 v5, 5, v2
v_bfe_u32 v6, v2, 2, 2
v_and_b32 v7, 3, v2
s_add_u32 s30, s31, 0
s_add_u32 m0, s29, 0
s_nop 0
buffer_load_dwordx4 v16, s[8:11], s30 offen offset:0 lds
buffer_load_dwordx4 v17, s[8:11], s30 offen offset:1024 lds
s_add_u32 m0, s29, 8192
s_nop 0
buffer_load_dwordx4 v16, s[12:15], s30 offen offset:0 lds
buffer_load_dwordx4 v17, s[12:15], s30 offen offset:1024 lds
s_add_u32 s30, s31, 221184
s_add_u32 m0, s29, 16384
s_nop 0
buffer_load_dwordx4 v16, s[8:11], s30 offen offset:0 lds
buffer_load_dwordx4 v17, s[8:11], s30 offen offset:1024 lds
s_add_u32 m0, s29, 24576
s_nop 0
buffer_load_dwordx4 v16, s[12:15], s30 offen offset:0 lds
buffer_load_dwordx4 v17, s[12:15], s30 offen offset:1024 lds
s_lshl_b32 s7, s5, 3
s_lshl_b32 s3, s100, 1
s_add_u32 s7, s7, s3
s_mul_i32 s3, s7, 40960
v_lshlrev_b32 v10, 4, v2
v_add_u32 v24, s3, v10
v_add_u32 v25, 40960, v24
s_lshl_b32 s7, s7, 8
s_add_u32 s7, s7, 0x1700000
v_and_b32 v10, 31, v2
v_lshlrev_b32 v10, 3, v10
v_add_u32 v26, s7, v10
v_lshl_add_u32 v8, v5, 3, v6
v_lshlrev_b32 v8, 7, v8
v_and_b32 v9, 1, v3
v_lshl_add_u32 v8, v9, 5, v8
v_and_b32 v9, 1, v7
v_lshl_add_u32 v8, v9, 4, v8
v_lshrrev_b32 v9, 1, v7
v_lshl_add_u32 v8, v9, 3, v8
v_lshrrev_b32 v10, 1, v6
v_xor_b32 v9, 0, v10
v_lshl_add_u32 v18, v9, 6, v8
v_add_u32 v20, 0x10000, v18
v_add_u32 v22, 0x20000, v18
v_xor_b32 v9, 1, v10
v_lshl_add_u32 v19, v9, 6, v8
v_add_u32 v21, 0x10000, v19
v_add_u32 v23, 0x20000, v19
v_lshrrev_b32 v8, 7, v0
v_mul_u32_u24 v8, 3456, v8
v_and_b32 v9, 1, v1
v_mul_u32_u24 v9, 1728, v9
v_add3_u32 v8, v8, v9, v2
s_lshl_b32 s3, s6, 6
v_add_u32 v8, s3, v8
v_lshlrev_b32 v27, 2, v8
v_lshlrev_b32 v34, 5, v5
s_lshl_b32 s7, s5, 4
s_lshl_b32 s3, s100, 2
s_add_u32 s7, s7, s3
s_mul_i32 s7, s7, 54
s_lshl_b32 s3, s6, 1
s_add_u32 s7, s7, s3
s_lshl_b32 s7, s7, 10
s_add_u32 s7, s7, 0x1800000
v_and_b32 v8, 1, v3
v_mul_u32_u24 v8, 55296, v8
v_lshl_add_u32 v8, v5, 8, v8
v_lshl_add_u32 v8, v4, 4, v8
v_add_u32 v28, s7, v8
v_add_u32 v29, 110592, v28
s_mul_i32 s37, s5, 4352
v_mov_b32 v35, v41
v_mov_b32 v68, 49387520
s_mov_b32 s101, 0
L_poll9:
buffer_load_dword v69, v68, s[96:99], s37 offen sc1
s_add_u32 s101, s101, 1
s_waitcnt vmcnt(0)
v_cmp_gt_u32 vcc, 1, v69
s_nop 0
s_cbranch_vccz L_poll9_go
s_sleep 2
s_cmp_lt_u32 s101, 0x20000
s_cbranch_scc1 L_poll9
L_poll9_go:
s_mov_b32 s34, 0x2000000
buffer_load_dwordx4 a[0:3], v24, s[96:99], s34 offen offset:0 sc1
buffer_load_dwordx4 a[4:7], v25, s[96:99], s34 offen offset:0 sc1
buffer_load_dwordx4 a[8:11], v24, s[96:99], s34 offen offset:1024 sc1
buffer_load_dwordx4 a[12:15], v25, s[96:99], s34 offen offset:1024 sc1
buffer_load_dwordx4 a[16:19], v24, s[96:99], s34 offen offset:2048 sc1
buffer_load_dwordx4 a[20:23], v25, s[96:99], s34 offen offset:2048 sc1
buffer_load_dwordx4 a[24:27], v24, s[96:99], s34 offen offset:3072 sc1
buffer_load_dwordx4 a[28:31], v25, s[96:99], s34 offen offset:3072 sc1
s_mov_b32 s34, 0x2001000
buffer_load_dwordx4 a[32:35], v24, s[96:99], s34 offen offset:0 sc1
buffer_load_dwordx4 a[36:39], v25, s[96:99], s34 offen offset:0 sc1
buffer_load_dwordx4 a[40:43], v24, s[96:99], s34 offen offset:1024 sc1
buffer_load_dwordx4 a[44:47], v25, s[96:99], s34 offen offset:1024 sc1
buffer_load_dwordx4 a[48:51], v24, s[96:99], s34 offen offset:2048 sc1
buffer_load_dwordx4 a[52:55], v25, s[96:99], s34 offen offset:2048 sc1
buffer_load_dwordx4 a[56:59], v24, s[96:99], s34 offen offset:3072 sc1
buffer_load_dwordx4 a[60:63], v25, s[96:99], s34 offen offset:3072 sc1
s_mov_b32 s34, 0x2002000
buffer_load_dwordx4 a[64:67], v24, s[96:99], s34 offen offset:0 sc1
buffer_load_dwordx4 a[68:71], v25, s[96:99], s34 offen offset:0 sc1
buffer_load_dwordx4 a[72:75], v24, s[96:99], s34 offen offset:1024 sc1
buffer_load_dwordx4 a[76:79], v25, s[96:99], s34 offen offset:1024 sc1
buffer_load_dwordx4 a[80:83], v24, s[96:99], s34 offen offset:2048 sc1
buffer_load_dwordx4 a[84:87], v25, s[96:99], s34 offen offset:2048 sc1
buffer_load_dwordx4 a[88:91], v24, s[96:99], s34 offen offset:3072 sc1
buffer_load_dwordx4 a[92:95], v25, s[96:99], s34 offen offset:3072 sc1
s_barrier
ds_read_b64_tr_b16 a[192:193], v18 offset:0
ds_read_b64_tr_b16 a[194:195], v18 offset:512
ds_read_b64_tr_b16 a[196:197], v19 offset:0
ds_read_b64_tr_b16 a[198:199], v19 offset:512
ds_read_b64_tr_b16 a[200:201], v18 offset:8192
ds_read_b64_tr_b16 a[202:203], v18 offset:8704
ds_read_b64_tr_b16 a[204:205], v19 offset:8192
ds_read_b64_tr_b16 a[206:207], v19 offset:8704
ds_read_b64_tr_b16 a[208:209], v18 offset:2048
ds_read_b64_tr_b16 a[210:211], v18 offset:2560
ds_read_b64_tr_b16 a[212:213], v19 offset:2048
ds_read_b64_tr_b16 a[214:215], v19 offset:2560
ds_read_b64_tr_b16 a[216:217], v18 offset:10240
ds_read_b64_tr_b16 a[218:219], v18 offset:10752
ds_read_b64_tr_b16 a[220:221], v19 offset:10240
ds_read_b64_tr_b16 a[222:223], v19 offset:10752
s_waitcnt vmcnt(23) lgkmcnt(14)
v_mfma_f32_32x32x16_bf16 v[80:95], a[192:195], a[0:3], 0
ds_read_b64_tr_b16 a[224:225], v18 offset:4096
s_mov_b32 s33, 0
buffer_load_dwordx2 v[36:37], v26, s[96:99], s33 offen offset:0 sc1
s_waitcnt vmcnt(23)
v_mfma_f32_32x32x16_bf16 v[144:159], a[192:195], a[4:7], 0
ds_read_b64_tr_b16 a[226:227], v18 offset:4608
s_mov_b32 s33, 16384
buffer_load_dwordx2 v[38:39], v26, s[96:99], s33 offen offset:0 sc1
s_waitcnt lgkmcnt(14)
v_mfma_f32_32x32x16_bf16 v[96:111], a[196:199], a[0:3], 0
ds_read_b64_tr_b16 a[228:229], v19 offset:4096
s_mov_b32 s33, 32768
buffer_load_dwordx2 v[40:41], v26, s[96:99], s33 offen offset:0 sc1
v_mfma_f32_32x32x16_bf16 v[160:175], a[196:199], a[4:7], 0
ds_read_b64_tr_b16 a[230:231], v19 offset:4608
s_mov_b32 s33, 49152
buffer_load_dwordx2 v[42:43], v26, s[96:99], s33 offen offset:0 sc1
s_waitcnt lgkmcnt(14)
v_mfma_f32_32x32x16_bf16 v[112:127], a[200:203], a[0:3], 0
ds_read_b64_tr_b16 a[232:233], v18 offset:12288
s_mov_b32 s33, 65536
buffer_load_dwordx2 v[44:45], v26, s[96:99], s33 offen offset:0 sc1
v_mfma_f32_32x32x16_bf16 v[176:191], a[200:203], a[4:7], 0
ds_read_b64_tr_b16 a[234:235], v18 offset:12800
s_mov_b32 s33, 81920
buffer_load_dwordx2 v[46:47], v26, s[96:99], s33 offen offset:0 sc1
s_waitcnt lgkmcnt(5)
v_mfma_f32_32x32x16_bf16 v[128:143], a[204:207], a[0:3], 0
ds_read_b64_tr_b16 a[236:237], v19 offset:12288
s_mov_b32 s33, 98304
buffer_load_dwordx2 v[48:49], v26, s[96:99], s33 offen offset:0 sc1
v_mfma_f32_32x32x16_bf16 v[192:207], a[204:207], a[4:7], 0
ds_read_b64_tr_b16 a[238:239], v19 offset:12800
s_mov_b32 s33, 114688
buffer_load_dwordx2 v[50:51], v26, s[96:99], s33 offen offset:0 sc1
s_waitcnt vmcnt(29)
v_mfma_f32_32x32x16_bf16 v[80:95], a[208:211], a[8:11], v[80:95]
ds_read_b64_tr_b16 a[240:241], v18 offset:6144
s_mov_b32 s33, 131072
buffer_load_dwordx2 v[52:53], v26, s[96:99], s33 offen offset:0 sc1
s_waitcnt vmcnt(29)
v_mfma_f32_32x32x16_bf16 v[144:159], a[208:211], a[12:15], v[144:159]
ds_read_b64_tr_b16 a[242:243], v18 offset:6656
s_mov_b32 s33, 147456
buffer_load_dwordx2 v[54:55], v26, s[96:99], s33 offen offset:0 sc1
v_mfma_f32_32x32x16_bf16 v[96:111], a[212:215], a[8:11], v[96:111]
ds_read_b64_tr_b16 a[244:245], v19 offset:6144
s_mov_b32 s33, 163840
buffer_load_dwordx2 v[56:57], v26, s[96:99], s33 offen offset:0 sc1
v_mfma_f32_32x32x16_bf16 v[160:175], a[212:215], a[12:15], v[160:175]
ds_read_b64_tr_b16 a[246:247], v19 offset:6656
s_mov_b32 s33, 180224
buffer_load_dwordx2 v[58:59], v26, s[96:99], s33 offen offset:0 sc1
v_mfma_f32_32x32x16_bf16 v[112:127], a[216:219], a[8:11], v[112:127]
ds_read_b64_tr_b16 a[248:249], v18 offset:14336
s_mov_b32 s33, 196608
buffer_load_dwordx2 v[60:61], v26, s[96:99], s33 offen offset:0 sc1
v_mfma_f32_32x32x16_bf16 v[176:191], a[216:219], a[12:15], v[176:191]
ds_read_b64_tr_b16 a[250:251], v18 offset:14848
s_mov_b32 s33, 212992
buffer_load_dwordx2 v[62:63], v26, s[96:99], s33 offen offset:0 sc1
v_mfma_f32_32x32x16_bf16 v[128:143], a[220:223], a[8:11], v[128:143]
ds_read_b64_tr_b16 a[252:253], v19 offset:14336
s_mov_b32 s33, 229376
buffer_load_dwordx2 v[64:65], v26, s[96:99], s33 offen offset:0 sc1
v_mfma_f32_32x32x16_bf16 v[192:207], a[220:223], a[12:15], v[192:207]
ds_read_b64_tr_b16 a[254:255], v19 offset:14848
s_mov_b32 s33, 245760
buffer_load_dwordx2 v[66:67], v26, s[96:99], s33 offen offset:0 sc1
s_waitcnt vmcnt(35) lgkmcnt(5)
v_mfma_f32_32x32x16_bf16 v[80:95], a[224:227], a[16:19], v[80:95]
ds_read_b64_tr_b16 a[192:193], v18 offset:16384
s_mov_b32 s34, 0x2003000
buffer_load_dwordx4 a[96:99], v24, s[96:99], s34 offen offset:0 sc1
s_waitcnt vmcnt(35)
v_mfma_f32_32x32x16_bf16 v[144:159], a[224:227], a[20:23], v[144:159]
ds_read_b64_tr_b16 a[194:195], v18 offset:16896
buffer_load_dwordx4 a[100:103], v25, s[96:99], s34 offen offset:0 sc1
v_mfma_f32_32x32x16_bf16 v[96:111], a[228:231], a[16:19], v[96:111]
ds_read_b64_tr_b16 a[196:197], v19 offset:16384
buffer_load_dwordx4 a[104:107], v24, s[96:99], s34 offen offset:1024 sc1
v_mfma_f32_32x32x16_bf16 v[160:175], a[228:231], a[20:23], v[160:175]
ds_read_b64_tr_b16 a[198:199], v19 offset:16896
buffer_load_dwordx4 a[108:111], v25, s[96:99], s34 offen offset:1024 sc1
v_mfma_f32_32x32x16_bf16 v[112:127], a[232:235], a[16:19], v[112:127]
ds_read_b64_tr_b16 a[200:201], v18 offset:24576
buffer_load_dwordx4 a[112:115], v24, s[96:99], s34 offen offset:2048 sc1
v_mfma_f32_32x32x16_bf16 v[176:191], a[232:235], a[20:23], v[176:191]
ds_read_b64_tr_b16 a[202:203], v18 offset:25088
buffer_load_dwordx4 a[116:119], v25, s[96:99], s34 offen offset:2048 sc1
v_mfma_f32_32x32x16_bf16 v[128:143], a[236:239], a[16:19], v[128:143]
ds_read_b64_tr_b16 a[204:205], v19 offset:24576
v_mfma_f32_32x32x16_bf16 v[192:207], a[236:239], a[20:23], v[192:207]
ds_read_b64_tr_b16 a[206:207], v19 offset:25088
s_waitcnt vmcnt(39)
v_mfma_f32_32x32x16_bf16 v[80:95], a[240:243], a[24:27], v[80:95]
ds_read_b64_tr_b16 a[208:209], v18 offset:18432
buffer_load_dwordx4 a[120:123], v24, s[96:99], s34 offen offset:3072 sc1
s_waitcnt vmcnt(39)
v_mfma_f32_32x32x16_bf16 v[144:159], a[240:243], a[28:31], v[144:159]
ds_read_b64_tr_b16 a[210:211], v18 offset:18944
s_waitcnt lgkmcnt(5)
v_mfma_f32_32x32x16_bf16 v[96:111], a[244:247], a[24:27], v[96:111]
ds_read_b64_tr_b16 a[212:213], v19 offset:18432
v_mfma_f32_32x32x16_bf16 v[160:175], a[244:247], a[28:31], v[160:175]
ds_read_b64_tr_b16 a[214:215], v19 offset:18944
v_mfma_f32_32x32x16_bf16 v[112:127], a[248:251], a[24:27], v[112:127]
ds_read_b64_tr_b16 a[216:217], v18 offset:26624
buffer_load_dwordx4 a[124:127], v25, s[96:99], s34 offen offset:3072 sc1
v_mfma_f32_32x32x16_bf16 v[176:191], a[248:251], a[28:31], v[176:191]
ds_read_b64_tr_b16 a[218:219], v18 offset:27136
s_mov_b32 s34, 0x2004000
v_mfma_f32_32x32x16_bf16 v[128:143], a[252:255], a[24:27], v[128:143]
ds_read_b64_tr_b16 a[220:221], v19 offset:26624
v_mfma_f32_32x32x16_bf16 v[192:207], a[252:255], a[28:31], v[192:207]
ds_read_b64_tr_b16 a[222:223], v19 offset:27136
s_waitcnt vmcnt(39)
v_mfma_f32_32x32x16_bf16 v[80:95], a[192:195], a[32:35], v[80:95]
ds_read_b64_tr_b16 a[224:225], v18 offset:20480
buffer_load_dwordx4 a[128:131], v24, s[96:99], s34 offen offset:0 sc1
s_waitcnt vmcnt(39)
v_mfma_f32_32x32x16_bf16 v[144:159], a[192:195], a[36:39], v[144:159]
ds_read_b64_tr_b16 a[226:227], v18 offset:20992
v_mfma_f32_32x32x16_bf16 v[96:111], a[196:199], a[32:35], v[96:111]
ds_read_b64_tr_b16 a[228:229], v19 offset:20480
v_mfma_f32_32x32x16_bf16 v[160:175], a[196:199], a[36:39], v[160:175]
ds_read_b64_tr_b16 a[230:231], v19 offset:20992
s_waitcnt lgkmcnt(5)
v_mfma_f32_32x32x16_bf16 v[112:127], a[200:203], a[32:35], v[112:127]
ds_read_b64_tr_b16 a[232:233], v18 offset:28672
buffer_load_dwordx4 a[132:135], v25, s[96:99], s34 offen offset:0 sc1
v_mfma_f32_32x32x16_bf16 v[176:191], a[200:203], a[36:39], v[176:191]
ds_read_b64_tr_b16 a[234:235], v18 offset:29184
v_mfma_f32_32x32x16_bf16 v[128:143], a[204:207], a[32:35], v[128:143]
ds_read_b64_tr_b16 a[236:237], v19 offset:28672
v_mfma_f32_32x32x16_bf16 v[192:207], a[204:207], a[36:39], v[192:207]
ds_read_b64_tr_b16 a[238:239], v19 offset:29184
s_waitcnt vmcnt(39)
v_mfma_f32_32x32x16_bf16 v[80:95], a[208:211], a[40:43], v[80:95]
ds_read_b64_tr_b16 a[240:241], v18 offset:22528
buffer_load_dwordx4 a[136:139], v24, s[96:99], s34 offen offset:1024 sc1
s_waitcnt vmcnt(39)
v_mfma_f32_32x32x16_bf16 v[144:159], a[208:211], a[44:47], v[144:159]
ds_read_b64_tr_b16 a[242:243], v18 offset:23040
v_mfma_f32_32x32x16_bf16 v[96:111], a[212:215], a[40:43], v[96:111]
ds_read_b64_tr_b16 a[244:245], v19 offset:22528
v_mfma_f32_32x32x16_bf16 v[160:175], a[212:215], a[44:47], v[160:175]
ds_read_b64_tr_b16 a[246:247], v19 offset:23040
v_mfma_f32_32x32x16_bf16 v[112:127], a[216:219], a[40:43], v[112:127]
ds_read_b64_tr_b16 a[248:249], v18 offset:30720
buffer_load_dwordx4 a[140:143], v25, s[96:99], s34 offen offset:1024 sc1
v_mfma_f32_32x32x16_bf16 v[176:191], a[216:219], a[44:47], v[176:191]
ds_read_b64_tr_b16 a[250:251], v18 offset:31232
s_waitcnt lgkmcnt(5)
v_mfma_f32_32x32x16_bf16 v[128:143], a[220:223], a[40:43], v[128:143]
ds_read_b64_tr_b16 a[252:253], v19 offset:30720
v_mfma_f32_32x32x16_bf16 v[192:207], a[220:223], a[44:47], v[192:207]
ds_read_b64_tr_b16 a[254:255], v19 offset:31232
s_waitcnt vmcnt(39)
v_mfma_f32_32x32x16_bf16 v[80:95], a[224:227], a[48:51], v[80:95]
ds_read_b64_tr_b16 a[192:193], v18 offset:32768
buffer_load_dwordx4 a[144:147], v24, s[96:99], s34 offen offset:2048 sc1
s_waitcnt vmcnt(39)
v_mfma_f32_32x32x16_bf16 v[144:159], a[224:227], a[52:55], v[144:159]
ds_read_b64_tr_b16 a[194:195], v18 offset:33280
v_mfma_f32_32x32x16_bf16 v[96:111], a[228:231], a[48:51], v[96:111]
ds_read_b64_tr_b16 a[196:197], v19 offset:32768
v_mfma_f32_32x32x16_bf16 v[160:175], a[228:231], a[52:55], v[160:175]
ds_read_b64_tr_b16 a[198:199], v19 offset:33280
v_mfma_f32_32x32x16_bf16 v[112:127], a[232:235], a[48:51], v[112:127]
ds_read_b64_tr_b16 a[200:201], v18 offset:40960
buffer_load_dwordx4 a[148:151], v25, s[96:99], s34 offen offset:2048 sc1
v_mfma_f32_32x32x16_bf16 v[176:191], a[232:235], a[52:55], v[176:191]
ds_read_b64_tr_b16 a[202:203], v18 offset:41472
v_mfma_f32_32x32x16_bf16 v[128:143], a[236:239], a[48:51], v[128:143]
ds_read_b64_tr_b16 a[204:205], v19 offset:40960
v_mfma_f32_32x32x16_bf16 v[192:207], a[236:239], a[52:55], v[192:207]
ds_read_b64_tr_b16 a[206:207], v19 offset:41472
s_waitcnt vmcnt(39) lgkmcnt(5)
v_mfma_f32_32x32x16_bf16 v[80:95], a[240:243], a[56:59], v[80:95]
ds_read_b64_tr_b16 a[208:209], v18 offset:34816
buffer_load_dwordx4 a[152:155], v24, s[96:99], s34 offen offset:3072 sc1
s_waitcnt vmcnt(39)
v_mfma_f32_32x32x16_bf16 v[144:159], a[240:243], a[60:63], v[144:159]
ds_read_b64_tr_b16 a[210:211], v18 offset:35328
v_mfma_f32_32x32x16_bf16 v[96:111], a[244:247], a[56:59], v[96:111]
ds_read_b64_tr_b16 a[212:213], v19 offset:34816
v_mfma_f32_32x32x16_bf16 v[160:175], a[244:247], a[60:63], v[160:175]
ds_read_b64_tr_b16 a[214:215], v19 offset:35328
v_mfma_f32_32x32x16_bf16 v[112:127], a[248:251], a[56:59], v[112:127]
ds_read_b64_tr_b16 a[216:217], v18 offset:43008
buffer_load_dwordx4 a[156:159], v25, s[96:99], s34 offen offset:3072 sc1
v_mfma_f32_32x32x16_bf16 v[176:191], a[248:251], a[60:63], v[176:191]
ds_read_b64_tr_b16 a[218:219], v18 offset:43520
s_mov_b32 s34, 0x2005000
v_mfma_f32_32x32x16_bf16 v[128:143], a[252:255], a[56:59], v[128:143]
ds_read_b64_tr_b16 a[220:221], v19 offset:43008
v_mfma_f32_32x32x16_bf16 v[192:207], a[252:255], a[60:63], v[192:207]
ds_read_b64_tr_b16 a[222:223], v19 offset:43520
s_waitcnt vmcnt(39)
v_mfma_f32_32x32x16_bf16 v[80:95], a[192:195], a[64:67], v[80:95]
ds_read_b64_tr_b16 a[224:225], v18 offset:36864
s_barrier
buffer_load_dwordx4 a[160:163], v24, s[96:99], s34 offen offset:0 sc1
s_waitcnt vmcnt(39)
v_mfma_f32_32x32x16_bf16 v[144:159], a[192:195], a[68:71], v[144:159]
ds_read_b64_tr_b16 a[226:227], v18 offset:37376
s_waitcnt lgkmcnt(5)
v_mfma_f32_32x32x16_bf16 v[96:111], a[196:199], a[64:67], v[96:111]
ds_read_b64_tr_b16 a[228:229], v19 offset:36864
v_mfma_f32_32x32x16_bf16 v[160:175], a[196:199], a[68:71], v[160:175]
ds_read_b64_tr_b16 a[230:231], v19 offset:37376
v_mfma_f32_32x32x16_bf16 v[112:127], a[200:203], a[64:67], v[112:127]
ds_read_b64_tr_b16 a[232:233], v18 offset:45056
buffer_load_dwordx4 a[164:167], v25, s[96:99], s34 offen offset:0 sc1
v_mfma_f32_32x32x16_bf16 v[176:191], a[200:203], a[68:71], v[176:191]
ds_read_b64_tr_b16 a[234:235], v18 offset:45568
v_mfma_f32_32x32x16_bf16 v[128:143], a[204:207], a[64:67], v[128:143]
ds_read_b64_tr_b16 a[236:237], v19 offset:45056
v_mfma_f32_32x32x16_bf16 v[192:207], a[204:207], a[68:71], v[192:207]
ds_read_b64_tr_b16 a[238:239], v19 offset:45568
s_waitcnt vmcnt(39)
v_mfma_f32_32x32x16_bf16 v[80:95], a[208:211], a[72:75], v[80:95]
ds_read_b64_tr_b16 a[240:241], v18 offset:38912
v_lshlrev_b32 v8, 2, v0
ds_write_b32 v8, v35
buffer_load_dwordx4 a[168:171], v24, s[96:99], s34 offen offset:1024 sc1
s_waitcnt vmcnt(39)
v_mfma_f32_32x32x16_bf16 v[144:159], a[208:211], a[76:79], v[144:159]
ds_read_b64_tr_b16 a[242:243], v18 offset:39424
s_waitcnt vmcnt(33)
v_add_f32 v8, v36, v38
s_waitcnt vmcnt(30)
v_add_f32 v8, v8, v44
s_waitcnt vmcnt(29)
v_add_f32 v8, v8, v46
v_mfma_f32_32x32x16_bf16 v[96:111], a[212:215], a[72:75], v[96:111]
ds_read_b64_tr_b16 a[244:245], v19 offset:38912
s_waitcnt vmcnt(26)
v_add_f32 v8, v8, v52
s_waitcnt vmcnt(25)
v_add_f32 v8, v8, v54
v_mfma_f32_32x32x16_bf16 v[160:175], a[212:215], a[76:79], v[160:175]
ds_read_b64_tr_b16 a[246:247], v19 offset:39424
s_waitcnt vmcnt(22)
v_add_f32 v8, v8, v60
s_waitcnt vmcnt(21)
v_add_f32 v8, v8, v62
s_waitcnt lgkmcnt(6)
v_mfma_f32_32x32x16_bf16 v[112:127], a[216:219], a[72:75], v[112:127]
ds_read_b64_tr_b16 a[248:249], v18 offset:47104
v_add_f32 v11, v40, v42
v_add_f32 v11, v11, v48
v_add_f32 v11, v11, v50
buffer_load_dwordx4 a[172:175], v25, s[96:99], s34 offen offset:1024 sc1
v_mfma_f32_32x32x16_bf16 v[176:191], a[216:219], a[76:79], v[176:191]
ds_read_b64_tr_b16 a[250:251], v18 offset:47616
v_add_f32 v11, v11, v56
v_add_f32 v11, v11, v58
v_mfma_f32_32x32x16_bf16 v[128:143], a[220:223], a[72:75], v[128:143]
ds_read_b64_tr_b16 a[252:253], v19 offset:47104
s_waitcnt vmcnt(21)
v_add_f32 v11, v11, v64
s_waitcnt vmcnt(20)
v_add_f32 v11, v11, v66
v_mfma_f32_32x32x16_bf16 v[192:207], a[220:223], a[76:79], v[192:207]
ds_read_b64_tr_b16 a[254:255], v19 offset:47616
v_mul_f32 v8, 0x3d99999a, v8
v_fmac_f32 v8, 0x3d4ccccd, v11
v_mfma_f32_32x32x16_bf16 v[80:95], a[224:227], a[80:83], v[80:95]
ds_read_b64_tr_b16 a[192:193], v18 offset:49152
v_add_f32 v9, v37, v39
v_add_f32 v9, v9, v41
v_add_f32 v9, v9, v43
buffer_load_dwordx4 a[176:179], v24, s[96:99], s34 offen offset:2048 sc1
v_mfma_f32_32x32x16_bf16 v[144:159], a[224:227], a[84:87], v[144:159]
ds_read_b64_tr_b16 a[194:195], v18 offset:49664
v_add_f32 v9, v9, v45
v_add_f32 v9, v9, v47
v_mfma_f32_32x32x16_bf16 v[96:111], a[228:231], a[80:83], v[96:111]
ds_read_b64_tr_b16 a[196:197], v19 offset:49152
v_add_f32 v9, v9, v49
v_add_f32 v9, v9, v51
v_mfma_f32_32x32x16_bf16 v[160:175], a[228:231], a[84:87], v[160:175]
ds_read_b64_tr_b16 a[198:199], v19 offset:49664
v_add_f32 v9, v9, v53
v_add_f32 v9, v9, v55
v_mfma_f32_32x32x16_bf16 v[112:127], a[232:235], a[80:83], v[112:127]
ds_read_b64_tr_b16 a[200:201], v18 offset:57344
v_add_f32 v9, v9, v57
v_add_f32 v9, v9, v59
v_add_f32 v9, v9, v61
buffer_load_dwordx4 a[180:183], v25, s[96:99], s34 offen offset:2048 sc1
v_mfma_f32_32x32x16_bf16 v[176:191], a[232:235], a[84:87], v[176:191]
ds_read_b64_tr_b16 a[202:203], v18 offset:57856
v_add_f32 v9, v9, v63
v_add_f32 v9, v9, v65
s_waitcnt lgkmcnt(5)
v_mfma_f32_32x32x16_bf16 v[128:143], a[236:239], a[80:83], v[128:143]
ds_read_b64_tr_b16 a[204:205], v19 offset:57344
v_add_f32 v9, v9, v67
v_sub_f32 v10, v36, v8
v_mfma_f32_32x32x16_bf16 v[192:207], a[236:239], a[84:87], v[192:207]
ds_read_b64_tr_b16 a[206:207], v19 offset:57856
v_mul_f32 v12, v10, v10
v_sub_f32 v10, v38, v8
v_mfma_f32_32x32x16_bf16 v[80:95], a[240:243], a[88:91], v[80:95]
ds_read_b64_tr_b16 a[208:209], v18 offset:51200
v_fmac_f32 v12, v10, v10
v_sub_f32 v10, v44, v8
v_fmac_f32 v12, v10, v10
buffer_load_dwordx4 a[184:187], v24, s[96:99], s34 offen offset:3072 sc1
v_mfma_f32_32x32x16_bf16 v[144:159], a[240:243], a[92:95], v[144:159]
ds_read_b64_tr_b16 a[210:211], v18 offset:51712
v_sub_f32 v10, v46, v8
v_fmac_f32 v12, v10, v10
v_mfma_f32_32x32x16_bf16 v[96:111], a[244:247], a[88:91], v[96:111]
ds_read_b64_tr_b16 a[212:213], v19 offset:51200
v_sub_f32 v10, v52, v8
v_fmac_f32 v12, v10, v10
v_mfma_f32_32x32x16_bf16 v[160:175], a[244:247], a[92:95], v[160:175]
ds_read_b64_tr_b16 a[214:215], v19 offset:51712
v_sub_f32 v10, v54, v8
v_fmac_f32 v12, v10, v10
v_mfma_f32_32x32x16_bf16 v[112:127], a[248:251], a[88:91], v[112:127]
ds_read_b64_tr_b16 a[216:217], v18 offset:59392
v_sub_f32 v10, v60, v8
v_fmac_f32 v12, v10, v10
v_sub_f32 v10, v62, v8
buffer_load_dwordx4 a[188:191], v25, s[96:99], s34 offen offset:3072 sc1
v_mfma_f32_32x32x16_bf16 v[176:191], a[248:251], a[92:95], v[176:191]
ds_read_b64_tr_b16 a[218:219], v18 offset:59904
v_fmac_f32 v12, v10, v10
v_sub_f32 v10, v40, v8
s_mov_b32 s34, 0x2006000
v_mfma_f32_32x32x16_bf16 v[128:143], a[252:255], a[88:91], v[128:143]
ds_read_b64_tr_b16 a[220:221], v19 offset:59392
v_mul_f32 v11, v10, v10
v_sub_f32 v10, v42, v8
v_mfma_f32_32x32x16_bf16 v[192:207], a[252:255], a[92:95], v[192:207]
ds_read_b64_tr_b16 a[222:223], v19 offset:59904
v_fmac_f32 v11, v10, v10
v_sub_f32 v10, v48, v8
s_waitcnt vmcnt(23) lgkmcnt(5)
v_mfma_f32_32x32x16_bf16 v[80:95], a[192:195], a[96:99], v[80:95]
ds_read_b64_tr_b16 a[224:225], v18 offset:53248
v_fmac_f32 v11, v10, v10
v_sub_f32 v10, v50, v8
v_fmac_f32 v11, v10, v10
buffer_load_dwordx4 a[0:3], v24, s[96:99], s34 offen offset:0 sc1
s_waitcnt vmcnt(23)
v_mfma_f32_32x32x16_bf16 v[144:159], a[192:195], a[100:103], v[144:159]
ds_read_b64_tr_b16 a[226:227], v18 offset:53760
v_sub_f32 v10, v56, v8
v_fmac_f32 v11, v10, v10
v_mfma_f32_32x32x16_bf16 v[96:111], a[196:199], a[96:99], v[96:111]
ds_read_b64_tr_b16 a[228:229], v19 offset:53248
v_sub_f32 v10, v58, v8
v_fmac_f32 v11, v10, v10
v_mfma_f32_32x32x16_bf16 v[160:175], a[196:199], a[100:103], v[160:175]
ds_read_b64_tr_b16 a[230:231], v19 offset:53760
v_sub_f32 v10, v64, v8
v_fmac_f32 v11, v10, v10
v_mfma_f32_32x32x16_bf16 v[112:127], a[200:203], a[96:99], v[112:127]
ds_read_b64_tr_b16 a[232:233], v18 offset:61440
v_sub_f32 v10, v66, v8
v_fmac_f32 v11, v10, v10
v_fmac_f32 v9, 0x42400000, v12
buffer_load_dwordx4 a[4:7], v25, s[96:99], s34 offen offset:0 sc1
v_mfma_f32_32x32x16_bf16 v[176:191], a[200:203], a[100:103], v[176:191]
ds_read_b64_tr_b16 a[234:235], v18 offset:61952
v_fmac_f32 v9, 0x42000000, v11
v_mov_b32 v10, 0x3727c5ac
v_mfma_f32_32x32x16_bf16 v[128:143], a[204:207], a[96:99], v[128:143]
ds_read_b64_tr_b16 a[236:237], v19 offset:61440
v_fmac_f32 v10, 0x3acccccd, v9
v_rsq_f32 v30, v10
v_mfma_f32_32x32x16_bf16 v[192:207], a[204:207], a[100:103], v[192:207]
ds_read_b64_tr_b16 a[238:239], v19 offset:61952
v_mul_f32 v32, v8, v30
v_sub_f32 v32, 0, v32
s_waitcnt vmcnt(23)
v_mfma_f32_32x32x16_bf16 v[80:95], a[208:211], a[104:107], v[80:95]
ds_read_b64_tr_b16 a[240:241], v18 offset:55296
buffer_load_dwordx4 a[8:11], v24, s[96:99], s34 offen offset:1024 sc1
s_waitcnt vmcnt(23)
v_mfma_f32_32x32x16_bf16 v[144:159], a[208:211], a[108:111], v[144:159]
ds_read_b64_tr_b16 a[242:243], v18 offset:55808
s_waitcnt lgkmcnt(5)
v_mfma_f32_32x32x16_bf16 v[96:111], a[212:215], a[104:107], v[96:111]
ds_read_b64_tr_b16 a[244:245], v19 offset:55296
v_mfma_f32_32x32x16_bf16 v[160:175], a[212:215], a[108:111], v[160:175]
ds_read_b64_tr_b16 a[246:247], v19 offset:55808
v_mfma_f32_32x32x16_bf16 v[112:127], a[216:219], a[104:107], v[112:127]
ds_read_b64_tr_b16 a[248:249], v18 offset:63488
buffer_load_dwordx4 a[12:15], v25, s[96:99], s34 offen offset:1024 sc1
v_mfma_f32_32x32x16_bf16 v[176:191], a[216:219], a[108:111], v[176:191]
ds_read_b64_tr_b16 a[250:251], v18 offset:64000
v_mfma_f32_32x32x16_bf16 v[128:143], a[220:223], a[104:107], v[128:143]
ds_read_b64_tr_b16 a[252:253], v19 offset:63488
v_mfma_f32_32x32x16_bf16 v[192:207], a[220:223], a[108:111], v[192:207]
ds_read_b64_tr_b16 a[254:255], v19 offset:64000
s_waitcnt vmcnt(23)
v_mfma_f32_32x32x16_bf16 v[80:95], a[224:227], a[112:115], v[80:95]
ds_read_b64_tr_b16 a[192:193], v20 offset:0
buffer_load_dwordx4 a[16:19], v24, s[96:99], s34 offen offset:2048 sc1
s_waitcnt vmcnt(23)
v_mfma_f32_32x32x16_bf16 v[144:159], a[224:227], a[116:119], v[144:159]
ds_read_b64_tr_b16 a[194:195], v20 offset:512
v_mfma_f32_32x32x16_bf16 v[96:111], a[228:231], a[112:115], v[96:111]
ds_read_b64_tr_b16 a[196:197], v21 offset:0
v_mfma_f32_32x32x16_bf16 v[160:175], a[228:231], a[116:119], v[160:175]
ds_read_b64_tr_b16 a[198:199], v21 offset:512
s_waitcnt lgkmcnt(5)
v_mfma_f32_32x32x16_bf16 v[112:127], a[232:235], a[112:115], v[112:127]
ds_read_b64_tr_b16 a[200:201], v20 offset:8192
buffer_load_dwordx4 a[20:23], v25, s[96:99], s34 offen offset:2048 sc1
v_mfma_f32_32x32x16_bf16 v[176:191], a[232:235], a[116:119], v[176:191]
ds_read_b64_tr_b16 a[202:203], v20 offset:8704
v_mfma_f32_32x32x16_bf16 v[128:143], a[236:239], a[112:115], v[128:143]
ds_read_b64_tr_b16 a[204:205], v21 offset:8192
v_mfma_f32_32x32x16_bf16 v[192:207], a[236:239], a[116:119], v[192:207]
ds_read_b64_tr_b16 a[206:207], v21 offset:8704
s_waitcnt vmcnt(23)
v_mfma_f32_32x32x16_bf16 v[80:95], a[240:243], a[120:123], v[80:95]
ds_read_b64_tr_b16 a[208:209], v20 offset:2048
buffer_load_dwordx4 a[24:27], v24, s[96:99], s34 offen offset:3072 sc1
s_waitcnt vmcnt(23)
v_mfma_f32_32x32x16_bf16 v[144:159], a[240:243], a[124:127], v[144:159]
ds_read_b64_tr_b16 a[210:211], v20 offset:2560
v_mfma_f32_32x32x16_bf16 v[96:111], a[244:247], a[120:123], v[96:111]
ds_read_b64_tr_b16 a[212:213], v21 offset:2048
v_mfma_f32_32x32x16_bf16 v[160:175], a[244:247], a[124:127], v[160:175]
ds_read_b64_tr_b16 a[214:215], v21 offset:2560
v_mfma_f32_32x32x16_bf16 v[112:127], a[248:251], a[120:123], v[112:127]
ds_read_b64_tr_b16 a[216:217], v20 offset:10240
buffer_load_dwordx4 a[28:31], v25, s[96:99], s34 offen offset:3072 sc1
v_mfma_f32_32x32x16_bf16 v[176:191], a[248:251], a[124:127], v[176:191]
ds_read_b64_tr_b16 a[218:219], v20 offset:10752
s_mov_b32 s33, 0
buffer_load_dwordx2 v[36:37], v26, s[96:99], s33 offen offset:256 sc1
s_waitcnt lgkmcnt(5)
v_mfma_f32_32x32x16_bf16 v[128:143], a[252:255], a[120:123], v[128:143]
ds_read_b64_tr_b16 a[220:221], v21 offset:10240
s_mov_b32 s33, 16384
buffer_load_dwordx2 v[38:39], v26, s[96:99], s33 offen offset:256 sc1
v_mfma_f32_32x32x16_bf16 v[192:207], a[252:255], a[124:127], v[192:207]
ds_read_b64_tr_b16 a[222:223], v21 offset:10752
s_mov_b32 s33, 32768
buffer_load_dwordx2 v[40:41], v26, s[96:99], s33 offen offset:256 sc1
s_waitcnt vmcnt(26)
v_mfma_f32_32x32x16_bf16 v[80:95], a[192:195], a[128:131], v[80:95]
ds_read_b64_tr_b16 a[224:225], v20 offset:4096
s_mov_b32 s33, 49152
buffer_load_dwordx2 v[42:43], v26, s[96:99], s33 offen offset:256 sc1
s_waitcnt vmcnt(26)
v_mfma_f32_32x32x16_bf16 v[144:159], a[192:195], a[132:135], v[144:159]
ds_read_b64_tr_b16 a[226:227], v20 offset:4608
s_mov_b32 s33, 65536
buffer_load_dwordx2 v[44:45], v26, s[96:99], s33 offen offset:256 sc1
v_mfma_f32_32x32x16_bf16 v[96:111], a[196:199], a[128:131], v[96:111]
ds_read_b64_tr_b16 a[228:229], v21 offset:4096
s_mov_b32 s33, 81920
buffer_load_dwordx2 v[46:47], v26, s[96:99], s33 offen offset:256 sc1
v_mfma_f32_32x32x16_bf16 v[160:175], a[196:199], a[132:135], v[160:175]
ds_read_b64_tr_b16 a[230:231], v21 offset:4608
s_mov_b32 s33, 98304
buffer_load_dwordx2 v[48:49], v26, s[96:99], s33 offen offset:256 sc1
v_mfma_f32_32x32x16_bf16 v[112:127], a[200:203], a[128:131], v[112:127]
ds_read_b64_tr_b16 a[232:233], v20 offset:12288
s_mov_b32 s33, 114688
buffer_load_dwordx2 v[50:51], v26, s[96:99], s33 offen offset:256 sc1
v_mfma_f32_32x32x16_bf16 v[176:191], a[200:203], a[132:135], v[176:191]
ds_read_b64_tr_b16 a[234:235], v20 offset:12800
s_mov_b32 s33, 131072
buffer_load_dwordx2 v[52:53], v26, s[96:99], s33 offen offset:256 sc1
v_mfma_f32_32x32x16_bf16 v[128:143], a[204:207], a[128:131], v[128:143]
ds_read_b64_tr_b16 a[236:237], v21 offset:12288
s_mov_b32 s33, 147456
buffer_load_dwordx2 v[54:55], v26, s[96:99], s33 offen offset:256 sc1
v_mfma_f32_32x32x16_bf16 v[192:207], a[204:207], a[132:135], v[192:207]
ds_read_b64_tr_b16 a[238:239], v21 offset:12800
s_mov_b32 s33, 163840
buffer_load_dwordx2 v[56:57], v26, s[96:99], s33 offen offset:256 sc1
s_waitcnt vmcnt(32) lgkmcnt(5)
v_mfma_f32_32x32x16_bf16 v[80:95], a[208:211], a[136:139], v[80:95]
ds_read_b64_tr_b16 a[240:241], v20 offset:6144
s_mov_b32 s33, 180224
buffer_load_dwordx2 v[58:59], v26, s[96:99], s33 offen offset:256 sc1
s_waitcnt vmcnt(32)
v_mfma_f32_32x32x16_bf16 v[144:159], a[208:211], a[140:143], v[144:159]
ds_read_b64_tr_b16 a[242:243], v20 offset:6656
s_mov_b32 s33, 196608
buffer_load_dwordx2 v[60:61], v26, s[96:99], s33 offen offset:256 sc1
v_mfma_f32_32x32x16_bf16 v[96:111], a[212:215], a[136:139], v[96:111]
ds_read_b64_tr_b16 a[244:245], v21 offset:6144
s_mov_b32 s33, 212992
buffer_load_dwordx2 v[62:63], v26, s[96:99], s33 offen offset:256 sc1
v_mfma_f32_32x32x16_bf16 v[160:175], a[212:215], a[140:143], v[160:175]
ds_read_b64_tr_b16 a[246:247], v21 offset:6656
s_mov_b32 s33, 229376
buffer_load_dwordx2 v[64:65], v26, s[96:99], s33 offen offset:256 sc1
v_mfma_f32_32x32x16_bf16 v[112:127], a[216:219], a[136:139], v[112:127]
ds_read_b64_tr_b16 a[248:249], v20 offset:14336
s_mov_b32 s33, 245760
buffer_load_dwordx2 v[66:67], v26, s[96:99], s33 offen offset:256 sc1
v_mfma_f32_32x32x16_bf16 v[176:191], a[216:219], a[140:143], v[176:191]
ds_read_b64_tr_b16 a[250:251], v20 offset:14848
s_mov_b32 s34, 0x2007000
buffer_load_dwordx4 a[32:35], v24, s[96:99], s34 offen offset:0 sc1
v_mfma_f32_32x32x16_bf16 v[128:143], a[220:223], a[136:139], v[128:143]
ds_read_b64_tr_b16 a[252:253], v21 offset:14336
buffer_load_dwordx4 a[36:39], v25, s[96:99], s34 offen offset:0 sc1
v_mfma_f32_32x32x16_bf16 v[192:207], a[220:223], a[140:143], v[192:207]
ds_read_b64_tr_b16 a[254:255], v21 offset:14848
buffer_load_dwordx4 a[40:43], v24, s[96:99], s34 offen offset:1024 sc1
s_waitcnt vmcnt(38)
v_mfma_f32_32x32x16_bf16 v[80:95], a[224:227], a[144:147], v[80:95]
ds_read_b64_tr_b16 a[192:193], v20 offset:16384
buffer_load_dwordx4 a[44:47], v25, s[96:99], s34 offen offset:1024 sc1
s_waitcnt vmcnt(38)
v_mfma_f32_32x32x16_bf16 v[144:159], a[224:227], a[148:151], v[144:159]
ds_read_b64_tr_b16 a[194:195], v20 offset:16896
buffer_load_dwordx4 a[48:51], v24, s[96:99], s34 offen offset:2048 sc1
s_waitcnt lgkmcnt(5)
v_mfma_f32_32x32x16_bf16 v[96:111], a[228:231], a[144:147], v[96:111]
ds_read_b64_tr_b16 a[196:197], v21 offset:16384
v_mfma_f32_32x32x16_bf16 v[160:175], a[228:231], a[148:151], v[160:175]
ds_read_b64_tr_b16 a[198:199], v21 offset:16896
v_mfma_f32_32x32x16_bf16 v[112:127], a[232:235], a[144:147], v[112:127]
ds_read_b64_tr_b16 a[200:201], v20 offset:24576
buffer_load_dwordx4 a[52:55], v25, s[96:99], s34 offen offset:2048 sc1
v_mfma_f32_32x32x16_bf16 v[176:191], a[232:235], a[148:151], v[176:191]
ds_read_b64_tr_b16 a[202:203], v20 offset:25088
v_mfma_f32_32x32x16_bf16 v[128:143], a[236:239], a[144:147], v[128:143]
ds_read_b64_tr_b16 a[204:205], v21 offset:24576
v_mfma_f32_32x32x16_bf16 v[192:207], a[236:239], a[148:151], v[192:207]
ds_read_b64_tr_b16 a[206:207], v21 offset:25088
s_waitcnt vmcnt(39)
v_mfma_f32_32x32x16_bf16 v[80:95], a[240:243], a[152:155], v[80:95]
ds_read_b64_tr_b16 a[208:209], v20 offset:18432
s_waitcnt vmcnt(20)
v_add_f32 v8, v36, v38
s_waitcnt vmcnt(17)
v_add_f32 v8, v8, v44
s_waitcnt vmcnt(16)
v_add_f32 v8, v8, v46
buffer_load_dwordx4 a[56:59], v24, s[96:99], s34 offen offset:3072 sc1
v_mfma_f32_32x32x16_bf16 v[144:159], a[240:243], a[156:159], v[144:159]
ds_read_b64_tr_b16 a[210:211], v20 offset:18944
s_waitcnt vmcnt(14)
v_add_f32 v8, v8, v52
s_waitcnt vmcnt(13)
v_add_f32 v8, v8, v54
v_mfma_f32_32x32x16_bf16 v[96:111], a[244:247], a[152:155], v[96:111]
ds_read_b64_tr_b16 a[212:213], v21 offset:18432
s_waitcnt vmcnt(10)
v_add_f32 v8, v8, v60
s_waitcnt vmcnt(9)
v_add_f32 v8, v8, v62
v_mfma_f32_32x32x16_bf16 v[160:175], a[244:247], a[156:159], v[160:175]
ds_read_b64_tr_b16 a[214:215], v21 offset:18944
v_add_f32 v11, v40, v42
v_add_f32 v11, v11, v48
s_waitcnt lgkmcnt(5)
v_mfma_f32_32x32x16_bf16 v[112:127], a[248:251], a[152:155], v[112:127]
ds_read_b64_tr_b16 a[216:217], v20 offset:26624
v_add_f32 v11, v11, v50
v_add_f32 v11, v11, v56
buffer_load_dwordx4 a[60:63], v25, s[96:99], s34 offen offset:3072 sc1
v_mfma_f32_32x32x16_bf16 v[176:191], a[248:251], a[156:159], v[176:191]
ds_read_b64_tr_b16 a[218:219], v20 offset:27136
v_add_f32 v11, v11, v58
s_waitcnt vmcnt(9)
v_add_f32 v11, v11, v64
s_waitcnt vmcnt(8)
v_add_f32 v11, v11, v66
s_mov_b32 s34, 0x2008000
v_mfma_f32_32x32x16_bf16 v[128:143], a[252:255], a[152:155], v[128:143]
ds_read_b64_tr_b16 a[220:221], v21 offset:26624
v_mul_f32 v8, 0x3d99999a, v8
v_fmac_f32 v8, 0x3d4ccccd, v11
v_mfma_f32_32x32x16_bf16 v[192:207], a[252:255], a[156:159], v[192:207]
ds_read_b64_tr_b16 a[222:223], v21 offset:27136
v_add_f32 v9, v37, v39
v_add_f32 v9, v9, v41
v_mfma_f32_32x32x16_bf16 v[80:95], a[192:195], a[160:163], v[80:95]
ds_read_b64_tr_b16 a[224:225], v20 offset:20480
v_add_f32 v9, v9, v43
v_add_f32 v9, v9, v45
s_barrier
buffer_load_dwordx4 a[64:67], v24, s[96:99], s34 offen offset:0 sc1
v_mfma_f32_32x32x16_bf16 v[144:159], a[192:195], a[164:167], v[144:159]
ds_read_b64_tr_b16 a[226:227], v20 offset:20992
v_add_f32 v9, v9, v47
v_add_f32 v9, v9, v49
v_mfma_f32_32x32x16_bf16 v[96:111], a[196:199], a[160:163], v[96:111]
ds_read_b64_tr_b16 a[228:229], v21 offset:20480
v_add_f32 v9, v9, v51
v_add_f32 v9, v9, v53
v_add_f32 v9, v9, v55
v_mfma_f32_32x32x16_bf16 v[160:175], a[196:199], a[164:167], v[160:175]
ds_read_b64_tr_b16 a[230:231], v21 offset:20992
v_add_f32 v9, v9, v57
v_add_f32 v9, v9, v59
v_mfma_f32_32x32x16_bf16 v[112:127], a[200:203], a[160:163], v[112:127]
ds_read_b64_tr_b16 a[232:233], v20 offset:28672
v_add_f32 v9, v9, v61
v_add_f32 v9, v9, v63
buffer_load_dwordx4 a[68:71], v25, s[96:99], s34 offen offset:0 sc1
v_mfma_f32_32x32x16_bf16 v[176:191], a[200:203], a[164:167], v[176:191]
ds_read_b64_tr_b16 a[234:235], v20 offset:29184
v_add_f32 v9, v9, v65
v_add_f32 v9, v9, v67
s_waitcnt lgkmcnt(5)
v_mfma_f32_32x32x16_bf16 v[128:143], a[204:207], a[160:163], v[128:143]
ds_read_b64_tr_b16 a[236:237], v21 offset:28672
v_sub_f32 v10, v36, v8
v_mul_f32 v12, v10, v10
v_mfma_f32_32x32x16_bf16 v[192:207], a[204:207], a[164:167], v[192:207]
ds_read_b64_tr_b16 a[238:239], v21 offset:29184
v_sub_f32 v10, v38, v8
v_fmac_f32 v12, v10, v10
v_mfma_f32_32x32x16_bf16 v[80:95], a[208:211], a[168:171], v[80:95]
ds_read_b64_tr_b16 a[240:241], v20 offset:22528
v_sub_f32 v10, v44, v8
v_fmac_f32 v12, v10, v10
v_sub_f32 v10, v46, v8
buffer_load_dwordx4 a[72:75], v24, s[96:99], s34 offen offset:1024 sc1
v_mfma_f32_32x32x16_bf16 v[144:159], a[208:211], a[172:175], v[144:159]
ds_read_b64_tr_b16 a[242:243], v20 offset:23040
v_fmac_f32 v12, v10, v10
v_sub_f32 v10, v52, v8
v_mfma_f32_32x32x16_bf16 v[96:111], a[212:215], a[168:171], v[96:111]
ds_read_b64_tr_b16 a[244:245], v21 offset:22528
v_fmac_f32 v12, v10, v10
v_sub_f32 v10, v54, v8
v_mfma_f32_32x32x16_bf16 v[160:175], a[212:215], a[172:175], v[160:175]
ds_read_b64_tr_b16 a[246:247], v21 offset:23040
v_fmac_f32 v12, v10, v10
v_sub_f32 v10, v60, v8
v_mfma_f32_32x32x16_bf16 v[112:127], a[216:219], a[168:171], v[112:127]
ds_read_b64_tr_b16 a[248:249], v20 offset:30720
v_fmac_f32 v12, v10, v10
v_sub_f32 v10, v62, v8
buffer_load_dwordx4 a[76:79], v25, s[96:99], s34 offen offset:1024 sc1
v_mfma_f32_32x32x16_bf16 v[176:191], a[216:219], a[172:175], v[176:191]
ds_read_b64_tr_b16 a[250:251], v20 offset:31232
v_fmac_f32 v12, v10, v10
v_sub_f32 v10, v40, v8
v_mul_f32 v11, v10, v10
v_mfma_f32_32x32x16_bf16 v[128:143], a[220:223], a[168:171], v[128:143]
ds_read_b64_tr_b16 a[252:253], v21 offset:30720
v_sub_f32 v10, v42, v8
v_fmac_f32 v11, v10, v10
v_mfma_f32_32x32x16_bf16 v[192:207], a[220:223], a[172:175], v[192:207]
ds_read_b64_tr_b16 a[254:255], v21 offset:31232
v_sub_f32 v10, v48, v8
v_fmac_f32 v11, v10, v10
buffer_load_dwordx4 a[80:83], v24, s[96:99], s34 offen offset:2048 sc1
s_waitcnt lgkmcnt(5)
v_mfma_f32_32x32x16_bf16 v[80:95], a[224:227], a[176:179], v[80:95]
ds_read_b64_tr_b16 a[192:193], v20 offset:32768
v_sub_f32 v10, v50, v8
v_fmac_f32 v11, v10, v10
v_mfma_f32_32x32x16_bf16 v[144:159], a[224:227], a[180:183], v[144:159]
ds_read_b64_tr_b16 a[194:195], v20 offset:33280
v_sub_f32 v10, v56, v8
v_fmac_f32 v11, v10, v10
v_mfma_f32_32x32x16_bf16 v[96:111], a[228:231], a[176:179], v[96:111]
ds_read_b64_tr_b16 a[196:197], v21 offset:32768
v_sub_f32 v10, v58, v8
v_fmac_f32 v11, v10, v10
v_sub_f32 v10, v64, v8
buffer_load_dwordx4 a[84:87], v25, s[96:99], s34 offen offset:2048 sc1
v_mfma_f32_32x32x16_bf16 v[160:175], a[228:231], a[180:183], v[160:175]
ds_read_b64_tr_b16 a[198:199], v21 offset:33280
v_fmac_f32 v11, v10, v10
v_sub_f32 v10, v66, v8
v_mfma_f32_32x32x16_bf16 v[112:127], a[232:235], a[176:179], v[112:127]
ds_read_b64_tr_b16 a[200:201], v20 offset:40960
v_fmac_f32 v11, v10, v10
v_fmac_f32 v9, 0x42400000, v12
v_mfma_f32_32x32x16_bf16 v[176:191], a[232:235], a[180:183], v[176:191]
ds_read_b64_tr_b16 a[202:203], v20 offset:41472
v_fmac_f32 v9, 0x42000000, v11
v_mov_b32 v10, 0x3727c5ac
buffer_load_dwordx4 a[88:91], v24, s[96:99], s34 offen offset:3072 sc1
v_mfma_f32_32x32x16_bf16 v[128:143], a[236:239], a[176:179], v[128:143]
ds_read_b64_tr_b16 a[204:205], v21 offset:40960
v_fmac_f32 v10, 0x3acccccd, v9
v_rsq_f32 v31, v10
v_mfma_f32_32x32x16_bf16 v[192:207], a[236:239], a[180:183], v[192:207]
ds_read_b64_tr_b16 a[206:207], v21 offset:41472
v_mul_f32 v33, v8, v31
v_sub_f32 v33, 0, v33
v_mfma_f32_32x32x16_bf16 v[80:95], a[240:243], a[184:187], v[80:95]
ds_read_b64_tr_b16 a[208:209], v20 offset:34816
buffer_load_dwordx4 a[92:95], v25, s[96:99], s34 offen offset:3072 sc1
v_mfma_f32_32x32x16_bf16 v[144:159], a[240:243], a[188:191], v[144:159]
ds_read_b64_tr_b16 a[210:211], v20 offset:35328
s_mov_b32 s34, 0x2009000
s_waitcnt lgkmcnt(5)
v_mfma_f32_32x32x16_bf16 v[96:111], a[244:247], a[184:187], v[96:111]
ds_read_b64_tr_b16 a[212:213], v21 offset:34816
v_mfma_f32_32x32x16_bf16 v[160:175], a[244:247], a[188:191], v[160:175]
ds_read_b64_tr_b16 a[214:215], v21 offset:35328
buffer_load_dwordx4 a[96:99], v24, s[96:99], s34 offen offset:0 sc1
v_mfma_f32_32x32x16_bf16 v[112:127], a[248:251], a[184:187], v[112:127]
ds_read_b64_tr_b16 a[216:217], v20 offset:43008
v_mfma_f32_32x32x16_bf16 v[176:191], a[248:251], a[188:191], v[176:191]
ds_read_b64_tr_b16 a[218:219], v20 offset:43520
v_mfma_f32_32x32x16_bf16 v[128:143], a[252:255], a[184:187], v[128:143]
ds_read_b64_tr_b16 a[220:221], v21 offset:43008
buffer_load_dwordx4 a[100:103], v25, s[96:99], s34 offen offset:0 sc1
v_mfma_f32_32x32x16_bf16 v[192:207], a[252:255], a[188:191], v[192:207]
ds_read_b64_tr_b16 a[222:223], v21 offset:43520
v_mfma_f32_32x32x16_bf16 v[80:95], a[192:195], a[0:3], v[80:95]
ds_read_b64_tr_b16 a[224:225], v20 offset:36864
ds_read_b64_tr_b16 a[226:227], v20 offset:37376
v_mfma_f32_32x32x16_bf16 v[96:111], a[196:199], a[0:3], v[96:111]
ds_read_b64_tr_b16 a[228:229], v21 offset:36864
ds_read_b64_tr_b16 a[230:231], v21 offset:37376
buffer_load_dwordx4 a[104:107], v24, s[96:99], s34 offen offset:1024 sc1
s_waitcnt lgkmcnt(7)
v_mfma_f32_32x32x16_bf16 v[112:127], a[200:203], a[0:3], v[112:127]
ds_read_b64_tr_b16 a[232:233], v20 offset:45056
ds_read_b64_tr_b16 a[234:235], v20 offset:45568
v_mfma_f32_32x32x16_bf16 v[128:143], a[204:207], a[0:3], v[128:143]
ds_read_b64_tr_b16 a[236:237], v21 offset:45056
ds_read_b64_tr_b16 a[238:239], v21 offset:45568
v_mfma_f32_32x32x16_bf16 v[80:95], a[208:211], a[8:11], v[80:95]
ds_read_b64_tr_b16 a[240:241], v20 offset:38912
ds_read_b64_tr_b16 a[242:243], v20 offset:39424
buffer_load_dwordx4 a[108:111], v25, s[96:99], s34 offen offset:1024 sc1
v_mfma_f32_32x32x16_bf16 v[96:111], a[212:215], a[8:11], v[96:111]
ds_read_b64_tr_b16 a[244:245], v21 offset:38912
ds_read_b64_tr_b16 a[246:247], v21 offset:39424
s_waitcnt lgkmcnt(10)
v_mfma_f32_32x32x16_bf16 v[112:127], a[216:219], a[8:11], v[112:127]
ds_read_b64_tr_b16 a[248:249], v20 offset:47104
ds_read_b64_tr_b16 a[250:251], v20 offset:47616
v_mfma_f32_32x32x16_bf16 v[128:143], a[220:223], a[8:11], v[128:143]
ds_read_b64_tr_b16 a[252:253], v21 offset:47104
ds_read_b64_tr_b16 a[254:255], v21 offset:47616
buffer_load_dwordx4 a[112:115], v24, s[96:99], s34 offen offset:2048 sc1
v_mfma_f32_32x32x16_bf16 v[80:95], a[224:227], a[16:19], v[80:95]
ds_read_b64_tr_b16 a[192:193], v20 offset:49152
ds_read_b64_tr_b16 a[194:195], v20 offset:49664
s_barrier
s_waitcnt lgkmcnt(10)
v_mfma_f32_32x32x16_bf16 v[96:111], a[228:231], a[16:19], v[96:111]
ds_read_b64_tr_b16 a[196:197], v21 offset:49152
ds_read_b64_tr_b16 a[198:199], v21 offset:49664
v_mfma_f32_32x32x16_bf16 v[112:127], a[232:235], a[16:19], v[112:127]
ds_read_b64_tr_b16 a[200:201], v20 offset:57344
ds_read_b64_tr_b16 a[202:203], v20 offset:57856
buffer_load_dwordx4 a[116:119], v25, s[96:99], s34 offen offset:2048 sc1
v_mfma_f32_32x32x16_bf16 v[128:143], a[236:239], a[16:19], v[128:143]
ds_read_b64_tr_b16 a[204:205], v21 offset:57344
ds_read_b64_tr_b16 a[206:207], v21 offset:57856
s_waitcnt lgkmcnt(10)
v_mfma_f32_32x32x16_bf16 v[80:95], a[240:243], a[24:27], v[80:95]
ds_read_b64_tr_b16 a[208:209], v20 offset:51200
ds_read_b64_tr_b16 a[210:211], v20 offset:51712
v_mfma_f32_32x32x16_bf16 v[96:111], a[244:247], a[24:27], v[96:111]
ds_read_b64_tr_b16 a[212:213], v21 offset:51200
ds_read_b64_tr_b16 a[214:215], v21 offset:51712
buffer_load_dwordx4 a[120:123], v24, s[96:99], s34 offen offset:3072 sc1
v_mfma_f32_32x32x16_bf16 v[112:127], a[248:251], a[24:27], v[112:127]
ds_read_b64_tr_b16 a[216:217], v20 offset:59392
ds_read_b64_tr_b16 a[218:219], v20 offset:59904
s_waitcnt lgkmcnt(10)
v_mfma_f32_32x32x16_bf16 v[128:143], a[252:255], a[24:27], v[128:143]
ds_read_b64_tr_b16 a[220:221], v21 offset:59392
ds_read_b64_tr_b16 a[222:223], v21 offset:59904
s_waitcnt vmcnt(22)
v_mfma_f32_32x32x16_bf16 v[80:95], a[192:195], a[32:35], v[80:95]
ds_read_b64_tr_b16 a[224:225], v20 offset:53248
ds_read_b64_tr_b16 a[226:227], v20 offset:53760
buffer_load_dwordx4 a[124:127], v25, s[96:99], s34 offen offset:3072 sc1
v_mfma_f32_32x32x16_bf16 v[96:111], a[196:199], a[32:35], v[96:111]
ds_read_b64_tr_b16 a[228:229], v21 offset:53248
ds_read_b64_tr_b16 a[230:231], v21 offset:53760
s_mov_b32 s32, 0x2a00000
buffer_load_dwordx4 a[128:131], v232, s[96:99], s32 offen offset:0 sc1
s_waitcnt lgkmcnt(10)
v_mfma_f32_32x32x16_bf16 v[112:127], a[200:203], a[32:35], v[112:127]
ds_read_b64_tr_b16 a[232:233], v20 offset:61440
ds_read_b64_tr_b16 a[234:235], v20 offset:61952
buffer_load_dwordx4 a[132:135], v232, s[96:99], s32 offen offset:1024 sc1
v_mfma_f32_32x32x16_bf16 v[128:143], a[204:207], a[32:35], v[128:143]
ds_read_b64_tr_b16 a[236:237], v21 offset:61440
ds_read_b64_tr_b16 a[238:239], v21 offset:61952
buffer_load_dwordx4 a[136:139], v232, s[96:99], s32 offen offset:2048 sc1
s_waitcnt vmcnt(24)
v_mfma_f32_32x32x16_bf16 v[80:95], a[208:211], a[40:43], v[80:95]
ds_read_b64_tr_b16 a[240:241], v20 offset:55296
ds_read_b64_tr_b16 a[242:243], v20 offset:55808
buffer_load_dwordx4 a[140:143], v232, s[96:99], s32 offen offset:3072 sc1
s_waitcnt lgkmcnt(10)
v_mfma_f32_32x32x16_bf16 v[96:111], a[212:215], a[40:43], v[96:111]
ds_read_b64_tr_b16 a[244:245], v21 offset:55296
ds_read_b64_tr_b16 a[246:247], v21 offset:55808
buffer_load_dwordx4 a[144:147], v233, s[96:99], s32 offen offset:0 sc1
v_mfma_f32_32x32x16_bf16 v[112:127], a[216:219], a[40:43], v[112:127]
ds_read_b64_tr_b16 a[248:249], v20 offset:63488
ds_read_b64_tr_b16 a[250:251], v20 offset:64000
v_mfma_f32_32x32x16_bf16 v[128:143], a[220:223], a[40:43], v[128:143]
ds_read_b64_tr_b16 a[252:253], v21 offset:63488
ds_read_b64_tr_b16 a[254:255], v21 offset:64000
s_waitcnt vmcnt(24) lgkmcnt(10)
v_mfma_f32_32x32x16_bf16 v[80:95], a[224:227], a[48:51], v[80:95]
ds_read_b64_tr_b16 a[192:193], v22 offset:0
ds_read_b64_tr_b16 a[194:195], v22 offset:512
s_mov_b32 s32, 0x2a01400
buffer_load_dwordx4 a[148:151], v232, s[96:99], s32 offen offset:0 sc1
v_mfma_f32_32x32x16_bf16 v[96:111], a[228:231], a[48:51], v[96:111]
ds_read_b64_tr_b16 a[196:197], v23 offset:0
ds_read_b64_tr_b16 a[198:199], v23 offset:512
v_mfma_f32_32x32x16_bf16 v[112:127], a[232:235], a[48:51], v[112:127]
ds_read_b64_tr_b16 a[200:201], v22 offset:8192
ds_read_b64_tr_b16 a[202:203], v22 offset:8704
s_waitcnt lgkmcnt(10)
v_mfma_f32_32x32x16_bf16 v[128:143], a[236:239], a[48:51], v[128:143]
ds_read_b64_tr_b16 a[204:205], v23 offset:8192
ds_read_b64_tr_b16 a[206:207], v23 offset:8704
buffer_load_dwordx4 a[152:155], v232, s[96:99], s32 offen offset:1024 sc1
s_waitcnt vmcnt(24)
v_mfma_f32_32x32x16_bf16 v[80:95], a[240:243], a[56:59], v[80:95]
ds_read_b64_tr_b16 a[208:209], v22 offset:2048
ds_read_b64_tr_b16 a[210:211], v22 offset:2560
v_mfma_f32_32x32x16_bf16 v[96:111], a[244:247], a[56:59], v[96:111]
ds_read_b64_tr_b16 a[212:213], v23 offset:2048
ds_read_b64_tr_b16 a[214:215], v23 offset:2560
s_waitcnt lgkmcnt(10)
v_mfma_f32_32x32x16_bf16 v[112:127], a[248:251], a[56:59], v[112:127]
ds_read_b64_tr_b16 a[216:217], v22 offset:10240
ds_read_b64_tr_b16 a[218:219], v22 offset:10752
buffer_load_dwordx4 a[156:159], v232, s[96:99], s32 offen offset:2048 sc1
v_mfma_f32_32x32x16_bf16 v[128:143], a[252:255], a[56:59], v[128:143]
ds_read_b64_tr_b16 a[220:221], v23 offset:10240
ds_read_b64_tr_b16 a[222:223], v23 offset:10752
s_waitcnt vmcnt(23)
v_mfma_f32_32x32x16_bf16 v[80:95], a[192:195], a[64:67], v[80:95]
ds_read_b64_tr_b16 a[224:225], v22 offset:4096
ds_read_b64_tr_b16 a[226:227], v22 offset:4608
s_waitcnt lgkmcnt(10)
v_mfma_f32_32x32x16_bf16 v[96:111], a[196:199], a[64:67], v[96:111]
ds_read_b64_tr_b16 a[228:229], v23 offset:4096
ds_read_b64_tr_b16 a[230:231], v23 offset:4608
buffer_load_dwordx4 a[160:163], v232, s[96:99], s32 offen offset:3072 sc1
v_mfma_f32_32x32x16_bf16 v[112:127], a[200:203], a[64:67], v[112:127]
ds_read_b64_tr_b16 a[232:233], v22 offset:12288
ds_read_b64_tr_b16 a[234:235], v22 offset:12800
v_mfma_f32_32x32x16_bf16 v[128:143], a[204:207], a[64:67], v[128:143]
ds_read_b64_tr_b16 a[236:237], v23 offset:12288
ds_read_b64_tr_b16 a[238:239], v23 offset:12800
s_waitcnt vmcnt(22) lgkmcnt(10)
v_mfma_f32_32x32x16_bf16 v[80:95], a[208:211], a[72:75], v[80:95]
ds_read_b64_tr_b16 a[240:241], v22 offset:6144
ds_read_b64_tr_b16 a[242:243], v22 offset:6656
buffer_load_dwordx4 a[164:167], v233, s[96:99], s32 offen offset:0 sc1
v_mfma_f32_32x32x16_bf16 v[96:111], a[212:215], a[72:75], v[96:111]
ds_read_b64_tr_b16 a[244:245], v23 offset:6144
ds_read_b64_tr_b16 a[246:247], v23 offset:6656
v_mfma_f32_32x32x16_bf16 v[112:127], a[216:219], a[72:75], v[112:127]
ds_read_b64_tr_b16 a[248:249], v22 offset:14336
ds_read_b64_tr_b16 a[250:251], v22 offset:14848
s_waitcnt lgkmcnt(10)
v_mfma_f32_32x32x16_bf16 v[128:143], a[220:223], a[72:75], v[128:143]
ds_read_b64_tr_b16 a[252:253], v23 offset:14336
ds_read_b64_tr_b16 a[254:255], v23 offset:14848
s_mov_b32 s32, 0x2a02800
buffer_load_dwordx4 a[168:171], v232, s[96:99], s32 offen offset:0 sc1
s_waitcnt vmcnt(22)
v_mfma_f32_32x32x16_bf16 v[80:95], a[224:227], a[80:83], v[80:95]
ds_read_b64_tr_b16 a[192:193], v22 offset:16384
ds_read_b64_tr_b16 a[194:195], v22 offset:16896
v_mfma_f32_32x32x16_bf16 v[96:111], a[228:231], a[80:83], v[96:111]
ds_read_b64_tr_b16 a[196:197], v23 offset:16384
ds_read_b64_tr_b16 a[198:199], v23 offset:16896
s_waitcnt lgkmcnt(10)
v_mfma_f32_32x32x16_bf16 v[112:127], a[232:235], a[80:83], v[112:127]
ds_read_b64_tr_b16 a[200:201], v22 offset:24576
ds_read_b64_tr_b16 a[202:203], v22 offset:25088
buffer_load_dwordx4 a[172:175], v232, s[96:99], s32 offen offset:1024 sc1
v_mfma_f32_32x32x16_bf16 v[128:143], a[236:239], a[80:83], v[128:143]
ds_read_b64_tr_b16 a[204:205], v23 offset:24576
ds_read_b64_tr_b16 a[206:207], v23 offset:25088
s_waitcnt vmcnt(21)
v_mfma_f32_32x32x16_bf16 v[80:95], a[240:243], a[88:91], v[80:95]
ds_read_b64_tr_b16 a[208:209], v22 offset:18432
ds_read_b64_tr_b16 a[210:211], v22 offset:18944
s_waitcnt lgkmcnt(10)
v_mfma_f32_32x32x16_bf16 v[96:111], a[244:247], a[88:91], v[96:111]
ds_read_b64_tr_b16 a[212:213], v23 offset:18432
ds_read_b64_tr_b16 a[214:215], v23 offset:18944
buffer_load_dwordx4 a[176:179], v232, s[96:99], s32 offen offset:2048 sc1
v_mfma_f32_32x32x16_bf16 v[112:127], a[248:251], a[88:91], v[112:127]
ds_read_b64_tr_b16 a[216:217], v22 offset:26624
ds_read_b64_tr_b16 a[218:219], v22 offset:27136
v_mfma_f32_32x32x16_bf16 v[128:143], a[252:255], a[88:91], v[128:143]
ds_read_b64_tr_b16 a[220:221], v23 offset:26624
ds_read_b64_tr_b16 a[222:223], v23 offset:27136
s_waitcnt vmcnt(20) lgkmcnt(10)
v_mfma_f32_32x32x16_bf16 v[80:95], a[192:195], a[96:99], v[80:95]
ds_read_b64_tr_b16 a[224:225], v22 offset:20480
ds_read_b64_tr_b16 a[226:227], v22 offset:20992
buffer_load_dwordx4 a[180:183], v232, s[96:99], s32 offen offset:3072 sc1
v_mfma_f32_32x32x16_bf16 v[96:111], a[196:199], a[96:99], v[96:111]
ds_read_b64_tr_b16 a[228:229], v23 offset:20480
ds_read_b64_tr_b16 a[230:231], v23 offset:20992
v_mfma_f32_32x32x16_bf16 v[112:127], a[200:203], a[96:99], v[112:127]
ds_read_b64_tr_b16 a[232:233], v22 offset:28672
ds_read_b64_tr_b16 a[234:235], v22 offset:29184
s_waitcnt lgkmcnt(10)
v_mfma_f32_32x32x16_bf16 v[128:143], a[204:207], a[96:99], v[128:143]
ds_read_b64_tr_b16 a[236:237], v23 offset:28672
ds_read_b64_tr_b16 a[238:239], v23 offset:29184
buffer_load_dwordx4 a[184:187], v233, s[96:99], s32 offen offset:0 sc1
s_waitcnt vmcnt(20)
v_mfma_f32_32x32x16_bf16 v[80:95], a[208:211], a[104:107], v[80:95]
ds_read_b64_tr_b16 a[240:241], v22 offset:22528
ds_read_b64_tr_b16 a[242:243], v22 offset:23040
v_mfma_f32_32x32x16_bf16 v[96:111], a[212:215], a[104:107], v[96:111]
ds_read_b64_tr_b16 a[244:245], v23 offset:22528
ds_read_b64_tr_b16 a[246:247], v23 offset:23040
s_waitcnt lgkmcnt(10)
v_mfma_f32_32x32x16_bf16 v[112:127], a[216:219], a[104:107], v[112:127]
ds_read_b64_tr_b16 a[248:249], v22 offset:30720
ds_read_b64_tr_b16 a[250:251], v22 offset:31232
s_mov_b32 s32, 0x2a03c00
s_add_u32 m0, s28, 0
s_nop 0
buffer_load_dwordx4 v232, s[96:99], s32 offen offset:0 sc1 lds
v_mfma_f32_32x32x16_bf16 v[128:143], a[220:223], a[104:107], v[128:143]
ds_read_b64_tr_b16 a[252:253], v23 offset:30720
ds_read_b64_tr_b16 a[254:255], v23 offset:31232
s_waitcnt vmcnt(19)
v_mfma_f32_32x32x16_bf16 v[80:95], a[224:227], a[112:115], v[80:95]
ds_read_b64_tr_b16 a[192:193], v20 offset:32768
ds_read_b64_tr_b16 a[194:195], v20 offset:33280
s_waitcnt lgkmcnt(10)
v_mfma_f32_32x32x16_bf16 v[96:111], a[228:231], a[112:115], v[96:111]
ds_read_b64_tr_b16 a[196:197], v21 offset:32768
ds_read_b64_tr_b16 a[198:199], v21 offset:33280
buffer_load_dwordx4 v232, s[96:99], s32 offen offset:1024 sc1 lds
v_mfma_f32_32x32x16_bf16 v[112:127], a[232:235], a[112:115], v[112:127]
ds_read_b64_tr_b16 a[200:201], v20 offset:40960
ds_read_b64_tr_b16 a[202:203], v20 offset:41472
v_mfma_f32_32x32x16_bf16 v[128:143], a[236:239], a[112:115], v[128:143]
ds_read_b64_tr_b16 a[204:205], v21 offset:40960
ds_read_b64_tr_b16 a[206:207], v21 offset:41472
s_waitcnt vmcnt(18) lgkmcnt(10)
v_mfma_f32_32x32x16_bf16 v[80:95], a[240:243], a[120:123], v[80:95]
ds_read_b64_tr_b16 a[208:209], v20 offset:34816
ds_read_b64_tr_b16 a[210:211], v20 offset:35328
buffer_load_dwordx4 v232, s[96:99], s32 offen offset:2048 sc1 lds
v_mfma_f32_32x32x16_bf16 v[96:111], a[244:247], a[120:123], v[96:111]
ds_read_b64_tr_b16 a[212:213], v21 offset:34816
ds_read_b64_tr_b16 a[214:215], v21 offset:35328
v_mfma_f32_32x32x16_bf16 v[112:127], a[248:251], a[120:123], v[112:127]
ds_read_b64_tr_b16 a[216:217], v20 offset:43008
ds_read_b64_tr_b16 a[218:219], v20 offset:43520
s_waitcnt lgkmcnt(10)
v_mfma_f32_32x32x16_bf16 v[128:143], a[252:255], a[120:123], v[128:143]
ds_read_b64_tr_b16 a[220:221], v21 offset:43008
ds_read_b64_tr_b16 a[222:223], v21 offset:43520
buffer_load_dwordx4 v232, s[96:99], s32 offen offset:3072 sc1 lds
v_mfma_f32_32x32x16_bf16 v[144:159], a[192:195], a[4:7], v[144:159]
ds_read_b64_tr_b16 a[224:225], v20 offset:36864
ds_read_b64_tr_b16 a[226:227], v20 offset:37376
v_mfma_f32_32x32x16_bf16 v[160:175], a[196:199], a[4:7], v[160:175]
ds_read_b64_tr_b16 a[228:229], v21 offset:36864
ds_read_b64_tr_b16 a[230:231], v21 offset:37376
ds_read_b128 v[36:39], v34 offset:0
ds_read_b128 v[40:43], v34 offset:16
ds_read_b128 v[44:47], v34 offset:256
ds_read_b128 v[48:51], v34 offset:272
ds_read_b128 v[52:55], v34 offset:512
ds_read_b128 v[56:59], v34 offset:528
s_waitcnt lgkmcnt(15)
v_mfma_f32_32x32x16_bf16 v[176:191], a[200:203], a[4:7], v[176:191]
ds_read_b64_tr_b16 a[232:233], v20 offset:45056
ds_read_b64_tr_b16 a[234:235], v20 offset:45568
ds_read_b128 v[60:63], v34 offset:768
ds_read_b128 v[64:67], v34 offset:784
s_waitcnt lgkmcnt(5)
v_fma_f32 v36, v36, v32, v52
v_fma_f32 v37, v37, v32, v53
v_fma_f32 v38, v38, v32, v54
v_fma_f32 v39, v39, v32, v55
s_add_u32 m0, s28, 4096
s_nop 0
buffer_load_dwordx4 v233, s[96:99], s32 offen offset:0 sc1 lds
v_mfma_f32_32x32x16_bf16 v[192:207], a[204:207], a[4:7], v[192:207]
ds_read_b64_tr_b16 a[236:237], v21 offset:45056
ds_read_b64_tr_b16 a[238:239], v21 offset:45568
s_waitcnt lgkmcnt(6)
v_fma_f32 v40, v40, v32, v56
v_fma_f32 v41, v41, v32, v57
v_fma_f32 v42, v42, v32, v58
v_fma_f32 v43, v43, v32, v59
v_fma_f32 v80, v80, v30, v36
v_fma_f32 v81, v81, v30, v37
v_mfma_f32_32x32x16_bf16 v[144:159], a[208:211], a[12:15], v[144:159]
ds_read_b64_tr_b16 a[240:241], v20 offset:38912
ds_read_b64_tr_b16 a[242:243], v20 offset:39424
v_fma_f32 v82, v82, v30, v38
v_fma_f32 v83, v83, v30, v39
v_fma_f32 v84, v84, v30, v40
v_fma_f32 v85, v85, v30, v41
v_fma_f32 v86, v86, v30, v42
v_fma_f32 v87, v87, v30, v43
v_mfma_f32_32x32x16_bf16 v[160:175], a[212:215], a[12:15], v[160:175]
ds_read_b64_tr_b16 a[244:245], v21 offset:38912
ds_read_b64_tr_b16 a[246:247], v21 offset:39424
s_waitcnt lgkmcnt(7)
v_fma_f32 v44, v44, v32, v60
v_fma_f32 v45, v45, v32, v61
v_fma_f32 v46, v46, v32, v62
v_fma_f32 v47, v47, v32, v63
s_waitcnt lgkmcnt(6)
v_fma_f32 v48, v48, v32, v64
v_fma_f32 v49, v49, v32, v65
s_mov_b32 s32, 0x2a05000
s_add_u32 m0, s28, 5120
s_nop 0
buffer_load_dwordx4 v232, s[96:99], s32 offen offset:0 sc1 lds
v_mfma_f32_32x32x16_bf16 v[176:191], a[216:219], a[12:15], v[176:191]
ds_read_b64_tr_b16 a[248:249], v20 offset:47104
ds_read_b64_tr_b16 a[250:251], v20 offset:47616
v_fma_f32 v50, v50, v32, v66
v_fma_f32 v51, v51, v32, v67
v_fma_f32 v112, v112, v30, v44
v_fma_f32 v113, v113, v30, v45
v_fma_f32 v114, v114, v30, v46
v_fma_f32 v115, v115, v30, v47
v_mfma_f32_32x32x16_bf16 v[192:207], a[220:223], a[12:15], v[192:207]
ds_read_b64_tr_b16 a[252:253], v21 offset:47104
ds_read_b64_tr_b16 a[254:255], v21 offset:47616
v_fma_f32 v116, v116, v30, v48
v_fma_f32 v117, v117, v30, v49
v_fma_f32 v118, v118, v30, v50
v_fma_f32 v119, v119, v30, v51
v_mul_f32 v208, 0xbfb8aa3b, v80
v_mul_f32 v209, 0xbfb8aa3b, v81
v_mfma_f32_32x32x16_bf16 v[144:159], a[224:227], a[20:23], v[144:159]
ds_read_b64_tr_b16 a[192:193], v20 offset:49152
ds_read_b64_tr_b16 a[194:195], v20 offset:49664
v_mul_f32 v210, 0xbfb8aa3b, v82
v_mul_f32 v211, 0xbfb8aa3b, v83
v_mul_f32 v212, 0xbfb8aa3b, v84
v_mul_f32 v213, 0xbfb8aa3b, v85
v_mul_f32 v214, 0xbfb8aa3b, v86
v_mul_f32 v215, 0xbfb8aa3b, v87
buffer_load_dwordx4 v232, s[96:99], s32 offen offset:1024 sc1 lds
v_mfma_f32_32x32x16_bf16 v[160:175], a[228:231], a[20:23], v[160:175]
ds_read_b64_tr_b16 a[196:197], v21 offset:49152
ds_read_b64_tr_b16 a[198:199], v21 offset:49664
v_exp_f32 v208, v208
v_exp_f32 v209, v209
v_exp_f32 v210, v210
v_exp_f32 v211, v211
v_exp_f32 v212, v212
v_exp_f32 v213, v213
v_mfma_f32_32x32x16_bf16 v[176:191], a[232:235], a[20:23], v[176:191]
ds_read_b64_tr_b16 a[200:201], v20 offset:57344
ds_read_b64_tr_b16 a[202:203], v20 offset:57856
v_exp_f32 v214, v214
v_exp_f32 v215, v215
v_mul_f32 v80, v80, v112
v_mul_f32 v81, v81, v113
v_mul_f32 v82, v82, v114
v_mul_f32 v83, v83, v115
s_waitcnt lgkmcnt(10)
v_mfma_f32_32x32x16_bf16 v[192:207], a[236:239], a[20:23], v[192:207]
ds_read_b64_tr_b16 a[204:205], v21 offset:57344
ds_read_b64_tr_b16 a[206:207], v21 offset:57856
v_mul_f32 v84, v84, v116
v_mul_f32 v85, v85, v117
v_mul_f32 v86, v86, v118
v_mul_f32 v87, v87, v119
v_add_f32 v208, 1.0, v208
buffer_load_dwordx4 v232, s[96:99], s32 offen offset:2048 sc1 lds
v_mfma_f32_32x32x16_bf16 v[144:159], a[240:243], a[28:31], v[144:159]
ds_read_b64_tr_b16 a[208:209], v20 offset:51200
ds_read_b64_tr_b16 a[210:211], v20 offset:51712
v_add_f32 v209, 1.0, v209
v_add_f32 v210, 1.0, v210
v_add_f32 v211, 1.0, v211
v_add_f32 v212, 1.0, v212
v_add_f32 v213, 1.0, v213
v_add_f32 v214, 1.0, v214
v_mfma_f32_32x32x16_bf16 v[160:175], a[244:247], a[28:31], v[160:175]
ds_read_b64_tr_b16 a[212:213], v21 offset:51200
ds_read_b64_tr_b16 a[214:215], v21 offset:51712
v_add_f32 v215, 1.0, v215
v_rcp_f32 v208, v208
v_rcp_f32 v209, v209
v_rcp_f32 v210, v210
v_rcp_f32 v211, v211
v_rcp_f32 v212, v212
s_waitcnt lgkmcnt(10)
v_mfma_f32_32x32x16_bf16 v[176:191], a[248:251], a[28:31], v[176:191]
ds_read_b64_tr_b16 a[216:217], v20 offset:59392
ds_read_b64_tr_b16 a[218:219], v20 offset:59904
v_rcp_f32 v213, v213
v_rcp_f32 v214, v214
v_rcp_f32 v215, v215
v_mul_f32 v80, v80, v208
v_mul_f32 v81, v81, v209
v_mul_f32 v82, v82, v210
buffer_load_dwordx4 v232, s[96:99], s32 offen offset:3072 sc1 lds
v_mfma_f32_32x32x16_bf16 v[192:207], a[252:255], a[28:31], v[192:207]
ds_read_b64_tr_b16 a[220:221], v21 offset:59392
ds_read_b64_tr_b16 a[222:223], v21 offset:59904
v_mul_f32 v83, v83, v211
v_mul_f32 v84, v84, v212
v_mul_f32 v85, v85, v213
v_mul_f32 v86, v86, v214
v_mul_f32 v87, v87, v215
v_cvt_pk_bf16_f32 v216, v80, v81
v_mfma_f32_32x32x16_bf16 v[144:159], a[192:195], a[36:39], v[144:159]
ds_read_b64_tr_b16 a[224:225], v20 offset:53248
ds_read_b64_tr_b16 a[226:227], v20 offset:53760
v_cvt_pk_bf16_f32 v217, v82, v83
v_cvt_pk_bf16_f32 v218, v84, v85
v_cvt_pk_bf16_f32 v219, v86, v87
buffer_store_dwordx4 v[216:219], v28, s[96:99], 0 offen offset:0 sc1
ds_read_b128 v[36:39], v34 offset:64
ds_read_b128 v[40:43], v34 offset:80
s_waitcnt lgkmcnt(12)
v_mfma_f32_32x32x16_bf16 v[160:175], a[196:199], a[36:39], v[160:175]
ds_read_b64_tr_b16 a[228:229], v21 offset:53248
ds_read_b64_tr_b16 a[230:231], v21 offset:53760
ds_read_b128 v[44:47], v34 offset:320
ds_read_b128 v[48:51], v34 offset:336
ds_read_b128 v[52:55], v34 offset:576
ds_read_b128 v[56:59], v34 offset:592
ds_read_b128 v[60:63], v34 offset:832
ds_read_b128 v[64:67], v34 offset:848
s_add_u32 m0, s28, 9216
s_nop 0
buffer_load_dwordx4 v233, s[96:99], s32 offen offset:0 sc1 lds
v_mfma_f32_32x32x16_bf16 v[176:191], a[200:203], a[36:39], v[176:191]
ds_read_b64_tr_b16 a[232:233], v20 offset:61440
ds_read_b64_tr_b16 a[234:235], v20 offset:61952
s_waitcnt lgkmcnt(5)
v_fma_f32 v36, v36, v32, v52
v_fma_f32 v37, v37, v32, v53
v_fma_f32 v38, v38, v32, v54
v_fma_f32 v39, v39, v32, v55
s_waitcnt lgkmcnt(4)
v_fma_f32 v40, v40, v32, v56
v_fma_f32 v41, v41, v32, v57
v_mfma_f32_32x32x16_bf16 v[192:207], a[204:207], a[36:39], v[192:207]
ds_read_b64_tr_b16 a[236:237], v21 offset:61440
ds_read_b64_tr_b16 a[238:239], v21 offset:61952
v_fma_f32 v42, v42, v32, v58
v_fma_f32 v43, v43, v32, v59
v_fma_f32 v88, v88, v30, v36
v_fma_f32 v89, v89, v30, v37
v_fma_f32 v90, v90, v30, v38
v_fma_f32 v91, v91, v30, v39
v_mfma_f32_32x32x16_bf16 v[144:159], a[208:211], a[44:47], v[144:159]
ds_read_b64_tr_b16 a[240:241], v20 offset:55296
ds_read_b64_tr_b16 a[242:243], v20 offset:55808
v_fma_f32 v92, v92, v30, v40
v_fma_f32 v93, v93, v30, v41
v_fma_f32 v94, v94, v30, v42
v_fma_f32 v95, v95, v30, v43
s_waitcnt lgkmcnt(7)
v_fma_f32 v44, v44, v32, v60
v_fma_f32 v45, v45, v32, v61
s_mov_b32 s32, 0x2a06400
s_add_u32 m0, s28, 10240
s_nop 0
buffer_load_dwordx4 v232, s[96:99], s32 offen offset:0 sc1 lds
v_mfma_f32_32x32x16_bf16 v[160:175], a[212:215], a[44:47], v[160:175]
ds_read_b64_tr_b16 a[244:245], v21 offset:55296
ds_read_b64_tr_b16 a[246:247], v21 offset:55808
v_fma_f32 v46, v46, v32, v62
v_fma_f32 v47, v47, v32, v63
s_waitcnt lgkmcnt(8)
v_fma_f32 v48, v48, v32, v64
v_fma_f32 v49, v49, v32, v65
v_fma_f32 v50, v50, v32, v66
v_mfma_f32_32x32x16_bf16 v[176:191], a[216:219], a[44:47], v[176:191]
ds_read_b64_tr_b16 a[248:249], v20 offset:63488
ds_read_b64_tr_b16 a[250:251], v20 offset:64000
v_fma_f32 v51, v51, v32, v67
v_fma_f32 v120, v120, v30, v44
v_fma_f32 v121, v121, v30, v45
v_fma_f32 v122, v122, v30, v46
v_fma_f32 v123, v123, v30, v47
v_fma_f32 v124, v124, v30, v48
v_mfma_f32_32x32x16_bf16 v[192:207], a[220:223], a[44:47], v[192:207]
ds_read_b64_tr_b16 a[252:253], v21 offset:63488
ds_read_b64_tr_b16 a[254:255], v21 offset:64000
v_fma_f32 v125, v125, v30, v49
v_fma_f32 v126, v126, v30, v50
v_fma_f32 v127, v127, v30, v51
v_mul_f32 v220, 0xbfb8aa3b, v88
v_mul_f32 v221, 0xbfb8aa3b, v89
v_mul_f32 v222, 0xbfb8aa3b, v90
buffer_load_dwordx4 v232, s[96:99], s32 offen offset:1024 sc1 lds
v_mfma_f32_32x32x16_bf16 v[144:159], a[224:227], a[52:55], v[144:159]
ds_read_b64_tr_b16 a[192:193], v22 offset:0
ds_read_b64_tr_b16 a[194:195], v22 offset:512
v_mul_f32 v223, 0xbfb8aa3b, v91
v_mul_f32 v224, 0xbfb8aa3b, v92
v_mul_f32 v225, 0xbfb8aa3b, v93
v_mul_f32 v226, 0xbfb8aa3b, v94
v_mul_f32 v227, 0xbfb8aa3b, v95
v_exp_f32 v220, v220
v_mfma_f32_32x32x16_bf16 v[160:175], a[228:231], a[52:55], v[160:175]
ds_read_b64_tr_b16 a[196:197], v23 offset:0
ds_read_b64_tr_b16 a[198:199], v23 offset:512
v_exp_f32 v221, v221
v_exp_f32 v222, v222
v_exp_f32 v223, v223
v_exp_f32 v224, v224
v_exp_f32 v225, v225
v_exp_f32 v226, v226
s_waitcnt lgkmcnt(10)
v_mfma_f32_32x32x16_bf16 v[176:191], a[232:235], a[52:55], v[176:191]
ds_read_b64_tr_b16 a[200:201], v22 offset:8192
ds_read_b64_tr_b16 a[202:203], v22 offset:8704
v_exp_f32 v227, v227
v_mul_f32 v88, v88, v120
v_mul_f32 v89, v89, v121
v_mul_f32 v90, v90, v122
v_mul_f32 v91, v91, v123
v_mul_f32 v92, v92, v124
buffer_load_dwordx4 v232, s[96:99], s32 offen offset:2048 sc1 lds
v_mfma_f32_32x32x16_bf16 v[192:207], a[236:239], a[52:55], v[192:207]
ds_read_b64_tr_b16 a[204:205], v23 offset:8192
ds_read_b64_tr_b16 a[206:207], v23 offset:8704
v_mul_f32 v93, v93, v125
v_mul_f32 v94, v94, v126
v_mul_f32 v95, v95, v127
v_add_f32 v220, 1.0, v220
v_add_f32 v221, 1.0, v221
v_add_f32 v222, 1.0, v222
v_mfma_f32_32x32x16_bf16 v[144:159], a[240:243], a[60:63], v[144:159]
ds_read_b64_tr_b16 a[208:209], v22 offset:2048
ds_read_b64_tr_b16 a[210:211], v22 offset:2560
v_add_f32 v223, 1.0, v223
v_add_f32 v224, 1.0, v224
v_add_f32 v225, 1.0, v225
v_add_f32 v226, 1.0, v226
v_add_f32 v227, 1.0, v227
v_rcp_f32 v220, v220
s_waitcnt lgkmcnt(10)
v_mfma_f32_32x32x16_bf16 v[160:175], a[244:247], a[60:63], v[160:175]
ds_read_b64_tr_b16 a[212:213], v23 offset:2048
ds_read_b64_tr_b16 a[214:215], v23 offset:2560
v_rcp_f32 v221, v221
v_rcp_f32 v222, v222
v_rcp_f32 v223, v223
v_rcp_f32 v224, v224
v_rcp_f32 v225, v225
v_rcp_f32 v226, v226
buffer_load_dwordx4 v232, s[96:99], s32 offen offset:3072 sc1 lds
v_mfma_f32_32x32x16_bf16 v[176:191], a[248:251], a[60:63], v[176:191]
ds_read_b64_tr_b16 a[216:217], v22 offset:10240
ds_read_b64_tr_b16 a[218:219], v22 offset:10752
v_rcp_f32 v227, v227
v_mul_f32 v88, v88, v220
v_mul_f32 v89, v89, v221
v_mul_f32 v90, v90, v222
v_mul_f32 v91, v91, v223
v_mul_f32 v92, v92, v224
v_mfma_f32_32x32x16_bf16 v[192:207], a[252:255], a[60:63], v[192:207]
ds_read_b64_tr_b16 a[220:221], v23 offset:10240
ds_read_b64_tr_b16 a[222:223], v23 offset:10752
v_mul_f32 v93, v93, v225
v_mul_f32 v94, v94, v226
v_mul_f32 v95, v95, v227
v_cvt_pk_bf16_f32 v228, v88, v89
v_cvt_pk_bf16_f32 v229, v90, v91
v_cvt_pk_bf16_f32 v230, v92, v93
s_waitcnt lgkmcnt(10)
v_mfma_f32_32x32x16_bf16 v[144:159], a[192:195], a[68:71], v[144:159]
ds_read_b64_tr_b16 a[224:225], v22 offset:4096
ds_read_b64_tr_b16 a[226:227], v22 offset:4608
v_cvt_pk_bf16_f32 v231, v94, v95
buffer_store_dwordx4 v[228:231], v28, s[96:99], 0 offen offset:512 sc1
ds_read_b128 v[36:39], v34 offset:128
ds_read_b128 v[40:43], v34 offset:144
ds_read_b128 v[44:47], v34 offset:384
s_add_u32 m0, s28, 14336
s_nop 0
buffer_load_dwordx4 v233, s[96:99], s32 offen offset:0 sc1 lds
v_mfma_f32_32x32x16_bf16 v[160:175], a[196:199], a[68:71], v[160:175]
ds_read_b64_tr_b16 a[228:229], v23 offset:4096
ds_read_b64_tr_b16 a[230:231], v23 offset:4608
ds_read_b128 v[48:51], v34 offset:400
ds_read_b128 v[52:55], v34 offset:640
ds_read_b128 v[56:59], v34 offset:656
ds_read_b128 v[60:63], v34 offset:896
ds_read_b128 v[64:67], v34 offset:912
s_waitcnt lgkmcnt(3)
v_fma_f32 v36, v36, v32, v52
v_mfma_f32_32x32x16_bf16 v[176:191], a[200:203], a[68:71], v[176:191]
ds_read_b64_tr_b16 a[232:233], v22 offset:12288
ds_read_b64_tr_b16 a[234:235], v22 offset:12800
v_fma_f32 v37, v37, v32, v53
v_fma_f32 v38, v38, v32, v54
v_fma_f32 v39, v39, v32, v55
s_waitcnt lgkmcnt(4)
v_fma_f32 v40, v40, v32, v56
v_fma_f32 v41, v41, v32, v57
v_fma_f32 v42, v42, v32, v58
v_mfma_f32_32x32x16_bf16 v[192:207], a[204:207], a[68:71], v[192:207]
ds_read_b64_tr_b16 a[236:237], v23 offset:12288
ds_read_b64_tr_b16 a[238:239], v23 offset:12800
v_fma_f32 v43, v43, v32, v59
v_fma_f32 v96, v96, v30, v36
v_fma_f32 v97, v97, v30, v37
v_fma_f32 v98, v98, v30, v38
v_fma_f32 v99, v99, v30, v39
v_fma_f32 v100, v100, v30, v40
s_mov_b32 s32, 0x2a07800
s_add_u32 m0, s28, 15360
s_nop 0
buffer_load_dwordx4 v232, s[96:99], s32 offen offset:0 sc1 lds
v_mfma_f32_32x32x16_bf16 v[144:159], a[208:211], a[76:79], v[144:159]
ds_read_b64_tr_b16 a[240:241], v22 offset:6144
ds_read_b64_tr_b16 a[242:243], v22 offset:6656
v_fma_f32 v101, v101, v30, v41
v_fma_f32 v102, v102, v30, v42
v_fma_f32 v103, v103, v30, v43
s_waitcnt lgkmcnt(7)
v_fma_f32 v44, v44, v32, v60
v_fma_f32 v45, v45, v32, v61
v_fma_f32 v46, v46, v32, v62
v_mfma_f32_32x32x16_bf16 v[160:175], a[212:215], a[76:79], v[160:175]
ds_read_b64_tr_b16 a[244:245], v23 offset:6144
ds_read_b64_tr_b16 a[246:247], v23 offset:6656
v_fma_f32 v47, v47, v32, v63
s_waitcnt lgkmcnt(8)
v_fma_f32 v48, v48, v32, v64
v_fma_f32 v49, v49, v32, v65
v_fma_f32 v50, v50, v32, v66
v_fma_f32 v51, v51, v32, v67
v_fma_f32 v128, v128, v30, v44
v_mfma_f32_32x32x16_bf16 v[176:191], a[216:219], a[76:79], v[176:191]
ds_read_b64_tr_b16 a[248:249], v22 offset:14336
ds_read_b64_tr_b16 a[250:251], v22 offset:14848
v_fma_f32 v129, v129, v30, v45
v_fma_f32 v130, v130, v30, v46
v_fma_f32 v131, v131, v30, v47
v_fma_f32 v132, v132, v30, v48
v_fma_f32 v133, v133, v30, v49
v_fma_f32 v134, v134, v30, v50
buffer_load_dwordx4 v232, s[96:99], s32 offen offset:1024 sc1 lds
v_mfma_f32_32x32x16_bf16 v[192:207], a[220:223], a[76:79], v[192:207]
ds_read_b64_tr_b16 a[252:253], v23 offset:14336
ds_read_b64_tr_b16 a[254:255], v23 offset:14848
v_fma_f32 v135, v135, v30, v51
v_mul_f32 v208, 0xbfb8aa3b, v96
v_mul_f32 v209, 0xbfb8aa3b, v97
v_mul_f32 v210, 0xbfb8aa3b, v98
v_mul_f32 v211, 0xbfb8aa3b, v99
v_mul_f32 v212, 0xbfb8aa3b, v100
v_mfma_f32_32x32x16_bf16 v[144:159], a[224:227], a[84:87], v[144:159]
ds_read_b64_tr_b16 a[192:193], v22 offset:16384
ds_read_b64_tr_b16 a[194:195], v22 offset:16896
v_mul_f32 v213, 0xbfb8aa3b, v101
v_mul_f32 v214, 0xbfb8aa3b, v102
v_mul_f32 v215, 0xbfb8aa3b, v103
v_exp_f32 v208, v208
v_exp_f32 v209, v209
v_exp_f32 v210, v210
v_mfma_f32_32x32x16_bf16 v[160:175], a[228:231], a[84:87], v[160:175]
ds_read_b64_tr_b16 a[196:197], v23 offset:16384
ds_read_b64_tr_b16 a[198:199], v23 offset:16896
v_exp_f32 v211, v211
v_exp_f32 v212, v212
v_exp_f32 v213, v213
v_exp_f32 v214, v214
v_exp_f32 v215, v215
v_mul_f32 v96, v96, v128
buffer_load_dwordx4 v232, s[96:99], s32 offen offset:2048 sc1 lds
s_waitcnt lgkmcnt(10)
v_mfma_f32_32x32x16_bf16 v[176:191], a[232:235], a[84:87], v[176:191]
ds_read_b64_tr_b16 a[200:201], v22 offset:24576
ds_read_b64_tr_b16 a[202:203], v22 offset:25088
v_mul_f32 v97, v97, v129
v_mul_f32 v98, v98, v130
v_mul_f32 v99, v99, v131
v_mul_f32 v100, v100, v132
v_mul_f32 v101, v101, v133
v_mfma_f32_32x32x16_bf16 v[192:207], a[236:239], a[84:87], v[192:207]
ds_read_b64_tr_b16 a[204:205], v23 offset:24576
ds_read_b64_tr_b16 a[206:207], v23 offset:25088
v_mul_f32 v102, v102, v134
v_mul_f32 v103, v103, v135
v_add_f32 v208, 1.0, v208
v_add_f32 v209, 1.0, v209
v_add_f32 v210, 1.0, v210
v_add_f32 v211, 1.0, v211
v_mfma_f32_32x32x16_bf16 v[144:159], a[240:243], a[92:95], v[144:159]
ds_read_b64_tr_b16 a[208:209], v22 offset:18432
ds_read_b64_tr_b16 a[210:211], v22 offset:18944
v_add_f32 v212, 1.0, v212
v_add_f32 v213, 1.0, v213
v_add_f32 v214, 1.0, v214
v_add_f32 v215, 1.0, v215
v_rcp_f32 v208, v208
v_rcp_f32 v209, v209
buffer_load_dwordx4 v232, s[96:99], s32 offen offset:3072 sc1 lds
s_waitcnt lgkmcnt(10)
v_mfma_f32_32x32x16_bf16 v[160:175], a[244:247], a[92:95], v[160:175]
ds_read_b64_tr_b16 a[212:213], v23 offset:18432
ds_read_b64_tr_b16 a[214:215], v23 offset:18944
v_rcp_f32 v210, v210
v_rcp_f32 v211, v211
v_rcp_f32 v212, v212
v_rcp_f32 v213, v213
v_rcp_f32 v214, v214
v_rcp_f32 v215, v215
v_mfma_f32_32x32x16_bf16 v[176:191], a[248:251], a[92:95], v[176:191]
ds_read_b64_tr_b16 a[216:217], v22 offset:26624
ds_read_b64_tr_b16 a[218:219], v22 offset:27136
v_mul_f32 v96, v96, v208
v_mul_f32 v97, v97, v209
v_mul_f32 v98, v98, v210
v_mul_f32 v99, v99, v211
v_mul_f32 v100, v100, v212
v_mul_f32 v101, v101, v213
v_mfma_f32_32x32x16_bf16 v[192:207], a[252:255], a[92:95], v[192:207]
ds_read_b64_tr_b16 a[220:221], v23 offset:26624
ds_read_b64_tr_b16 a[222:223], v23 offset:27136
v_mul_f32 v102, v102, v214
v_mul_f32 v103, v103, v215
v_cvt_pk_bf16_f32 v216, v96, v97
v_cvt_pk_bf16_f32 v217, v98, v99
v_cvt_pk_bf16_f32 v218, v100, v101
v_cvt_pk_bf16_f32 v219, v102, v103
s_add_u32 m0, s28, 19456
s_nop 0
buffer_load_dwordx4 v233, s[96:99], s32 offen offset:0 sc1 lds
s_waitcnt lgkmcnt(10)
v_mfma_f32_32x32x16_bf16 v[144:159], a[192:195], a[100:103], v[144:159]
ds_read_b64_tr_b16 a[224:225], v22 offset:20480
ds_read_b64_tr_b16 a[226:227], v22 offset:20992
buffer_store_dwordx4 v[216:219], v28, s[96:99], 0 offen offset:1024 sc1
ds_read_b128 v[36:39], v34 offset:192
ds_read_b128 v[40:43], v34 offset:208
ds_read_b128 v[44:47], v34 offset:448
ds_read_b128 v[48:51], v34 offset:464
ds_read_b128 v[52:55], v34 offset:704
v_mfma_f32_32x32x16_bf16 v[160:175], a[196:199], a[100:103], v[160:175]
ds_read_b64_tr_b16 a[228:229], v23 offset:20480
ds_read_b64_tr_b16 a[230:231], v23 offset:20992
ds_read_b128 v[56:59], v34 offset:720
ds_read_b128 v[60:63], v34 offset:960
ds_read_b128 v[64:67], v34 offset:976
s_waitcnt lgkmcnt(5)
v_fma_f32 v36, v36, v32, v52
v_fma_f32 v37, v37, v32, v53
v_fma_f32 v38, v38, v32, v54
v_mfma_f32_32x32x16_bf16 v[176:191], a[200:203], a[100:103], v[176:191]
ds_read_b64_tr_b16 a[232:233], v22 offset:28672
ds_read_b64_tr_b16 a[234:235], v22 offset:29184
v_fma_f32 v39, v39, v32, v55
s_waitcnt lgkmcnt(4)
v_fma_f32 v40, v40, v32, v56
v_fma_f32 v41, v41, v32, v57
v_fma_f32 v42, v42, v32, v58
v_fma_f32 v43, v43, v32, v59
v_fma_f32 v104, v104, v30, v36
v_mfma_f32_32x32x16_bf16 v[192:207], a[204:207], a[100:103], v[192:207]
ds_read_b64_tr_b16 a[236:237], v23 offset:28672
ds_read_b64_tr_b16 a[238:239], v23 offset:29184
v_fma_f32 v105, v105, v30, v37
v_fma_f32 v106, v106, v30, v38
v_fma_f32 v107, v107, v30, v39
v_fma_f32 v108, v108, v30, v40
v_fma_f32 v109, v109, v30, v41
v_fma_f32 v110, v110, v30, v42
v_mfma_f32_32x32x16_bf16 v[144:159], a[208:211], a[108:111], v[144:159]
ds_read_b64_tr_b16 a[240:241], v22 offset:22528
ds_read_b64_tr_b16 a[242:243], v22 offset:23040
v_fma_f32 v111, v111, v30, v43
s_waitcnt lgkmcnt(7)
v_fma_f32 v44, v44, v32, v60
v_fma_f32 v45, v45, v32, v61
v_fma_f32 v46, v46, v32, v62
v_fma_f32 v47, v47, v32, v63
s_waitcnt lgkmcnt(6)
v_fma_f32 v48, v48, v32, v64
v_mfma_f32_32x32x16_bf16 v[160:175], a[212:215], a[108:111], v[160:175]
ds_read_b64_tr_b16 a[244:245], v23 offset:22528
ds_read_b64_tr_b16 a[246:247], v23 offset:23040
v_fma_f32 v49, v49, v32, v65
v_fma_f32 v50, v50, v32, v66
v_fma_f32 v51, v51, v32, v67
v_fma_f32 v136, v136, v30, v44
v_fma_f32 v137, v137, v30, v45
v_mfma_f32_32x32x16_bf16 v[176:191], a[216:219], a[108:111], v[176:191]
ds_read_b64_tr_b16 a[248:249], v22 offset:30720
ds_read_b64_tr_b16 a[250:251], v22 offset:31232
v_fma_f32 v138, v138, v30, v46
v_fma_f32 v139, v139, v30, v47
v_fma_f32 v140, v140, v30, v48
v_fma_f32 v141, v141, v30, v49
v_fma_f32 v142, v142, v30, v50
v_fma_f32 v143, v143, v30, v51
v_mfma_f32_32x32x16_bf16 v[192:207], a[220:223], a[108:111], v[192:207]
ds_read_b64_tr_b16 a[252:253], v23 offset:30720
ds_read_b64_tr_b16 a[254:255], v23 offset:31232
v_mul_f32 v220, 0xbfb8aa3b, v104
v_mul_f32 v221, 0xbfb8aa3b, v105
v_mul_f32 v222, 0xbfb8aa3b, v106
v_mul_f32 v223, 0xbfb8aa3b, v107
v_mul_f32 v224, 0xbfb8aa3b, v108
v_mul_f32 v225, 0xbfb8aa3b, v109
v_mfma_f32_32x32x16_bf16 v[144:159], a[224:227], a[116:119], v[144:159]
v_mul_f32 v226, 0xbfb8aa3b, v110
v_mul_f32 v227, 0xbfb8aa3b, v111
v_exp_f32 v220, v220
v_exp_f32 v221, v221
v_exp_f32 v222, v222
v_exp_f32 v223, v223
v_mfma_f32_32x32x16_bf16 v[160:175], a[228:231], a[116:119], v[160:175]
v_exp_f32 v224, v224
v_exp_f32 v225, v225
v_exp_f32 v226, v226
v_exp_f32 v227, v227
v_mul_f32 v104, v104, v136
v_mul_f32 v105, v105, v137
s_waitcnt lgkmcnt(6)
v_mfma_f32_32x32x16_bf16 v[176:191], a[232:235], a[116:119], v[176:191]
v_mul_f32 v106, v106, v138
v_mul_f32 v107, v107, v139
v_mul_f32 v108, v108, v140
v_mul_f32 v109, v109, v141
v_mul_f32 v110, v110, v142
v_mul_f32 v111, v111, v143
v_mfma_f32_32x32x16_bf16 v[192:207], a[236:239], a[116:119], v[192:207]
v_add_f32 v220, 1.0, v220
v_add_f32 v221, 1.0, v221
v_add_f32 v222, 1.0, v222
v_add_f32 v223, 1.0, v223
v_add_f32 v224, 1.0, v224
v_add_f32 v225, 1.0, v225
s_waitcnt vmcnt(38)
v_mfma_f32_32x32x16_bf16 v[144:159], a[240:243], a[124:127], v[144:159]
v_add_f32 v226, 1.0, v226
v_add_f32 v227, 1.0, v227
v_rcp_f32 v220, v220
v_rcp_f32 v221, v221
v_rcp_f32 v222, v222
v_rcp_f32 v223, v223
s_waitcnt lgkmcnt(0)
v_mfma_f32_32x32x16_bf16 v[160:175], a[244:247], a[124:127], v[160:175]
v_rcp_f32 v224, v224
v_rcp_f32 v225, v225
v_rcp_f32 v226, v226
v_rcp_f32 v227, v227
v_mul_f32 v104, v104, v220
v_mul_f32 v105, v105, v221
v_mfma_f32_32x32x16_bf16 v[176:191], a[248:251], a[124:127], v[176:191]
v_mul_f32 v106, v106, v222
v_mul_f32 v107, v107, v223
v_mul_f32 v108, v108, v224
v_mul_f32 v109, v109, v225
v_mul_f32 v110, v110, v226
v_mul_f32 v111, v111, v227
v_mfma_f32_32x32x16_bf16 v[192:207], a[252:255], a[124:127], v[192:207]
v_cvt_pk_bf16_f32 v228, v104, v105
v_cvt_pk_bf16_f32 v229, v106, v107
v_cvt_pk_bf16_f32 v230, v108, v109
v_cvt_pk_bf16_f32 v231, v110, v111
buffer_store_dwordx4 v[228:231], v28, s[96:99], 0 offen offset:1536 sc1
s_mov_b32 s32, 0x2a08c00
buffer_load_dwordx4 a[80:83], v232, s[96:99], s32 offen offset:0 sc1
buffer_load_dwordx4 a[84:87], v232, s[96:99], s32 offen offset:1024 sc1
buffer_load_dwordx4 a[88:91], v232, s[96:99], s32 offen offset:2048 sc1
buffer_load_dwordx4 a[92:95], v232, s[96:99], s32 offen offset:3072 sc1
buffer_load_dwordx4 a[96:99], v233, s[96:99], s32 offen offset:0 sc1
s_mov_b32 s32, 0x2a0a000
buffer_load_dwordx4 a[100:103], v232, s[96:99], s32 offen offset:0 sc1
buffer_load_dwordx4 a[104:107], v232, s[96:99], s32 offen offset:1024 sc1
buffer_load_dwordx4 a[108:111], v232, s[96:99], s32 offen offset:2048 sc1
buffer_load_dwordx4 a[112:115], v232, s[96:99], s32 offen offset:3072 sc1
buffer_load_dwordx4 a[116:119], v233, s[96:99], s32 offen offset:0 sc1
s_mov_b32 s32, 0x2a0b400
buffer_load_dwordx4 a[192:195], v232, s[96:99], s32 offen offset:0 sc1
buffer_load_dwordx4 a[196:199], v232, s[96:99], s32 offen offset:1024 sc1
buffer_load_dwordx4 a[200:203], v232, s[96:99], s32 offen offset:2048 sc1
buffer_load_dwordx4 a[204:207], v232, s[96:99], s32 offen offset:3072 sc1
buffer_load_dwordx4 a[208:211], v233, s[96:99], s32 offen offset:0 sc1
s_mov_b32 s32, 0x2a0c800
buffer_load_dwordx4 a[212:215], v232, s[96:99], s32 offen offset:0 sc1
buffer_load_dwordx4 a[216:219], v232, s[96:99], s32 offen offset:1024 sc1
buffer_load_dwordx4 a[220:223], v232, s[96:99], s32 offen offset:2048 sc1
buffer_load_dwordx4 a[224:227], v232, s[96:99], s32 offen offset:3072 sc1
buffer_load_dwordx4 a[228:231], v233, s[96:99], s32 offen offset:0 sc1
s_mov_b32 s32, 0x2a0dc00
buffer_load_dwordx4 a[232:235], v232, s[96:99], s32 offen offset:0 sc1
buffer_load_dwordx4 a[236:239], v232, s[96:99], s32 offen offset:1024 sc1
buffer_load_dwordx4 a[240:243], v232, s[96:99], s32 offen offset:2048 sc1
buffer_load_dwordx4 a[244:247], v232, s[96:99], s32 offen offset:3072 sc1
buffer_load_dwordx4 a[248:251], v233, s[96:99], s32 offen offset:0 sc1
ds_read_b128 v[36:39], v34 offset:0
ds_read_b128 v[40:43], v34 offset:16
ds_read_b128 v[44:47], v34 offset:256
ds_read_b128 v[48:51], v34 offset:272
ds_read_b128 v[52:55], v34 offset:512
ds_read_b128 v[56:59], v34 offset:528
ds_read_b128 v[60:63], v34 offset:768
ds_read_b128 v[64:67], v34 offset:784
s_waitcnt lgkmcnt(3)
v_fma_f32 v36, v36, v33, v52
v_fma_f32 v37, v37, v33, v53
v_fma_f32 v38, v38, v33, v54
v_fma_f32 v39, v39, v33, v55
s_waitcnt lgkmcnt(2)
v_fma_f32 v40, v40, v33, v56
v_fma_f32 v41, v41, v33, v57
v_fma_f32 v42, v42, v33, v58
v_fma_f32 v43, v43, v33, v59
v_fma_f32 v144, v144, v31, v36
v_fma_f32 v145, v145, v31, v37
v_fma_f32 v146, v146, v31, v38
v_fma_f32 v147, v147, v31, v39
v_fma_f32 v148, v148, v31, v40
v_fma_f32 v149, v149, v31, v41
v_fma_f32 v150, v150, v31, v42
v_fma_f32 v151, v151, v31, v43
s_waitcnt lgkmcnt(1)
v_fma_f32 v44, v44, v33, v60
v_fma_f32 v45, v45, v33, v61
v_fma_f32 v46, v46, v33, v62
v_fma_f32 v47, v47, v33, v63
s_waitcnt lgkmcnt(0)
v_fma_f32 v48, v48, v33, v64
v_fma_f32 v49, v49, v33, v65
v_fma_f32 v50, v50, v33, v66
v_fma_f32 v51, v51, v33, v67
v_fma_f32 v176, v176, v31, v44
v_fma_f32 v177, v177, v31, v45
v_fma_f32 v178, v178, v31, v46
v_fma_f32 v179, v179, v31, v47
v_fma_f32 v180, v180, v31, v48
v_fma_f32 v181, v181, v31, v49
v_fma_f32 v182, v182, v31, v50
v_fma_f32 v183, v183, v31, v51
v_mul_f32 v208, 0xbfb8aa3b, v144
v_mul_f32 v209, 0xbfb8aa3b, v145
v_mul_f32 v210, 0xbfb8aa3b, v146
v_mul_f32 v211, 0xbfb8aa3b, v147
v_mul_f32 v212, 0xbfb8aa3b, v148
v_mul_f32 v213, 0xbfb8aa3b, v149
v_mul_f32 v214, 0xbfb8aa3b, v150
v_mul_f32 v215, 0xbfb8aa3b, v151
v_exp_f32 v208, v208
v_exp_f32 v209, v209
v_exp_f32 v210, v210
v_exp_f32 v211, v211
v_exp_f32 v212, v212
v_exp_f32 v213, v213
v_exp_f32 v214, v214
v_exp_f32 v215, v215
v_mul_f32 v144, v144, v176
v_mul_f32 v145, v145, v177
v_mul_f32 v146, v146, v178
v_mul_f32 v147, v147, v179
v_mul_f32 v148, v148, v180
v_mul_f32 v149, v149, v181
v_mul_f32 v150, v150, v182
v_mul_f32 v151, v151, v183
v_add_f32 v208, 1.0, v208
v_add_f32 v209, 1.0, v209
v_add_f32 v210, 1.0, v210
v_add_f32 v211, 1.0, v211
v_add_f32 v212, 1.0, v212
v_add_f32 v213, 1.0, v213
v_add_f32 v214, 1.0, v214
v_add_f32 v215, 1.0, v215
v_rcp_f32 v208, v208
v_rcp_f32 v209, v209
v_rcp_f32 v210, v210
v_rcp_f32 v211, v211
v_rcp_f32 v212, v212
v_rcp_f32 v213, v213
v_rcp_f32 v214, v214
v_rcp_f32 v215, v215
v_mul_f32 v144, v144, v208
v_mul_f32 v145, v145, v209
v_mul_f32 v146, v146, v210
v_mul_f32 v147, v147, v211
v_mul_f32 v148, v148, v212
v_mul_f32 v149, v149, v213
v_mul_f32 v150, v150, v214
v_mul_f32 v151, v151, v215
v_cvt_pk_bf16_f32 v216, v144, v145
v_cvt_pk_bf16_f32 v217, v146, v147
v_cvt_pk_bf16_f32 v218, v148, v149
v_cvt_pk_bf16_f32 v219, v150, v151
buffer_store_dwordx4 v[216:219], v29, s[96:99], 0 offen offset:0 sc1
ds_read_b128 v[36:39], v34 offset:64
ds_read_b128 v[40:43], v34 offset:80
ds_read_b128 v[44:47], v34 offset:320
ds_read_b128 v[48:51], v34 offset:336
ds_read_b128 v[52:55], v34 offset:576
ds_read_b128 v[56:59], v34 offset:592
ds_read_b128 v[60:63], v34 offset:832
ds_read_b128 v[64:67], v34 offset:848
s_waitcnt lgkmcnt(3)
v_fma_f32 v36, v36, v33, v52
v_fma_f32 v37, v37, v33, v53
v_fma_f32 v38, v38, v33, v54
v_fma_f32 v39, v39, v33, v55
s_waitcnt lgkmcnt(2)
v_fma_f32 v40, v40, v33, v56
v_fma_f32 v41, v41, v33, v57
v_fma_f32 v42, v42, v33, v58
v_fma_f32 v43, v43, v33, v59
v_fma_f32 v152, v152, v31, v36
v_fma_f32 v153, v153, v31, v37
v_fma_f32 v154, v154, v31, v38
v_fma_f32 v155, v155, v31, v39
v_fma_f32 v156, v156, v31, v40
v_fma_f32 v157, v157, v31, v41
v_fma_f32 v158, v158, v31, v42
v_fma_f32 v159, v159, v31, v43
s_waitcnt lgkmcnt(1)
v_fma_f32 v44, v44, v33, v60
v_fma_f32 v45, v45, v33, v61
v_fma_f32 v46, v46, v33, v62
v_fma_f32 v47, v47, v33, v63
s_waitcnt lgkmcnt(0)
v_fma_f32 v48, v48, v33, v64
v_fma_f32 v49, v49, v33, v65
v_fma_f32 v50, v50, v33, v66
v_fma_f32 v51, v51, v33, v67
v_fma_f32 v184, v184, v31, v44
v_fma_f32 v185, v185, v31, v45
v_fma_f32 v186, v186, v31, v46
v_fma_f32 v187, v187, v31, v47
v_fma_f32 v188, v188, v31, v48
v_fma_f32 v189, v189, v31, v49
v_fma_f32 v190, v190, v31, v50
v_fma_f32 v191, v191, v31, v51
v_mul_f32 v220, 0xbfb8aa3b, v152
v_mul_f32 v221, 0xbfb8aa3b, v153
v_mul_f32 v222, 0xbfb8aa3b, v154
v_mul_f32 v223, 0xbfb8aa3b, v155
v_mul_f32 v224, 0xbfb8aa3b, v156
v_mul_f32 v225, 0xbfb8aa3b, v157
v_mul_f32 v226, 0xbfb8aa3b, v158
v_mul_f32 v227, 0xbfb8aa3b, v159
v_exp_f32 v220, v220
v_exp_f32 v221, v221
v_exp_f32 v222, v222
v_exp_f32 v223, v223
v_exp_f32 v224, v224
v_exp_f32 v225, v225
v_exp_f32 v226, v226
v_exp_f32 v227, v227
v_mul_f32 v152, v152, v184
v_mul_f32 v153, v153, v185
v_mul_f32 v154, v154, v186
v_mul_f32 v155, v155, v187
v_mul_f32 v156, v156, v188
v_mul_f32 v157, v157, v189
v_mul_f32 v158, v158, v190
v_mul_f32 v159, v159, v191
v_add_f32 v220, 1.0, v220
v_add_f32 v221, 1.0, v221
v_add_f32 v222, 1.0, v222
v_add_f32 v223, 1.0, v223
v_add_f32 v224, 1.0, v224
v_add_f32 v225, 1.0, v225
v_add_f32 v226, 1.0, v226
v_add_f32 v227, 1.0, v227
v_rcp_f32 v220, v220
v_rcp_f32 v221, v221
v_rcp_f32 v222, v222
v_rcp_f32 v223, v223
v_rcp_f32 v224, v224
v_rcp_f32 v225, v225
v_rcp_f32 v226, v226
v_rcp_f32 v227, v227
v_mul_f32 v152, v152, v220
v_mul_f32 v153, v153, v221
v_mul_f32 v154, v154, v222
v_mul_f32 v155, v155, v223
v_mul_f32 v156, v156, v224
v_mul_f32 v157, v157, v225
v_mul_f32 v158, v158, v226
v_mul_f32 v159, v159, v227
v_cvt_pk_bf16_f32 v228, v152, v153
v_cvt_pk_bf16_f32 v229, v154, v155
v_cvt_pk_bf16_f32 v230, v156, v157
v_cvt_pk_bf16_f32 v231, v158, v159
buffer_store_dwordx4 v[228:231], v29, s[96:99], 0 offen offset:512 sc1
ds_read_b128 v[36:39], v34 offset:128
ds_read_b128 v[40:43], v34 offset:144
ds_read_b128 v[44:47], v34 offset:384
ds_read_b128 v[48:51], v34 offset:400
ds_read_b128 v[52:55], v34 offset:640
ds_read_b128 v[56:59], v34 offset:656
ds_read_b128 v[60:63], v34 offset:896
ds_read_b128 v[64:67], v34 offset:912
s_waitcnt lgkmcnt(3)
v_fma_f32 v36, v36, v33, v52
v_fma_f32 v37, v37, v33, v53
v_fma_f32 v38, v38, v33, v54
v_fma_f32 v39, v39, v33, v55
s_waitcnt lgkmcnt(2)
v_fma_f32 v40, v40, v33, v56
v_fma_f32 v41, v41, v33, v57
v_fma_f32 v42, v42, v33, v58
v_fma_f32 v43, v43, v33, v59
v_fma_f32 v160, v160, v31, v36
v_fma_f32 v161, v161, v31, v37
v_fma_f32 v162, v162, v31, v38
v_fma_f32 v163, v163, v31, v39
v_fma_f32 v164, v164, v31, v40
v_fma_f32 v165, v165, v31, v41
v_fma_f32 v166, v166, v31, v42
v_fma_f32 v167, v167, v31, v43
s_waitcnt lgkmcnt(1)
v_fma_f32 v44, v44, v33, v60
v_fma_f32 v45, v45, v33, v61
v_fma_f32 v46, v46, v33, v62
v_fma_f32 v47, v47, v33, v63
s_waitcnt lgkmcnt(0)
v_fma_f32 v48, v48, v33, v64
v_fma_f32 v49, v49, v33, v65
v_fma_f32 v50, v50, v33, v66
v_fma_f32 v51, v51, v33, v67
v_fma_f32 v192, v192, v31, v44
v_fma_f32 v193, v193, v31, v45
v_fma_f32 v194, v194, v31, v46
v_fma_f32 v195, v195, v31, v47
v_fma_f32 v196, v196, v31, v48
v_fma_f32 v197, v197, v31, v49
v_fma_f32 v198, v198, v31, v50
v_fma_f32 v199, v199, v31, v51
v_mul_f32 v208, 0xbfb8aa3b, v160
v_mul_f32 v209, 0xbfb8aa3b, v161
v_mul_f32 v210, 0xbfb8aa3b, v162
v_mul_f32 v211, 0xbfb8aa3b, v163
v_mul_f32 v212, 0xbfb8aa3b, v164
v_mul_f32 v213, 0xbfb8aa3b, v165
v_mul_f32 v214, 0xbfb8aa3b, v166
v_mul_f32 v215, 0xbfb8aa3b, v167
v_exp_f32 v208, v208
v_exp_f32 v209, v209
v_exp_f32 v210, v210
v_exp_f32 v211, v211
v_exp_f32 v212, v212
v_exp_f32 v213, v213
v_exp_f32 v214, v214
v_exp_f32 v215, v215
v_mul_f32 v160, v160, v192
v_mul_f32 v161, v161, v193
v_mul_f32 v162, v162, v194
v_mul_f32 v163, v163, v195
v_mul_f32 v164, v164, v196
v_mul_f32 v165, v165, v197
v_mul_f32 v166, v166, v198
v_mul_f32 v167, v167, v199
v_add_f32 v208, 1.0, v208
v_add_f32 v209, 1.0, v209
v_add_f32 v210, 1.0, v210
v_add_f32 v211, 1.0, v211
v_add_f32 v212, 1.0, v212
v_add_f32 v213, 1.0, v213
v_add_f32 v214, 1.0, v214
v_add_f32 v215, 1.0, v215
v_rcp_f32 v208, v208
v_rcp_f32 v209, v209
v_rcp_f32 v210, v210
v_rcp_f32 v211, v211
v_rcp_f32 v212, v212
v_rcp_f32 v213, v213
v_rcp_f32 v214, v214
v_rcp_f32 v215, v215
v_mul_f32 v160, v160, v208
v_mul_f32 v161, v161, v209
v_mul_f32 v162, v162, v210
v_mul_f32 v163, v163, v211
v_mul_f32 v164, v164, v212
v_mul_f32 v165, v165, v213
v_mul_f32 v166, v166, v214
v_mul_f32 v167, v167, v215
v_cvt_pk_bf16_f32 v216, v160, v161
v_cvt_pk_bf16_f32 v217, v162, v163
v_cvt_pk_bf16_f32 v218, v164, v165
v_cvt_pk_bf16_f32 v219, v166, v167
buffer_store_dwordx4 v[216:219], v29, s[96:99], 0 offen offset:1024 sc1
ds_read_b128 v[36:39], v34 offset:192
ds_read_b128 v[40:43], v34 offset:208
ds_read_b128 v[44:47], v34 offset:448
ds_read_b128 v[48:51], v34 offset:464
ds_read_b128 v[52:55], v34 offset:704
ds_read_b128 v[56:59], v34 offset:720
ds_read_b128 v[60:63], v34 offset:960
ds_read_b128 v[64:67], v34 offset:976
s_waitcnt lgkmcnt(3)
v_fma_f32 v36, v36, v33, v52
v_fma_f32 v37, v37, v33, v53
v_fma_f32 v38, v38, v33, v54
v_fma_f32 v39, v39, v33, v55
s_waitcnt lgkmcnt(2)
v_fma_f32 v40, v40, v33, v56
v_fma_f32 v41, v41, v33, v57
v_fma_f32 v42, v42, v33, v58
v_fma_f32 v43, v43, v33, v59
v_fma_f32 v168, v168, v31, v36
v_fma_f32 v169, v169, v31, v37
v_fma_f32 v170, v170, v31, v38
v_fma_f32 v171, v171, v31, v39
v_fma_f32 v172, v172, v31, v40
v_fma_f32 v173, v173, v31, v41
v_fma_f32 v174, v174, v31, v42
v_fma_f32 v175, v175, v31, v43
s_waitcnt lgkmcnt(1)
v_fma_f32 v44, v44, v33, v60
v_fma_f32 v45, v45, v33, v61
v_fma_f32 v46, v46, v33, v62
v_fma_f32 v47, v47, v33, v63
s_waitcnt lgkmcnt(0)
v_fma_f32 v48, v48, v33, v64
v_fma_f32 v49, v49, v33, v65
v_fma_f32 v50, v50, v33, v66
v_fma_f32 v51, v51, v33, v67
v_fma_f32 v200, v200, v31, v44
v_fma_f32 v201, v201, v31, v45
v_fma_f32 v202, v202, v31, v46
v_fma_f32 v203, v203, v31, v47
v_fma_f32 v204, v204, v31, v48
v_fma_f32 v205, v205, v31, v49
v_fma_f32 v206, v206, v31, v50
v_fma_f32 v207, v207, v31, v51
v_mul_f32 v220, 0xbfb8aa3b, v168
v_mul_f32 v221, 0xbfb8aa3b, v169
v_mul_f32 v222, 0xbfb8aa3b, v170
v_mul_f32 v223, 0xbfb8aa3b, v171
v_mul_f32 v224, 0xbfb8aa3b, v172
v_mul_f32 v225, 0xbfb8aa3b, v173
v_mul_f32 v226, 0xbfb8aa3b, v174
v_mul_f32 v227, 0xbfb8aa3b, v175
v_exp_f32 v220, v220
v_exp_f32 v221, v221
v_exp_f32 v222, v222
v_exp_f32 v223, v223
v_exp_f32 v224, v224
v_exp_f32 v225, v225
v_exp_f32 v226, v226
v_exp_f32 v227, v227
v_mul_f32 v168, v168, v200
v_mul_f32 v169, v169, v201
v_mul_f32 v170, v170, v202
v_mul_f32 v171, v171, v203
v_mul_f32 v172, v172, v204
v_mul_f32 v173, v173, v205
v_mul_f32 v174, v174, v206
v_mul_f32 v175, v175, v207
v_add_f32 v220, 1.0, v220
v_add_f32 v221, 1.0, v221
v_add_f32 v222, 1.0, v222
v_add_f32 v223, 1.0, v223
v_add_f32 v224, 1.0, v224
v_add_f32 v225, 1.0, v225
v_add_f32 v226, 1.0, v226
v_add_f32 v227, 1.0, v227
v_rcp_f32 v220, v220
v_rcp_f32 v221, v221
v_rcp_f32 v222, v222
v_rcp_f32 v223, v223
v_rcp_f32 v224, v224
v_rcp_f32 v225, v225
v_rcp_f32 v226, v226
v_rcp_f32 v227, v227
v_mul_f32 v168, v168, v220
v_mul_f32 v169, v169, v221
v_mul_f32 v170, v170, v222
v_mul_f32 v171, v171, v223
v_mul_f32 v172, v172, v224
v_mul_f32 v173, v173, v225
v_mul_f32 v174, v174, v226
v_mul_f32 v175, v175, v227
v_cvt_pk_bf16_f32 v228, v168, v169
v_cvt_pk_bf16_f32 v229, v170, v171
v_cvt_pk_bf16_f32 v230, v172, v173
v_cvt_pk_bf16_f32 v231, v174, v175
buffer_store_dwordx4 v[228:231], v29, s[96:99], 0 offen offset:1536 sc1
s_waitcnt vmcnt(0)
s_barrier
s_cmp_lg_u32 s100, 0
s_cbranch_scc1 L_sig10
s_mov_b64 exec, 1
v_mov_b32 v8, 1
v_mov_b32 v9, 49422336
v_mov_b32 v10, 1
buffer_atomic_add v8, v9, s[96:99], s37 offen sc0
s_waitcnt vmcnt(0)
v_cmp_eq_u32 vcc, 26, v8
v_mov_b32 v11, 0x40000000
s_nop 0
v_cndmask_b32 v9, v11, v9, vcc
v_add_u32 v9, 34816, v9
buffer_store_dword v10, v9, s[96:99], s37 offen sc1
s_mov_b64 exec, -1
L_sig10:
s_branch L_ffn1_end
L_ffn1_skip:
s_mov_b32 s32, 0x2a00000
buffer_load_dwordx4 a[128:131], v232, s[96:99], s32 offen offset:0 sc1
buffer_load_dwordx4 a[132:135], v232, s[96:99], s32 offen offset:1024 sc1
buffer_load_dwordx4 a[136:139], v232, s[96:99], s32 offen offset:2048 sc1
buffer_load_dwordx4 a[140:143], v232, s[96:99], s32 offen offset:3072 sc1
buffer_load_dwordx4 a[144:147], v233, s[96:99], s32 offen offset:0 sc1
s_mov_b32 s32, 0x2a01400
buffer_load_dwordx4 a[148:151], v232, s[96:99], s32 offen offset:0 sc1
buffer_load_dwordx4 a[152:155], v232, s[96:99], s32 offen offset:1024 sc1
buffer_load_dwordx4 a[156:159], v232, s[96:99], s32 offen offset:2048 sc1
buffer_load_dwordx4 a[160:163], v232, s[96:99], s32 offen offset:3072 sc1
buffer_load_dwordx4 a[164:167], v233, s[96:99], s32 offen offset:0 sc1
s_mov_b32 s32, 0x2a02800
buffer_load_dwordx4 a[168:171], v232, s[96:99], s32 offen offset:0 sc1
buffer_load_dwordx4 a[172:175], v232, s[96:99], s32 offen offset:1024 sc1
buffer_load_dwordx4 a[176:179], v232, s[96:99], s32 offen offset:2048 sc1
buffer_load_dwordx4 a[180:183], v232, s[96:99], s32 offen offset:3072 sc1
buffer_load_dwordx4 a[184:187], v233, s[96:99], s32 offen offset:0 sc1
s_mov_b32 s32, 0x2a03c00
s_add_u32 m0, s28, 0
s_nop 0
buffer_load_dwordx4 v232, s[96:99], s32 offen offset:0 sc1 lds
buffer_load_dwordx4 v232, s[96:99], s32 offen offset:1024 sc1 lds
buffer_load_dwordx4 v232, s[96:99], s32 offen offset:2048 sc1 lds
buffer_load_dwordx4 v232, s[96:99], s32 offen offset:3072 sc1 lds
s_add_u32 m0, s28, 4096
s_nop 0
buffer_load_dwordx4 v233, s[96:99], s32 offen offset:0 sc1 lds
s_mov_b32 s32, 0x2a05000
s_add_u32 m0, s28, 5120
s_nop 0
buffer_load_dwordx4 v232, s[96:99], s32 offen offset:0 sc1 lds
buffer_load_dwordx4 v232, s[96:99], s32 offen offset:1024 sc1 lds
buffer_load_dwordx4 v232, s[96:99], s32 offen offset:2048 sc1 lds
buffer_load_dwordx4 v232, s[96:99], s32 offen offset:3072 sc1 lds
s_add_u32 m0, s28, 9216
s_nop 0
buffer_load_dwordx4 v233, s[96:99], s32 offen offset:0 sc1 lds
s_mov_b32 s32, 0x2a06400
s_add_u32 m0, s28, 10240
s_nop 0
buffer_load_dwordx4 v232, s[96:99], s32 offen offset:0 sc1 lds
buffer_load_dwordx4 v232, s[96:99], s32 offen offset:1024 sc1 lds
buffer_load_dwordx4 v232, s[96:99], s32 offen offset:2048 sc1 lds
buffer_load_dwordx4 v232, s[96:99], s32 offen offset:3072 sc1 lds
s_add_u32 m0, s28, 14336
s_nop 0
buffer_load_dwordx4 v233, s[96:99], s32 offen offset:0 sc1 lds
s_mov_b32 s32, 0x2a07800
s_add_u32 m0, s28, 15360
s_nop 0
buffer_load_dwordx4 v232, s[96:99], s32 offen offset:0 sc1 lds
buffer_load_dwordx4 v232, s[96:99], s32 offen offset:1024 sc1 lds
buffer_load_dwordx4 v232, s[96:99], s32 offen offset:2048 sc1 lds
buffer_load_dwordx4 v232, s[96:99], s32 offen offset:3072 sc1 lds
s_add_u32 m0, s28, 19456
s_nop 0
buffer_load_dwordx4 v233, s[96:99], s32 offen offset:0 sc1 lds
s_mov_b32 s32, 0x2a08c00
buffer_load_dwordx4 a[80:83], v232, s[96:99], s32 offen offset:0 sc1
buffer_load_dwordx4 a[84:87], v232, s[96:99], s32 offen offset:1024 sc1
buffer_load_dwordx4 a[88:91], v232, s[96:99], s32 offen offset:2048 sc1
buffer_load_dwordx4 a[92:95], v232, s[96:99], s32 offen offset:3072 sc1
buffer_load_dwordx4 a[96:99], v233, s[96:99], s32 offen offset:0 sc1
s_mov_b32 s32, 0x2a0a000
buffer_load_dwordx4 a[100:103], v232, s[96:99], s32 offen offset:0 sc1
buffer_load_dwordx4 a[104:107], v232, s[96:99], s32 offen offset:1024 sc1
buffer_load_dwordx4 a[108:111], v232, s[96:99], s32 offen offset:2048 sc1
buffer_load_dwordx4 a[112:115], v232, s[96:99], s32 offen offset:3072 sc1
buffer_load_dwordx4 a[116:119], v233, s[96:99], s32 offen offset:0 sc1
s_mov_b32 s32, 0x2a0b400
buffer_load_dwordx4 a[192:195], v232, s[96:99], s32 offen offset:0 sc1
buffer_load_dwordx4 a[196:199], v232, s[96:99], s32 offen offset:1024 sc1
buffer_load_dwordx4 a[200:203], v232, s[96:99], s32 offen offset:2048 sc1
buffer_load_dwordx4 a[204:207], v232, s[96:99], s32 offen offset:3072 sc1
buffer_load_dwordx4 a[208:211], v233, s[96:99], s32 offen offset:0 sc1
s_mov_b32 s32, 0x2a0c800
buffer_load_dwordx4 a[212:215], v232, s[96:99], s32 offen offset:0 sc1
buffer_load_dwordx4 a[216:219], v232, s[96:99], s32 offen offset:1024 sc1
buffer_load_dwordx4 a[220:223], v232, s[96:99], s32 offen offset:2048 sc1
buffer_load_dwordx4 a[224:227], v232, s[96:99], s32 offen offset:3072 sc1
buffer_load_dwordx4 a[228:231], v233, s[96:99], s32 offen offset:0 sc1
s_mov_b32 s32, 0x2a0dc00
buffer_load_dwordx4 a[232:235], v232, s[96:99], s32 offen offset:0 sc1
buffer_load_dwordx4 a[236:239], v232, s[96:99], s32 offen offset:1024 sc1
buffer_load_dwordx4 a[240:243], v232, s[96:99], s32 offen offset:2048 sc1
buffer_load_dwordx4 a[244:247], v232, s[96:99], s32 offen offset:3072 sc1
buffer_load_dwordx4 a[248:251], v233, s[96:99], s32 offen offset:0 sc1
L_ffn1_end:
s_mov_b32 s32, 0x2a0f000
s_add_u32 m0, s38, 0
s_nop 0
buffer_load_dwordx4 v232, s[96:99], s32 offen offset:0 sc1 lds
buffer_load_dwordx4 v232, s[96:99], s32 offen offset:1024 sc1 lds
buffer_load_dwordx4 v232, s[96:99], s32 offen offset:2048 sc1 lds
buffer_load_dwordx4 v232, s[96:99], s32 offen offset:3072 sc1 lds
s_add_u32 m0, s38, 4096
s_nop 0
buffer_load_dwordx4 v233, s[96:99], s32 offen offset:0 sc1 lds
s_mov_b32 s32, 0x2a10400
s_add_u32 s32, s32, s39
s_add_u32 m0, s38, 5120
s_nop 0
buffer_load_dwordx4 v232, s[96:99], s32 offen offset:0 sc1 lds
buffer_load_dwordx4 v232, s[96:99], s32 offen offset:1024 sc1 lds
buffer_load_dwordx4 v232, s[96:99], s32 offen offset:2048 sc1 lds
buffer_load_dwordx4 v232, s[96:99], s32 offen offset:3072 sc1 lds
s_add_u32 m0, s38, 9216
s_nop 0
buffer_load_dwordx4 v233, s[96:99], s32 offen offset:0 sc1 lds
s_load_dwordx2 s[40:41], s[0:1], 88
s_and_b32 s5, s2, 1
s_lshl_b32 s5, s5, 2
s_bfe_u32 s6, s2, 0x20003
s_add_u32 s5, s5, s6
s_lshl_b32 s5, s5, 1
s_bfe_u32 s6, s2, 0x10002
s_add_u32 s5, s5, s6
s_lshl_b32 s5, s5, 1
s_lshr_b32 s6, s2, 7
s_add_u32 s5, s5, s6
s_bfe_u32 s6, s2, 0x10001
s_lshl_b32 s6, s6, 2
s_bfe_u32 s7, s2, 0x20005
s_add_u32 s6, s6, s7
s_mul_i32 s30, s100, 14
s_lshr_b32 s37, s5, 2
s_mul_i32 s37, s37, 4352
s_cmp_eq_u32 s100, 3
s_cselect_b32 s7, 1, 0
s_sub_u32 s30, s30, s7
v_lshlrev_b32 v3, 4, v2
s_mul_i32 s7, s5, 216
s_add_u32 s7, s7, s30
s_lshl_b32 s7, s7, 10
v_add_u32 v22, s7, v3
v_add_u32 v19, s28, v3
v_add_u32 v20, s38, v3
s_mov_b32 s48, 0x1800000
s_mov_b32 s49, 0x180d800
s_mov_b32 s50, 0x181b000
s_mov_b32 s51, 0x1828800
v_mov_b32 v63, 0
v_lshrrev_b32 v23, 2, v0
s_lshl_b32 s7, s5, 6
v_add_u32 v27, s7, v23
v_and_b32 v28, 3, v0
v_mul_u32_u24 v24, 1280, v27
v_lshl_add_u32 v24, v28, 4, v24
s_mul_i32 s7, s6, 160
v_add_u32 v24, s7, v24
s_mul_i32 s7, s6, 10
v_add_u32 v29, s7, v28
v_lshrrev_b32 v25, 5, v27
v_mul_u32_u24 v25, 40960, v25
v_lshl_add_u32 v25, v29, 9, v25
v_and_b32 v30, 31, v27
v_lshl_add_u32 v25, v30, 4, v25
v_lshlrev_b32 v26, 5, v29
v_cmp_gt_u32 vcc, 2, v28
v_mov_b32 v31, 0x40000000
s_nop 0
v_cndmask_b32 v31, v31, v63, vcc
v_add_u32 v32, v24, v31
v_add_u32 v33, v25, v31
v_add_u32 v34, v26, v31
s_mov_b32 s53, 0x1401000
s_mov_b32 s54, 12800
s_mov_b32 s42, 0x1400000
s_waitcnt lgkmcnt(0)
s_mov_b32 s24, s40
s_mov_b32 s25, s41
s_mov_b32 s26, 0x280000
s_mov_b32 s27, 0x20000
buffer_load_dwordx4 v[188:191], v26, s[96:99], s54 offen offset:0 sc1
buffer_load_dwordx4 v[192:195], v26, s[96:99], s54 offen offset:16 sc1
buffer_load_dwordx4 v[196:199], v26, s[96:99], s54 offen offset:128 sc1
buffer_load_dwordx4 v[200:203], v26, s[96:99], s54 offen offset:144 sc1
buffer_load_dwordx4 v[204:207], v34, s[96:99], s54 offen offset:256 sc1
buffer_load_dwordx4 v[208:211], v34, s[96:99], s54 offen offset:272 sc1
v_mov_b32 v56, 49457152
s_mov_b32 s101, 0
L_poll11:
buffer_load_dword v57, v56, s[96:99], s37 offen sc1
s_add_u32 s101, s101, 1
s_waitcnt vmcnt(0)
v_cmp_gt_u32 vcc, 1, v57
s_nop 0
s_cbranch_vccz L_poll11_go
s_sleep 2
s_cmp_lt_u32 s101, 0x20000
s_cbranch_scc1 L_poll11
L_poll11_go:
buffer_load_dwordx4 v[64:67], v22, s[96:99], s48 offen offset:0 sc1
buffer_load_dwordx4 v[68:71], v22, s[96:99], s49 offen offset:0 sc1
buffer_load_dwordx4 v[72:75], v22, s[96:99], s50 offen offset:0 sc1
buffer_load_dwordx4 v[76:79], v22, s[96:99], s51 offen offset:0 sc1
buffer_load_dwordx4 v[80:83], v22, s[96:99], s48 offen offset:1024 sc1
buffer_load_dwordx4 v[84:87], v22, s[96:99], s49 offen offset:1024 sc1
buffer_load_dwordx4 v[88:91], v22, s[96:99], s50 offen offset:1024 sc1
buffer_load_dwordx4 v[92:95], v22, s[96:99], s51 offen offset:1024 sc1
buffer_load_dwordx4 v[96:99], v22, s[96:99], s48 offen offset:2048 sc1
buffer_load_dwordx4 v[100:103], v22, s[96:99], s49 offen offset:2048 sc1
buffer_load_dwordx4 v[104:107], v22, s[96:99], s50 offen offset:2048 sc1
buffer_load_dwordx4 v[108:111], v22, s[96:99], s51 offen offset:2048 sc1
buffer_load_dwordx4 v[112:115], v22, s[96:99], s48 offen offset:3072 sc1
buffer_load_dwordx4 v[116:119], v22, s[96:99], s49 offen offset:3072 sc1
buffer_load_dwordx4 v[120:123], v22, s[96:99], s50 offen offset:3072 sc1
buffer_load_dwordx4 v[124:127], v22, s[96:99], s51 offen offset:3072 sc1
v_add_u32 v22, 4096, v22
buffer_load_dwordx4 v[128:131], v22, s[96:99], s48 offen offset:0 sc1
buffer_load_dwordx4 v[132:135], v22, s[96:99], s49 offen offset:0 sc1
buffer_load_dwordx4 v[136:139], v22, s[96:99], s50 offen offset:0 sc1
buffer_load_dwordx4 v[140:143], v22, s[96:99], s51 offen offset:0 sc1
buffer_load_dwordx4 v[144:147], v22, s[96:99], s48 offen offset:1024 sc1
buffer_load_dwordx4 v[148:151], v22, s[96:99], s49 offen offset:1024 sc1
buffer_load_dwordx4 v[152:155], v22, s[96:99], s50 offen offset:1024 sc1
buffer_load_dwordx4 v[156:159], v22, s[96:99], s51 offen offset:1024 sc1
buffer_load_dwordx4 v[176:179], v25, s[96:99], s42 offen offset:0 sc1
buffer_load_dwordx4 v[180:183], v25, s[96:99], s42 offen offset:2048 sc1
buffer_load_dwordx4 v[184:187], v33, s[96:99], s53 offen offset:0 sc1
s_waitcnt vmcnt(26)
v_mfma_f32_16x16x32_bf16 a[0:3], a[128:131], v[64:67], 0
buffer_load_dwordx4 v[160:163], v22, s[96:99], s48 offen offset:2048 sc1
s_waitcnt vmcnt(26)
v_mfma_f32_16x16x32_bf16 a[20:23], a[128:131], v[68:71], 0
s_waitcnt vmcnt(25)
v_mfma_f32_16x16x32_bf16 a[40:43], a[128:131], v[72:75], 0
s_waitcnt vmcnt(24)
v_mfma_f32_16x16x32_bf16 a[60:63], a[128:131], v[76:79], 0
v_mfma_f32_16x16x32_bf16 a[4:7], a[132:135], v[64:67], 0
v_mfma_f32_16x16x32_bf16 a[24:27], a[132:135], v[68:71], 0
buffer_load_dwordx4 v[164:167], v22, s[96:99], s49 offen offset:2048 sc1
v_mfma_f32_16x16x32_bf16 a[44:47], a[132:135], v[72:75], 0
v_mfma_f32_16x16x32_bf16 a[64:67], a[132:135], v[76:79], 0
v_mfma_f32_16x16x32_bf16 a[8:11], a[136:139], v[64:67], 0
v_mfma_f32_16x16x32_bf16 a[28:31], a[136:139], v[68:71], 0
v_mfma_f32_16x16x32_bf16 a[48:51], a[136:139], v[72:75], 0
buffer_load_dwordx4 v[168:171], v22, s[96:99], s50 offen offset:2048 sc1
v_mfma_f32_16x16x32_bf16 a[68:71], a[136:139], v[76:79], 0
v_mfma_f32_16x16x32_bf16 a[12:15], a[140:143], v[64:67], 0
v_mfma_f32_16x16x32_bf16 a[32:35], a[140:143], v[68:71], 0
v_mfma_f32_16x16x32_bf16 a[52:55], a[140:143], v[72:75], 0
v_mfma_f32_16x16x32_bf16 a[72:75], a[140:143], v[76:79], 0
buffer_load_dwordx4 v[172:175], v22, s[96:99], s51 offen offset:2048 sc1
v_mfma_f32_16x16x32_bf16 a[16:19], a[144:147], v[64:67], 0
v_mfma_f32_16x16x32_bf16 a[36:39], a[144:147], v[68:71], 0
v_mfma_f32_16x16x32_bf16 a[56:59], a[144:147], v[72:75], 0
v_mfma_f32_16x16x32_bf16 a[76:79], a[144:147], v[76:79], 0
s_waitcnt vmcnt(26)
v_mfma_f32_16x16x32_bf16 a[0:3], a[148:151], v[80:83], a[0:3]
buffer_load_dwordx4 v[64:67], v22, s[96:99], s48 offen offset:3072 sc1
s_waitcnt vmcnt(26)
v_mfma_f32_16x16x32_bf16 a[20:23], a[148:151], v[84:87], a[20:23]
s_waitcnt vmcnt(25)
v_mfma_f32_16x16x32_bf16 a[40:43], a[148:151], v[88:91], a[40:43]
s_waitcnt vmcnt(24)
v_mfma_f32_16x16x32_bf16 a[60:63], a[148:151], v[92:95], a[60:63]
v_mfma_f32_16x16x32_bf16 a[4:7], a[152:155], v[80:83], a[4:7]
v_mfma_f32_16x16x32_bf16 a[24:27], a[152:155], v[84:87], a[24:27]
buffer_load_dwordx4 v[68:71], v22, s[96:99], s49 offen offset:3072 sc1
v_mfma_f32_16x16x32_bf16 a[44:47], a[152:155], v[88:91], a[44:47]
v_mfma_f32_16x16x32_bf16 a[64:67], a[152:155], v[92:95], a[64:67]
v_mfma_f32_16x16x32_bf16 a[8:11], a[156:159], v[80:83], a[8:11]
v_mfma_f32_16x16x32_bf16 a[28:31], a[156:159], v[84:87], a[28:31]
v_mfma_f32_16x16x32_bf16 a[48:51], a[156:159], v[88:91], a[48:51]
buffer_load_dwordx4 v[72:75], v22, s[96:99], s50 offen offset:3072 sc1
v_mfma_f32_16x16x32_bf16 a[68:71], a[156:159], v[92:95], a[68:71]
v_mfma_f32_16x16x32_bf16 a[12:15], a[160:163], v[80:83], a[12:15]
v_mfma_f32_16x16x32_bf16 a[32:35], a[160:163], v[84:87], a[32:35]
v_mfma_f32_16x16x32_bf16 a[52:55], a[160:163], v[88:91], a[52:55]
v_mfma_f32_16x16x32_bf16 a[72:75], a[160:163], v[92:95], a[72:75]
buffer_load_dwordx4 v[76:79], v22, s[96:99], s51 offen offset:3072 sc1
v_mfma_f32_16x16x32_bf16 a[16:19], a[164:167], v[80:83], a[16:19]
v_mfma_f32_16x16x32_bf16 a[36:39], a[164:167], v[84:87], a[36:39]
v_mfma_f32_16x16x32_bf16 a[56:59], a[164:167], v[88:91], a[56:59]
v_mfma_f32_16x16x32_bf16 a[76:79], a[164:167], v[92:95], a[76:79]
s_waitcnt vmcnt(26)
v_mfma_f32_16x16x32_bf16 a[0:3], a[168:171], v[96:99], a[0:3]
v_add_u32 v22, 4096, v22
s_waitcnt vmcnt(25)
v_mfma_f32_16x16x32_bf16 a[20:23], a[168:171], v[100:103], a[20:23]
s_waitcnt vmcnt(24)
v_mfma_f32_16x16x32_bf16 a[40:43], a[168:171], v[104:107], a[40:43]
s_waitcnt vmcnt(23)
v_mfma_f32_16x16x32_bf16 a[60:63], a[168:171], v[108:111], a[60:63]
v_mfma_f32_16x16x32_bf16 a[4:7], a[172:175], v[96:99], a[4:7]
buffer_load_dwordx4 v[80:83], v22, s[96:99], s48 offen offset:0 sc1
ds_read_b128 v[36:39], v19 offset:0
v_mfma_f32_16x16x32_bf16 a[24:27], a[172:175], v[100:103], a[24:27]
v_mfma_f32_16x16x32_bf16 a[44:47], a[172:175], v[104:107], a[44:47]
ds_read_b128 v[40:43], v19 offset:1024
v_mfma_f32_16x16x32_bf16 a[64:67], a[172:175], v[108:111], a[64:67]
v_mfma_f32_16x16x32_bf16 a[8:11], a[176:179], v[96:99], a[8:11]
buffer_load_dwordx4 v[84:87], v22, s[96:99], s49 offen offset:0 sc1
ds_read_b128 v[44:47], v19 offset:2048
v_mfma_f32_16x16x32_bf16 a[28:31], a[176:179], v[100:103], a[28:31]
v_mfma_f32_16x16x32_bf16 a[48:51], a[176:179], v[104:107], a[48:51]
v_mfma_f32_16x16x32_bf16 a[68:71], a[176:179], v[108:111], a[68:71]
ds_read_b128 v[48:51], v19 offset:3072
v_mfma_f32_16x16x32_bf16 a[12:15], a[180:183], v[96:99], a[12:15]
buffer_load_dwordx4 v[88:91], v22, s[96:99], s50 offen offset:0 sc1
v_mfma_f32_16x16x32_bf16 a[32:35], a[180:183], v[100:103], a[32:35]
ds_read_b128 v[52:55], v19 offset:4096
v_mfma_f32_16x16x32_bf16 a[52:55], a[180:183], v[104:107], a[52:55]
v_mfma_f32_16x16x32_bf16 a[72:75], a[180:183], v[108:111], a[72:75]
v_mfma_f32_16x16x32_bf16 a[16:19], a[184:187], v[96:99], a[16:19]
buffer_load_dwordx4 v[92:95], v22, s[96:99], s51 offen offset:0 sc1
v_mfma_f32_16x16x32_bf16 a[36:39], a[184:187], v[100:103], a[36:39]
v_mfma_f32_16x16x32_bf16 a[56:59], a[184:187], v[104:107], a[56:59]
v_mfma_f32_16x16x32_bf16 a[76:79], a[184:187], v[108:111], a[76:79]
s_waitcnt vmcnt(26) lgkmcnt(2)
v_mfma_f32_16x16x32_bf16 a[0:3], v[36:39], v[112:115], a[0:3]
buffer_load_dwordx4 v[96:99], v22, s[96:99], s48 offen offset:1024 sc1
s_waitcnt vmcnt(26)
v_mfma_f32_16x16x32_bf16 a[20:23], v[36:39], v[116:119], a[20:23]
s_waitcnt vmcnt(25)
v_mfma_f32_16x16x32_bf16 a[40:43], v[36:39], v[120:123], a[40:43]
s_waitcnt vmcnt(24)
v_mfma_f32_16x16x32_bf16 a[60:63], v[36:39], v[124:127], a[60:63]
v_mfma_f32_16x16x32_bf16 a[4:7], v[40:43], v[112:115], a[4:7]
ds_read_b128 v[212:215], v19 offset:5120
v_mfma_f32_16x16x32_bf16 a[24:27], v[40:43], v[116:119], a[24:27]
buffer_load_dwordx4 v[100:103], v22, s[96:99], s49 offen offset:1024 sc1
v_mfma_f32_16x16x32_bf16 a[44:47], v[40:43], v[120:123], a[44:47]
ds_read_b128 v[216:219], v19 offset:6144
v_mfma_f32_16x16x32_bf16 a[64:67], v[40:43], v[124:127], a[64:67]
v_mfma_f32_16x16x32_bf16 a[8:11], v[44:47], v[112:115], a[8:11]
ds_read_b128 v[220:223], v19 offset:7168
v_mfma_f32_16x16x32_bf16 a[28:31], v[44:47], v[116:119], a[28:31]
v_mfma_f32_16x16x32_bf16 a[48:51], v[44:47], v[120:123], a[48:51]
buffer_load_dwordx4 v[104:107], v22, s[96:99], s50 offen offset:1024 sc1
v_mfma_f32_16x16x32_bf16 a[68:71], v[44:47], v[124:127], a[68:71]
ds_read_b128 v[224:227], v19 offset:8192
s_waitcnt lgkmcnt(4)
v_mfma_f32_16x16x32_bf16 a[12:15], v[48:51], v[112:115], a[12:15]
v_mfma_f32_16x16x32_bf16 a[32:35], v[48:51], v[116:119], a[32:35]
ds_read_b128 v[228:231], v19 offset:9216
v_mfma_f32_16x16x32_bf16 a[52:55], v[48:51], v[120:123], a[52:55]
v_mfma_f32_16x16x32_bf16 a[72:75], v[48:51], v[124:127], a[72:75]
buffer_load_dwordx4 v[108:111], v22, s[96:99], s51 offen offset:1024 sc1
v_mfma_f32_16x16x32_bf16 a[16:19], v[52:55], v[112:115], a[16:19]
v_mfma_f32_16x16x32_bf16 a[36:39], v[52:55], v[116:119], a[36:39]
v_mfma_f32_16x16x32_bf16 a[56:59], v[52:55], v[120:123], a[56:59]
v_mfma_f32_16x16x32_bf16 a[76:79], v[52:55], v[124:127], a[76:79]
s_waitcnt vmcnt(26) lgkmcnt(2)
v_mfma_f32_16x16x32_bf16 a[0:3], v[212:215], v[128:131], a[0:3]
buffer_load_dwordx4 v[112:115], v22, s[96:99], s48 offen offset:2048 sc1
s_waitcnt vmcnt(26)
v_mfma_f32_16x16x32_bf16 a[20:23], v[212:215], v[132:135], a[20:23]
s_waitcnt vmcnt(25)
v_mfma_f32_16x16x32_bf16 a[40:43], v[212:215], v[136:139], a[40:43]
s_waitcnt vmcnt(24)
v_mfma_f32_16x16x32_bf16 a[60:63], v[212:215], v[140:143], a[60:63]
v_mfma_f32_16x16x32_bf16 a[4:7], v[216:219], v[128:131], a[4:7]
ds_read_b128 v[36:39], v19 offset:10240
v_mfma_f32_16x16x32_bf16 a[24:27], v[216:219], v[132:135], a[24:27]
buffer_load_dwordx4 v[116:119], v22, s[96:99], s49 offen offset:2048 sc1
v_mfma_f32_16x16x32_bf16 a[44:47], v[216:219], v[136:139], a[44:47]
ds_read_b128 v[40:43], v19 offset:11264
v_mfma_f32_16x16x32_bf16 a[64:67], v[216:219], v[140:143], a[64:67]
v_mfma_f32_16x16x32_bf16 a[8:11], v[220:223], v[128:131], a[8:11]
ds_read_b128 v[44:47], v19 offset:12288
v_mfma_f32_16x16x32_bf16 a[28:31], v[220:223], v[132:135], a[28:31]
v_mfma_f32_16x16x32_bf16 a[48:51], v[220:223], v[136:139], a[48:51]
buffer_load_dwordx4 v[120:123], v22, s[96:99], s50 offen offset:2048 sc1
v_mfma_f32_16x16x32_bf16 a[68:71], v[220:223], v[140:143], a[68:71]
ds_read_b128 v[48:51], v19 offset:13312
s_waitcnt lgkmcnt(4)
v_mfma_f32_16x16x32_bf16 a[12:15], v[224:227], v[128:131], a[12:15]
v_mfma_f32_16x16x32_bf16 a[32:35], v[224:227], v[132:135], a[32:35]
ds_read_b128 v[52:55], v19 offset:14336
v_mfma_f32_16x16x32_bf16 a[52:55], v[224:227], v[136:139], a[52:55]
v_mfma_f32_16x16x32_bf16 a[72:75], v[224:227], v[140:143], a[72:75]
buffer_load_dwordx4 v[124:127], v22, s[96:99], s51 offen offset:2048 sc1
v_mfma_f32_16x16x32_bf16 a[16:19], v[228:231], v[128:131], a[16:19]
v_mfma_f32_16x16x32_bf16 a[36:39], v[228:231], v[132:135], a[36:39]
v_mfma_f32_16x16x32_bf16 a[56:59], v[228:231], v[136:139], a[56:59]
v_mfma_f32_16x16x32_bf16 a[76:79], v[228:231], v[140:143], a[76:79]
s_waitcnt vmcnt(26) lgkmcnt(2)
v_mfma_f32_16x16x32_bf16 a[0:3], v[36:39], v[144:147], a[0:3]
buffer_load_dwordx4 v[128:131], v22, s[96:99], s48 offen offset:3072 sc1
s_waitcnt vmcnt(26)
v_mfma_f32_16x16x32_bf16 a[20:23], v[36:39], v[148:151], a[20:23]
s_waitcnt vmcnt(25)
v_mfma_f32_16x16x32_bf16 a[40:43], v[36:39], v[152:155], a[40:43]
s_waitcnt vmcnt(24)
v_mfma_f32_16x16x32_bf16 a[60:63], v[36:39], v[156:159], a[60:63]
v_mfma_f32_16x16x32_bf16 a[4:7], v[40:43], v[144:147], a[4:7]
ds_read_b128 v[212:215], v19 offset:15360
v_mfma_f32_16x16x32_bf16 a[24:27], v[40:43], v[148:151], a[24:27]
buffer_load_dwordx4 v[132:135], v22, s[96:99], s49 offen offset:3072 sc1
v_mfma_f32_16x16x32_bf16 a[44:47], v[40:43], v[152:155], a[44:47]
ds_read_b128 v[216:219], v19 offset:16384
v_mfma_f32_16x16x32_bf16 a[64:67], v[40:43], v[156:159], a[64:67]
v_mfma_f32_16x16x32_bf16 a[8:11], v[44:47], v[144:147], a[8:11]
ds_read_b128 v[220:223], v19 offset:17408
v_mfma_f32_16x16x32_bf16 a[28:31], v[44:47], v[148:151], a[28:31]
v_mfma_f32_16x16x32_bf16 a[48:51], v[44:47], v[152:155], a[48:51]
buffer_load_dwordx4 v[136:139], v22, s[96:99], s50 offen offset:3072 sc1
v_mfma_f32_16x16x32_bf16 a[68:71], v[44:47], v[156:159], a[68:71]
ds_read_b128 v[224:227], v19 offset:18432
s_waitcnt lgkmcnt(4)
v_mfma_f32_16x16x32_bf16 a[12:15], v[48:51], v[144:147], a[12:15]
v_mfma_f32_16x16x32_bf16 a[32:35], v[48:51], v[148:151], a[32:35]
ds_read_b128 v[228:231], v19 offset:19456
v_mfma_f32_16x16x32_bf16 a[52:55], v[48:51], v[152:155], a[52:55]
v_mfma_f32_16x16x32_bf16 a[72:75], v[48:51], v[156:159], a[72:75]
buffer_load_dwordx4 v[140:143], v22, s[96:99], s51 offen offset:3072 sc1
v_mfma_f32_16x16x32_bf16 a[16:19], v[52:55], v[144:147], a[16:19]
v_mfma_f32_16x16x32_bf16 a[36:39], v[52:55], v[148:151], a[36:39]
v_mfma_f32_16x16x32_bf16 a[56:59], v[52:55], v[152:155], a[56:59]
v_mfma_f32_16x16x32_bf16 a[76:79], v[52:55], v[156:159], a[76:79]
s_waitcnt vmcnt(23) lgkmcnt(2)
v_mfma_f32_16x16x32_bf16 a[0:3], v[212:215], v[160:163], a[0:3]
v_add_u32 v22, 4096, v22
s_waitcnt vmcnt(22)
v_mfma_f32_16x16x32_bf16 a[20:23], v[212:215], v[164:167], a[20:23]
s_waitcnt vmcnt(21)
v_mfma_f32_16x16x32_bf16 a[40:43], v[212:215], v[168:171], a[40:43]
s_waitcnt vmcnt(20)
v_mfma_f32_16x16x32_bf16 a[60:63], v[212:215], v[172:175], a[60:63]
v_mfma_f32_16x16x32_bf16 a[4:7], v[216:219], v[160:163], a[4:7]
buffer_load_dwordx4 v[144:147], v22, s[96:99], s48 offen offset:0 sc1
v_mfma_f32_16x16x32_bf16 a[24:27], v[216:219], v[164:167], a[24:27]
v_mfma_f32_16x16x32_bf16 a[44:47], v[216:219], v[168:171], a[44:47]
v_mfma_f32_16x16x32_bf16 a[64:67], v[216:219], v[172:175], a[64:67]
v_mfma_f32_16x16x32_bf16 a[8:11], v[220:223], v[160:163], a[8:11]
buffer_load_dwordx4 v[148:151], v22, s[96:99], s49 offen offset:0 sc1
v_mfma_f32_16x16x32_bf16 a[28:31], v[220:223], v[164:167], a[28:31]
v_mfma_f32_16x16x32_bf16 a[48:51], v[220:223], v[168:171], a[48:51]
v_mfma_f32_16x16x32_bf16 a[68:71], v[220:223], v[172:175], a[68:71]
s_waitcnt lgkmcnt(0)
v_mfma_f32_16x16x32_bf16 a[12:15], v[224:227], v[160:163], a[12:15]
buffer_load_dwordx4 v[152:155], v22, s[96:99], s50 offen offset:0 sc1
v_mfma_f32_16x16x32_bf16 a[32:35], v[224:227], v[164:167], a[32:35]
v_mfma_f32_16x16x32_bf16 a[52:55], v[224:227], v[168:171], a[52:55]
v_mfma_f32_16x16x32_bf16 a[72:75], v[224:227], v[172:175], a[72:75]
v_mfma_f32_16x16x32_bf16 a[16:19], v[228:231], v[160:163], a[16:19]
buffer_load_dwordx4 v[156:159], v22, s[96:99], s51 offen offset:0 sc1
v_mfma_f32_16x16x32_bf16 a[36:39], v[228:231], v[164:167], a[36:39]
v_mfma_f32_16x16x32_bf16 a[56:59], v[228:231], v[168:171], a[56:59]
v_mfma_f32_16x16x32_bf16 a[76:79], v[228:231], v[172:175], a[76:79]
s_waitcnt vmcnt(23)
v_mfma_f32_16x16x32_bf16 a[0:3], a[80:83], v[64:67], a[0:3]
v_add_u32 v22, s39, v22
s_waitcnt vmcnt(22)
v_mfma_f32_16x16x32_bf16 a[20:23], a[80:83], v[68:71], a[20:23]
s_waitcnt vmcnt(21)
v_mfma_f32_16x16x32_bf16 a[40:43], a[80:83], v[72:75], a[40:43]
s_waitcnt vmcnt(20)
v_mfma_f32_16x16x32_bf16 a[60:63], a[80:83], v[76:79], a[60:63]
v_mfma_f32_16x16x32_bf16 a[4:7], a[84:87], v[64:67], a[4:7]
buffer_load_dwordx4 v[160:163], v22, s[96:99], s48 offen offset:1024 sc1
v_mfma_f32_16x16x32_bf16 a[24:27], a[84:87], v[68:71], a[24:27]
v_mfma_f32_16x16x32_bf16 a[44:47], a[84:87], v[72:75], a[44:47]
v_mfma_f32_16x16x32_bf16 a[64:67], a[84:87], v[76:79], a[64:67]
v_mfma_f32_16x16x32_bf16 a[8:11], a[88:91], v[64:67], a[8:11]
buffer_load_dwordx4 v[164:167], v22, s[96:99], s49 offen offset:1024 sc1
v_mfma_f32_16x16x32_bf16 a[28:31], a[88:91], v[68:71], a[28:31]
v_mfma_f32_16x16x32_bf16 a[48:51], a[88:91], v[72:75], a[48:51]
v_mfma_f32_16x16x32_bf16 a[68:71], a[88:91], v[76:79], a[68:71]
v_mfma_f32_16x16x32_bf16 a[12:15], a[92:95], v[64:67], a[12:15]
buffer_load_dwordx4 v[168:171], v22, s[96:99], s50 offen offset:1024 sc1
v_mfma_f32_16x16x32_bf16 a[32:35], a[92:95], v[68:71], a[32:35]
v_mfma_f32_16x16x32_bf16 a[52:55], a[92:95], v[72:75], a[52:55]
v_mfma_f32_16x16x32_bf16 a[72:75], a[92:95], v[76:79], a[72:75]
v_mfma_f32_16x16x32_bf16 a[16:19], a[96:99], v[64:67], a[16:19]
buffer_load_dwordx4 v[172:175], v22, s[96:99], s51 offen offset:1024 sc1
v_mfma_f32_16x16x32_bf16 a[36:39], a[96:99], v[68:71], a[36:39]
v_mfma_f32_16x16x32_bf16 a[56:59], a[96:99], v[72:75], a[56:59]
v_mfma_f32_16x16x32_bf16 a[76:79], a[96:99], v[76:79], a[76:79]
s_waitcnt vmcnt(23)
v_mfma_f32_16x16x32_bf16 a[0:3], a[100:103], v[80:83], a[0:3]
s_waitcnt vmcnt(22)
v_mfma_f32_16x16x32_bf16 a[20:23], a[100:103], v[84:87], a[20:23]
s_waitcnt vmcnt(21)
v_mfma_f32_16x16x32_bf16 a[40:43], a[100:103], v[88:91], a[40:43]
s_waitcnt vmcnt(20)
v_mfma_f32_16x16x32_bf16 a[60:63], a[100:103], v[92:95], a[60:63]
v_mfma_f32_16x16x32_bf16 a[4:7], a[104:107], v[80:83], a[4:7]
v_mfma_f32_16x16x32_bf16 a[24:27], a[104:107], v[84:87], a[24:27]
v_mfma_f32_16x16x32_bf16 a[44:47], a[104:107], v[88:91], a[44:47]
v_mfma_f32_16x16x32_bf16 a[64:67], a[104:107], v[92:95], a[64:67]
v_mfma_f32_16x16x32_bf16 a[8:11], a[108:111], v[80:83], a[8:11]
v_mfma_f32_16x16x32_bf16 a[28:31], a[108:111], v[84:87], a[28:31]
v_mfma_f32_16x16x32_bf16 a[48:51], a[108:111], v[88:91], a[48:51]
v_mfma_f32_16x16x32_bf16 a[68:71], a[108:111], v[92:95], a[68:71]
v_mfma_f32_16x16x32_bf16 a[12:15], a[112:115], v[80:83], a[12:15]
v_mfma_f32_16x16x32_bf16 a[32:35], a[112:115], v[84:87], a[32:35]
v_mfma_f32_16x16x32_bf16 a[52:55], a[112:115], v[88:91], a[52:55]
v_mfma_f32_16x16x32_bf16 a[72:75], a[112:115], v[92:95], a[72:75]
v_mfma_f32_16x16x32_bf16 a[16:19], a[116:119], v[80:83], a[16:19]
v_mfma_f32_16x16x32_bf16 a[36:39], a[116:119], v[84:87], a[36:39]
v_mfma_f32_16x16x32_bf16 a[56:59], a[116:119], v[88:91], a[56:59]
v_mfma_f32_16x16x32_bf16 a[76:79], a[116:119], v[92:95], a[76:79]
s_waitcnt vmcnt(19)
v_mfma_f32_16x16x32_bf16 a[0:3], a[192:195], v[96:99], a[0:3]
s_waitcnt vmcnt(18)
v_mfma_f32_16x16x32_bf16 a[20:23], a[192:195], v[100:103], a[20:23]
s_waitcnt vmcnt(17)
v_mfma_f32_16x16x32_bf16 a[40:43], a[192:195], v[104:107], a[40:43]
s_waitcnt vmcnt(16)
v_mfma_f32_16x16x32_bf16 a[60:63], a[192:195], v[108:111], a[60:63]
v_mfma_f32_16x16x32_bf16 a[4:7], a[196:199], v[96:99], a[4:7]
v_mfma_f32_16x16x32_bf16 a[24:27], a[196:199], v[100:103], a[24:27]
v_mfma_f32_16x16x32_bf16 a[44:47], a[196:199], v[104:107], a[44:47]
v_mfma_f32_16x16x32_bf16 a[64:67], a[196:199], v[108:111], a[64:67]
v_mfma_f32_16x16x32_bf16 a[8:11], a[200:203], v[96:99], a[8:11]
v_mfma_f32_16x16x32_bf16 a[28:31], a[200:203], v[100:103], a[28:31]
v_mfma_f32_16x16x32_bf16 a[48:51], a[200:203], v[104:107], a[48:51]
v_mfma_f32_16x16x32_bf16 a[68:71], a[200:203], v[108:111], a[68:71]
v_mfma_f32_16x16x32_bf16 a[12:15], a[204:207], v[96:99], a[12:15]
v_mfma_f32_16x16x32_bf16 a[32:35], a[204:207], v[100:103], a[32:35]
v_mfma_f32_16x16x32_bf16 a[52:55], a[204:207], v[104:107], a[52:55]
v_mfma_f32_16x16x32_bf16 a[72:75], a[204:207], v[108:111], a[72:75]
v_mfma_f32_16x16x32_bf16 a[16:19], a[208:211], v[96:99], a[16:19]
v_mfma_f32_16x16x32_bf16 a[36:39], a[208:211], v[100:103], a[36:39]
v_mfma_f32_16x16x32_bf16 a[56:59], a[208:211], v[104:107], a[56:59]
v_mfma_f32_16x16x32_bf16 a[76:79], a[208:211], v[108:111], a[76:79]
s_waitcnt vmcnt(15)
v_mfma_f32_16x16x32_bf16 a[0:3], a[212:215], v[112:115], a[0:3]
s_waitcnt vmcnt(14)
v_mfma_f32_16x16x32_bf16 a[20:23], a[212:215], v[116:119], a[20:23]
s_waitcnt vmcnt(13)
v_mfma_f32_16x16x32_bf16 a[40:43], a[212:215], v[120:123], a[40:43]
s_waitcnt vmcnt(12)
v_mfma_f32_16x16x32_bf16 a[60:63], a[212:215], v[124:127], a[60:63]
v_mfma_f32_16x16x32_bf16 a[4:7], a[216:219], v[112:115], a[4:7]
v_mfma_f32_16x16x32_bf16 a[24:27], a[216:219], v[116:119], a[24:27]
v_mfma_f32_16x16x32_bf16 a[44:47], a[216:219], v[120:123], a[44:47]
v_mfma_f32_16x16x32_bf16 a[64:67], a[216:219], v[124:127], a[64:67]
v_mfma_f32_16x16x32_bf16 a[8:11], a[220:223], v[112:115], a[8:11]
v_mfma_f32_16x16x32_bf16 a[28:31], a[220:223], v[116:119], a[28:31]
v_mfma_f32_16x16x32_bf16 a[48:51], a[220:223], v[120:123], a[48:51]
v_mfma_f32_16x16x32_bf16 a[68:71], a[220:223], v[124:127], a[68:71]
v_mfma_f32_16x16x32_bf16 a[12:15], a[224:227], v[112:115], a[12:15]
v_mfma_f32_16x16x32_bf16 a[32:35], a[224:227], v[116:119], a[32:35]
v_mfma_f32_16x16x32_bf16 a[52:55], a[224:227], v[120:123], a[52:55]
v_mfma_f32_16x16x32_bf16 a[72:75], a[224:227], v[124:127], a[72:75]
v_mfma_f32_16x16x32_bf16 a[16:19], a[228:231], v[112:115], a[16:19]
v_mfma_f32_16x16x32_bf16 a[36:39], a[228:231], v[116:119], a[36:39]
v_mfma_f32_16x16x32_bf16 a[56:59], a[228:231], v[120:123], a[56:59]
v_mfma_f32_16x16x32_bf16 a[76:79], a[228:231], v[124:127], a[76:79]
s_waitcnt vmcnt(11)
v_mfma_f32_16x16x32_bf16 a[0:3], a[232:235], v[128:131], a[0:3]
s_waitcnt vmcnt(10)
v_mfma_f32_16x16x32_bf16 a[20:23], a[232:235], v[132:135], a[20:23]
s_waitcnt vmcnt(9)
v_mfma_f32_16x16x32_bf16 a[40:43], a[232:235], v[136:139], a[40:43]
s_waitcnt vmcnt(8)
v_mfma_f32_16x16x32_bf16 a[60:63], a[232:235], v[140:143], a[60:63]
v_mfma_f32_16x16x32_bf16 a[4:7], a[236:239], v[128:131], a[4:7]
ds_read_b128 v[36:39], v20 offset:0
v_mfma_f32_16x16x32_bf16 a[24:27], a[236:239], v[132:135], a[24:27]
v_mfma_f32_16x16x32_bf16 a[44:47], a[236:239], v[136:139], a[44:47]
ds_read_b128 v[40:43], v20 offset:1024
v_mfma_f32_16x16x32_bf16 a[64:67], a[236:239], v[140:143], a[64:67]
v_mfma_f32_16x16x32_bf16 a[8:11], a[240:243], v[128:131], a[8:11]
ds_read_b128 v[44:47], v20 offset:2048
v_mfma_f32_16x16x32_bf16 a[28:31], a[240:243], v[132:135], a[28:31]
v_mfma_f32_16x16x32_bf16 a[48:51], a[240:243], v[136:139], a[48:51]
v_mfma_f32_16x16x32_bf16 a[68:71], a[240:243], v[140:143], a[68:71]
ds_read_b128 v[48:51], v20 offset:3072
v_mfma_f32_16x16x32_bf16 a[12:15], a[244:247], v[128:131], a[12:15]
v_mfma_f32_16x16x32_bf16 a[32:35], a[244:247], v[132:135], a[32:35]
ds_read_b128 v[52:55], v20 offset:4096
v_mfma_f32_16x16x32_bf16 a[52:55], a[244:247], v[136:139], a[52:55]
v_mfma_f32_16x16x32_bf16 a[72:75], a[244:247], v[140:143], a[72:75]
v_mfma_f32_16x16x32_bf16 a[16:19], a[248:251], v[128:131], a[16:19]
v_mfma_f32_16x16x32_bf16 a[36:39], a[248:251], v[132:135], a[36:39]
v_mfma_f32_16x16x32_bf16 a[56:59], a[248:251], v[136:139], a[56:59]
v_mfma_f32_16x16x32_bf16 a[76:79], a[248:251], v[140:143], a[76:79]
s_waitcnt vmcnt(7) lgkmcnt(2)
v_mfma_f32_16x16x32_bf16 a[0:3], v[36:39], v[144:147], a[0:3]
s_waitcnt vmcnt(6)
v_mfma_f32_16x16x32_bf16 a[20:23], v[36:39], v[148:151], a[20:23]
s_waitcnt vmcnt(5)
v_mfma_f32_16x16x32_bf16 a[40:43], v[36:39], v[152:155], a[40:43]
s_waitcnt vmcnt(4)
v_mfma_f32_16x16x32_bf16 a[60:63], v[36:39], v[156:159], a[60:63]
v_mfma_f32_16x16x32_bf16 a[4:7], v[40:43], v[144:147], a[4:7]
ds_read_b128 v[212:215], v20 offset:5120
v_mfma_f32_16x16x32_bf16 a[24:27], v[40:43], v[148:151], a[24:27]
v_mfma_f32_16x16x32_bf16 a[44:47], v[40:43], v[152:155], a[44:47]
ds_read_b128 v[216:219], v20 offset:6144
v_mfma_f32_16x16x32_bf16 a[64:67], v[40:43], v[156:159], a[64:67]
v_mfma_f32_16x16x32_bf16 a[8:11], v[44:47], v[144:147], a[8:11]
ds_read_b128 v[220:223], v20 offset:7168
v_mfma_f32_16x16x32_bf16 a[28:31], v[44:47], v[148:151], a[28:31]
v_mfma_f32_16x16x32_bf16 a[48:51], v[44:47], v[152:155], a[48:51]
v_mfma_f32_16x16x32_bf16 a[68:71], v[44:47], v[156:159], a[68:71]
ds_read_b128 v[224:227], v20 offset:8192
s_waitcnt lgkmcnt(4)
v_mfma_f32_16x16x32_bf16 a[12:15], v[48:51], v[144:147], a[12:15]
v_mfma_f32_16x16x32_bf16 a[32:35], v[48:51], v[148:151], a[32:35]
ds_read_b128 v[228:231], v20 offset:9216
v_mfma_f32_16x16x32_bf16 a[52:55], v[48:51], v[152:155], a[52:55]
v_mfma_f32_16x16x32_bf16 a[72:75], v[48:51], v[156:159], a[72:75]
v_mfma_f32_16x16x32_bf16 a[16:19], v[52:55], v[144:147], a[16:19]
v_mfma_f32_16x16x32_bf16 a[36:39], v[52:55], v[148:151], a[36:39]
v_mfma_f32_16x16x32_bf16 a[56:59], v[52:55], v[152:155], a[56:59]
v_mfma_f32_16x16x32_bf16 a[76:79], v[52:55], v[156:159], a[76:79]
s_waitcnt vmcnt(3) lgkmcnt(2)
v_mfma_f32_16x16x32_bf16 a[0:3], v[212:215], v[160:163], a[0:3]
s_waitcnt vmcnt(2)
v_mfma_f32_16x16x32_bf16 a[20:23], v[212:215], v[164:167], a[20:23]
s_waitcnt vmcnt(1)
v_mfma_f32_16x16x32_bf16 a[40:43], v[212:215], v[168:171], a[40:43]
s_waitcnt vmcnt(0)
v_mfma_f32_16x16x32_bf16 a[60:63], v[212:215], v[172:175], a[60:63]
v_mfma_f32_16x16x32_bf16 a[4:7], v[216:219], v[160:163], a[4:7]
v_mfma_f32_16x16x32_bf16 a[24:27], v[216:219], v[164:167], a[24:27]
v_mfma_f32_16x16x32_bf16 a[44:47], v[216:219], v[168:171], a[44:47]
v_mfma_f32_16x16x32_bf16 a[64:67], v[216:219], v[172:175], a[64:67]
v_mfma_f32_16x16x32_bf16 a[8:11], v[220:223], v[160:163], a[8:11]
v_mfma_f32_16x16x32_bf16 a[28:31], v[220:223], v[164:167], a[28:31]
v_mfma_f32_16x16x32_bf16 a[48:51], v[220:223], v[168:171], a[48:51]
v_mfma_f32_16x16x32_bf16 a[68:71], v[220:223], v[172:175], a[68:71]
s_waitcnt lgkmcnt(0)
v_mfma_f32_16x16x32_bf16 a[12:15], v[224:227], v[160:163], a[12:15]
v_mfma_f32_16x16x32_bf16 a[32:35], v[224:227], v[164:167], a[32:35]
v_mfma_f32_16x16x32_bf16 a[52:55], v[224:227], v[168:171], a[52:55]
v_mfma_f32_16x16x32_bf16 a[72:75], v[224:227], v[172:175], a[72:75]
v_mfma_f32_16x16x32_bf16 a[16:19], v[228:231], v[160:163], a[16:19]
v_mfma_f32_16x16x32_bf16 a[36:39], v[228:231], v[164:167], a[36:39]
v_mfma_f32_16x16x32_bf16 a[56:59], v[228:231], v[168:171], a[56:59]
v_mfma_f32_16x16x32_bf16 a[76:79], v[228:231], v[172:175], a[76:79]
s_barrier
v_and_b32 v3, 15, v2
v_mul_u32_u24 v3, 336, v3
v_lshrrev_b32 v4, 4, v2
v_lshl_add_u32 v3, v4, 4, v3
s_mul_i32 s7, s100, 21504
v_add_u32 v3, s7, v3
ds_write_b128 v3, a[0:3] offset:0
ds_write_b128 v3, a[4:7] offset:64
ds_write_b128 v3, a[8:11] offset:128
ds_write_b128 v3, a[12:15] offset:192
ds_write_b128 v3, a[16:19] offset:256
ds_write_b128 v3, a[20:23] offset:5376
ds_write_b128 v3, a[24:27] offset:5440
ds_write_b128 v3, a[28:31] offset:5504
ds_write_b128 v3, a[32:35] offset:5568
ds_write_b128 v3, a[36:39] offset:5632
ds_write_b128 v3, a[40:43] offset:10752
ds_write_b128 v3, a[44:47] offset:10816
ds_write_b128 v3, a[48:51] offset:10880
ds_write_b128 v3, a[52:55] offset:10944
ds_write_b128 v3, a[56:59] offset:11008
ds_write_b128 v3, a[60:63] offset:16128
ds_write_b128 v3, a[64:67] offset:16192
ds_write_b128 v3, a[68:71] offset:16256
ds_write_b128 v3, a[72:75] offset:16320
ds_write_b128 v3, a[76:79] offset:16384
s_waitcnt lgkmcnt(0)
s_barrier
v_mul_u32_u24 v3, 336, v23
v_lshl_add_u32 v3, v28, 5, v3
v_add_u32 v4, 43008, v3
ds_read_b128 v[64:67], v3 offset:0
ds_read_b128 v[68:71], v3 offset:16
ds_read_b128 v[96:99], v3 offset:21504
ds_read_b128 v[100:103], v3 offset:21520
ds_read_b128 v[104:107], v4 offset:0
ds_read_b128 v[108:111], v4 offset:16
ds_read_b128 v[112:115], v4 offset:21504
ds_read_b128 v[116:119], v4 offset:21520
ds_read_b128 v[72:75], v3 offset:128
ds_read_b128 v[76:79], v3 offset:144
ds_read_b128 v[120:123], v3 offset:21632
ds_read_b128 v[124:127], v3 offset:21648
ds_read_b128 v[128:131], v4 offset:128
ds_read_b128 v[132:135], v4 offset:144
ds_read_b128 v[136:139], v4 offset:21632
ds_read_b128 v[140:143], v4 offset:21648
ds_read_b128 v[80:83], v3 offset:256
ds_read_b128 v[84:87], v3 offset:272
ds_read_b128 v[144:147], v3 offset:21760
ds_read_b128 v[148:151], v3 offset:21776
ds_read_b128 v[152:155], v4 offset:256
ds_read_b128 v[156:159], v4 offset:272
ds_read_b128 v[160:163], v4 offset:21760
ds_read_b128 v[164:167], v4 offset:21776
s_waitcnt lgkmcnt(15)
v_add_f32 v64, v64, v96
v_add_f32 v65, v65, v97
v_add_f32 v66, v66, v98
v_add_f32 v67, v67, v99
s_waitcnt lgkmcnt(15)
v_add_f32 v68, v68, v100
v_add_f32 v69, v69, v101
v_add_f32 v70, v70, v102
v_add_f32 v71, v71, v103
s_waitcnt lgkmcnt(15)
v_add_f32 v64, v64, v104
v_add_f32 v65, v65, v105
v_add_f32 v66, v66, v106
v_add_f32 v67, v67, v107
s_waitcnt lgkmcnt(15)
v_add_f32 v68, v68, v108
v_add_f32 v69, v69, v109
v_add_f32 v70, v70, v110
v_add_f32 v71, v71, v111
s_waitcnt lgkmcnt(15)
v_add_f32 v64, v64, v112
v_add_f32 v65, v65, v113
v_add_f32 v66, v66, v114
v_add_f32 v67, v67, v115
s_waitcnt lgkmcnt(15)
v_add_f32 v68, v68, v116
v_add_f32 v69, v69, v117
v_add_f32 v70, v70, v118
v_add_f32 v71, v71, v119
v_lshlrev_b32 v5, 16, v176
v_fma_f32 v64, v64, v188, v5
v_and_b32 v5, 0xffff0000, v176
v_fma_f32 v65, v65, v189, v5
v_lshlrev_b32 v5, 16, v177
v_fma_f32 v66, v66, v190, v5
v_and_b32 v5, 0xffff0000, v177
v_fma_f32 v67, v67, v191, v5
v_lshlrev_b32 v5, 16, v178
v_fma_f32 v68, v68, v192, v5
v_and_b32 v5, 0xffff0000, v178
v_fma_f32 v69, v69, v193, v5
v_lshlrev_b32 v5, 16, v179
v_fma_f32 v70, v70, v194, v5
v_and_b32 v5, 0xffff0000, v179
v_fma_f32 v71, v71, v195, v5
v_cvt_pk_bf16_f32 v36, v64, v65
v_cvt_pk_bf16_f32 v37, v66, v67
v_cvt_pk_bf16_f32 v38, v68, v69
v_cvt_pk_bf16_f32 v39, v70, v71
buffer_store_dwordx4 v[36:39], v24, s[24:27], 0 offen offset:0
s_waitcnt lgkmcnt(13)
v_add_f32 v72, v72, v120
v_add_f32 v73, v73, v121
v_add_f32 v74, v74, v122
v_add_f32 v75, v75, v123
s_waitcnt lgkmcnt(12)
v_add_f32 v76, v76, v124
v_add_f32 v77, v77, v125
v_add_f32 v78, v78, v126
v_add_f32 v79, v79, v127
s_waitcnt lgkmcnt(11)
v_add_f32 v72, v72, v128
v_add_f32 v73, v73, v129
v_add_f32 v74, v74, v130
v_add_f32 v75, v75, v131
s_waitcnt lgkmcnt(10)
v_add_f32 v76, v76, v132
v_add_f32 v77, v77, v133
v_add_f32 v78, v78, v134
v_add_f32 v79, v79, v135
s_waitcnt lgkmcnt(9)
v_add_f32 v72, v72, v136
v_add_f32 v73, v73, v137
v_add_f32 v74, v74, v138
v_add_f32 v75, v75, v139
s_waitcnt lgkmcnt(8)
v_add_f32 v76, v76, v140
v_add_f32 v77, v77, v141
v_add_f32 v78, v78, v142
v_add_f32 v79, v79, v143
v_lshlrev_b32 v5, 16, v180
v_fma_f32 v72, v72, v196, v5
v_and_b32 v5, 0xffff0000, v180
v_fma_f32 v73, v73, v197, v5
v_lshlrev_b32 v5, 16, v181
v_fma_f32 v74, v74, v198, v5
v_and_b32 v5, 0xffff0000, v181
v_fma_f32 v75, v75, v199, v5
v_lshlrev_b32 v5, 16, v182
v_fma_f32 v76, v76, v200, v5
v_and_b32 v5, 0xffff0000, v182
v_fma_f32 v77, v77, v201, v5
v_lshlrev_b32 v5, 16, v183
v_fma_f32 v78, v78, v202, v5
v_and_b32 v5, 0xffff0000, v183
v_fma_f32 v79, v79, v203, v5
v_cvt_pk_bf16_f32 v40, v72, v73
v_cvt_pk_bf16_f32 v41, v74, v75
v_cvt_pk_bf16_f32 v42, v76, v77
v_cvt_pk_bf16_f32 v43, v78, v79
buffer_store_dwordx4 v[40:43], v24, s[24:27], 0 offen offset:64
s_waitcnt lgkmcnt(5)
v_add_f32 v80, v80, v144
v_add_f32 v81, v81, v145
v_add_f32 v82, v82, v146
v_add_f32 v83, v83, v147
s_waitcnt lgkmcnt(4)
v_add_f32 v84, v84, v148
v_add_f32 v85, v85, v149
v_add_f32 v86, v86, v150
v_add_f32 v87, v87, v151
s_waitcnt lgkmcnt(3)
v_add_f32 v80, v80, v152
v_add_f32 v81, v81, v153
v_add_f32 v82, v82, v154
v_add_f32 v83, v83, v155
s_waitcnt lgkmcnt(2)
v_add_f32 v84, v84, v156
v_add_f32 v85, v85, v157
v_add_f32 v86, v86, v158
v_add_f32 v87, v87, v159
s_waitcnt lgkmcnt(1)
v_add_f32 v80, v80, v160
v_add_f32 v81, v81, v161
v_add_f32 v82, v82, v162
v_add_f32 v83, v83, v163
s_waitcnt lgkmcnt(0)
v_add_f32 v84, v84, v164
v_add_f32 v85, v85, v165
v_add_f32 v86, v86, v166
v_add_f32 v87, v87, v167
v_lshlrev_b32 v5, 16, v184
v_fma_f32 v80, v80, v204, v5
v_and_b32 v5, 0xffff0000, v184
v_fma_f32 v81, v81, v205, v5
v_lshlrev_b32 v5, 16, v185
v_fma_f32 v82, v82, v206, v5
v_and_b32 v5, 0xffff0000, v185
v_fma_f32 v83, v83, v207, v5
v_lshlrev_b32 v5, 16, v186
v_fma_f32 v84, v84, v208, v5
v_and_b32 v5, 0xffff0000, v186
v_fma_f32 v85, v85, v209, v5
v_lshlrev_b32 v5, 16, v187
v_fma_f32 v86, v86, v210, v5
v_and_b32 v5, 0xffff0000, v187
v_fma_f32 v87, v87, v211, v5
v_cvt_pk_bf16_f32 v44, v80, v81
v_cvt_pk_bf16_f32 v45, v82, v83
v_cvt_pk_bf16_f32 v46, v84, v85
v_cvt_pk_bf16_f32 v47, v86, v87
buffer_store_dwordx4 v[44:47], v32, s[24:27], 0 offen offset:128
L_mega_end:
s_endpgm
L_slow_2:
s_call_b64 s[46:47], L_rescale_0
s_branch L_back_2
L_slow_3:
s_call_b64 s[46:47], L_rescale_1
s_branch L_back_3
L_slow_4:
s_call_b64 s[46:47], L_rescale_0
s_branch L_back_4
L_slow_5:
s_call_b64 s[46:47], L_rescale_1
s_branch L_back_5
L_slow_6:
s_call_b64 s[46:47], L_rescale_0
s_branch L_back_6
L_slow_7:
s_call_b64 s[46:47], L_rescale_1
s_branch L_back_7
L_slow_8:
s_call_b64 s[46:47], L_rescale_0
s_branch L_back_8
L_slow_9:
s_call_b64 s[46:47], L_rescale_1
s_branch L_back_9
L_slow_10:
s_call_b64 s[46:47], L_rescale_0
s_branch L_back_10
L_slow_11:
s_call_b64 s[46:47], L_rescale_1
s_branch L_back_11
L_slow_12:
s_call_b64 s[46:47], L_rescale_0
s_branch L_back_12
L_slow_13:
s_call_b64 s[46:47], L_rescale_1
s_branch L_back_13
L_slow_14:
s_call_b64 s[46:47], L_rescale_0
s_branch L_back_14
L_slow_15:
s_call_b64 s[46:47], L_rescale_1
s_branch L_back_15
L_slow_16:
s_call_b64 s[46:47], L_rescale_0
s_branch L_back_16
L_slow_17:
s_call_b64 s[46:47], L_rescale_1
s_branch L_back_17
L_slow_18:
s_call_b64 s[46:47], L_rescale_0
s_branch L_back_18
L_slow_19:
s_call_b64 s[46:47], L_rescale_1
s_branch L_back_19
L_slow_20:
s_call_b64 s[46:47], L_rescale_0
s_branch L_back_20
L_slow_21:
s_call_b64 s[46:47], L_rescale_1
s_branch L_back_21
L_slow_22:
s_call_b64 s[46:47], L_rescale_0
s_branch L_back_22
L_slow_23:
s_call_b64 s[46:47], L_rescale_1
s_branch L_back_23
L_slow_24:
s_call_b64 s[46:47], L_rescale_0
s_branch L_back_24
L_slow_25:
s_call_b64 s[46:47], L_rescale_1
s_branch L_back_25
L_slow_26:
s_call_b64 s[46:47], L_rescale_0
s_branch L_back_26
L_slow_27:
s_call_b64 s[46:47], L_rescale_1
s_branch L_back_27
L_slow_28:
s_call_b64 s[46:47], L_rescale_0
s_branch L_back_28
L_slow_29:
s_call_b64 s[46:47], L_rescale_1
s_branch L_back_29
L_slow_30:
s_call_b64 s[46:47], L_rescale_0
s_branch L_back_30
L_slow_31:
s_call_b64 s[46:47], L_rescale_1
s_branch L_back_31
L_rescale_0:
s_nop 15
s_nop 15
v_max3_f32 v252, v80, v81, v82
v_max3_f32 v252, v252, v83, v84
v_max3_f32 v252, v252, v85, v86
v_max3_f32 v252, v252, v87, v88
v_max3_f32 v252, v252, v89, v90
v_max3_f32 v252, v252, v91, v92
v_max3_f32 v252, v252, v93, v94
v_max_f32 v252, v252, v95
v_mov_b32 v253, v252
s_nop 1
v_permlane32_swap_b32 v253, v252
v_max_f32 v252, v252, v253
v_max_f32 v252, 0, v252
v_sub_f32 v253, 0, v252
v_exp_f32 v253, v253
v_sub_f32 v80, v80, v252
v_sub_f32 v144, v144, v252
v_sub_f32 v81, v81, v252
v_sub_f32 v145, v145, v252
v_sub_f32 v82, v82, v252
v_sub_f32 v146, v146, v252
v_sub_f32 v83, v83, v252
v_sub_f32 v147, v147, v252
v_sub_f32 v84, v84, v252
v_sub_f32 v148, v148, v252
v_sub_f32 v85, v85, v252
v_sub_f32 v149, v149, v252
v_sub_f32 v86, v86, v252
v_sub_f32 v150, v150, v252
v_sub_f32 v87, v87, v252
v_sub_f32 v151, v151, v252
v_sub_f32 v88, v88, v252
v_sub_f32 v152, v152, v252
v_sub_f32 v89, v89, v252
v_sub_f32 v153, v153, v252
v_sub_f32 v90, v90, v252
v_sub_f32 v154, v154, v252
v_sub_f32 v91, v91, v252
v_sub_f32 v155, v155, v252
v_sub_f32 v92, v92, v252
v_sub_f32 v156, v156, v252
v_sub_f32 v93, v93, v252
v_sub_f32 v157, v157, v252
v_sub_f32 v94, v94, v252
v_sub_f32 v158, v158, v252
v_sub_f32 v95, v95, v252
v_sub_f32 v159, v159, v252
v_mul_f32 v240, v240, v253
v_accvgpr_read_b32 v254, a0
v_mul_f32 v254, v254, v253
v_accvgpr_write_b32 a0, v254
v_accvgpr_read_b32 v254, a1
v_mul_f32 v254, v254, v253
v_accvgpr_write_b32 a1, v254
v_accvgpr_read_b32 v254, a2
v_mul_f32 v254, v254, v253
v_accvgpr_write_b32 a2, v254
v_accvgpr_read_b32 v254, a3
v_mul_f32 v254, v254, v253
v_accvgpr_write_b32 a3, v254
v_accvgpr_read_b32 v254, a4
v_mul_f32 v254, v254, v253
v_accvgpr_write_b32 a4, v254
v_accvgpr_read_b32 v254, a5
v_mul_f32 v254, v254, v253
v_accvgpr_write_b32 a5, v254
v_accvgpr_read_b32 v254, a6
v_mul_f32 v254, v254, v253
v_accvgpr_write_b32 a6, v254
v_accvgpr_read_b32 v254, a7
v_mul_f32 v254, v254, v253
v_accvgpr_write_b32 a7, v254
v_accvgpr_read_b32 v254, a8
v_mul_f32 v254, v254, v253
v_accvgpr_write_b32 a8, v254
v_accvgpr_read_b32 v254, a9
v_mul_f32 v254, v254, v253
v_accvgpr_write_b32 a9, v254
v_accvgpr_read_b32 v254, a10
v_mul_f32 v254, v254, v253
v_accvgpr_write_b32 a10, v254
v_accvgpr_read_b32 v254, a11
v_mul_f32 v254, v254, v253
v_accvgpr_write_b32 a11, v254
v_accvgpr_read_b32 v254, a12
v_mul_f32 v254, v254, v253
v_accvgpr_write_b32 a12, v254
v_accvgpr_read_b32 v254, a13
v_mul_f32 v254, v254, v253
v_accvgpr_write_b32 a13, v254
v_accvgpr_read_b32 v254, a14
v_mul_f32 v254, v254, v253
v_accvgpr_write_b32 a14, v254
v_accvgpr_read_b32 v254, a15
v_mul_f32 v254, v254, v253
v_accvgpr_write_b32 a15, v254
v_accvgpr_read_b32 v254, a16
v_mul_f32 v254, v254, v253
v_accvgpr_write_b32 a16, v254
v_accvgpr_read_b32 v254, a17
v_mul_f32 v254, v254, v253
v_accvgpr_write_b32 a17, v254
v_accvgpr_read_b32 v254, a18
v_mul_f32 v254, v254, v253
v_accvgpr_write_b32 a18, v254
v_accvgpr_read_b32 v254, a19
v_mul_f32 v254, v254, v253
v_accvgpr_write_b32 a19, v254
v_accvgpr_read_b32 v254, a20
v_mul_f32 v254, v254, v253
v_accvgpr_write_b32 a20, v254
v_accvgpr_read_b32 v254, a21
v_mul_f32 v254, v254, v253
v_accvgpr_write_b32 a21, v254
v_accvgpr_read_b32 v254, a22
v_mul_f32 v254, v254, v253
v_accvgpr_write_b32 a22, v254
v_accvgpr_read_b32 v254, a23
v_mul_f32 v254, v254, v253
v_accvgpr_write_b32 a23, v254
v_accvgpr_read_b32 v254, a24
v_mul_f32 v254, v254, v253
v_accvgpr_write_b32 a24, v254
v_accvgpr_read_b32 v254, a25
v_mul_f32 v254, v254, v253
v_accvgpr_write_b32 a25, v254
v_accvgpr_read_b32 v254, a26
v_mul_f32 v254, v254, v253
v_accvgpr_write_b32 a26, v254
v_accvgpr_read_b32 v254, a27
v_mul_f32 v254, v254, v253
v_accvgpr_write_b32 a27, v254
v_accvgpr_read_b32 v254, a28
v_mul_f32 v254, v254, v253
v_accvgpr_write_b32 a28, v254
v_accvgpr_read_b32 v254, a29
v_mul_f32 v254, v254, v253
v_accvgpr_write_b32 a29, v254
v_accvgpr_read_b32 v254, a30
v_mul_f32 v254, v254, v253
v_accvgpr_write_b32 a30, v254
v_accvgpr_read_b32 v254, a31
v_mul_f32 v254, v254, v253
v_accvgpr_write_b32 a31, v254
v_accvgpr_read_b32 v254, a32
v_mul_f32 v254, v254, v253
v_accvgpr_write_b32 a32, v254
v_accvgpr_read_b32 v254, a33
v_mul_f32 v254, v254, v253
v_accvgpr_write_b32 a33, v254
v_accvgpr_read_b32 v254, a34
v_mul_f32 v254, v254, v253
v_accvgpr_write_b32 a34, v254
v_accvgpr_read_b32 v254, a35
v_mul_f32 v254, v254, v253
v_accvgpr_write_b32 a35, v254
v_accvgpr_read_b32 v254, a36
v_mul_f32 v254, v254, v253
v_accvgpr_write_b32 a36, v254
v_accvgpr_read_b32 v254, a37
v_mul_f32 v254, v254, v253
v_accvgpr_write_b32 a37, v254
v_accvgpr_read_b32 v254, a38
v_mul_f32 v254, v254, v253
v_accvgpr_write_b32 a38, v254
v_accvgpr_read_b32 v254, a39
v_mul_f32 v254, v254, v253
v_accvgpr_write_b32 a39, v254
v_accvgpr_read_b32 v254, a40
v_mul_f32 v254, v254, v253
v_accvgpr_write_b32 a40, v254
v_accvgpr_read_b32 v254, a41
v_mul_f32 v254, v254, v253
v_accvgpr_write_b32 a41, v254
v_accvgpr_read_b32 v254, a42
v_mul_f32 v254, v254, v253
v_accvgpr_write_b32 a42, v254
v_accvgpr_read_b32 v254, a43
v_mul_f32 v254, v254, v253
v_accvgpr_write_b32 a43, v254
v_accvgpr_read_b32 v254, a44
v_mul_f32 v254, v254, v253
v_accvgpr_write_b32 a44, v254
v_accvgpr_read_b32 v254, a45
v_mul_f32 v254, v254, v253
v_accvgpr_write_b32 a45, v254
v_accvgpr_read_b32 v254, a46
v_mul_f32 v254, v254, v253
v_accvgpr_write_b32 a46, v254
v_accvgpr_read_b32 v254, a47
v_mul_f32 v254, v254, v253
v_accvgpr_write_b32 a47, v254
v_accvgpr_read_b32 v254, a48
v_mul_f32 v254, v254, v253
v_accvgpr_write_b32 a48, v254
v_accvgpr_read_b32 v254, a49
v_mul_f32 v254, v254, v253
v_accvgpr_write_b32 a49, v254
v_accvgpr_read_b32 v254, a50
v_mul_f32 v254, v254, v253
v_accvgpr_write_b32 a50, v254
v_accvgpr_read_b32 v254, a51
v_mul_f32 v254, v254, v253
v_accvgpr_write_b32 a51, v254
v_accvgpr_read_b32 v254, a52
v_mul_f32 v254, v254, v253
v_accvgpr_write_b32 a52, v254
v_accvgpr_read_b32 v254, a53
v_mul_f32 v254, v254, v253
v_accvgpr_write_b32 a53, v254
v_accvgpr_read_b32 v254, a54
v_mul_f32 v254, v254, v253
v_accvgpr_write_b32 a54, v254
v_accvgpr_read_b32 v254, a55
v_mul_f32 v254, v254, v253
v_accvgpr_write_b32 a55, v254
v_accvgpr_read_b32 v254, a56
v_mul_f32 v254, v254, v253
v_accvgpr_write_b32 a56, v254
v_accvgpr_read_b32 v254, a57
v_mul_f32 v254, v254, v253
v_accvgpr_write_b32 a57, v254
v_accvgpr_read_b32 v254, a58
v_mul_f32 v254, v254, v253
v_accvgpr_write_b32 a58, v254
v_accvgpr_read_b32 v254, a59
v_mul_f32 v254, v254, v253
v_accvgpr_write_b32 a59, v254
v_accvgpr_read_b32 v254, a60
v_mul_f32 v254, v254, v253
v_accvgpr_write_b32 a60, v254
v_accvgpr_read_b32 v254, a61
v_mul_f32 v254, v254, v253
v_accvgpr_write_b32 a61, v254
v_accvgpr_read_b32 v254, a62
v_mul_f32 v254, v254, v253
v_accvgpr_write_b32 a62, v254
v_accvgpr_read_b32 v254, a63
v_mul_f32 v254, v254, v253
v_accvgpr_write_b32 a63, v254
v_exp_f32 v244, v80
v_exp_f32 v245, v81
v_exp_f32 v246, v82
v_exp_f32 v247, v83
v_add_f32 v242, v244, v245
v_exp_f32 v248, v84
v_cvt_pk_bf16_f32 v112, v244, v245
v_add_f32 v242, v242, v246
v_add_f32 v242, v242, v247
v_exp_f32 v249, v85
v_cvt_pk_bf16_f32 v113, v246, v247
v_add_f32 v242, v242, v248
v_exp_f32 v250, v86
v_add_f32 v242, v242, v249
v_cvt_pk_bf16_f32 v114, v248, v249
v_exp_f32 v251, v87
v_add_f32 v242, v242, v250
v_exp_f32 v244, v88
v_add_f32 v242, v242, v251
v_cvt_pk_bf16_f32 v115, v250, v251
v_exp_f32 v245, v89
v_add_f32 v242, v242, v244
v_exp_f32 v246, v90
v_add_f32 v242, v242, v245
v_cvt_pk_bf16_f32 v116, v244, v245
v_exp_f32 v247, v91
v_add_f32 v242, v242, v246
v_exp_f32 v248, v92
v_add_f32 v242, v242, v247
v_cvt_pk_bf16_f32 v117, v246, v247
v_exp_f32 v249, v93
v_add_f32 v242, v242, v248
v_exp_f32 v250, v94
v_add_f32 v242, v242, v249
v_cvt_pk_bf16_f32 v118, v248, v249
v_exp_f32 v251, v95
v_add_f32 v242, v242, v250
v_add_f32 v242, v242, v251
v_cvt_pk_bf16_f32 v119, v250, v251
s_nop 3
s_setpc_b64 s[46:47]
L_rescale_1:
s_nop 15
s_nop 15
v_max3_f32 v252, v96, v97, v98
v_max3_f32 v252, v252, v99, v100
v_max3_f32 v252, v252, v101, v102
v_max3_f32 v252, v252, v103, v104
v_max3_f32 v252, v252, v105, v106
v_max3_f32 v252, v252, v107, v108
v_max3_f32 v252, v252, v109, v110
v_max_f32 v252, v252, v111
v_mov_b32 v253, v252
s_nop 1
v_permlane32_swap_b32 v253, v252
v_max_f32 v252, v252, v253
v_max_f32 v252, 0, v252
v_sub_f32 v253, 0, v252
v_exp_f32 v253, v253
v_sub_f32 v96, v96, v252
v_sub_f32 v160, v160, v252
v_sub_f32 v97, v97, v252
v_sub_f32 v161, v161, v252
v_sub_f32 v98, v98, v252
v_sub_f32 v162, v162, v252
v_sub_f32 v99, v99, v252
v_sub_f32 v163, v163, v252
v_sub_f32 v100, v100, v252
v_sub_f32 v164, v164, v252
v_sub_f32 v101, v101, v252
v_sub_f32 v165, v165, v252
v_sub_f32 v102, v102, v252
v_sub_f32 v166, v166, v252
v_sub_f32 v103, v103, v252
v_sub_f32 v167, v167, v252
v_sub_f32 v104, v104, v252
v_sub_f32 v168, v168, v252
v_sub_f32 v105, v105, v252
v_sub_f32 v169, v169, v252
v_sub_f32 v106, v106, v252
v_sub_f32 v170, v170, v252
v_sub_f32 v107, v107, v252
v_sub_f32 v171, v171, v252
v_sub_f32 v108, v108, v252
v_sub_f32 v172, v172, v252
v_sub_f32 v109, v109, v252
v_sub_f32 v173, v173, v252
v_sub_f32 v110, v110, v252
v_sub_f32 v174, v174, v252
v_sub_f32 v111, v111, v252
v_sub_f32 v175, v175, v252
v_mul_f32 v241, v241, v253
v_accvgpr_read_b32 v254, a64
v_mul_f32 v254, v254, v253
v_accvgpr_write_b32 a64, v254
v_accvgpr_read_b32 v254, a65
v_mul_f32 v254, v254, v253
v_accvgpr_write_b32 a65, v254
v_accvgpr_read_b32 v254, a66
v_mul_f32 v254, v254, v253
v_accvgpr_write_b32 a66, v254
v_accvgpr_read_b32 v254, a67
v_mul_f32 v254, v254, v253
v_accvgpr_write_b32 a67, v254
v_accvgpr_read_b32 v254, a68
v_mul_f32 v254, v254, v253
v_accvgpr_write_b32 a68, v254
v_accvgpr_read_b32 v254, a69
v_mul_f32 v254, v254, v253
v_accvgpr_write_b32 a69, v254
v_accvgpr_read_b32 v254, a70
v_mul_f32 v254, v254, v253
v_accvgpr_write_b32 a70, v254
v_accvgpr_read_b32 v254, a71
v_mul_f32 v254, v254, v253
v_accvgpr_write_b32 a71, v254
v_accvgpr_read_b32 v254, a72
v_mul_f32 v254, v254, v253
v_accvgpr_write_b32 a72, v254
v_accvgpr_read_b32 v254, a73
v_mul_f32 v254, v254, v253
v_accvgpr_write_b32 a73, v254
v_accvgpr_read_b32 v254, a74
v_mul_f32 v254, v254, v253
v_accvgpr_write_b32 a74, v254
v_accvgpr_read_b32 v254, a75
v_mul_f32 v254, v254, v253
v_accvgpr_write_b32 a75, v254
v_accvgpr_read_b32 v254, a76
v_mul_f32 v254, v254, v253
v_accvgpr_write_b32 a76, v254
v_accvgpr_read_b32 v254, a77
v_mul_f32 v254, v254, v253
v_accvgpr_write_b32 a77, v254
v_accvgpr_read_b32 v254, a78
v_mul_f32 v254, v254, v253
v_accvgpr_write_b32 a78, v254
v_accvgpr_read_b32 v254, a79
v_mul_f32 v254, v254, v253
v_accvgpr_write_b32 a79, v254
v_accvgpr_read_b32 v254, a80
v_mul_f32 v254, v254, v253
v_accvgpr_write_b32 a80, v254
v_accvgpr_read_b32 v254, a81
v_mul_f32 v254, v254, v253
v_accvgpr_write_b32 a81, v254
v_accvgpr_read_b32 v254, a82
v_mul_f32 v254, v254, v253
v_accvgpr_write_b32 a82, v254
v_accvgpr_read_b32 v254, a83
v_mul_f32 v254, v254, v253
v_accvgpr_write_b32 a83, v254
v_accvgpr_read_b32 v254, a84
v_mul_f32 v254, v254, v253
v_accvgpr_write_b32 a84, v254
v_accvgpr_read_b32 v254, a85
v_mul_f32 v254, v254, v253
v_accvgpr_write_b32 a85, v254
v_accvgpr_read_b32 v254, a86
v_mul_f32 v254, v254, v253
v_accvgpr_write_b32 a86, v254
v_accvgpr_read_b32 v254, a87
v_mul_f32 v254, v254, v253
v_accvgpr_write_b32 a87, v254
v_accvgpr_read_b32 v254, a88
v_mul_f32 v254, v254, v253
v_accvgpr_write_b32 a88, v254
v_accvgpr_read_b32 v254, a89
v_mul_f32 v254, v254, v253
v_accvgpr_write_b32 a89, v254
v_accvgpr_read_b32 v254, a90
v_mul_f32 v254, v254, v253
v_accvgpr_write_b32 a90, v254
v_accvgpr_read_b32 v254, a91
v_mul_f32 v254, v254, v253
v_accvgpr_write_b32 a91, v254
v_accvgpr_read_b32 v254, a92
v_mul_f32 v254, v254, v253
v_accvgpr_write_b32 a92, v254
v_accvgpr_read_b32 v254, a93
v_mul_f32 v254, v254, v253
v_accvgpr_write_b32 a93, v254
v_accvgpr_read_b32 v254, a94
v_mul_f32 v254, v254, v253
v_accvgpr_write_b32 a94, v254
v_accvgpr_read_b32 v254, a95
v_mul_f32 v254, v254, v253
v_accvgpr_write_b32 a95, v254
v_accvgpr_read_b32 v254, a96
v_mul_f32 v254, v254, v253
v_accvgpr_write_b32 a96, v254
v_accvgpr_read_b32 v254, a97
v_mul_f32 v254, v254, v253
v_accvgpr_write_b32 a97, v254
v_accvgpr_read_b32 v254, a98
v_mul_f32 v254, v254, v253
v_accvgpr_write_b32 a98, v254
v_accvgpr_read_b32 v254, a99
v_mul_f32 v254, v254, v253
v_accvgpr_write_b32 a99, v254
v_accvgpr_read_b32 v254, a100
v_mul_f32 v254, v254, v253
v_accvgpr_write_b32 a100, v254
v_accvgpr_read_b32 v254, a101
v_mul_f32 v254, v254, v253
v_accvgpr_write_b32 a101, v254
v_accvgpr_read_b32 v254, a102
v_mul_f32 v254, v254, v253
v_accvgpr_write_b32 a102, v254
v_accvgpr_read_b32 v254, a103
v_mul_f32 v254, v254, v253
v_accvgpr_write_b32 a103, v254
v_accvgpr_read_b32 v254, a104
v_mul_f32 v254, v254, v253
v_accvgpr_write_b32 a104, v254
v_accvgpr_read_b32 v254, a105
v_mul_f32 v254, v254, v253
v_accvgpr_write_b32 a105, v254
v_accvgpr_read_b32 v254, a106
v_mul_f32 v254, v254, v253
v_accvgpr_write_b32 a106, v254
v_accvgpr_read_b32 v254, a107
v_mul_f32 v254, v254, v253
v_accvgpr_write_b32 a107, v254
v_accvgpr_read_b32 v254, a108
v_mul_f32 v254, v254, v253
v_accvgpr_write_b32 a108, v254
v_accvgpr_read_b32 v254, a109
v_mul_f32 v254, v254, v253
v_accvgpr_write_b32 a109, v254
v_accvgpr_read_b32 v254, a110
v_mul_f32 v254, v254, v253
v_accvgpr_write_b32 a110, v254
v_accvgpr_read_b32 v254, a111
v_mul_f32 v254, v254, v253
v_accvgpr_write_b32 a111, v254
v_accvgpr_read_b32 v254, a112
v_mul_f32 v254, v254, v253
v_accvgpr_write_b32 a112, v254
v_accvgpr_read_b32 v254, a113
v_mul_f32 v254, v254, v253
v_accvgpr_write_b32 a113, v254
v_accvgpr_read_b32 v254, a114
v_mul_f32 v254, v254, v253
v_accvgpr_write_b32 a114, v254
v_accvgpr_read_b32 v254, a115
v_mul_f32 v254, v254, v253
v_accvgpr_write_b32 a115, v254
v_accvgpr_read_b32 v254, a116
v_mul_f32 v254, v254, v253
v_accvgpr_write_b32 a116, v254
v_accvgpr_read_b32 v254, a117
v_mul_f32 v254, v254, v253
v_accvgpr_write_b32 a117, v254
v_accvgpr_read_b32 v254, a118
v_mul_f32 v254, v254, v253
v_accvgpr_write_b32 a118, v254
v_accvgpr_read_b32 v254, a119
v_mul_f32 v254, v254, v253
v_accvgpr_write_b32 a119, v254
v_accvgpr_read_b32 v254, a120
v_mul_f32 v254, v254, v253
v_accvgpr_write_b32 a120, v254
v_accvgpr_read_b32 v254, a121
v_mul_f32 v254, v254, v253
v_accvgpr_write_b32 a121, v254
v_accvgpr_read_b32 v254, a122
v_mul_f32 v254, v254, v253
v_accvgpr_write_b32 a122, v254
v_accvgpr_read_b32 v254, a123
v_mul_f32 v254, v254, v253
v_accvgpr_write_b32 a123, v254
v_accvgpr_read_b32 v254, a124
v_mul_f32 v254, v254, v253
v_accvgpr_write_b32 a124, v254
v_accvgpr_read_b32 v254, a125
v_mul_f32 v254, v254, v253
v_accvgpr_write_b32 a125, v254
v_accvgpr_read_b32 v254, a126
v_mul_f32 v254, v254, v253
v_accvgpr_write_b32 a126, v254
v_accvgpr_read_b32 v254, a127
v_mul_f32 v254, v254, v253
v_accvgpr_write_b32 a127, v254
v_exp_f32 v244, v96
v_exp_f32 v245, v97
v_exp_f32 v246, v98
v_exp_f32 v247, v99
v_add_f32 v243, v244, v245
v_exp_f32 v248, v100
v_cvt_pk_bf16_f32 v120, v244, v245
v_add_f32 v243, v243, v246
v_add_f32 v243, v243, v247
v_exp_f32 v249, v101
v_cvt_pk_bf16_f32 v121, v246, v247
v_add_f32 v243, v243, v248
v_exp_f32 v250, v102
v_add_f32 v243, v243, v249
v_cvt_pk_bf16_f32 v122, v248, v249
v_exp_f32 v251, v103
v_add_f32 v243, v243, v250
v_exp_f32 v244, v104
v_add_f32 v243, v243, v251
v_cvt_pk_bf16_f32 v123, v250, v251
v_exp_f32 v245, v105
v_add_f32 v243, v243, v244
v_exp_f32 v246, v106
v_add_f32 v243, v243, v245
v_cvt_pk_bf16_f32 v124, v244, v245
v_exp_f32 v247, v107
v_add_f32 v243, v243, v246
v_exp_f32 v248, v108
v_add_f32 v243, v243, v247
v_cvt_pk_bf16_f32 v125, v246, v247
v_exp_f32 v249, v109
v_add_f32 v243, v243, v248
v_exp_f32 v250, v110
v_add_f32 v243, v243, v249
v_cvt_pk_bf16_f32 v126, v248, v249
v_exp_f32 v251, v111
v_add_f32 v243, v243, v250
v_add_f32 v243, v243, v251
v_cvt_pk_bf16_f32 v127, v250, v251
s_nop 3
s_setpc_b64 s[46:47]
L_code_end:

.section .rodata,"a"
.p2align 6
.amdhsa_kernel adaLN_cond__sliding_block_cached__swiglu_ffn__prompt_kernel
  .amdhsa_next_free_vgpr 512
  .amdhsa_next_free_sgpr 102
  .amdhsa_accum_offset 256
  .amdhsa_group_segment_fixed_size 0
  .amdhsa_kernarg_size 112
  .amdhsa_user_sgpr_count 2
  .amdhsa_user_sgpr_kernarg_segment_ptr 1
  .amdhsa_system_sgpr_workgroup_id_x 1
  .amdhsa_float_denorm_mode_32 3
.end_amdhsa_kernel
```
